```python
import torch

def _softmax(x, axis=-1):
    return torch.softmax(x, dim=axis)
def _gelu(x):
    return torch.nn.functional.gelu(x, approximate="tanh")
def _silu(x):
    return torch.nn.functional.silu(x)
def _sigmoid(x):
    return torch.sigmoid(x)
def _layernorm(x, axis=-1, eps=1e-5):
    m = x.mean(dim=axis, keepdim=True)
    v = x.var(dim=axis, keepdim=True, unbiased=False)
    return (x - m) / torch.sqrt(v + eps)
def _scatter_add(tgt, idx, src, axis=0):
    return tgt.clone().index_add_(axis, idx, src)
def _segment_sum(src, seg, n):
    out = torch.zeros((n,) + src.shape[1:], dtype=src.dtype)
    return out.index_add_(0, seg, src)
def _pad(x, pw):
    flat = tuple(v for pair in reversed(pw) for v in pair)
    return torch.nn.functional.pad(x, flat)

kernel_name = 'parallel_sum__sliding_local_dilated__geglu_ffn__prompt'

def setup_inputs():

    _w = (lambda a: (lambda t: t.to(torch.bfloat16) if t.is_floating_point() else t)(torch.as_tensor(a)))
    def _A_setup():
        B, S, D = 1, 2048, 1024
        return {
            "x": _w((lambda *s: torch.randn(*s, dtype=torch.bfloat16) * 0.05)(B, S, D)),
            "wqkv": _w((lambda *s: torch.randn(*s, dtype=torch.bfloat16) * 0.05)(D, 3 * D)),
            "wo": _w((lambda *s: torch.randn(*s, dtype=torch.bfloat16) * 0.05)(D, D)),
        }
    _A_in = _A_setup()

    def _B_setup():
        B, S, D, F = 1, 2048, 1024, 3584
        return {
            "x": _w((lambda *s: torch.randn(*s, dtype=torch.bfloat16) * 0.05)(B, S, D)),
            "w_gate": _w((lambda *s: torch.randn(*s, dtype=torch.bfloat16) * 0.05)(D, F)),
            "w_up": _w((lambda *s: torch.randn(*s, dtype=torch.bfloat16) * 0.05)(D, F)),
            "w_down": _w((lambda *s: torch.randn(*s, dtype=torch.bfloat16) * 0.05)(F, D)),
        }
    _B_in = _B_setup()

    return {
        "A_x": _A_in["x"],
        "A_wqkv": _A_in["wqkv"],
        "A_wo": _A_in["wo"],
        "B_x": _B_in["x"],
        "B_w_gate": _B_in["w_gate"],
        "B_w_up": _B_in["w_up"],
        "B_w_down": _B_in["w_down"],
    }

def reference(A_x, A_wqkv, A_wo, B_x, B_w_gate, B_w_up, B_w_down):
    def _A_ref(x, wqkv, wo):
        B, S, D = x.shape
        H = 32; Dh = D // H
        W, dil = 8, 2
        qkv = (lambda x, *d: x.permute(*d))((x @ wqkv).reshape(B, S, 3, H, Dh), 2, 0, 3, 1, 4)
        q, k, v = qkv[0], qkv[1], qkv[2]
        scale = Dh ** -0.5
        pos = torch.arange(S)
        off = torch.arange(W) * dil
        idx = pos[:, None] - off[None, :]
        mask = idx >= 0
        idx_c = torch.where(mask, idx, 0).reshape(-1)
        kg = k[:, :, idx_c, :].reshape(B, H, S, W, Dh)
        vg = v[:, :, idx_c, :].reshape(B, H, S, W, Dh)
        logits = torch.einsum("bhsd,bhswd->bhsw", q, kg) * scale
        logits = torch.where(mask[None, None, :, :], logits, -1e9)
        attn = _softmax(logits, axis=-1)
        o = torch.einsum("bhsw,bhswd->bhsd", attn, vg)
        return (lambda x, *d: x.permute(*d))(o, 0, 2, 1, 3).reshape(B, S, D) @ wo

    def _B_ref(x, w_gate, w_up, w_down):
        return (_gelu(x @ w_gate) * (x @ w_up)) @ w_down

    x = A_x
    xn = _layernorm(x, axis=-1)
    return x + _A_ref(xn, A_wqkv, A_wo) + _B_ref(xn, B_w_gate, B_w_up, B_w_down)
```

```asm
; @launch grid=(256,1,1) block=(512,1,1) lds=163840
.amdgcn_target "amdgcn-amd-amdhsa--gfx950"
.text
.globl parallel_sum__sliding_local_dilated__geglu_ffn__prompt_kernel
.p2align 8
.type parallel_sum__sliding_local_dilated__geglu_ffn__prompt_kernel,@function
parallel_sum__sliding_local_dilated__geglu_ffn__prompt_kernel:
  s_cmp_ge_u32 s2, 256
  s_cbranch_scc1 L_main_end
  s_load_dwordx2 s[84:85], s[0:1], 48
  s_load_dwordx2 s[86:87], s[0:1], 16
  s_load_dwordx2 s[36:37], s[0:1], 0
  s_load_dwordx2 s[4:5], s[0:1], 8
  s_load_dwordx4 s[8:11], s[0:1], 32
  s_load_dwordx2 s[6:7], s[0:1], 72
  v_lshrrev_b32 v1, 6, v0
  v_and_b32 v0, 63, v0
  v_readfirstlane_b32 s76, v1
  s_waitcnt lgkmcnt(0)
  s_mov_b32 s28, s36
  s_mov_b32 s29, s37
  s_mov_b32 s30, 4194304
  s_mov_b32 s31, 0x20000
  s_lshl_b32 s14, s2, 3
  s_add_u32 s14, s14, s76
  s_lshl_b32 s14, s14, 11
  v_lshlrev_b32 v2, 5, v0
  v_add_u32 v2, s14, v2
  buffer_load_dwordx4 v[96:99], v2, s[28:31], 0 offen
  buffer_load_dwordx4 v[100:103], v2, s[28:31], 0 offen offset:16
  s_and_b32 s3, s2, 7
  s_lshr_b32 s12, s2, 3
  s_and_b32 s13, s12, 3
  s_lshl_b32 s3, s3, 2
  s_add_u32 s78, s3, s13
  s_lshr_b32 s79, s12, 2
  s_and_b32 s77, s76, 3
  s_lshl_b32 s24, s78, 6
  s_lshr_b32 s12, s78, 1
  s_and_b32 s13, s78, 1
  s_mul_i32 s12, s12, 448
  s_mul_i32 s14, s13, 192
  s_add_u32 s25, s12, s14
  s_lshl_b32 s14, s13, 5
  s_add_u32 s26, s12, s14
  s_add_u32 s26, s26, 192
  s_cmp_ge_u32 s76, 4
  s_cbranch_scc1 L_ysetup
  v_and_b32 v2, 15, v0
  v_lshrrev_b32 v3, 4, v0
  v_lshrrev_b32 v4, 1, v2
  v_xor_b32 v3, v3, v4
  v_lshlrev_b32 v3, 4, v3
  v_lshl_add_u32 v2, v2, 7, v3
  s_lshl_b32 s12, s77, 13
  v_add_u32 v73, s12, v2
  v_xor_b32 v74, 64, v73
  v_add_u32 v75, 32768, v2
  v_xor_b32 v76, 64, v75
  v_lshrrev_b32 v3, 2, v0
  v_and_b32 v4, 3, v0
  v_lshlrev_b32 v4, 3, v4
  v_mul_u32_u24 v5, 224, v3
  v_add_u32 v5, v5, v4
  v_add_u32 v81, 75776, v5
  v_add_u32 v82, 40960, v81
  v_mul_u32_u24 v5, 192, v3
  v_add_u32 v5, v5, v4
  v_add_u32 v5, 69632, v5
  v_bfe_u32 v6, v0, 4, 1
  v_lshlrev_b32 v6, 5, v6
  v_add_u32 v77, v5, v6
  v_sub_u32 v79, v5, v6
  v_add_u32 v78, 40960, v77
  v_add_u32 v80, 40960, v79
  s_waitcnt lgkmcnt(0)
  s_cmp_eq_u32 s77, 0
  s_cbranch_scc1 L_X0
  s_cmp_eq_u32 s77, 1
  s_cbranch_scc1 L_X1
  s_cmp_eq_u32 s77, 2
  s_cbranch_scc1 L_X2
  s_branch L_X3
L_main_end:
  s_endpgm
L_ysetup:
  v_and_b32 v2, 15, v0
  v_lshrrev_b32 v3, 4, v0
  v_lshrrev_b32 v4, 1, v2
  v_xor_b32 v3, v3, v4
  v_lshlrev_b32 v3, 4, v3
  v_lshl_add_u32 v2, v2, 7, v3
  s_lshl_b32 s12, s77, 13
  v_add_u32 v73, s12, v2
  v_xor_b32 v74, 64, v73
  v_add_u32 v75, 32768, v2
  v_xor_b32 v76, 64, v75
  v_lshrrev_b32 v3, 2, v0
  v_and_b32 v4, 3, v0
  v_lshlrev_b32 v4, 3, v4
  v_mul_u32_u24 v5, 224, v3
  v_add_u32 v5, v5, v4
  v_add_u32 v81, 75776, v5
  v_add_u32 v82, 40960, v81
  s_waitcnt lgkmcnt(0)
  s_mov_b32 s40, s36
  s_mov_b32 s41, s37
  s_mov_b32 s42, 4194304
  s_mov_b32 s43, 0x20000
  s_mov_b32 s60, 0
  s_lshl_b32 s12, s79, 8
  s_lshl_b32 s13, s77, 6
  s_add_u32 s13, s13, s12
  v_lshrrev_b32 v1, 3, v0
  v_and_b32 v2, 7, v0
  v_lshrrev_b32 v3, 1, v1
  v_xor_b32 v3, v2, v3
  v_add_u32 v4, s13, v1
  v_lshlrev_b32 v4, 11, v4
  v_lshl_add_u32 v68, v3, 4, v4
  v_xor_b32 v69, 64, v68
  s_lshl_b32 s70, s77, 13
  s_lshl_b32 s13, s77, 2
  v_add_u32 v1, s13, v1
  v_lshrrev_b32 v3, 1, v1
  v_and_b32 v3, 7, v3
  v_xor_b32 v3, v2, v3
  s_sub_u32 s12, s12, 16
  v_add_u32 v4, s12, v1
  v_max_i32 v4, 0, v4
  v_lshlrev_b32 v4, 11, v4
  v_lshl_add_u32 v70, v3, 4, v4
  s_lshl_b32 s13, s77, 9
  s_add_u32 s71, s13, 32768
  s_mov_b32 s13, 0xffff0000
  s_cmp_eq_u32 s77, 0
  s_cselect_b32 s62, s13, -1
  s_mov_b32 s63, 0
  s_lshr_b32 s16, s2, 3
  s_and_b32 s17, s2, 7
  s_cmp_eq_u32 s77, 0
  s_cbranch_scc1 L_pf0
  s_cmp_eq_u32 s77, 1
  s_cselect_b32 s48, s8, s10
  s_cselect_b32 s49, s9, s11
  s_mov_b32 s18, 7340032
  s_cmp_eq_u32 s77, 3
  s_cselect_b32 s50, 0, s18
  s_mov_b32 s51, 0x20000
  v_mul_u32_u24 v2, 9363, v0
  v_lshrrev_b32 v2, 16, v2
  v_mul_u32_u24 v3, 7, v2
  v_sub_u32 v3, v0, v3
  v_mul_u32_u24 v2, 229376, v2
  v_lshl_add_u32 v2, v3, 7, v2
  s_mul_i32 s18, s16, 7168
  s_mul_i32 s19, s17, 896
  s_add_u32 s18, s18, s19
  v_add_u32 v83, s18, v2
  v_cmp_gt_u32 vcc, 28, v0
  v_mov_b32 v3, 0x7ffffff0
  s_nop 0
  v_cndmask_b32 v83, v3, v83, vcc
  s_mov_b32 s53, 917504
  s_branch L_pfd
L_pf0:
  s_mov_b32 s48, s4
  s_mov_b32 s49, s5
  s_mov_b32 s50, 6291456
  s_mov_b32 s51, 0x20000
  v_mul_u32_u24 v2, 10923, v0
  v_lshrrev_b32 v2, 16, v2
  v_mul_u32_u24 v3, 6, v2
  v_sub_u32 v3, v0, v3
  v_mul_u32_u24 v2, 196608, v2
  v_lshrrev_b32 v4, 1, v3
  v_lshl_add_u32 v2, v4, 11, v2
  v_and_b32 v3, 1, v3
  v_lshl_add_u32 v2, v3, 7, v2
  s_mul_i32 s18, s16, 6144
  s_lshl_b32 s19, s17, 8
  s_add_u32 s18, s18, s19
  v_add_u32 v83, s18, v2
  v_cmp_gt_u32 vcc, 24, v0
  v_mov_b32 v3, 0x7ffffff0
  s_nop 0
  v_cndmask_b32 v83, v3, v83, vcc
  s_mov_b32 s53, 786432
L_pfd:
  s_mov_b32 s52, 0
  s_cmp_eq_u32 s77, 3
  s_cbranch_scc0 L_pf3
  s_lshl_b32 s18, s2, 13
  s_add_u32 s48, s86, s18
  s_addc_u32 s49, s87, 0
  s_mov_b32 s50, 8192
  v_lshlrev_b32 v83, 7, v0
  s_mov_b32 s53, 8192
  s_mov_b32 s52, 4294901760
L_pf3:
  s_branch L_Y
L_X0:
  s_mov_b32 s40, s4
  s_mov_b32 s41, s5
  s_mov_b32 s42, 6291456
  s_mov_b32 s43, 0x20000
  s_mov_b32 s70, 69632
  s_mov_b32 s65, 196608
  s_mov_b32 s60, 0
  v_add_u32 v1, 0, v0
  v_mul_u32_u24 v2, 43691, v1
  v_lshrrev_b32 v2, 19, v2
  v_mul_u32_u24 v3, 12, v2
  v_sub_u32 v3, v1, v3
  v_lshrrev_b32 v4, 1, v2
  v_and_b32 v4, 2, v4
  v_xor_b32 v3, v3, v4
  v_lshrrev_b32 v4, 2, v3
  v_lshlrev_b32 v4, 11, v4
  v_and_b32 v3, 3, v3
  v_lshl_add_u32 v4, v3, 4, v4
  v_add_u32 v4, s24, v4
  v_bfe_u32 v5, v2, 2, 2
  v_lshlrev_b32 v5, 3, v5
  v_lshrrev_b32 v6, 4, v2
  v_lshl_add_u32 v5, v6, 2, v5
  v_and_b32 v6, 3, v2
  v_add_u32 v5, v5, v6
  v_mul_u32_u24 v5, 6144, v5
  v_add_u32 v68, v5, v4
  s_mov_b32 s44, s4
  s_mov_b32 s45, s5
  s_mov_b32 s46, 6291456
  s_mov_b32 s47, 0x20000
  s_mov_b32 s71, 70656
  s_mov_b32 s66, 196608
  s_mov_b32 s61, 0
  v_add_u32 v1, 64, v0
  v_mul_u32_u24 v2, 43691, v1
  v_lshrrev_b32 v2, 19, v2
  v_mul_u32_u24 v3, 12, v2
  v_sub_u32 v3, v1, v3
  v_lshrrev_b32 v4, 1, v2
  v_and_b32 v4, 2, v4
  v_xor_b32 v3, v3, v4
  v_lshrrev_b32 v4, 2, v3
  v_lshlrev_b32 v4, 11, v4
  v_and_b32 v3, 3, v3
  v_lshl_add_u32 v4, v3, 4, v4
  v_add_u32 v4, s24, v4
  v_bfe_u32 v5, v2, 2, 2
  v_lshlrev_b32 v5, 3, v5
  v_lshrrev_b32 v6, 4, v2
  v_lshl_add_u32 v5, v6, 2, v5
  v_and_b32 v6, 3, v2
  v_add_u32 v5, v5, v6
  v_mul_u32_u24 v5, 6144, v5
  v_add_u32 v69, v5, v4
  s_mov_b32 s48, s4
  s_mov_b32 s49, s5
  s_mov_b32 s50, 6291456
  s_mov_b32 s51, 0x20000
  s_mov_b32 s72, 71680
  s_mov_b32 s67, 196608
  s_mov_b32 s62, 0
  v_add_u32 v1, 128, v0
  v_mul_u32_u24 v2, 43691, v1
  v_lshrrev_b32 v2, 19, v2
  v_mul_u32_u24 v3, 12, v2
  v_sub_u32 v3, v1, v3
  v_lshrrev_b32 v4, 1, v2
  v_and_b32 v4, 2, v4
  v_xor_b32 v3, v3, v4
  v_lshrrev_b32 v4, 2, v3
  v_lshlrev_b32 v4, 11, v4
  v_and_b32 v3, 3, v3
  v_lshl_add_u32 v4, v3, 4, v4
  v_add_u32 v4, s24, v4
  v_bfe_u32 v5, v2, 2, 2
  v_lshlrev_b32 v5, 3, v5
  v_lshrrev_b32 v6, 4, v2
  v_lshl_add_u32 v5, v6, 2, v5
  v_and_b32 v6, 3, v2
  v_add_u32 v5, v5, v6
  v_mul_u32_u24 v5, 6144, v5
  v_add_u32 v70, v5, v4
  s_mov_b32 s52, s4
  s_mov_b32 s53, s5
  s_mov_b32 s54, 6291456
  s_mov_b32 s55, 0x20000
  s_mov_b32 s73, 72704
  s_mov_b32 s68, 196608
  s_mov_b32 s63, 0
  v_add_u32 v1, 192, v0
  v_mul_u32_u24 v2, 43691, v1
  v_lshrrev_b32 v2, 19, v2
  v_mul_u32_u24 v3, 12, v2
  v_sub_u32 v3, v1, v3
  v_lshrrev_b32 v4, 1, v2
  v_and_b32 v4, 2, v4
  v_xor_b32 v3, v3, v4
  v_lshrrev_b32 v4, 2, v3
  v_lshlrev_b32 v4, 11, v4
  v_and_b32 v3, 3, v3
  v_lshl_add_u32 v4, v3, 4, v4
  v_add_u32 v4, s24, v4
  v_bfe_u32 v5, v2, 2, 2
  v_lshlrev_b32 v5, 3, v5
  v_lshrrev_b32 v6, 4, v2
  v_lshl_add_u32 v5, v6, 2, v5
  v_and_b32 v6, 3, v2
  v_add_u32 v5, v5, v6
  v_mul_u32_u24 v5, 6144, v5
  v_add_u32 v71, v5, v4
  s_mov_b32 s56, s4
  s_mov_b32 s57, s5
  s_mov_b32 s58, 6291456
  s_mov_b32 s59, 0x20000
  s_mov_b32 s74, 73728
  s_mov_b32 s69, 196608
  s_mov_b32 s64, 0
  v_add_u32 v1, 256, v0
  v_mul_u32_u24 v2, 43691, v1
  v_lshrrev_b32 v2, 19, v2
  v_mul_u32_u24 v3, 12, v2
  v_sub_u32 v3, v1, v3
  v_lshrrev_b32 v4, 1, v2
  v_and_b32 v4, 2, v4
  v_xor_b32 v3, v3, v4
  v_lshrrev_b32 v4, 2, v3
  v_lshlrev_b32 v4, 11, v4
  v_and_b32 v3, 3, v3
  v_lshl_add_u32 v4, v3, 4, v4
  v_add_u32 v4, s24, v4
  v_bfe_u32 v5, v2, 2, 2
  v_lshlrev_b32 v5, 3, v5
  v_lshrrev_b32 v6, 4, v2
  v_lshl_add_u32 v5, v6, 2, v5
  v_and_b32 v6, 3, v2
  v_add_u32 v5, v5, v6
  v_mul_u32_u24 v5, 6144, v5
  v_add_u32 v72, v5, v4
  s_add_u32 m0, s70, 0
  s_nop 0
  buffer_load_dwordx4 v68, s[40:43], s60 offen lds
  s_add_u32 s60, s60, s65
  s_add_u32 m0, s71, 0
  s_nop 0
  buffer_load_dwordx4 v69, s[44:47], s61 offen lds
  s_add_u32 s61, s61, s66
  s_add_u32 m0, s72, 0
  s_nop 0
  buffer_load_dwordx4 v70, s[48:51], s62 offen lds
  s_add_u32 s62, s62, s67
  s_add_u32 m0, s73, 0
  s_nop 0
  buffer_load_dwordx4 v71, s[52:55], s63 offen lds
  s_add_u32 s63, s63, s68
  s_add_u32 m0, s74, 0
  s_nop 0
  buffer_load_dwordx4 v72, s[56:59], s64 offen lds
  s_add_u32 s64, s64, s69
  s_add_u32 m0, s70, 20480
  s_nop 0
  buffer_load_dwordx4 v68, s[40:43], s60 offen lds
  s_add_u32 s60, s60, s65
  s_add_u32 m0, s71, 20480
  s_nop 0
  buffer_load_dwordx4 v69, s[44:47], s61 offen lds
  s_add_u32 s61, s61, s66
  s_add_u32 m0, s72, 20480
  s_nop 0
  buffer_load_dwordx4 v70, s[48:51], s62 offen lds
  s_add_u32 s62, s62, s67
  s_add_u32 m0, s73, 20480
  s_nop 0
  buffer_load_dwordx4 v71, s[52:55], s63 offen lds
  s_add_u32 s63, s63, s68
  s_add_u32 m0, s74, 20480
  s_nop 0
  buffer_load_dwordx4 v72, s[56:59], s64 offen lds
  s_add_u32 s64, s64, s69
  s_add_u32 m0, s70, 40960
  s_nop 0
  buffer_load_dwordx4 v68, s[40:43], s60 offen lds
  s_add_u32 s60, s60, s65
  s_add_u32 m0, s71, 40960
  s_nop 0
  buffer_load_dwordx4 v69, s[44:47], s61 offen lds
  s_add_u32 s61, s61, s66
  s_add_u32 m0, s72, 40960
  s_nop 0
  buffer_load_dwordx4 v70, s[48:51], s62 offen lds
  s_add_u32 s62, s62, s67
  s_add_u32 m0, s73, 40960
  s_nop 0
  buffer_load_dwordx4 v71, s[52:55], s63 offen lds
  s_add_u32 s63, s63, s68
  s_add_u32 m0, s74, 40960
  s_nop 0
  buffer_load_dwordx4 v72, s[56:59], s64 offen lds
  s_add_u32 s64, s64, s69
  s_lshl_b32 s12, s79, 7
  s_lshl_b32 s13, s78, 2
  s_add_u32 s12, s12, s13
  s_add_u32 s12, s12, 16384
  s_add_u32 s16, s6, 104857600
  s_addc_u32 s17, s7, 0
  s_mov_b32 s18, 21504
  s_mov_b32 s19, 0x20000
  v_lshlrev_b32 v2, 10, v0
  v_add_u32 v2, s12, v2
  s_lshl_b32 s13, s2, 2
  s_add_u32 s13, s13, 20480
  s_getreg_b32 s14, hwreg(HW_REG_XCC_ID)
  s_and_b32 s14, s14, 15
  v_mov_b32 v3, s13
  v_mov_b32 v4, s14
  v_cmp_eq_u32 vcc, 2, v0
  s_nop 1
  v_cndmask_b32 v2, v2, v3, vcc
  v_mov_b32 v3, 0
  v_cndmask_b32 v3, v3, v4, vcc
  v_cmp_gt_u32 vcc, 3, v0
  s_and_saveexec_b64 s[20:21], vcc
  buffer_store_dword v3, v2, s[16:19], 0 offen sc1
  s_mov_b64 exec, s[20:21]
  s_mov_b32 s24, s36
  s_mov_b32 s25, s37
  s_mov_b32 s26, 4194304
  s_mov_b32 s27, 0x20000
  s_lshr_b32 s28, s2, 3
  s_lshl_b32 s28, s28, 6
  s_add_u32 s28, s28, 0
  v_add_u32 v83, s28, v0
  v_lshlrev_b32 v83, 11, v83
  v_add_u32 v83, 0, v83
  v_cmp_gt_u32 vcc, 32, v0
  v_mov_b32 v3, 0x7ffffff0
  s_nop 0
  v_cndmask_b32 v83, v3, v83, vcc
  s_mov_b32 s28, 256
  buffer_load_dword v6, v83, s[24:27], s28 offen
  s_add_u32 s28, s28, 256
  s_and_b32 s3, s2, 7
  s_lshr_b32 s16, s2, 3
  s_and_b32 s20, s16, 1
  s_lshr_b32 s16, s16, 1
  s_lshr_b32 s17, s3, 1
  s_lshl_b32 s17, s17, 2
  s_and_b32 s18, s16, 3
  s_add_u32 s21, s17, s18
  s_and_b32 s17, s3, 1
  s_lshl_b32 s17, s17, 2
  s_lshr_b32 s18, s16, 2
  s_add_u32 s22, s17, s18
  s_lshl_b32 s23, s21, 3
  s_add_u32 s23, s23, s22
  s_lshl_b32 s16, s23, 16
  s_lshl_b32 s17, s20, 15
  s_add_u32 s16, s16, s17
  s_lshl_b32 s17, s76, 12
  s_add_u32 s16, s16, s17
  s_add_u32 s16, s16, 67108864
  s_add_u32 s88, s6, s16
  s_addc_u32 s89, s7, 0
  s_mov_b32 s90, 20480
  s_mov_b32 s91, 0x20000
  s_waitcnt vmcnt(16)
  v_lshlrev_b32 v104, 16, v96
  v_and_b32 v105, 0xffff0000, v96
  v_lshlrev_b32 v106, 16, v97
  v_and_b32 v107, 0xffff0000, v97
  v_lshlrev_b32 v108, 16, v98
  v_and_b32 v109, 0xffff0000, v98
  v_lshlrev_b32 v110, 16, v99
  v_and_b32 v111, 0xffff0000, v99
  v_lshlrev_b32 v112, 16, v100
  v_and_b32 v113, 0xffff0000, v100
  v_lshlrev_b32 v114, 16, v101
  v_and_b32 v115, 0xffff0000, v101
  v_lshlrev_b32 v116, 16, v102
  v_and_b32 v117, 0xffff0000, v102
  v_lshlrev_b32 v118, 16, v103
  v_and_b32 v119, 0xffff0000, v103
  v_add_f32 v120, v104, v108
  v_add_f32 v124, v112, v116
  v_add_f32 v121, v105, v109
  v_add_f32 v125, v113, v117
  v_add_f32 v122, v106, v110
  v_add_f32 v126, v114, v118
  v_add_f32 v123, v107, v111
  v_add_f32 v127, v115, v119
  v_add_f32 v120, v120, v124
  v_add_f32 v121, v121, v125
  v_add_f32 v122, v122, v126
  v_add_f32 v123, v123, v127
  v_add_f32 v120, v120, v121
  v_add_f32 v122, v122, v123
  v_add_f32 v120, v120, v122
  s_nop 1
  v_add_f32_dpp v120, v120, v120 row_ror:8 row_mask:0xf bank_mask:0xf
  s_nop 1
  v_add_f32_dpp v120, v120, v120 row_ror:4 row_mask:0xf bank_mask:0xf
  s_nop 1
  v_add_f32_dpp v120, v120, v120 row_ror:2 row_mask:0xf bank_mask:0xf
  s_nop 1
  v_add_f32_dpp v120, v120, v120 row_ror:1 row_mask:0xf bank_mask:0xf
  v_mov_b32 v121, v120
  s_nop 1
  v_permlane16_swap_b32 v120, v121
  v_add_f32 v120, v120, v121
  v_mov_b32 v121, v120
  s_nop 1
  v_permlane32_swap_b32 v120, v121
  v_add_f32 v120, v120, v121
  v_mul_f32 v120, 0x3a800000, v120
  v_sub_f32 v104, v104, v120
  v_sub_f32 v105, v105, v120
  v_sub_f32 v106, v106, v120
  v_sub_f32 v107, v107, v120
  v_sub_f32 v108, v108, v120
  v_sub_f32 v109, v109, v120
  v_sub_f32 v110, v110, v120
  v_sub_f32 v111, v111, v120
  v_sub_f32 v112, v112, v120
  v_sub_f32 v113, v113, v120
  v_sub_f32 v114, v114, v120
  v_sub_f32 v115, v115, v120
  v_sub_f32 v116, v116, v120
  v_sub_f32 v117, v117, v120
  v_sub_f32 v118, v118, v120
  v_sub_f32 v119, v119, v120
  v_mul_f32 v124, v104, v104
  v_mul_f32 v125, v105, v105
  v_mul_f32 v126, v106, v106
  v_mul_f32 v127, v107, v107
  v_fmac_f32 v124, v108, v108
  v_fmac_f32 v125, v109, v109
  v_fmac_f32 v126, v110, v110
  v_fmac_f32 v127, v111, v111
  v_fmac_f32 v124, v112, v112
  v_fmac_f32 v125, v113, v113
  v_fmac_f32 v126, v114, v114
  v_fmac_f32 v127, v115, v115
  v_fmac_f32 v124, v116, v116
  v_fmac_f32 v125, v117, v117
  v_fmac_f32 v126, v118, v118
  v_fmac_f32 v127, v119, v119
  v_add_f32 v124, v124, v125
  v_add_f32 v126, v126, v127
  v_add_f32 v124, v124, v126
  s_nop 1
  v_add_f32_dpp v124, v124, v124 row_ror:8 row_mask:0xf bank_mask:0xf
  s_nop 1
  v_add_f32_dpp v124, v124, v124 row_ror:4 row_mask:0xf bank_mask:0xf
  s_nop 1
  v_add_f32_dpp v124, v124, v124 row_ror:2 row_mask:0xf bank_mask:0xf
  s_nop 1
  v_add_f32_dpp v124, v124, v124 row_ror:1 row_mask:0xf bank_mask:0xf
  v_mov_b32 v125, v124
  s_nop 1
  v_permlane16_swap_b32 v124, v125
  v_add_f32 v124, v124, v125
  v_mov_b32 v125, v124
  s_nop 1
  v_permlane32_swap_b32 v124, v125
  v_add_f32 v124, v124, v125
  v_mov_b32 v122, 0x3727c5ac
  v_fmac_f32 v122, 0x3a800000, v124
  v_rsq_f32 v121, v122
  v_mov_b32 v123, 0
  s_mov_b32 s16, s6
  s_mov_b32 s17, s7
  s_mov_b32 s18, 32768
  s_mov_b32 s19, 0x20000
  s_lshl_b32 s14, s2, 3
  s_add_u32 s14, s14, s76
  s_lshl_b32 s14, s14, 4
  v_mov_b32 v2, s14
  v_cmp_eq_u32 vcc, 0, v0
  s_and_saveexec_b64 s[20:21], vcc
  buffer_store_dwordx4 v[120:123], v2, s[16:19], 0 offen sc1
  s_mov_b64 exec, s[20:21]
  v_mov_b32 v84, 0
  v_mov_b32 v85, 0
  v_mov_b32 v86, 0
  v_mov_b32 v87, 0
  v_mov_b32 v88, 0
  v_mov_b32 v89, 0
  v_mov_b32 v90, 0
  v_mov_b32 v91, 0
  v_mov_b32 v92, 0
  v_mov_b32 v93, 0
  v_mov_b32 v94, 0
  v_mov_b32 v95, 0
  v_mov_b32 v96, 0
  v_mov_b32 v97, 0
  v_mov_b32 v98, 0
  v_mov_b32 v99, 0
  v_mov_b32 v100, 0
  v_mov_b32 v101, 0
  v_mov_b32 v102, 0
  v_mov_b32 v103, 0
  v_mov_b32 v104, 0
  v_mov_b32 v105, 0
  v_mov_b32 v106, 0
  v_mov_b32 v107, 0
  v_mov_b32 v108, 0
  v_mov_b32 v109, 0
  v_mov_b32 v110, 0
  v_mov_b32 v111, 0
  v_mov_b32 v112, 0
  v_mov_b32 v113, 0
  v_mov_b32 v114, 0
  v_mov_b32 v115, 0
  v_mov_b32 v116, 0
  v_mov_b32 v117, 0
  v_mov_b32 v118, 0
  v_mov_b32 v119, 0
  v_mov_b32 v120, 0
  v_mov_b32 v121, 0
  v_mov_b32 v122, 0
  v_mov_b32 v123, 0
  v_mov_b32 v124, 0
  v_mov_b32 v125, 0
  v_mov_b32 v126, 0
  v_mov_b32 v127, 0
  v_mov_b32 v128, 0
  v_mov_b32 v129, 0
  v_mov_b32 v130, 0
  v_mov_b32 v131, 0
  v_mov_b32 v132, 0
  v_mov_b32 v133, 0
  v_mov_b32 v134, 0
  v_mov_b32 v135, 0
  v_mov_b32 v136, 0
  v_mov_b32 v137, 0
  v_mov_b32 v138, 0
  v_mov_b32 v139, 0
  v_mov_b32 v140, 0
  v_mov_b32 v141, 0
  v_mov_b32 v142, 0
  v_mov_b32 v143, 0
  v_mov_b32 v144, 0
  v_mov_b32 v145, 0
  v_mov_b32 v146, 0
  v_mov_b32 v147, 0
  v_mov_b32 v148, 0
  v_mov_b32 v149, 0
  v_mov_b32 v150, 0
  v_mov_b32 v151, 0
  v_mov_b32 v152, 0
  v_mov_b32 v153, 0
  v_mov_b32 v154, 0
  v_mov_b32 v155, 0
  v_mov_b32 v156, 0
  v_mov_b32 v157, 0
  v_mov_b32 v158, 0
  v_mov_b32 v159, 0
  v_mov_b32 v160, 0
  v_mov_b32 v161, 0
  v_mov_b32 v162, 0
  v_mov_b32 v163, 0
  v_mov_b32 v164, 0
  v_mov_b32 v165, 0
  v_mov_b32 v166, 0
  v_mov_b32 v167, 0
  v_mov_b32 v168, 0
  v_mov_b32 v169, 0
  v_mov_b32 v170, 0
  v_mov_b32 v171, 0
  v_mov_b32 v172, 0
  v_mov_b32 v173, 0
  v_mov_b32 v174, 0
  v_mov_b32 v175, 0
  v_mov_b32 v176, 0
  v_mov_b32 v177, 0
  v_mov_b32 v178, 0
  v_mov_b32 v179, 0
  v_mov_b32 v180, 0
  v_mov_b32 v181, 0
  v_mov_b32 v182, 0
  v_mov_b32 v183, 0
  v_mov_b32 v184, 0
  v_mov_b32 v185, 0
  v_mov_b32 v186, 0
  v_mov_b32 v187, 0
  v_mov_b32 v188, 0
  v_mov_b32 v189, 0
  v_mov_b32 v190, 0
  v_mov_b32 v191, 0
  v_mov_b32 v192, 0
  v_mov_b32 v193, 0
  v_mov_b32 v194, 0
  v_mov_b32 v195, 0
  v_mov_b32 v196, 0
  v_mov_b32 v197, 0
  v_mov_b32 v198, 0
  v_mov_b32 v199, 0
  v_mov_b32 v200, 0
  v_mov_b32 v201, 0
  v_mov_b32 v202, 0
  v_mov_b32 v203, 0
  v_mov_b32 v204, 0
  v_mov_b32 v205, 0
  v_mov_b32 v206, 0
  v_mov_b32 v207, 0
  v_mov_b32 v208, 0
  v_mov_b32 v209, 0
  v_mov_b32 v210, 0
  v_mov_b32 v211, 0
  v_mov_b32 v212, 0
  v_mov_b32 v213, 0
  v_mov_b32 v214, 0
  v_mov_b32 v215, 0
  v_mov_b32 v216, 0
  v_mov_b32 v217, 0
  v_mov_b32 v218, 0
  v_mov_b32 v219, 0
  v_mov_b32 v220, 0
  v_mov_b32 v221, 0
  v_mov_b32 v222, 0
  v_mov_b32 v223, 0
  v_mov_b32 v224, 0
  v_mov_b32 v225, 0
  v_mov_b32 v226, 0
  v_mov_b32 v227, 0
  v_mov_b32 v228, 0
  v_mov_b32 v229, 0
  v_mov_b32 v230, 0
  v_mov_b32 v231, 0
  v_mov_b32 v232, 0
  v_mov_b32 v233, 0
  v_mov_b32 v234, 0
  v_mov_b32 v235, 0
  v_mov_b32 v236, 0
  v_mov_b32 v237, 0
  v_mov_b32 v238, 0
  v_mov_b32 v239, 0
  v_mov_b32 v240, 0
  v_mov_b32 v241, 0
  v_mov_b32 v242, 0
  v_mov_b32 v243, 0
  v_mov_b32 v244, 0
  v_mov_b32 v245, 0
  v_mov_b32 v246, 0
  v_mov_b32 v247, 0
  v_mov_b32 v248, 0
  v_mov_b32 v249, 0
  v_mov_b32 v250, 0
  v_mov_b32 v251, 0
  v_mov_b32 v252, 0
  v_mov_b32 v253, 0
  v_mov_b32 v254, 0
  v_mov_b32 v255, 0
  s_waitcnt vmcnt(12)
  s_barrier
  .p2align 3
  s_add_u32 m0, s70, 61440
  s_nop 0
  buffer_load_dwordx4 v68, s[40:43], s60 offen lds
  ds_read_b128 v[8:11], v73 offset:0
  ds_read_b128 v[12:15], v73 offset:2048
  ds_read_b128 v[16:19], v73 offset:4096
  ds_read_b128 v[20:23], v73 offset:6144
  ds_read_b128 v[24:27], v75 offset:0
  s_add_u32 s60, s60, s65
  s_add_u32 m0, s71, 61440
  s_nop 0
  buffer_load_dwordx4 v69, s[44:47], s61 offen lds
  ds_read_b64_tr_b16 v[28:29], v77 offset:0
  ds_read_b64_tr_b16 v[30:31], v77 offset:3072
  ds_read_b64_tr_b16 v[32:33], v79 offset:32
  ds_read_b64_tr_b16 v[34:35], v79 offset:3104
  ds_read_b64_tr_b16 v[36:37], v77 offset:64
  s_add_u32 s61, s61, s66
  s_add_u32 m0, s72, 61440
  s_nop 0
  buffer_load_dwordx4 v70, s[48:51], s62 offen lds
  ds_read_b64_tr_b16 v[38:39], v77 offset:3136
  ds_read_b64_tr_b16 v[40:41], v79 offset:96
  ds_read_b64_tr_b16 v[42:43], v79 offset:3168
  ds_read_b64_tr_b16 v[44:45], v77 offset:128
  ds_read_b64_tr_b16 v[46:47], v77 offset:3200
  s_add_u32 s62, s62, s67
  s_add_u32 m0, s73, 61440
  s_nop 0
  buffer_load_dwordx4 v71, s[52:55], s63 offen lds
  ds_read_b64_tr_b16 v[48:49], v79 offset:160
  ds_read_b64_tr_b16 v[50:51], v79 offset:3232
  ds_read_b64_tr_b16 v[52:53], v81 offset:0
  ds_read_b64_tr_b16 v[54:55], v81 offset:3584
  ds_read_b64_tr_b16 v[56:57], v81 offset:32
  s_add_u32 s63, s63, s68
  s_add_u32 m0, s74, 61440
  s_nop 0
  buffer_load_dwordx4 v72, s[56:59], s64 offen lds
  s_add_u32 s64, s64, s69
  ds_read_b64_tr_b16 v[58:59], v81 offset:3616
  ds_read_b64_tr_b16 v[60:61], v81 offset:7168
  ds_read_b64_tr_b16 v[62:63], v81 offset:10752
  ds_read_b64_tr_b16 v[64:65], v81 offset:7200
  ds_read_b64_tr_b16 v[66:67], v81 offset:10784
  s_waitcnt lgkmcnt(0)
  s_barrier
  s_mov_b32 s75, 7
  .p2align 6
L_X0_loop:
  .p2align 3
  v_mfma_f32_16x16x32_bf16 v[92:95], v[36:39], v[24:27], v[92:95]
  v_mfma_f32_16x16x32_bf16 v[128:131], v[36:39], v[8:11], v[128:131]
  v_mfma_f32_16x16x32_bf16 v[132:135], v[36:39], v[12:15], v[132:135]
  v_mfma_f32_16x16x32_bf16 v[136:139], v[36:39], v[16:19], v[136:139]
  v_mfma_f32_16x16x32_bf16 v[140:143], v[36:39], v[20:23], v[140:143]
  v_mfma_f32_16x16x32_bf16 v[144:147], v[40:43], v[8:11], v[144:147]
  v_mfma_f32_16x16x32_bf16 v[148:151], v[40:43], v[12:15], v[148:151]
  v_mfma_f32_16x16x32_bf16 v[152:155], v[40:43], v[16:19], v[152:155]
  v_mfma_f32_16x16x32_bf16 v[156:159], v[40:43], v[20:23], v[156:159]
  v_mfma_f32_16x16x32_bf16 v[160:163], v[8:11], v[44:47], v[160:163]
  v_mfma_f32_16x16x32_bf16 v[164:167], v[12:15], v[44:47], v[164:167]
  v_mfma_f32_16x16x32_bf16 v[168:171], v[16:19], v[44:47], v[168:171]
  v_mfma_f32_16x16x32_bf16 v[172:175], v[20:23], v[44:47], v[172:175]
  v_mfma_f32_16x16x32_bf16 v[176:179], v[8:11], v[48:51], v[176:179]
  v_mfma_f32_16x16x32_bf16 v[180:183], v[12:15], v[48:51], v[180:183]
  v_mfma_f32_16x16x32_bf16 v[184:187], v[16:19], v[48:51], v[184:187]
  v_mfma_f32_16x16x32_bf16 v[188:191], v[20:23], v[48:51], v[188:191]
  v_mfma_f32_16x16x32_bf16 v[96:99], v[28:31], v[8:11], v[96:99]
  v_mfma_f32_16x16x32_bf16 v[100:103], v[28:31], v[12:15], v[100:103]
  v_mfma_f32_16x16x32_bf16 v[104:107], v[28:31], v[16:19], v[104:107]
  v_mfma_f32_16x16x32_bf16 v[84:87], v[28:31], v[24:27], v[84:87]
  v_mfma_f32_16x16x32_bf16 v[108:111], v[28:31], v[20:23], v[108:111]
  v_mfma_f32_16x16x32_bf16 v[112:115], v[32:35], v[8:11], v[112:115]
  v_mfma_f32_16x16x32_bf16 v[116:119], v[32:35], v[12:15], v[116:119]
  v_mfma_f32_16x16x32_bf16 v[120:123], v[32:35], v[16:19], v[120:123]
  v_mfma_f32_16x16x32_bf16 v[124:127], v[32:35], v[20:23], v[124:127]
  v_mfma_f32_16x16x32_bf16 v[192:195], v[52:55], v[8:11], v[192:195]
  v_mfma_f32_16x16x32_bf16 v[196:199], v[52:55], v[12:15], v[196:199]
  v_mfma_f32_16x16x32_bf16 v[200:203], v[52:55], v[16:19], v[200:203]
  v_mfma_f32_16x16x32_bf16 v[204:207], v[52:55], v[20:23], v[204:207]
  v_mfma_f32_16x16x32_bf16 v[208:211], v[56:59], v[8:11], v[208:211]
  v_mfma_f32_16x16x32_bf16 v[212:215], v[56:59], v[12:15], v[212:215]
  v_mfma_f32_16x16x32_bf16 v[216:219], v[56:59], v[16:19], v[216:219]
  v_mfma_f32_16x16x32_bf16 v[220:223], v[56:59], v[20:23], v[220:223]
  v_mfma_f32_16x16x32_bf16 v[224:227], v[60:63], v[8:11], v[224:227]
  v_mfma_f32_16x16x32_bf16 v[228:231], v[60:63], v[12:15], v[228:231]
  v_mfma_f32_16x16x32_bf16 v[232:235], v[60:63], v[16:19], v[232:235]
  v_mfma_f32_16x16x32_bf16 v[236:239], v[60:63], v[20:23], v[236:239]
  v_mfma_f32_16x16x32_bf16 v[240:243], v[64:67], v[8:11], v[240:243]
  v_mfma_f32_16x16x32_bf16 v[244:247], v[64:67], v[12:15], v[244:247]
  v_mfma_f32_16x16x32_bf16 v[248:251], v[64:67], v[16:19], v[248:251]
  v_mfma_f32_16x16x32_bf16 v[252:255], v[64:67], v[20:23], v[252:255]
  s_waitcnt vmcnt(10)
  s_barrier
  .p2align 3
  s_add_u32 m0, s70, 0
  s_nop 0
  buffer_load_dwordx4 v68, s[40:43], s60 offen lds
  ds_read_b128 v[8:11], v74 offset:0
  ds_read_b128 v[12:15], v74 offset:2048
  ds_read_b128 v[16:19], v74 offset:4096
  ds_read_b128 v[20:23], v74 offset:6144
  s_add_u32 s60, s60, s65
  s_add_u32 m0, s71, 0
  s_nop 0
  buffer_load_dwordx4 v69, s[44:47], s61 offen lds
  ds_read_b128 v[24:27], v76 offset:0
  ds_read_b64_tr_b16 v[28:29], v77 offset:20480
  ds_read_b64_tr_b16 v[30:31], v77 offset:23552
  ds_read_b64_tr_b16 v[32:33], v79 offset:20512
  s_add_u32 s61, s61, s66
  s_add_u32 m0, s72, 0
  s_nop 0
  buffer_load_dwordx4 v70, s[48:51], s62 offen lds
  ds_read_b64_tr_b16 v[34:35], v79 offset:23584
  ds_read_b64_tr_b16 v[36:37], v77 offset:20544
  ds_read_b64_tr_b16 v[38:39], v77 offset:23616
  ds_read_b64_tr_b16 v[40:41], v79 offset:20576
  s_add_u32 s62, s62, s67
  s_add_u32 m0, s73, 0
  s_nop 0
  buffer_load_dwordx4 v71, s[52:55], s63 offen lds
  ds_read_b64_tr_b16 v[42:43], v79 offset:23648
  ds_read_b64_tr_b16 v[44:45], v77 offset:20608
  ds_read_b64_tr_b16 v[46:47], v77 offset:23680
  ds_read_b64_tr_b16 v[48:49], v79 offset:20640
  ds_read_b64_tr_b16 v[50:51], v79 offset:23712
  s_add_u32 s63, s63, s68
  s_add_u32 m0, s74, 0
  s_nop 0
  buffer_load_dwordx4 v72, s[56:59], s64 offen lds
  s_add_u32 s64, s64, s69
  ds_read_b64_tr_b16 v[52:53], v81 offset:20480
  ds_read_b64_tr_b16 v[54:55], v81 offset:24064
  ds_read_b64_tr_b16 v[56:57], v81 offset:20512
  ds_read_b64_tr_b16 v[58:59], v81 offset:24096
  s_cmp_eq_u32 s75, 1
  s_cbranch_scc1 L_cpf0
  buffer_load_dword v6, v83, s[24:27], s28 offen
  s_add_u32 s28, s28, 256
  s_branch L_cpf0_d
L_cpf0:
  s_mul_i32 s16, s2, 28672
  s_add_u32 s16, s84, s16
  s_addc_u32 s17, s85, 0
  s_mov_b32 s18, 28672
  s_mov_b32 s19, 0x20000
  s_mov_b32 s20, 0
  v_lshlrev_b32 v2, 7, v0
  buffer_load_dword v6, v2, s[16:19], s20 offen
L_cpf0_d:
  ds_read_b64_tr_b16 v[60:61], v81 offset:27648
  ds_read_b64_tr_b16 v[62:63], v81 offset:31232
  ds_read_b64_tr_b16 v[64:65], v81 offset:27680
  ds_read_b64_tr_b16 v[66:67], v81 offset:31264
  s_sub_u32 s12, s75, 5
  s_cmp_le_u32 s12, 1
  s_cbranch_scc0 L_X0_noclr0
  s_sub_u32 s12, 6, s75
  s_lshl_b32 s12, s12, 14
  v_mov_b32 v2, -1
  v_mov_b32 v3, -1
  v_mov_b32 v4, -1
  v_mov_b32 v5, -1
  v_lshlrev_b32 v1, 4, v0
  buffer_store_dwordx4 v[2:5], v1, s[88:91], s12 offen offset:0 sc1
L_X0_noclr0:
  s_waitcnt lgkmcnt(0)
  s_barrier
  .p2align 3
  v_mfma_f32_16x16x32_bf16 v[92:95], v[36:39], v[24:27], v[92:95]
  v_mfma_f32_16x16x32_bf16 v[128:131], v[36:39], v[8:11], v[128:131]
  v_mfma_f32_16x16x32_bf16 v[132:135], v[36:39], v[12:15], v[132:135]
  v_mfma_f32_16x16x32_bf16 v[136:139], v[36:39], v[16:19], v[136:139]
  v_mfma_f32_16x16x32_bf16 v[140:143], v[36:39], v[20:23], v[140:143]
  v_mfma_f32_16x16x32_bf16 v[144:147], v[40:43], v[8:11], v[144:147]
  v_mfma_f32_16x16x32_bf16 v[148:151], v[40:43], v[12:15], v[148:151]
  v_mfma_f32_16x16x32_bf16 v[152:155], v[40:43], v[16:19], v[152:155]
  v_mfma_f32_16x16x32_bf16 v[156:159], v[40:43], v[20:23], v[156:159]
  v_mfma_f32_16x16x32_bf16 v[160:163], v[8:11], v[44:47], v[160:163]
  v_mfma_f32_16x16x32_bf16 v[164:167], v[12:15], v[44:47], v[164:167]
  v_mfma_f32_16x16x32_bf16 v[168:171], v[16:19], v[44:47], v[168:171]
  v_mfma_f32_16x16x32_bf16 v[172:175], v[20:23], v[44:47], v[172:175]
  v_mfma_f32_16x16x32_bf16 v[176:179], v[8:11], v[48:51], v[176:179]
  v_mfma_f32_16x16x32_bf16 v[180:183], v[12:15], v[48:51], v[180:183]
  v_mfma_f32_16x16x32_bf16 v[184:187], v[16:19], v[48:51], v[184:187]
  v_mfma_f32_16x16x32_bf16 v[188:191], v[20:23], v[48:51], v[188:191]
  v_mfma_f32_16x16x32_bf16 v[96:99], v[28:31], v[8:11], v[96:99]
  v_mfma_f32_16x16x32_bf16 v[100:103], v[28:31], v[12:15], v[100:103]
  v_mfma_f32_16x16x32_bf16 v[104:107], v[28:31], v[16:19], v[104:107]
  v_mfma_f32_16x16x32_bf16 v[84:87], v[28:31], v[24:27], v[84:87]
  v_mfma_f32_16x16x32_bf16 v[108:111], v[28:31], v[20:23], v[108:111]
  v_mfma_f32_16x16x32_bf16 v[112:115], v[32:35], v[8:11], v[112:115]
  v_mfma_f32_16x16x32_bf16 v[116:119], v[32:35], v[12:15], v[116:119]
  v_mfma_f32_16x16x32_bf16 v[120:123], v[32:35], v[16:19], v[120:123]
  v_mfma_f32_16x16x32_bf16 v[124:127], v[32:35], v[20:23], v[124:127]
  v_mfma_f32_16x16x32_bf16 v[192:195], v[52:55], v[8:11], v[192:195]
  v_mfma_f32_16x16x32_bf16 v[196:199], v[52:55], v[12:15], v[196:199]
  v_mfma_f32_16x16x32_bf16 v[200:203], v[52:55], v[16:19], v[200:203]
  v_mfma_f32_16x16x32_bf16 v[204:207], v[52:55], v[20:23], v[204:207]
  v_mfma_f32_16x16x32_bf16 v[208:211], v[56:59], v[8:11], v[208:211]
  v_mfma_f32_16x16x32_bf16 v[212:215], v[56:59], v[12:15], v[212:215]
  v_mfma_f32_16x16x32_bf16 v[216:219], v[56:59], v[16:19], v[216:219]
  v_mfma_f32_16x16x32_bf16 v[220:223], v[56:59], v[20:23], v[220:223]
  v_mfma_f32_16x16x32_bf16 v[224:227], v[60:63], v[8:11], v[224:227]
  v_mfma_f32_16x16x32_bf16 v[228:231], v[60:63], v[12:15], v[228:231]
  v_mfma_f32_16x16x32_bf16 v[232:235], v[60:63], v[16:19], v[232:235]
  v_mfma_f32_16x16x32_bf16 v[236:239], v[60:63], v[20:23], v[236:239]
  v_mfma_f32_16x16x32_bf16 v[240:243], v[64:67], v[8:11], v[240:243]
  v_mfma_f32_16x16x32_bf16 v[244:247], v[64:67], v[12:15], v[244:247]
  v_mfma_f32_16x16x32_bf16 v[248:251], v[64:67], v[16:19], v[248:251]
  v_mfma_f32_16x16x32_bf16 v[252:255], v[64:67], v[20:23], v[252:255]
  s_waitcnt vmcnt(11)
  s_barrier
  .p2align 3
  s_add_u32 m0, s70, 20480
  s_nop 0
  buffer_load_dwordx4 v68, s[40:43], s60 offen lds
  ds_read_b128 v[8:11], v73 offset:34816
  ds_read_b128 v[12:15], v73 offset:36864
  ds_read_b128 v[16:19], v73 offset:38912
  ds_read_b128 v[20:23], v73 offset:40960
  ds_read_b128 v[24:27], v75 offset:34816
  s_add_u32 s60, s60, s65
  s_add_u32 m0, s71, 20480
  s_nop 0
  buffer_load_dwordx4 v69, s[44:47], s61 offen lds
  ds_read_b64_tr_b16 v[28:29], v78 offset:0
  ds_read_b64_tr_b16 v[30:31], v78 offset:3072
  ds_read_b64_tr_b16 v[32:33], v80 offset:32
  ds_read_b64_tr_b16 v[34:35], v80 offset:3104
  ds_read_b64_tr_b16 v[36:37], v78 offset:64
  s_add_u32 s61, s61, s66
  s_add_u32 m0, s72, 20480
  s_nop 0
  buffer_load_dwordx4 v70, s[48:51], s62 offen lds
  ds_read_b64_tr_b16 v[38:39], v78 offset:3136
  ds_read_b64_tr_b16 v[40:41], v80 offset:96
  ds_read_b64_tr_b16 v[42:43], v80 offset:3168
  ds_read_b64_tr_b16 v[44:45], v78 offset:128
  ds_read_b64_tr_b16 v[46:47], v78 offset:3200
  s_add_u32 s62, s62, s67
  s_add_u32 m0, s73, 20480
  s_nop 0
  buffer_load_dwordx4 v71, s[52:55], s63 offen lds
  ds_read_b64_tr_b16 v[48:49], v80 offset:160
  ds_read_b64_tr_b16 v[50:51], v80 offset:3232
  ds_read_b64_tr_b16 v[52:53], v82 offset:0
  ds_read_b64_tr_b16 v[54:55], v82 offset:3584
  ds_read_b64_tr_b16 v[56:57], v82 offset:32
  s_add_u32 s63, s63, s68
  s_add_u32 m0, s74, 20480
  s_nop 0
  buffer_load_dwordx4 v72, s[56:59], s64 offen lds
  s_add_u32 s64, s64, s69
  ds_read_b64_tr_b16 v[58:59], v82 offset:3616
  ds_read_b64_tr_b16 v[60:61], v82 offset:7168
  ds_read_b64_tr_b16 v[62:63], v82 offset:10752
  ds_read_b64_tr_b16 v[64:65], v82 offset:7200
  ds_read_b64_tr_b16 v[66:67], v82 offset:10784
  s_sub_u32 s12, s75, 5
  s_cmp_le_u32 s12, 1
  s_cbranch_scc0 L_X0_noclr1
  s_sub_u32 s12, 6, s75
  s_lshl_b32 s12, s12, 14
  v_lshlrev_b32 v1, 4, v0
  buffer_store_dwordx4 v[2:5], v1, s[88:91], s12 offen offset:1024 sc1
L_X0_noclr1:
  s_cmp_eq_u32 s75, 3
  s_cbranch_scc0 L_X0_noinit
  s_load_dwordx2 s[16:17], s[0:1], 64
  v_mov_b32 v2, 0
  v_mov_b32 v3, 1
  s_waitcnt lgkmcnt(0)
  s_mov_b32 s18, 256
  s_mov_b32 s19, 0x20000
  v_cmp_eq_u32 vcc, 0, v0
  s_and_saveexec_b64 s[20:21], vcc
  buffer_atomic_add v3, v2, s[16:19], 0 offen
  s_mov_b64 exec, s[20:21]
L_X0_noinit:
  s_waitcnt lgkmcnt(0)
  s_barrier
  .p2align 3
  v_mfma_f32_16x16x32_bf16 v[92:95], v[36:39], v[24:27], v[92:95]
  v_mfma_f32_16x16x32_bf16 v[128:131], v[36:39], v[8:11], v[128:131]
  v_mfma_f32_16x16x32_bf16 v[132:135], v[36:39], v[12:15], v[132:135]
  v_mfma_f32_16x16x32_bf16 v[136:139], v[36:39], v[16:19], v[136:139]
  v_mfma_f32_16x16x32_bf16 v[140:143], v[36:39], v[20:23], v[140:143]
  v_mfma_f32_16x16x32_bf16 v[144:147], v[40:43], v[8:11], v[144:147]
  v_mfma_f32_16x16x32_bf16 v[148:151], v[40:43], v[12:15], v[148:151]
  v_mfma_f32_16x16x32_bf16 v[152:155], v[40:43], v[16:19], v[152:155]
  v_mfma_f32_16x16x32_bf16 v[156:159], v[40:43], v[20:23], v[156:159]
  v_mfma_f32_16x16x32_bf16 v[160:163], v[8:11], v[44:47], v[160:163]
  v_mfma_f32_16x16x32_bf16 v[164:167], v[12:15], v[44:47], v[164:167]
  v_mfma_f32_16x16x32_bf16 v[168:171], v[16:19], v[44:47], v[168:171]
  v_mfma_f32_16x16x32_bf16 v[172:175], v[20:23], v[44:47], v[172:175]
  v_mfma_f32_16x16x32_bf16 v[176:179], v[8:11], v[48:51], v[176:179]
  v_mfma_f32_16x16x32_bf16 v[180:183], v[12:15], v[48:51], v[180:183]
  v_mfma_f32_16x16x32_bf16 v[184:187], v[16:19], v[48:51], v[184:187]
  v_mfma_f32_16x16x32_bf16 v[188:191], v[20:23], v[48:51], v[188:191]
  v_mfma_f32_16x16x32_bf16 v[96:99], v[28:31], v[8:11], v[96:99]
  v_mfma_f32_16x16x32_bf16 v[100:103], v[28:31], v[12:15], v[100:103]
  v_mfma_f32_16x16x32_bf16 v[104:107], v[28:31], v[16:19], v[104:107]
  v_mfma_f32_16x16x32_bf16 v[84:87], v[28:31], v[24:27], v[84:87]
  v_mfma_f32_16x16x32_bf16 v[108:111], v[28:31], v[20:23], v[108:111]
  v_mfma_f32_16x16x32_bf16 v[112:115], v[32:35], v[8:11], v[112:115]
  v_mfma_f32_16x16x32_bf16 v[116:119], v[32:35], v[12:15], v[116:119]
  v_mfma_f32_16x16x32_bf16 v[120:123], v[32:35], v[16:19], v[120:123]
  v_mfma_f32_16x16x32_bf16 v[124:127], v[32:35], v[20:23], v[124:127]
  v_mfma_f32_16x16x32_bf16 v[192:195], v[52:55], v[8:11], v[192:195]
  v_mfma_f32_16x16x32_bf16 v[196:199], v[52:55], v[12:15], v[196:199]
  v_mfma_f32_16x16x32_bf16 v[200:203], v[52:55], v[16:19], v[200:203]
  v_mfma_f32_16x16x32_bf16 v[204:207], v[52:55], v[20:23], v[204:207]
  v_mfma_f32_16x16x32_bf16 v[208:211], v[56:59], v[8:11], v[208:211]
  v_mfma_f32_16x16x32_bf16 v[212:215], v[56:59], v[12:15], v[212:215]
  v_mfma_f32_16x16x32_bf16 v[216:219], v[56:59], v[16:19], v[216:219]
  v_mfma_f32_16x16x32_bf16 v[220:223], v[56:59], v[20:23], v[220:223]
  v_mfma_f32_16x16x32_bf16 v[224:227], v[60:63], v[8:11], v[224:227]
  v_mfma_f32_16x16x32_bf16 v[228:231], v[60:63], v[12:15], v[228:231]
  v_mfma_f32_16x16x32_bf16 v[232:235], v[60:63], v[16:19], v[232:235]
  v_mfma_f32_16x16x32_bf16 v[236:239], v[60:63], v[20:23], v[236:239]
  v_mfma_f32_16x16x32_bf16 v[240:243], v[64:67], v[8:11], v[240:243]
  v_mfma_f32_16x16x32_bf16 v[244:247], v[64:67], v[12:15], v[244:247]
  v_mfma_f32_16x16x32_bf16 v[248:251], v[64:67], v[16:19], v[248:251]
  v_mfma_f32_16x16x32_bf16 v[252:255], v[64:67], v[20:23], v[252:255]
  s_waitcnt vmcnt(11)
  s_barrier
  .p2align 3
  s_add_u32 m0, s70, 40960
  s_nop 0
  buffer_load_dwordx4 v68, s[40:43], s60 offen lds
  ds_read_b128 v[8:11], v74 offset:34816
  ds_read_b128 v[12:15], v74 offset:36864
  ds_read_b128 v[16:19], v74 offset:38912
  ds_read_b128 v[20:23], v74 offset:40960
  ds_read_b128 v[24:27], v76 offset:34816
  s_add_u32 s60, s60, s65
  s_add_u32 m0, s71, 40960
  s_nop 0
  buffer_load_dwordx4 v69, s[44:47], s61 offen lds
  ds_read_b64_tr_b16 v[28:29], v78 offset:20480
  ds_read_b64_tr_b16 v[30:31], v78 offset:23552
  ds_read_b64_tr_b16 v[32:33], v80 offset:20512
  ds_read_b64_tr_b16 v[34:35], v80 offset:23584
  ds_read_b64_tr_b16 v[36:37], v78 offset:20544
  s_add_u32 s61, s61, s66
  s_add_u32 m0, s72, 40960
  s_nop 0
  buffer_load_dwordx4 v70, s[48:51], s62 offen lds
  ds_read_b64_tr_b16 v[38:39], v78 offset:23616
  ds_read_b64_tr_b16 v[40:41], v80 offset:20576
  ds_read_b64_tr_b16 v[42:43], v80 offset:23648
  ds_read_b64_tr_b16 v[44:45], v78 offset:20608
  ds_read_b64_tr_b16 v[46:47], v78 offset:23680
  s_add_u32 s62, s62, s67
  s_add_u32 m0, s73, 40960
  s_nop 0
  buffer_load_dwordx4 v71, s[52:55], s63 offen lds
  ds_read_b64_tr_b16 v[48:49], v80 offset:20640
  ds_read_b64_tr_b16 v[50:51], v80 offset:23712
  ds_read_b64_tr_b16 v[52:53], v82 offset:20480
  ds_read_b64_tr_b16 v[54:55], v82 offset:24064
  ds_read_b64_tr_b16 v[56:57], v82 offset:20512
  s_add_u32 s63, s63, s68
  s_add_u32 m0, s74, 40960
  s_nop 0
  buffer_load_dwordx4 v72, s[56:59], s64 offen lds
  s_add_u32 s64, s64, s69
  ds_read_b64_tr_b16 v[58:59], v82 offset:24096
  ds_read_b64_tr_b16 v[60:61], v82 offset:27648
  ds_read_b64_tr_b16 v[62:63], v82 offset:31232
  ds_read_b64_tr_b16 v[64:65], v82 offset:27680
  ds_read_b64_tr_b16 v[66:67], v82 offset:31264
  s_sub_u32 s12, s75, 5
  s_cmp_le_u32 s12, 1
  s_cbranch_scc0 L_X0_noclr2
  s_sub_u32 s12, 6, s75
  s_lshl_b32 s12, s12, 14
  v_lshlrev_b32 v1, 4, v0
  buffer_store_dwordx4 v[2:5], v1, s[88:91], s12 offen offset:2048 sc1
L_X0_noclr2:
  s_waitcnt lgkmcnt(0)
  s_barrier
  .p2align 3
  v_mfma_f32_16x16x32_bf16 v[92:95], v[36:39], v[24:27], v[92:95]
  v_mfma_f32_16x16x32_bf16 v[128:131], v[36:39], v[8:11], v[128:131]
  v_mfma_f32_16x16x32_bf16 v[132:135], v[36:39], v[12:15], v[132:135]
  v_mfma_f32_16x16x32_bf16 v[136:139], v[36:39], v[16:19], v[136:139]
  v_mfma_f32_16x16x32_bf16 v[140:143], v[36:39], v[20:23], v[140:143]
  v_mfma_f32_16x16x32_bf16 v[144:147], v[40:43], v[8:11], v[144:147]
  v_mfma_f32_16x16x32_bf16 v[148:151], v[40:43], v[12:15], v[148:151]
  v_mfma_f32_16x16x32_bf16 v[152:155], v[40:43], v[16:19], v[152:155]
  v_mfma_f32_16x16x32_bf16 v[156:159], v[40:43], v[20:23], v[156:159]
  v_mfma_f32_16x16x32_bf16 v[160:163], v[8:11], v[44:47], v[160:163]
  v_mfma_f32_16x16x32_bf16 v[164:167], v[12:15], v[44:47], v[164:167]
  v_mfma_f32_16x16x32_bf16 v[168:171], v[16:19], v[44:47], v[168:171]
  v_mfma_f32_16x16x32_bf16 v[172:175], v[20:23], v[44:47], v[172:175]
  v_mfma_f32_16x16x32_bf16 v[176:179], v[8:11], v[48:51], v[176:179]
  v_mfma_f32_16x16x32_bf16 v[180:183], v[12:15], v[48:51], v[180:183]
  v_mfma_f32_16x16x32_bf16 v[184:187], v[16:19], v[48:51], v[184:187]
  v_mfma_f32_16x16x32_bf16 v[188:191], v[20:23], v[48:51], v[188:191]
  v_mfma_f32_16x16x32_bf16 v[96:99], v[28:31], v[8:11], v[96:99]
  v_mfma_f32_16x16x32_bf16 v[100:103], v[28:31], v[12:15], v[100:103]
  v_mfma_f32_16x16x32_bf16 v[104:107], v[28:31], v[16:19], v[104:107]
  v_mfma_f32_16x16x32_bf16 v[84:87], v[28:31], v[24:27], v[84:87]
  v_mfma_f32_16x16x32_bf16 v[108:111], v[28:31], v[20:23], v[108:111]
  v_mfma_f32_16x16x32_bf16 v[112:115], v[32:35], v[8:11], v[112:115]
  v_mfma_f32_16x16x32_bf16 v[116:119], v[32:35], v[12:15], v[116:119]
  v_mfma_f32_16x16x32_bf16 v[120:123], v[32:35], v[16:19], v[120:123]
  v_mfma_f32_16x16x32_bf16 v[124:127], v[32:35], v[20:23], v[124:127]
  v_mfma_f32_16x16x32_bf16 v[192:195], v[52:55], v[8:11], v[192:195]
  v_mfma_f32_16x16x32_bf16 v[196:199], v[52:55], v[12:15], v[196:199]
  v_mfma_f32_16x16x32_bf16 v[200:203], v[52:55], v[16:19], v[200:203]
  v_mfma_f32_16x16x32_bf16 v[204:207], v[52:55], v[20:23], v[204:207]
  v_mfma_f32_16x16x32_bf16 v[208:211], v[56:59], v[8:11], v[208:211]
  v_mfma_f32_16x16x32_bf16 v[212:215], v[56:59], v[12:15], v[212:215]
  v_mfma_f32_16x16x32_bf16 v[216:219], v[56:59], v[16:19], v[216:219]
  v_mfma_f32_16x16x32_bf16 v[220:223], v[56:59], v[20:23], v[220:223]
  v_mfma_f32_16x16x32_bf16 v[224:227], v[60:63], v[8:11], v[224:227]
  v_mfma_f32_16x16x32_bf16 v[228:231], v[60:63], v[12:15], v[228:231]
  v_mfma_f32_16x16x32_bf16 v[232:235], v[60:63], v[16:19], v[232:235]
  v_mfma_f32_16x16x32_bf16 v[236:239], v[60:63], v[20:23], v[236:239]
  v_mfma_f32_16x16x32_bf16 v[240:243], v[64:67], v[8:11], v[240:243]
  v_mfma_f32_16x16x32_bf16 v[244:247], v[64:67], v[12:15], v[244:247]
  v_mfma_f32_16x16x32_bf16 v[248:251], v[64:67], v[16:19], v[248:251]
  v_mfma_f32_16x16x32_bf16 v[252:255], v[64:67], v[20:23], v[252:255]
  s_waitcnt vmcnt(11)
  s_barrier
  .p2align 3
  s_add_u32 m0, s70, 61440
  s_nop 0
  buffer_load_dwordx4 v68, s[40:43], s60 offen lds
  ds_read_b128 v[8:11], v73 offset:0
  ds_read_b128 v[12:15], v73 offset:2048
  ds_read_b128 v[16:19], v73 offset:4096
  ds_read_b128 v[20:23], v73 offset:6144
  ds_read_b128 v[24:27], v75 offset:0
  s_add_u32 s60, s60, s65
  s_add_u32 m0, s71, 61440
  s_nop 0
  buffer_load_dwordx4 v69, s[44:47], s61 offen lds
  ds_read_b64_tr_b16 v[28:29], v77 offset:0
  ds_read_b64_tr_b16 v[30:31], v77 offset:3072
  ds_read_b64_tr_b16 v[32:33], v79 offset:32
  ds_read_b64_tr_b16 v[34:35], v79 offset:3104
  ds_read_b64_tr_b16 v[36:37], v77 offset:64
  s_add_u32 s61, s61, s66
  s_add_u32 m0, s72, 61440
  s_nop 0
  buffer_load_dwordx4 v70, s[48:51], s62 offen lds
  ds_read_b64_tr_b16 v[38:39], v77 offset:3136
  ds_read_b64_tr_b16 v[40:41], v79 offset:96
  ds_read_b64_tr_b16 v[42:43], v79 offset:3168
  ds_read_b64_tr_b16 v[44:45], v77 offset:128
  ds_read_b64_tr_b16 v[46:47], v77 offset:3200
  s_add_u32 s62, s62, s67
  s_add_u32 m0, s73, 61440
  s_nop 0
  buffer_load_dwordx4 v71, s[52:55], s63 offen lds
  ds_read_b64_tr_b16 v[48:49], v79 offset:160
  ds_read_b64_tr_b16 v[50:51], v79 offset:3232
  ds_read_b64_tr_b16 v[52:53], v81 offset:0
  ds_read_b64_tr_b16 v[54:55], v81 offset:3584
  ds_read_b64_tr_b16 v[56:57], v81 offset:32
  s_add_u32 s63, s63, s68
  s_add_u32 m0, s74, 61440
  s_nop 0
  buffer_load_dwordx4 v72, s[56:59], s64 offen lds
  s_add_u32 s64, s64, s69
  ds_read_b64_tr_b16 v[58:59], v81 offset:3616
  ds_read_b64_tr_b16 v[60:61], v81 offset:7168
  ds_read_b64_tr_b16 v[62:63], v81 offset:10752
  ds_read_b64_tr_b16 v[64:65], v81 offset:7200
  ds_read_b64_tr_b16 v[66:67], v81 offset:10784
  s_sub_u32 s12, s75, 5
  s_cmp_le_u32 s12, 1
  s_cbranch_scc0 L_X0_noclr3
  s_sub_u32 s12, 6, s75
  s_lshl_b32 s12, s12, 14
  v_lshlrev_b32 v1, 4, v0
  buffer_store_dwordx4 v[2:5], v1, s[88:91], s12 offen offset:3072 sc1
L_X0_noclr3:
  s_waitcnt lgkmcnt(0)
  s_barrier
  s_sub_u32 s75, s75, 1
  s_cmp_lg_u32 s75, 0
  s_cbranch_scc1 L_X0_loop
  s_load_dwordx2 s[24:25], s[0:1], 16
  s_load_dwordx2 s[26:27], s[0:1], 48
  s_load_dwordx2 s[28:29], s[0:1], 64
  .p2align 3
  v_mfma_f32_16x16x32_bf16 v[92:95], v[36:39], v[24:27], v[92:95]
  v_mfma_f32_16x16x32_bf16 v[128:131], v[36:39], v[8:11], v[128:131]
  v_mfma_f32_16x16x32_bf16 v[132:135], v[36:39], v[12:15], v[132:135]
  v_mfma_f32_16x16x32_bf16 v[136:139], v[36:39], v[16:19], v[136:139]
  v_mfma_f32_16x16x32_bf16 v[140:143], v[36:39], v[20:23], v[140:143]
  v_mfma_f32_16x16x32_bf16 v[144:147], v[40:43], v[8:11], v[144:147]
  v_mfma_f32_16x16x32_bf16 v[148:151], v[40:43], v[12:15], v[148:151]
  v_mfma_f32_16x16x32_bf16 v[152:155], v[40:43], v[16:19], v[152:155]
  v_mfma_f32_16x16x32_bf16 v[156:159], v[40:43], v[20:23], v[156:159]
  v_mfma_f32_16x16x32_bf16 v[160:163], v[8:11], v[44:47], v[160:163]
  v_mfma_f32_16x16x32_bf16 v[164:167], v[12:15], v[44:47], v[164:167]
  v_mfma_f32_16x16x32_bf16 v[168:171], v[16:19], v[44:47], v[168:171]
  v_mfma_f32_16x16x32_bf16 v[172:175], v[20:23], v[44:47], v[172:175]
  v_mfma_f32_16x16x32_bf16 v[176:179], v[8:11], v[48:51], v[176:179]
  v_mfma_f32_16x16x32_bf16 v[180:183], v[12:15], v[48:51], v[180:183]
  v_mfma_f32_16x16x32_bf16 v[184:187], v[16:19], v[48:51], v[184:187]
  v_mfma_f32_16x16x32_bf16 v[188:191], v[20:23], v[48:51], v[188:191]
  v_mfma_f32_16x16x32_bf16 v[96:99], v[28:31], v[8:11], v[96:99]
  v_mfma_f32_16x16x32_bf16 v[100:103], v[28:31], v[12:15], v[100:103]
  v_mfma_f32_16x16x32_bf16 v[104:107], v[28:31], v[16:19], v[104:107]
  v_mfma_f32_16x16x32_bf16 v[84:87], v[28:31], v[24:27], v[84:87]
  v_mfma_f32_16x16x32_bf16 v[108:111], v[28:31], v[20:23], v[108:111]
  v_mfma_f32_16x16x32_bf16 v[112:115], v[32:35], v[8:11], v[112:115]
  v_mfma_f32_16x16x32_bf16 v[116:119], v[32:35], v[12:15], v[116:119]
  v_mfma_f32_16x16x32_bf16 v[120:123], v[32:35], v[16:19], v[120:123]
  v_mfma_f32_16x16x32_bf16 v[124:127], v[32:35], v[20:23], v[124:127]
  v_mfma_f32_16x16x32_bf16 v[192:195], v[52:55], v[8:11], v[192:195]
  v_mfma_f32_16x16x32_bf16 v[196:199], v[52:55], v[12:15], v[196:199]
  v_mfma_f32_16x16x32_bf16 v[200:203], v[52:55], v[16:19], v[200:203]
  v_mfma_f32_16x16x32_bf16 v[204:207], v[52:55], v[20:23], v[204:207]
  v_mfma_f32_16x16x32_bf16 v[208:211], v[56:59], v[8:11], v[208:211]
  v_mfma_f32_16x16x32_bf16 v[212:215], v[56:59], v[12:15], v[212:215]
  v_mfma_f32_16x16x32_bf16 v[216:219], v[56:59], v[16:19], v[216:219]
  v_mfma_f32_16x16x32_bf16 v[220:223], v[56:59], v[20:23], v[220:223]
  v_mfma_f32_16x16x32_bf16 v[224:227], v[60:63], v[8:11], v[224:227]
  v_mfma_f32_16x16x32_bf16 v[228:231], v[60:63], v[12:15], v[228:231]
  v_mfma_f32_16x16x32_bf16 v[232:235], v[60:63], v[16:19], v[232:235]
  v_mfma_f32_16x16x32_bf16 v[236:239], v[60:63], v[20:23], v[236:239]
  v_mfma_f32_16x16x32_bf16 v[240:243], v[64:67], v[8:11], v[240:243]
  v_mfma_f32_16x16x32_bf16 v[244:247], v[64:67], v[12:15], v[244:247]
  v_mfma_f32_16x16x32_bf16 v[248:251], v[64:67], v[16:19], v[248:251]
  v_mfma_f32_16x16x32_bf16 v[252:255], v[64:67], v[20:23], v[252:255]
  s_waitcnt vmcnt(10)
  s_barrier
  ds_read_b128 v[8:11], v74 offset:0
  ds_read_b128 v[12:15], v74 offset:2048
  ds_read_b128 v[16:19], v74 offset:4096
  ds_read_b128 v[20:23], v74 offset:6144
  ds_read_b128 v[24:27], v76 offset:0
  ds_read_b64_tr_b16 v[28:29], v77 offset:20480
  ds_read_b64_tr_b16 v[30:31], v77 offset:23552
  ds_read_b64_tr_b16 v[32:33], v79 offset:20512
  ds_read_b64_tr_b16 v[34:35], v79 offset:23584
  ds_read_b64_tr_b16 v[36:37], v77 offset:20544
  ds_read_b64_tr_b16 v[38:39], v77 offset:23616
  ds_read_b64_tr_b16 v[40:41], v79 offset:20576
  ds_read_b64_tr_b16 v[42:43], v79 offset:23648
  ds_read_b64_tr_b16 v[44:45], v77 offset:20608
  ds_read_b64_tr_b16 v[46:47], v77 offset:23680
  ds_read_b64_tr_b16 v[48:49], v79 offset:20640
  ds_read_b64_tr_b16 v[50:51], v79 offset:23712
  ds_read_b64_tr_b16 v[52:53], v81 offset:20480
  ds_read_b64_tr_b16 v[54:55], v81 offset:24064
  ds_read_b64_tr_b16 v[56:57], v81 offset:20512
  ds_read_b64_tr_b16 v[58:59], v81 offset:24096
  ds_read_b64_tr_b16 v[60:61], v81 offset:27648
  ds_read_b64_tr_b16 v[62:63], v81 offset:31232
  ds_read_b64_tr_b16 v[64:65], v81 offset:27680
  ds_read_b64_tr_b16 v[66:67], v81 offset:31264
  s_waitcnt lgkmcnt(0)
  s_mov_b32 s30, 256
  s_mov_b32 s31, 0x20000
  v_mov_b32 v2, 0
  buffer_load_dword v1, v2, s[28:31], 0 offen sc1
  s_waitcnt lgkmcnt(0)
  s_barrier
  .p2align 3
  v_mfma_f32_16x16x32_bf16 v[92:95], v[36:39], v[24:27], v[92:95]
  v_mfma_f32_16x16x32_bf16 v[128:131], v[36:39], v[8:11], v[128:131]
  v_mfma_f32_16x16x32_bf16 v[132:135], v[36:39], v[12:15], v[132:135]
  v_mfma_f32_16x16x32_bf16 v[136:139], v[36:39], v[16:19], v[136:139]
  v_mfma_f32_16x16x32_bf16 v[140:143], v[36:39], v[20:23], v[140:143]
  v_mfma_f32_16x16x32_bf16 v[144:147], v[40:43], v[8:11], v[144:147]
  v_mfma_f32_16x16x32_bf16 v[148:151], v[40:43], v[12:15], v[148:151]
  v_mfma_f32_16x16x32_bf16 v[152:155], v[40:43], v[16:19], v[152:155]
  v_mfma_f32_16x16x32_bf16 v[156:159], v[40:43], v[20:23], v[156:159]
  v_mfma_f32_16x16x32_bf16 v[160:163], v[8:11], v[44:47], v[160:163]
  v_mfma_f32_16x16x32_bf16 v[164:167], v[12:15], v[44:47], v[164:167]
  v_mfma_f32_16x16x32_bf16 v[168:171], v[16:19], v[44:47], v[168:171]
  v_mfma_f32_16x16x32_bf16 v[172:175], v[20:23], v[44:47], v[172:175]
  v_mfma_f32_16x16x32_bf16 v[176:179], v[8:11], v[48:51], v[176:179]
  v_mfma_f32_16x16x32_bf16 v[180:183], v[12:15], v[48:51], v[180:183]
  v_mfma_f32_16x16x32_bf16 v[184:187], v[16:19], v[48:51], v[184:187]
  v_mfma_f32_16x16x32_bf16 v[188:191], v[20:23], v[48:51], v[188:191]
  v_mfma_f32_16x16x32_bf16 v[96:99], v[28:31], v[8:11], v[96:99]
  v_mfma_f32_16x16x32_bf16 v[100:103], v[28:31], v[12:15], v[100:103]
  v_mfma_f32_16x16x32_bf16 v[104:107], v[28:31], v[16:19], v[104:107]
  v_mfma_f32_16x16x32_bf16 v[84:87], v[28:31], v[24:27], v[84:87]
  v_mfma_f32_16x16x32_bf16 v[108:111], v[28:31], v[20:23], v[108:111]
  v_mfma_f32_16x16x32_bf16 v[112:115], v[32:35], v[8:11], v[112:115]
  v_mfma_f32_16x16x32_bf16 v[116:119], v[32:35], v[12:15], v[116:119]
  v_mfma_f32_16x16x32_bf16 v[120:123], v[32:35], v[16:19], v[120:123]
  v_mfma_f32_16x16x32_bf16 v[124:127], v[32:35], v[20:23], v[124:127]
  v_mfma_f32_16x16x32_bf16 v[192:195], v[52:55], v[8:11], v[192:195]
  v_mfma_f32_16x16x32_bf16 v[196:199], v[52:55], v[12:15], v[196:199]
  v_mfma_f32_16x16x32_bf16 v[200:203], v[52:55], v[16:19], v[200:203]
  v_mfma_f32_16x16x32_bf16 v[204:207], v[52:55], v[20:23], v[204:207]
  v_mfma_f32_16x16x32_bf16 v[208:211], v[56:59], v[8:11], v[208:211]
  v_mfma_f32_16x16x32_bf16 v[212:215], v[56:59], v[12:15], v[212:215]
  v_mfma_f32_16x16x32_bf16 v[216:219], v[56:59], v[16:19], v[216:219]
  v_mfma_f32_16x16x32_bf16 v[220:223], v[56:59], v[20:23], v[220:223]
  v_mfma_f32_16x16x32_bf16 v[224:227], v[60:63], v[8:11], v[224:227]
  v_mfma_f32_16x16x32_bf16 v[228:231], v[60:63], v[12:15], v[228:231]
  v_mfma_f32_16x16x32_bf16 v[232:235], v[60:63], v[16:19], v[232:235]
  v_mfma_f32_16x16x32_bf16 v[236:239], v[60:63], v[20:23], v[236:239]
  v_mfma_f32_16x16x32_bf16 v[240:243], v[64:67], v[8:11], v[240:243]
  v_mfma_f32_16x16x32_bf16 v[244:247], v[64:67], v[12:15], v[244:247]
  v_mfma_f32_16x16x32_bf16 v[248:251], v[64:67], v[16:19], v[248:251]
  v_mfma_f32_16x16x32_bf16 v[252:255], v[64:67], v[20:23], v[252:255]
  s_waitcnt vmcnt(5)
  s_barrier
  ds_read_b128 v[8:11], v73 offset:34816
  ds_read_b128 v[12:15], v73 offset:36864
  ds_read_b128 v[16:19], v73 offset:38912
  ds_read_b128 v[20:23], v73 offset:40960
  ds_read_b128 v[24:27], v75 offset:34816
  ds_read_b64_tr_b16 v[28:29], v78 offset:0
  ds_read_b64_tr_b16 v[30:31], v78 offset:3072
  ds_read_b64_tr_b16 v[32:33], v80 offset:32
  ds_read_b64_tr_b16 v[34:35], v80 offset:3104
  ds_read_b64_tr_b16 v[36:37], v78 offset:64
  ds_read_b64_tr_b16 v[38:39], v78 offset:3136
  ds_read_b64_tr_b16 v[40:41], v80 offset:96
  ds_read_b64_tr_b16 v[42:43], v80 offset:3168
  ds_read_b64_tr_b16 v[44:45], v78 offset:128
  ds_read_b64_tr_b16 v[46:47], v78 offset:3200
  ds_read_b64_tr_b16 v[48:49], v80 offset:160
  ds_read_b64_tr_b16 v[50:51], v80 offset:3232
  ds_read_b64_tr_b16 v[52:53], v82 offset:0
  ds_read_b64_tr_b16 v[54:55], v82 offset:3584
  ds_read_b64_tr_b16 v[56:57], v82 offset:32
  ds_read_b64_tr_b16 v[58:59], v82 offset:3616
  ds_read_b64_tr_b16 v[60:61], v82 offset:7168
  ds_read_b64_tr_b16 v[62:63], v82 offset:10752
  ds_read_b64_tr_b16 v[64:65], v82 offset:7200
  ds_read_b64_tr_b16 v[66:67], v82 offset:10784
  s_waitcnt lgkmcnt(0)
  s_barrier
  .p2align 3
  v_mfma_f32_16x16x32_bf16 v[92:95], v[36:39], v[24:27], v[92:95]
  v_mfma_f32_16x16x32_bf16 v[128:131], v[36:39], v[8:11], v[128:131]
  v_mfma_f32_16x16x32_bf16 v[132:135], v[36:39], v[12:15], v[132:135]
  v_mfma_f32_16x16x32_bf16 v[136:139], v[36:39], v[16:19], v[136:139]
  v_mfma_f32_16x16x32_bf16 v[140:143], v[36:39], v[20:23], v[140:143]
  v_mfma_f32_16x16x32_bf16 v[144:147], v[40:43], v[8:11], v[144:147]
  v_mfma_f32_16x16x32_bf16 v[148:151], v[40:43], v[12:15], v[148:151]
  v_mfma_f32_16x16x32_bf16 v[152:155], v[40:43], v[16:19], v[152:155]
  v_mfma_f32_16x16x32_bf16 v[156:159], v[40:43], v[20:23], v[156:159]
  v_mfma_f32_16x16x32_bf16 v[160:163], v[8:11], v[44:47], v[160:163]
  v_mfma_f32_16x16x32_bf16 v[164:167], v[12:15], v[44:47], v[164:167]
  v_mfma_f32_16x16x32_bf16 v[168:171], v[16:19], v[44:47], v[168:171]
  v_mfma_f32_16x16x32_bf16 v[172:175], v[20:23], v[44:47], v[172:175]
  v_mfma_f32_16x16x32_bf16 v[176:179], v[8:11], v[48:51], v[176:179]
  v_mfma_f32_16x16x32_bf16 v[180:183], v[12:15], v[48:51], v[180:183]
  v_mfma_f32_16x16x32_bf16 v[184:187], v[16:19], v[48:51], v[184:187]
  v_mfma_f32_16x16x32_bf16 v[188:191], v[20:23], v[48:51], v[188:191]
  v_mfma_f32_16x16x32_bf16 v[96:99], v[28:31], v[8:11], v[96:99]
  v_mfma_f32_16x16x32_bf16 v[100:103], v[28:31], v[12:15], v[100:103]
  v_mfma_f32_16x16x32_bf16 v[104:107], v[28:31], v[16:19], v[104:107]
  v_mfma_f32_16x16x32_bf16 v[84:87], v[28:31], v[24:27], v[84:87]
  v_mfma_f32_16x16x32_bf16 v[108:111], v[28:31], v[20:23], v[108:111]
  v_mfma_f32_16x16x32_bf16 v[112:115], v[32:35], v[8:11], v[112:115]
  v_mfma_f32_16x16x32_bf16 v[116:119], v[32:35], v[12:15], v[116:119]
  v_mfma_f32_16x16x32_bf16 v[120:123], v[32:35], v[16:19], v[120:123]
  v_mfma_f32_16x16x32_bf16 v[124:127], v[32:35], v[20:23], v[124:127]
  v_mfma_f32_16x16x32_bf16 v[192:195], v[52:55], v[8:11], v[192:195]
  v_mfma_f32_16x16x32_bf16 v[196:199], v[52:55], v[12:15], v[196:199]
  v_mfma_f32_16x16x32_bf16 v[200:203], v[52:55], v[16:19], v[200:203]
  v_mfma_f32_16x16x32_bf16 v[204:207], v[52:55], v[20:23], v[204:207]
  v_mfma_f32_16x16x32_bf16 v[208:211], v[56:59], v[8:11], v[208:211]
  v_mfma_f32_16x16x32_bf16 v[212:215], v[56:59], v[12:15], v[212:215]
  v_mfma_f32_16x16x32_bf16 v[216:219], v[56:59], v[16:19], v[216:219]
  v_mfma_f32_16x16x32_bf16 v[220:223], v[56:59], v[20:23], v[220:223]
  v_mfma_f32_16x16x32_bf16 v[224:227], v[60:63], v[8:11], v[224:227]
  v_mfma_f32_16x16x32_bf16 v[228:231], v[60:63], v[12:15], v[228:231]
  v_mfma_f32_16x16x32_bf16 v[232:235], v[60:63], v[16:19], v[232:235]
  v_mfma_f32_16x16x32_bf16 v[236:239], v[60:63], v[20:23], v[236:239]
  v_mfma_f32_16x16x32_bf16 v[240:243], v[64:67], v[8:11], v[240:243]
  v_mfma_f32_16x16x32_bf16 v[244:247], v[64:67], v[12:15], v[244:247]
  v_mfma_f32_16x16x32_bf16 v[248:251], v[64:67], v[16:19], v[248:251]
  v_mfma_f32_16x16x32_bf16 v[252:255], v[64:67], v[20:23], v[252:255]
  s_waitcnt vmcnt(0)
  s_barrier
  ds_read_b128 v[8:11], v74 offset:34816
  ds_read_b128 v[12:15], v74 offset:36864
  ds_read_b128 v[16:19], v74 offset:38912
  ds_read_b128 v[20:23], v74 offset:40960
  ds_read_b128 v[24:27], v76 offset:34816
  ds_read_b64_tr_b16 v[28:29], v78 offset:20480
  ds_read_b64_tr_b16 v[30:31], v78 offset:23552
  ds_read_b64_tr_b16 v[32:33], v80 offset:20512
  ds_read_b64_tr_b16 v[34:35], v80 offset:23584
  ds_read_b64_tr_b16 v[36:37], v78 offset:20544
  ds_read_b64_tr_b16 v[38:39], v78 offset:23616
  ds_read_b64_tr_b16 v[40:41], v80 offset:20576
  ds_read_b64_tr_b16 v[42:43], v80 offset:23648
  ds_read_b64_tr_b16 v[44:45], v78 offset:20608
  ds_read_b64_tr_b16 v[46:47], v78 offset:23680
  ds_read_b64_tr_b16 v[48:49], v80 offset:20640
  ds_read_b64_tr_b16 v[50:51], v80 offset:23712
  ds_read_b64_tr_b16 v[52:53], v82 offset:20480
  ds_read_b64_tr_b16 v[54:55], v82 offset:24064
  ds_read_b64_tr_b16 v[56:57], v82 offset:20512
  ds_read_b64_tr_b16 v[58:59], v82 offset:24096
  ds_read_b64_tr_b16 v[60:61], v82 offset:27648
  ds_read_b64_tr_b16 v[62:63], v82 offset:31232
  ds_read_b64_tr_b16 v[64:65], v82 offset:27680
  ds_read_b64_tr_b16 v[66:67], v82 offset:31264
  s_mov_b32 s12, 0x40000
  v_mov_b32 v2, 0
L_ichk:
  v_readfirstlane_b32 s13, v1
  s_cmp_eq_u32 s13, 256
  s_cbranch_scc1 L_ichk_ok
  s_sub_u32 s12, s12, 1
  s_cmp_eq_u32 s12, 0
  s_cbranch_scc1 L_ichk_ok
  s_sleep 8
  buffer_load_dword v1, v2, s[28:31], 0 offen sc1
  s_waitcnt vmcnt(0)
  s_branch L_ichk
L_ichk_ok:
  s_add_u32 s16, s6, 104857600
  s_addc_u32 s17, s7, 0
  s_mov_b32 s18, 21504
  s_mov_b32 s19, 0x20000
  s_xor_b32 s12, s2, 8
  s_lshl_b32 s12, s12, 2
  s_add_u32 s12, s12, 20480
  v_mov_b32 v2, s12
  buffer_load_dword v5, v2, s[16:19], 0 offen sc1
  s_mov_b32 s16, s6
  s_mov_b32 s17, s7
  s_mov_b32 s18, 32768
  s_mov_b32 s19, 0x20000
  s_lshl_b32 s12, s79, 8
  v_add_u32 v2, s12, v0
  v_lshlrev_b32 v2, 4, v2
  s_mov_b32 m0, 151808
  s_sub_u32 s12, s12, 16
  buffer_load_dwordx4 v2, s[16:19], 0 offen offset:0 sc1 lds
  buffer_load_dwordx4 v2, s[16:19], 0 offen offset:1024 sc1 lds
  buffer_load_dwordx4 v2, s[16:19], 0 offen offset:2048 sc1 lds
  buffer_load_dwordx4 v2, s[16:19], 0 offen offset:3072 sc1 lds
  v_add_u32 v2, s12, v0
  v_max_i32 v2, 0, v2
  v_lshlrev_b32 v2, 4, v2
  s_mov_b32 m0, 151552
  s_mov_b64 exec, 0xffff
  buffer_load_dwordx4 v2, s[16:19], 0 offen sc1 lds
  s_mov_b64 exec, -1
  s_and_b32 s3, s2, 7
  s_lshr_b32 s16, s2, 3
  s_and_b32 s20, s16, 1
  s_lshr_b32 s16, s16, 1
  s_lshr_b32 s17, s3, 1
  s_lshl_b32 s17, s17, 2
  s_and_b32 s18, s16, 3
  s_add_u32 s21, s17, s18
  s_and_b32 s17, s3, 1
  s_lshl_b32 s17, s17, 2
  s_lshr_b32 s18, s16, 2
  s_add_u32 s22, s17, s18
  s_lshl_b32 s23, s21, 3
  s_add_u32 s23, s23, s22
  s_lshr_b32 s19, s76, 2
  s_mov_b32 s64, s24
  s_mov_b32 s65, s25
  s_mov_b32 s66, 2097152
  s_mov_b32 s67, 0x20000
  s_lshl_b32 s16, s20, 4
  s_lshl_b32 s17, s19, 1
  s_add_u32 s16, s16, s17
  s_lshl_b32 s73, s16, 16
  s_mov_b32 s70, 262144
  s_mov_b32 s72, 65536
  s_mov_b32 s68, 4
  s_mov_b32 s69, 0
  s_mul_i32 s16, s20, 56
  s_mul_i32 s17, s19, 7
  s_add_u32 s18, s16, s17
  s_lshl_b32 s80, s18, 16
  s_mul_i32 s17, s19, 3
  s_add_u32 s18, s16, s17
  s_add_u32 s18, s18, 1
  s_lshl_b32 s81, s18, 16
  s_mul_i32 s17, s19, 14
  s_add_u32 s18, s16, s17
  s_add_u32 s18, s18, 6
  s_lshl_b32 s82, s18, 16
  s_mul_i32 s17, s19, 49152
  s_lshl_b32 s18, s77, 11
  s_add_u32 s74, s17, s18
  v_lshrrev_b32 v3, 4, v0
  v_lshlrev_b32 v4, 1, v3
  v_and_b32 v2, 15, v0
  v_xor_b32 v6, v4, v2
  v_xor_b32 v2, 8, v6
  s_lshl_b32 s17, s77, 3
  v_add_u32 v3, s17, v3
  v_lshlrev_b32 v3, 11, v3
  s_lshl_b32 s17, s22, 8
  v_add_u32 v3, s17, v3
  v_lshl_add_u32 v68, v6, 4, v3
  v_lshl_add_u32 v69, v2, 4, v3
  v_add_u32 v69, 8192, v69
  s_add_u32 m0, s74, 0
  s_add_u32 s75, s73, s72
  buffer_load_dwordx4 v68, s[64:67], s73 offen lds
  s_add_u32 m0, s74, 1024
  s_sub_u32 s68, s68, 1
  buffer_load_dwordx4 v69, s[64:67], s73 offen lds
  s_add_u32 m0, s74, 8192
  s_add_u32 s73, s73, s70
  buffer_load_dwordx4 v68, s[64:67], s75 offen lds
  s_add_u32 m0, s74, 9216
  s_cmp_eq_u32 s68, 0
  buffer_load_dwordx4 v69, s[64:67], s75 offen lds
  s_cbranch_scc0 L_bo1
  s_add_u32 s69, s69, 1
  s_mov_b32 s64, s26
  s_mov_b32 s65, s27
  s_mov_b32 s66, 7340032
  s_mov_b32 s73, s80
  s_mov_b32 s70, 917504
  s_mov_b32 s72, 196608
  s_mov_b32 s68, 4
  s_cmp_eq_u32 s69, 1
  s_cbranch_scc1 L_bo1
  s_mov_b32 s73, s81
  s_mov_b32 s70, 458752
  s_mov_b32 s72, 65536
  s_mov_b32 s68, 8
  s_cmp_eq_u32 s69, 2
  s_cbranch_scc1 L_bo1
  s_mov_b32 s73, s82
  s_mov_b32 s70, 1835008
  s_mov_b32 s72, 458752
  s_mov_b32 s68, 2
  s_cmp_eq_u32 s69, 3
  s_cbranch_scc1 L_bo1
  s_mov_b32 s66, 0
  s_mov_b32 s68, 64
L_bo1:
  s_add_u32 m0, s74, 16384
  s_add_u32 s75, s73, s72
  buffer_load_dwordx4 v68, s[64:67], s73 offen lds
  s_add_u32 m0, s74, 17408
  s_sub_u32 s68, s68, 1
  buffer_load_dwordx4 v69, s[64:67], s73 offen lds
  s_add_u32 m0, s74, 24576
  s_add_u32 s73, s73, s70
  buffer_load_dwordx4 v68, s[64:67], s75 offen lds
  s_add_u32 m0, s74, 25600
  s_cmp_eq_u32 s68, 0
  buffer_load_dwordx4 v69, s[64:67], s75 offen lds
  s_cbranch_scc0 L_bo2
  s_add_u32 s69, s69, 1
  s_mov_b32 s64, s26
  s_mov_b32 s65, s27
  s_mov_b32 s66, 7340032
  s_mov_b32 s73, s80
  s_mov_b32 s70, 917504
  s_mov_b32 s72, 196608
  s_mov_b32 s68, 4
  s_cmp_eq_u32 s69, 1
  s_cbranch_scc1 L_bo2
  s_mov_b32 s73, s81
  s_mov_b32 s70, 458752
  s_mov_b32 s72, 65536
  s_mov_b32 s68, 8
  s_cmp_eq_u32 s69, 2
  s_cbranch_scc1 L_bo2
  s_mov_b32 s73, s82
  s_mov_b32 s70, 1835008
  s_mov_b32 s72, 458752
  s_mov_b32 s68, 2
  s_cmp_eq_u32 s69, 3
  s_cbranch_scc1 L_bo2
  s_mov_b32 s66, 0
  s_mov_b32 s68, 64
L_bo2:
  s_waitcnt lgkmcnt(0)
  s_barrier
  .p2align 3
  v_mfma_f32_16x16x32_bf16 v[92:95], v[36:39], v[24:27], v[92:95]
  v_mfma_f32_16x16x32_bf16 v[128:131], v[36:39], v[8:11], v[128:131]
  v_mfma_f32_16x16x32_bf16 v[132:135], v[36:39], v[12:15], v[132:135]
  v_mfma_f32_16x16x32_bf16 v[136:139], v[36:39], v[16:19], v[136:139]
  v_mfma_f32_16x16x32_bf16 v[140:143], v[36:39], v[20:23], v[140:143]
  v_mfma_f32_16x16x32_bf16 v[144:147], v[40:43], v[8:11], v[144:147]
  v_mfma_f32_16x16x32_bf16 v[148:151], v[40:43], v[12:15], v[148:151]
  v_mfma_f32_16x16x32_bf16 v[152:155], v[40:43], v[16:19], v[152:155]
  v_mfma_f32_16x16x32_bf16 v[156:159], v[40:43], v[20:23], v[156:159]
  v_mfma_f32_16x16x32_bf16 v[160:163], v[8:11], v[44:47], v[160:163]
  v_mfma_f32_16x16x32_bf16 v[164:167], v[12:15], v[44:47], v[164:167]
  v_mfma_f32_16x16x32_bf16 v[168:171], v[16:19], v[44:47], v[168:171]
  v_mfma_f32_16x16x32_bf16 v[172:175], v[20:23], v[44:47], v[172:175]
  v_mfma_f32_16x16x32_bf16 v[176:179], v[8:11], v[48:51], v[176:179]
  v_mfma_f32_16x16x32_bf16 v[180:183], v[12:15], v[48:51], v[180:183]
  v_mfma_f32_16x16x32_bf16 v[184:187], v[16:19], v[48:51], v[184:187]
  v_mfma_f32_16x16x32_bf16 v[188:191], v[20:23], v[48:51], v[188:191]
  v_mfma_f32_16x16x32_bf16 v[96:99], v[28:31], v[8:11], v[96:99]
  v_mfma_f32_16x16x32_bf16 v[100:103], v[28:31], v[12:15], v[100:103]
  v_mfma_f32_16x16x32_bf16 v[104:107], v[28:31], v[16:19], v[104:107]
  v_mfma_f32_16x16x32_bf16 v[84:87], v[28:31], v[24:27], v[84:87]
  v_mfma_f32_16x16x32_bf16 v[108:111], v[28:31], v[20:23], v[108:111]
  v_mfma_f32_16x16x32_bf16 v[112:115], v[32:35], v[8:11], v[112:115]
  v_mfma_f32_16x16x32_bf16 v[116:119], v[32:35], v[12:15], v[116:119]
  v_mfma_f32_16x16x32_bf16 v[120:123], v[32:35], v[16:19], v[120:123]
  v_mfma_f32_16x16x32_bf16 v[124:127], v[32:35], v[20:23], v[124:127]
  v_mfma_f32_16x16x32_bf16 v[192:195], v[52:55], v[8:11], v[192:195]
  v_mfma_f32_16x16x32_bf16 v[196:199], v[52:55], v[12:15], v[196:199]
  v_mfma_f32_16x16x32_bf16 v[200:203], v[52:55], v[16:19], v[200:203]
  v_mfma_f32_16x16x32_bf16 v[204:207], v[52:55], v[20:23], v[204:207]
  v_mfma_f32_16x16x32_bf16 v[208:211], v[56:59], v[8:11], v[208:211]
  v_mfma_f32_16x16x32_bf16 v[212:215], v[56:59], v[12:15], v[212:215]
  v_mfma_f32_16x16x32_bf16 v[216:219], v[56:59], v[16:19], v[216:219]
  v_mfma_f32_16x16x32_bf16 v[220:223], v[56:59], v[20:23], v[220:223]
  v_mfma_f32_16x16x32_bf16 v[224:227], v[60:63], v[8:11], v[224:227]
  v_mfma_f32_16x16x32_bf16 v[228:231], v[60:63], v[12:15], v[228:231]
  v_mfma_f32_16x16x32_bf16 v[232:235], v[60:63], v[16:19], v[232:235]
  v_mfma_f32_16x16x32_bf16 v[236:239], v[60:63], v[20:23], v[236:239]
  v_mfma_f32_16x16x32_bf16 v[240:243], v[64:67], v[8:11], v[240:243]
  v_mfma_f32_16x16x32_bf16 v[244:247], v[64:67], v[12:15], v[244:247]
  v_mfma_f32_16x16x32_bf16 v[248:251], v[64:67], v[16:19], v[248:251]
  v_mfma_f32_16x16x32_bf16 v[252:255], v[64:67], v[20:23], v[252:255]
  s_barrier
  s_mov_b32 s39, 0
  s_branch L_xepi
L_X1:
  s_mov_b32 s40, s4
  s_mov_b32 s41, s5
  s_mov_b32 s42, 6291456
  s_mov_b32 s43, 0x20000
  s_mov_b32 s70, 74752
  s_mov_b32 s65, 196608
  s_mov_b32 s60, 0
  v_add_u32 v1, 320, v0
  v_mul_u32_u24 v2, 43691, v1
  v_lshrrev_b32 v2, 19, v2
  v_mul_u32_u24 v3, 12, v2
  v_sub_u32 v3, v1, v3
  v_lshrrev_b32 v4, 1, v2
  v_and_b32 v4, 2, v4
  v_xor_b32 v3, v3, v4
  v_lshrrev_b32 v4, 2, v3
  v_lshlrev_b32 v4, 11, v4
  v_and_b32 v3, 3, v3
  v_lshl_add_u32 v4, v3, 4, v4
  v_add_u32 v4, s24, v4
  v_bfe_u32 v5, v2, 2, 2
  v_lshlrev_b32 v5, 3, v5
  v_lshrrev_b32 v6, 4, v2
  v_lshl_add_u32 v5, v6, 2, v5
  v_and_b32 v6, 3, v2
  v_add_u32 v5, v5, v6
  v_mul_u32_u24 v5, 6144, v5
  v_add_u32 v68, v5, v4
  s_mov_b32 s44, s8
  s_mov_b32 s45, s9
  s_mov_b32 s46, 7340032
  s_mov_b32 s47, 0x20000
  s_mov_b32 s71, 75776
  s_mov_b32 s66, 229376
  s_mov_b32 s61, 0
  v_add_u32 v1, 0, v0
  v_mul_u32_u24 v2, 37450, v1
  v_lshrrev_b32 v2, 19, v2
  v_mul_u32_u24 v3, 14, v2
  v_sub_u32 v3, v1, v3
  v_lshlrev_b32 v4, 4, v3
  v_mov_b32 v6, s25
  v_mov_b32 v5, s26
  v_cmp_gt_u32 vcc, 12, v3
  s_nop 1
  v_cndmask_b32 v6, v5, v6, vcc
  v_add_u32 v4, v6, v4
  v_bfe_u32 v5, v2, 2, 2
  v_lshlrev_b32 v5, 3, v5
  v_lshrrev_b32 v6, 4, v2
  v_lshl_add_u32 v5, v6, 2, v5
  v_and_b32 v6, 3, v2
  v_add_u32 v5, v5, v6
  v_mul_u32_u24 v5, 7168, v5
  v_add_u32 v69, v5, v4
  s_mov_b32 s48, s8
  s_mov_b32 s49, s9
  s_mov_b32 s50, 7340032
  s_mov_b32 s51, 0x20000
  s_mov_b32 s72, 76800
  s_mov_b32 s67, 229376
  s_mov_b32 s62, 0
  v_add_u32 v1, 64, v0
  v_mul_u32_u24 v2, 37450, v1
  v_lshrrev_b32 v2, 19, v2
  v_mul_u32_u24 v3, 14, v2
  v_sub_u32 v3, v1, v3
  v_lshlrev_b32 v4, 4, v3
  v_mov_b32 v6, s25
  v_mov_b32 v5, s26
  v_cmp_gt_u32 vcc, 12, v3
  s_nop 1
  v_cndmask_b32 v6, v5, v6, vcc
  v_add_u32 v4, v6, v4
  v_bfe_u32 v5, v2, 2, 2
  v_lshlrev_b32 v5, 3, v5
  v_lshrrev_b32 v6, 4, v2
  v_lshl_add_u32 v5, v6, 2, v5
  v_and_b32 v6, 3, v2
  v_add_u32 v5, v5, v6
  v_mul_u32_u24 v5, 7168, v5
  v_add_u32 v70, v5, v4
  s_mov_b32 s52, s8
  s_mov_b32 s53, s9
  s_mov_b32 s54, 7340032
  s_mov_b32 s55, 0x20000
  s_mov_b32 s73, 77824
  s_mov_b32 s68, 229376
  s_mov_b32 s63, 0
  v_add_u32 v1, 128, v0
  v_mul_u32_u24 v2, 37450, v1
  v_lshrrev_b32 v2, 19, v2
  v_mul_u32_u24 v3, 14, v2
  v_sub_u32 v3, v1, v3
  v_lshlrev_b32 v4, 4, v3
  v_mov_b32 v6, s25
  v_mov_b32 v5, s26
  v_cmp_gt_u32 vcc, 12, v3
  s_nop 1
  v_cndmask_b32 v6, v5, v6, vcc
  v_add_u32 v4, v6, v4
  v_bfe_u32 v5, v2, 2, 2
  v_lshlrev_b32 v5, 3, v5
  v_lshrrev_b32 v6, 4, v2
  v_lshl_add_u32 v5, v6, 2, v5
  v_and_b32 v6, 3, v2
  v_add_u32 v5, v5, v6
  v_mul_u32_u24 v5, 7168, v5
  v_add_u32 v71, v5, v4
  s_mov_b32 s56, s8
  s_mov_b32 s57, s9
  s_mov_b32 s58, 7340032
  s_mov_b32 s59, 0x20000
  s_mov_b32 s74, 78848
  s_mov_b32 s69, 229376
  s_mov_b32 s64, 0
  v_add_u32 v1, 192, v0
  v_mul_u32_u24 v2, 37450, v1
  v_lshrrev_b32 v2, 19, v2
  v_mul_u32_u24 v3, 14, v2
  v_sub_u32 v3, v1, v3
  v_lshlrev_b32 v4, 4, v3
  v_mov_b32 v6, s25
  v_mov_b32 v5, s26
  v_cmp_gt_u32 vcc, 12, v3
  s_nop 1
  v_cndmask_b32 v6, v5, v6, vcc
  v_add_u32 v4, v6, v4
  v_bfe_u32 v5, v2, 2, 2
  v_lshlrev_b32 v5, 3, v5
  v_lshrrev_b32 v6, 4, v2
  v_lshl_add_u32 v5, v6, 2, v5
  v_and_b32 v6, 3, v2
  v_add_u32 v5, v5, v6
  v_mul_u32_u24 v5, 7168, v5
  v_add_u32 v72, v5, v4
  s_add_u32 m0, s70, 0
  s_nop 0
  buffer_load_dwordx4 v68, s[40:43], s60 offen lds
  s_add_u32 s60, s60, s65
  s_add_u32 m0, s71, 0
  s_nop 0
  buffer_load_dwordx4 v69, s[44:47], s61 offen lds
  s_add_u32 s61, s61, s66
  s_add_u32 m0, s72, 0
  s_nop 0
  buffer_load_dwordx4 v70, s[48:51], s62 offen lds
  s_add_u32 s62, s62, s67
  s_add_u32 m0, s73, 0
  s_nop 0
  buffer_load_dwordx4 v71, s[52:55], s63 offen lds
  s_add_u32 s63, s63, s68
  s_add_u32 m0, s74, 0
  s_nop 0
  buffer_load_dwordx4 v72, s[56:59], s64 offen lds
  s_add_u32 s64, s64, s69
  s_add_u32 m0, s70, 20480
  s_nop 0
  buffer_load_dwordx4 v68, s[40:43], s60 offen lds
  s_add_u32 s60, s60, s65
  s_add_u32 m0, s71, 20480
  s_nop 0
  buffer_load_dwordx4 v69, s[44:47], s61 offen lds
  s_add_u32 s61, s61, s66
  s_add_u32 m0, s72, 20480
  s_nop 0
  buffer_load_dwordx4 v70, s[48:51], s62 offen lds
  s_add_u32 s62, s62, s67
  s_add_u32 m0, s73, 20480
  s_nop 0
  buffer_load_dwordx4 v71, s[52:55], s63 offen lds
  s_add_u32 s63, s63, s68
  s_add_u32 m0, s74, 20480
  s_nop 0
  buffer_load_dwordx4 v72, s[56:59], s64 offen lds
  s_add_u32 s64, s64, s69
  s_add_u32 m0, s70, 40960
  s_nop 0
  buffer_load_dwordx4 v68, s[40:43], s60 offen lds
  s_add_u32 s60, s60, s65
  s_add_u32 m0, s71, 40960
  s_nop 0
  buffer_load_dwordx4 v69, s[44:47], s61 offen lds
  s_add_u32 s61, s61, s66
  s_add_u32 m0, s72, 40960
  s_nop 0
  buffer_load_dwordx4 v70, s[48:51], s62 offen lds
  s_add_u32 s62, s62, s67
  s_add_u32 m0, s73, 40960
  s_nop 0
  buffer_load_dwordx4 v71, s[52:55], s63 offen lds
  s_add_u32 s63, s63, s68
  s_add_u32 m0, s74, 40960
  s_nop 0
  buffer_load_dwordx4 v72, s[56:59], s64 offen lds
  s_add_u32 s64, s64, s69
  s_mov_b32 s24, s36
  s_mov_b32 s25, s37
  s_mov_b32 s26, 4194304
  s_mov_b32 s27, 0x20000
  s_lshr_b32 s28, s2, 3
  s_lshl_b32 s28, s28, 6
  s_add_u32 s28, s28, 0
  v_add_u32 v83, s28, v0
  v_lshlrev_b32 v83, 11, v83
  v_add_u32 v83, 128, v83
  v_cmp_gt_u32 vcc, 32, v0
  v_mov_b32 v3, 0x7ffffff0
  s_nop 0
  v_cndmask_b32 v83, v3, v83, vcc
  s_mov_b32 s28, 256
  buffer_load_dword v6, v83, s[24:27], s28 offen
  s_add_u32 s28, s28, 256
  s_and_b32 s3, s2, 7
  s_lshr_b32 s16, s2, 3
  s_and_b32 s20, s16, 1
  s_lshr_b32 s16, s16, 1
  s_lshr_b32 s17, s3, 1
  s_lshl_b32 s17, s17, 2
  s_and_b32 s18, s16, 3
  s_add_u32 s21, s17, s18
  s_and_b32 s17, s3, 1
  s_lshl_b32 s17, s17, 2
  s_lshr_b32 s18, s16, 2
  s_add_u32 s22, s17, s18
  s_lshl_b32 s23, s21, 3
  s_add_u32 s23, s23, s22
  s_lshl_b32 s16, s23, 16
  s_lshl_b32 s17, s20, 15
  s_add_u32 s16, s16, s17
  s_lshl_b32 s17, s76, 12
  s_add_u32 s16, s16, s17
  s_add_u32 s16, s16, 67108864
  s_add_u32 s88, s6, s16
  s_addc_u32 s89, s7, 0
  s_mov_b32 s90, 20480
  s_mov_b32 s91, 0x20000
  s_waitcnt vmcnt(16)
  v_lshlrev_b32 v104, 16, v96
  v_and_b32 v105, 0xffff0000, v96
  v_lshlrev_b32 v106, 16, v97
  v_and_b32 v107, 0xffff0000, v97
  v_lshlrev_b32 v108, 16, v98
  v_and_b32 v109, 0xffff0000, v98
  v_lshlrev_b32 v110, 16, v99
  v_and_b32 v111, 0xffff0000, v99
  v_lshlrev_b32 v112, 16, v100
  v_and_b32 v113, 0xffff0000, v100
  v_lshlrev_b32 v114, 16, v101
  v_and_b32 v115, 0xffff0000, v101
  v_lshlrev_b32 v116, 16, v102
  v_and_b32 v117, 0xffff0000, v102
  v_lshlrev_b32 v118, 16, v103
  v_and_b32 v119, 0xffff0000, v103
  v_add_f32 v120, v104, v108
  v_add_f32 v124, v112, v116
  v_add_f32 v121, v105, v109
  v_add_f32 v125, v113, v117
  v_add_f32 v122, v106, v110
  v_add_f32 v126, v114, v118
  v_add_f32 v123, v107, v111
  v_add_f32 v127, v115, v119
  v_add_f32 v120, v120, v124
  v_add_f32 v121, v121, v125
  v_add_f32 v122, v122, v126
  v_add_f32 v123, v123, v127
  v_add_f32 v120, v120, v121
  v_add_f32 v122, v122, v123
  v_add_f32 v120, v120, v122
  s_nop 1
  v_add_f32_dpp v120, v120, v120 row_ror:8 row_mask:0xf bank_mask:0xf
  s_nop 1
  v_add_f32_dpp v120, v120, v120 row_ror:4 row_mask:0xf bank_mask:0xf
  s_nop 1
  v_add_f32_dpp v120, v120, v120 row_ror:2 row_mask:0xf bank_mask:0xf
  s_nop 1
  v_add_f32_dpp v120, v120, v120 row_ror:1 row_mask:0xf bank_mask:0xf
  v_mov_b32 v121, v120
  s_nop 1
  v_permlane16_swap_b32 v120, v121
  v_add_f32 v120, v120, v121
  v_mov_b32 v121, v120
  s_nop 1
  v_permlane32_swap_b32 v120, v121
  v_add_f32 v120, v120, v121
  v_mul_f32 v120, 0x3a800000, v120
  v_sub_f32 v104, v104, v120
  v_sub_f32 v105, v105, v120
  v_sub_f32 v106, v106, v120
  v_sub_f32 v107, v107, v120
  v_sub_f32 v108, v108, v120
  v_sub_f32 v109, v109, v120
  v_sub_f32 v110, v110, v120
  v_sub_f32 v111, v111, v120
  v_sub_f32 v112, v112, v120
  v_sub_f32 v113, v113, v120
  v_sub_f32 v114, v114, v120
  v_sub_f32 v115, v115, v120
  v_sub_f32 v116, v116, v120
  v_sub_f32 v117, v117, v120
  v_sub_f32 v118, v118, v120
  v_sub_f32 v119, v119, v120
  v_mul_f32 v124, v104, v104
  v_mul_f32 v125, v105, v105
  v_mul_f32 v126, v106, v106
  v_mul_f32 v127, v107, v107
  v_fmac_f32 v124, v108, v108
  v_fmac_f32 v125, v109, v109
  v_fmac_f32 v126, v110, v110
  v_fmac_f32 v127, v111, v111
  v_fmac_f32 v124, v112, v112
  v_fmac_f32 v125, v113, v113
  v_fmac_f32 v126, v114, v114
  v_fmac_f32 v127, v115, v115
  v_fmac_f32 v124, v116, v116
  v_fmac_f32 v125, v117, v117
  v_fmac_f32 v126, v118, v118
  v_fmac_f32 v127, v119, v119
  v_add_f32 v124, v124, v125
  v_add_f32 v126, v126, v127
  v_add_f32 v124, v124, v126
  s_nop 1
  v_add_f32_dpp v124, v124, v124 row_ror:8 row_mask:0xf bank_mask:0xf
  s_nop 1
  v_add_f32_dpp v124, v124, v124 row_ror:4 row_mask:0xf bank_mask:0xf
  s_nop 1
  v_add_f32_dpp v124, v124, v124 row_ror:2 row_mask:0xf bank_mask:0xf
  s_nop 1
  v_add_f32_dpp v124, v124, v124 row_ror:1 row_mask:0xf bank_mask:0xf
  v_mov_b32 v125, v124
  s_nop 1
  v_permlane16_swap_b32 v124, v125
  v_add_f32 v124, v124, v125
  v_mov_b32 v125, v124
  s_nop 1
  v_permlane32_swap_b32 v124, v125
  v_add_f32 v124, v124, v125
  v_mov_b32 v122, 0x3727c5ac
  v_fmac_f32 v122, 0x3a800000, v124
  v_rsq_f32 v121, v122
  v_mov_b32 v123, 0
  s_mov_b32 s16, s6
  s_mov_b32 s17, s7
  s_mov_b32 s18, 32768
  s_mov_b32 s19, 0x20000
  s_lshl_b32 s14, s2, 3
  s_add_u32 s14, s14, s76
  s_lshl_b32 s14, s14, 4
  v_mov_b32 v2, s14
  v_cmp_eq_u32 vcc, 0, v0
  s_and_saveexec_b64 s[20:21], vcc
  buffer_store_dwordx4 v[120:123], v2, s[16:19], 0 offen sc1
  s_mov_b64 exec, s[20:21]
  v_mov_b32 v84, 0
  v_mov_b32 v85, 0
  v_mov_b32 v86, 0
  v_mov_b32 v87, 0
  v_mov_b32 v88, 0
  v_mov_b32 v89, 0
  v_mov_b32 v90, 0
  v_mov_b32 v91, 0
  v_mov_b32 v92, 0
  v_mov_b32 v93, 0
  v_mov_b32 v94, 0
  v_mov_b32 v95, 0
  v_mov_b32 v96, 0
  v_mov_b32 v97, 0
  v_mov_b32 v98, 0
  v_mov_b32 v99, 0
  v_mov_b32 v100, 0
  v_mov_b32 v101, 0
  v_mov_b32 v102, 0
  v_mov_b32 v103, 0
  v_mov_b32 v104, 0
  v_mov_b32 v105, 0
  v_mov_b32 v106, 0
  v_mov_b32 v107, 0
  v_mov_b32 v108, 0
  v_mov_b32 v109, 0
  v_mov_b32 v110, 0
  v_mov_b32 v111, 0
  v_mov_b32 v112, 0
  v_mov_b32 v113, 0
  v_mov_b32 v114, 0
  v_mov_b32 v115, 0
  v_mov_b32 v116, 0
  v_mov_b32 v117, 0
  v_mov_b32 v118, 0
  v_mov_b32 v119, 0
  v_mov_b32 v120, 0
  v_mov_b32 v121, 0
  v_mov_b32 v122, 0
  v_mov_b32 v123, 0
  v_mov_b32 v124, 0
  v_mov_b32 v125, 0
  v_mov_b32 v126, 0
  v_mov_b32 v127, 0
  v_mov_b32 v128, 0
  v_mov_b32 v129, 0
  v_mov_b32 v130, 0
  v_mov_b32 v131, 0
  v_mov_b32 v132, 0
  v_mov_b32 v133, 0
  v_mov_b32 v134, 0
  v_mov_b32 v135, 0
  v_mov_b32 v136, 0
  v_mov_b32 v137, 0
  v_mov_b32 v138, 0
  v_mov_b32 v139, 0
  v_mov_b32 v140, 0
  v_mov_b32 v141, 0
  v_mov_b32 v142, 0
  v_mov_b32 v143, 0
  v_mov_b32 v144, 0
  v_mov_b32 v145, 0
  v_mov_b32 v146, 0
  v_mov_b32 v147, 0
  v_mov_b32 v148, 0
  v_mov_b32 v149, 0
  v_mov_b32 v150, 0
  v_mov_b32 v151, 0
  v_mov_b32 v152, 0
  v_mov_b32 v153, 0
  v_mov_b32 v154, 0
  v_mov_b32 v155, 0
  v_mov_b32 v156, 0
  v_mov_b32 v157, 0
  v_mov_b32 v158, 0
  v_mov_b32 v159, 0
  v_mov_b32 v160, 0
  v_mov_b32 v161, 0
  v_mov_b32 v162, 0
  v_mov_b32 v163, 0
  v_mov_b32 v164, 0
  v_mov_b32 v165, 0
  v_mov_b32 v166, 0
  v_mov_b32 v167, 0
  v_mov_b32 v168, 0
  v_mov_b32 v169, 0
  v_mov_b32 v170, 0
  v_mov_b32 v171, 0
  v_mov_b32 v172, 0
  v_mov_b32 v173, 0
  v_mov_b32 v174, 0
  v_mov_b32 v175, 0
  v_mov_b32 v176, 0
  v_mov_b32 v177, 0
  v_mov_b32 v178, 0
  v_mov_b32 v179, 0
  v_mov_b32 v180, 0
  v_mov_b32 v181, 0
  v_mov_b32 v182, 0
  v_mov_b32 v183, 0
  v_mov_b32 v184, 0
  v_mov_b32 v185, 0
  v_mov_b32 v186, 0
  v_mov_b32 v187, 0
  v_mov_b32 v188, 0
  v_mov_b32 v189, 0
  v_mov_b32 v190, 0
  v_mov_b32 v191, 0
  v_mov_b32 v192, 0
  v_mov_b32 v193, 0
  v_mov_b32 v194, 0
  v_mov_b32 v195, 0
  v_mov_b32 v196, 0
  v_mov_b32 v197, 0
  v_mov_b32 v198, 0
  v_mov_b32 v199, 0
  v_mov_b32 v200, 0
  v_mov_b32 v201, 0
  v_mov_b32 v202, 0
  v_mov_b32 v203, 0
  v_mov_b32 v204, 0
  v_mov_b32 v205, 0
  v_mov_b32 v206, 0
  v_mov_b32 v207, 0
  v_mov_b32 v208, 0
  v_mov_b32 v209, 0
  v_mov_b32 v210, 0
  v_mov_b32 v211, 0
  v_mov_b32 v212, 0
  v_mov_b32 v213, 0
  v_mov_b32 v214, 0
  v_mov_b32 v215, 0
  v_mov_b32 v216, 0
  v_mov_b32 v217, 0
  v_mov_b32 v218, 0
  v_mov_b32 v219, 0
  v_mov_b32 v220, 0
  v_mov_b32 v221, 0
  v_mov_b32 v222, 0
  v_mov_b32 v223, 0
  v_mov_b32 v224, 0
  v_mov_b32 v225, 0
  v_mov_b32 v226, 0
  v_mov_b32 v227, 0
  v_mov_b32 v228, 0
  v_mov_b32 v229, 0
  v_mov_b32 v230, 0
  v_mov_b32 v231, 0
  v_mov_b32 v232, 0
  v_mov_b32 v233, 0
  v_mov_b32 v234, 0
  v_mov_b32 v235, 0
  v_mov_b32 v236, 0
  v_mov_b32 v237, 0
  v_mov_b32 v238, 0
  v_mov_b32 v239, 0
  v_mov_b32 v240, 0
  v_mov_b32 v241, 0
  v_mov_b32 v242, 0
  v_mov_b32 v243, 0
  v_mov_b32 v244, 0
  v_mov_b32 v245, 0
  v_mov_b32 v246, 0
  v_mov_b32 v247, 0
  v_mov_b32 v248, 0
  v_mov_b32 v249, 0
  v_mov_b32 v250, 0
  v_mov_b32 v251, 0
  v_mov_b32 v252, 0
  v_mov_b32 v253, 0
  v_mov_b32 v254, 0
  v_mov_b32 v255, 0
  s_waitcnt vmcnt(12)
  s_barrier
  .p2align 3
  s_add_u32 m0, s70, 61440
  s_nop 0
  buffer_load_dwordx4 v68, s[40:43], s60 offen lds
  ds_read_b128 v[8:11], v73 offset:0
  ds_read_b128 v[12:15], v73 offset:2048
  ds_read_b128 v[16:19], v73 offset:4096
  ds_read_b128 v[20:23], v73 offset:6144
  ds_read_b128 v[24:27], v75 offset:0
  s_add_u32 s60, s60, s65
  s_add_u32 m0, s71, 61440
  s_nop 0
  buffer_load_dwordx4 v69, s[44:47], s61 offen lds
  ds_read_b64_tr_b16 v[28:29], v77 offset:0
  ds_read_b64_tr_b16 v[30:31], v77 offset:3072
  ds_read_b64_tr_b16 v[32:33], v79 offset:32
  ds_read_b64_tr_b16 v[34:35], v79 offset:3104
  ds_read_b64_tr_b16 v[36:37], v77 offset:64
  s_add_u32 s61, s61, s66
  s_add_u32 m0, s72, 61440
  s_nop 0
  buffer_load_dwordx4 v70, s[48:51], s62 offen lds
  ds_read_b64_tr_b16 v[38:39], v77 offset:3136
  ds_read_b64_tr_b16 v[40:41], v79 offset:96
  ds_read_b64_tr_b16 v[42:43], v79 offset:3168
  ds_read_b64_tr_b16 v[44:45], v77 offset:128
  ds_read_b64_tr_b16 v[46:47], v77 offset:3200
  s_add_u32 s62, s62, s67
  s_add_u32 m0, s73, 61440
  s_nop 0
  buffer_load_dwordx4 v71, s[52:55], s63 offen lds
  ds_read_b64_tr_b16 v[48:49], v79 offset:160
  ds_read_b64_tr_b16 v[50:51], v79 offset:3232
  ds_read_b64_tr_b16 v[52:53], v81 offset:0
  ds_read_b64_tr_b16 v[54:55], v81 offset:3584
  ds_read_b64_tr_b16 v[56:57], v81 offset:32
  s_add_u32 s63, s63, s68
  s_add_u32 m0, s74, 61440
  s_nop 0
  buffer_load_dwordx4 v72, s[56:59], s64 offen lds
  s_add_u32 s64, s64, s69
  ds_read_b64_tr_b16 v[58:59], v81 offset:3616
  ds_read_b64_tr_b16 v[60:61], v81 offset:7168
  ds_read_b64_tr_b16 v[62:63], v81 offset:10752
  ds_read_b64_tr_b16 v[64:65], v81 offset:7200
  ds_read_b64_tr_b16 v[66:67], v81 offset:10784
  s_waitcnt lgkmcnt(0)
  s_barrier
  s_mov_b32 s75, 7
  .p2align 6
L_X1_loop:
  .p2align 3
  v_mfma_f32_16x16x32_bf16 v[92:95], v[40:43], v[24:27], v[92:95]
  v_mfma_f32_16x16x32_bf16 v[128:131], v[36:39], v[8:11], v[128:131]
  v_mfma_f32_16x16x32_bf16 v[132:135], v[36:39], v[12:15], v[132:135]
  v_mfma_f32_16x16x32_bf16 v[136:139], v[36:39], v[16:19], v[136:139]
  v_mfma_f32_16x16x32_bf16 v[140:143], v[36:39], v[20:23], v[140:143]
  v_mfma_f32_16x16x32_bf16 v[144:147], v[40:43], v[8:11], v[144:147]
  v_mfma_f32_16x16x32_bf16 v[148:151], v[40:43], v[12:15], v[148:151]
  v_mfma_f32_16x16x32_bf16 v[152:155], v[40:43], v[16:19], v[152:155]
  v_mfma_f32_16x16x32_bf16 v[156:159], v[40:43], v[20:23], v[156:159]
  v_mfma_f32_16x16x32_bf16 v[160:163], v[8:11], v[44:47], v[160:163]
  v_mfma_f32_16x16x32_bf16 v[164:167], v[12:15], v[44:47], v[164:167]
  v_mfma_f32_16x16x32_bf16 v[168:171], v[16:19], v[44:47], v[168:171]
  v_mfma_f32_16x16x32_bf16 v[172:175], v[20:23], v[44:47], v[172:175]
  v_mfma_f32_16x16x32_bf16 v[176:179], v[8:11], v[48:51], v[176:179]
  v_mfma_f32_16x16x32_bf16 v[180:183], v[12:15], v[48:51], v[180:183]
  v_mfma_f32_16x16x32_bf16 v[184:187], v[16:19], v[48:51], v[184:187]
  v_mfma_f32_16x16x32_bf16 v[188:191], v[20:23], v[48:51], v[188:191]
  v_mfma_f32_16x16x32_bf16 v[96:99], v[28:31], v[8:11], v[96:99]
  v_mfma_f32_16x16x32_bf16 v[100:103], v[28:31], v[12:15], v[100:103]
  v_mfma_f32_16x16x32_bf16 v[104:107], v[28:31], v[16:19], v[104:107]
  v_mfma_f32_16x16x32_bf16 v[84:87], v[32:35], v[24:27], v[84:87]
  v_mfma_f32_16x16x32_bf16 v[108:111], v[28:31], v[20:23], v[108:111]
  v_mfma_f32_16x16x32_bf16 v[112:115], v[32:35], v[8:11], v[112:115]
  v_mfma_f32_16x16x32_bf16 v[116:119], v[32:35], v[12:15], v[116:119]
  v_mfma_f32_16x16x32_bf16 v[120:123], v[32:35], v[16:19], v[120:123]
  v_mfma_f32_16x16x32_bf16 v[124:127], v[32:35], v[20:23], v[124:127]
  v_mfma_f32_16x16x32_bf16 v[192:195], v[52:55], v[8:11], v[192:195]
  v_mfma_f32_16x16x32_bf16 v[196:199], v[52:55], v[12:15], v[196:199]
  v_mfma_f32_16x16x32_bf16 v[200:203], v[52:55], v[16:19], v[200:203]
  v_mfma_f32_16x16x32_bf16 v[204:207], v[52:55], v[20:23], v[204:207]
  v_mfma_f32_16x16x32_bf16 v[208:211], v[56:59], v[8:11], v[208:211]
  v_mfma_f32_16x16x32_bf16 v[212:215], v[56:59], v[12:15], v[212:215]
  v_mfma_f32_16x16x32_bf16 v[216:219], v[56:59], v[16:19], v[216:219]
  v_mfma_f32_16x16x32_bf16 v[220:223], v[56:59], v[20:23], v[220:223]
  v_mfma_f32_16x16x32_bf16 v[224:227], v[60:63], v[8:11], v[224:227]
  v_mfma_f32_16x16x32_bf16 v[228:231], v[60:63], v[12:15], v[228:231]
  v_mfma_f32_16x16x32_bf16 v[232:235], v[60:63], v[16:19], v[232:235]
  v_mfma_f32_16x16x32_bf16 v[236:239], v[60:63], v[20:23], v[236:239]
  v_mfma_f32_16x16x32_bf16 v[240:243], v[64:67], v[8:11], v[240:243]
  v_mfma_f32_16x16x32_bf16 v[244:247], v[64:67], v[12:15], v[244:247]
  v_mfma_f32_16x16x32_bf16 v[248:251], v[64:67], v[16:19], v[248:251]
  v_mfma_f32_16x16x32_bf16 v[252:255], v[64:67], v[20:23], v[252:255]
  s_waitcnt vmcnt(11)
  s_barrier
  .p2align 3
  s_add_u32 m0, s70, 0
  s_nop 0
  buffer_load_dwordx4 v68, s[40:43], s60 offen lds
  ds_read_b128 v[8:11], v74 offset:0
  ds_read_b128 v[12:15], v74 offset:2048
  ds_read_b128 v[16:19], v74 offset:4096
  ds_read_b128 v[20:23], v74 offset:6144
  ds_read_b128 v[24:27], v76 offset:0
  s_add_u32 s60, s60, s65
  s_add_u32 m0, s71, 0
  s_nop 0
  buffer_load_dwordx4 v69, s[44:47], s61 offen lds
  ds_read_b64_tr_b16 v[28:29], v77 offset:20480
  ds_read_b64_tr_b16 v[30:31], v77 offset:23552
  ds_read_b64_tr_b16 v[32:33], v79 offset:20512
  ds_read_b64_tr_b16 v[34:35], v79 offset:23584
  ds_read_b64_tr_b16 v[36:37], v77 offset:20544
  s_add_u32 s61, s61, s66
  s_add_u32 m0, s72, 0
  s_nop 0
  buffer_load_dwordx4 v70, s[48:51], s62 offen lds
  ds_read_b64_tr_b16 v[38:39], v77 offset:23616
  ds_read_b64_tr_b16 v[40:41], v79 offset:20576
  ds_read_b64_tr_b16 v[42:43], v79 offset:23648
  ds_read_b64_tr_b16 v[44:45], v77 offset:20608
  ds_read_b64_tr_b16 v[46:47], v77 offset:23680
  s_add_u32 s62, s62, s67
  s_add_u32 m0, s73, 0
  s_nop 0
  buffer_load_dwordx4 v71, s[52:55], s63 offen lds
  ds_read_b64_tr_b16 v[48:49], v79 offset:20640
  ds_read_b64_tr_b16 v[50:51], v79 offset:23712
  ds_read_b64_tr_b16 v[52:53], v81 offset:20480
  ds_read_b64_tr_b16 v[54:55], v81 offset:24064
  ds_read_b64_tr_b16 v[56:57], v81 offset:20512
  s_add_u32 s63, s63, s68
  s_add_u32 m0, s74, 0
  s_nop 0
  buffer_load_dwordx4 v72, s[56:59], s64 offen lds
  s_add_u32 s64, s64, s69
  ds_read_b64_tr_b16 v[58:59], v81 offset:24096
  ds_read_b64_tr_b16 v[60:61], v81 offset:27648
  ds_read_b64_tr_b16 v[62:63], v81 offset:31232
  ds_read_b64_tr_b16 v[64:65], v81 offset:27680
  ds_read_b64_tr_b16 v[66:67], v81 offset:31264
  s_sub_u32 s12, s75, 5
  s_cmp_le_u32 s12, 1
  s_cbranch_scc0 L_X1_noclr0
  s_sub_u32 s12, 6, s75
  s_lshl_b32 s12, s12, 14
  v_mov_b32 v2, -1
  v_mov_b32 v3, -1
  v_mov_b32 v4, -1
  v_mov_b32 v5, -1
  v_lshlrev_b32 v1, 4, v0
  buffer_store_dwordx4 v[2:5], v1, s[88:91], s12 offen offset:0 sc1
L_X1_noclr0:
  s_waitcnt lgkmcnt(0)
  s_barrier
  .p2align 3
  v_mfma_f32_16x16x32_bf16 v[92:95], v[40:43], v[24:27], v[92:95]
  v_mfma_f32_16x16x32_bf16 v[128:131], v[36:39], v[8:11], v[128:131]
  v_mfma_f32_16x16x32_bf16 v[132:135], v[36:39], v[12:15], v[132:135]
  v_mfma_f32_16x16x32_bf16 v[136:139], v[36:39], v[16:19], v[136:139]
  v_mfma_f32_16x16x32_bf16 v[140:143], v[36:39], v[20:23], v[140:143]
  v_mfma_f32_16x16x32_bf16 v[144:147], v[40:43], v[8:11], v[144:147]
  v_mfma_f32_16x16x32_bf16 v[148:151], v[40:43], v[12:15], v[148:151]
  v_mfma_f32_16x16x32_bf16 v[152:155], v[40:43], v[16:19], v[152:155]
  v_mfma_f32_16x16x32_bf16 v[156:159], v[40:43], v[20:23], v[156:159]
  v_mfma_f32_16x16x32_bf16 v[160:163], v[8:11], v[44:47], v[160:163]
  v_mfma_f32_16x16x32_bf16 v[164:167], v[12:15], v[44:47], v[164:167]
  v_mfma_f32_16x16x32_bf16 v[168:171], v[16:19], v[44:47], v[168:171]
  v_mfma_f32_16x16x32_bf16 v[172:175], v[20:23], v[44:47], v[172:175]
  v_mfma_f32_16x16x32_bf16 v[176:179], v[8:11], v[48:51], v[176:179]
  v_mfma_f32_16x16x32_bf16 v[180:183], v[12:15], v[48:51], v[180:183]
  v_mfma_f32_16x16x32_bf16 v[184:187], v[16:19], v[48:51], v[184:187]
  v_mfma_f32_16x16x32_bf16 v[188:191], v[20:23], v[48:51], v[188:191]
  v_mfma_f32_16x16x32_bf16 v[96:99], v[28:31], v[8:11], v[96:99]
  v_mfma_f32_16x16x32_bf16 v[100:103], v[28:31], v[12:15], v[100:103]
  v_mfma_f32_16x16x32_bf16 v[104:107], v[28:31], v[16:19], v[104:107]
  v_mfma_f32_16x16x32_bf16 v[84:87], v[32:35], v[24:27], v[84:87]
  v_mfma_f32_16x16x32_bf16 v[108:111], v[28:31], v[20:23], v[108:111]
  v_mfma_f32_16x16x32_bf16 v[112:115], v[32:35], v[8:11], v[112:115]
  v_mfma_f32_16x16x32_bf16 v[116:119], v[32:35], v[12:15], v[116:119]
  v_mfma_f32_16x16x32_bf16 v[120:123], v[32:35], v[16:19], v[120:123]
  v_mfma_f32_16x16x32_bf16 v[124:127], v[32:35], v[20:23], v[124:127]
  v_mfma_f32_16x16x32_bf16 v[192:195], v[52:55], v[8:11], v[192:195]
  v_mfma_f32_16x16x32_bf16 v[196:199], v[52:55], v[12:15], v[196:199]
  v_mfma_f32_16x16x32_bf16 v[200:203], v[52:55], v[16:19], v[200:203]
  v_mfma_f32_16x16x32_bf16 v[204:207], v[52:55], v[20:23], v[204:207]
  v_mfma_f32_16x16x32_bf16 v[208:211], v[56:59], v[8:11], v[208:211]
  v_mfma_f32_16x16x32_bf16 v[212:215], v[56:59], v[12:15], v[212:215]
  v_mfma_f32_16x16x32_bf16 v[216:219], v[56:59], v[16:19], v[216:219]
  v_mfma_f32_16x16x32_bf16 v[220:223], v[56:59], v[20:23], v[220:223]
  v_mfma_f32_16x16x32_bf16 v[224:227], v[60:63], v[8:11], v[224:227]
  v_mfma_f32_16x16x32_bf16 v[228:231], v[60:63], v[12:15], v[228:231]
  v_mfma_f32_16x16x32_bf16 v[232:235], v[60:63], v[16:19], v[232:235]
  v_mfma_f32_16x16x32_bf16 v[236:239], v[60:63], v[20:23], v[236:239]
  v_mfma_f32_16x16x32_bf16 v[240:243], v[64:67], v[8:11], v[240:243]
  v_mfma_f32_16x16x32_bf16 v[244:247], v[64:67], v[12:15], v[244:247]
  v_mfma_f32_16x16x32_bf16 v[248:251], v[64:67], v[16:19], v[248:251]
  v_mfma_f32_16x16x32_bf16 v[252:255], v[64:67], v[20:23], v[252:255]
  s_waitcnt vmcnt(10)
  s_barrier
  .p2align 3
  s_add_u32 m0, s70, 20480
  s_nop 0
  buffer_load_dwordx4 v68, s[40:43], s60 offen lds
  ds_read_b128 v[8:11], v73 offset:34816
  ds_read_b128 v[12:15], v73 offset:36864
  ds_read_b128 v[16:19], v73 offset:38912
  ds_read_b128 v[20:23], v73 offset:40960
  s_add_u32 s60, s60, s65
  s_add_u32 m0, s71, 20480
  s_nop 0
  buffer_load_dwordx4 v69, s[44:47], s61 offen lds
  ds_read_b128 v[24:27], v75 offset:34816
  ds_read_b64_tr_b16 v[28:29], v78 offset:0
  ds_read_b64_tr_b16 v[30:31], v78 offset:3072
  ds_read_b64_tr_b16 v[32:33], v80 offset:32
  s_add_u32 s61, s61, s66
  s_add_u32 m0, s72, 20480
  s_nop 0
  buffer_load_dwordx4 v70, s[48:51], s62 offen lds
  ds_read_b64_tr_b16 v[34:35], v80 offset:3104
  ds_read_b64_tr_b16 v[36:37], v78 offset:64
  ds_read_b64_tr_b16 v[38:39], v78 offset:3136
  ds_read_b64_tr_b16 v[40:41], v80 offset:96
  s_add_u32 s62, s62, s67
  s_add_u32 m0, s73, 20480
  s_nop 0
  buffer_load_dwordx4 v71, s[52:55], s63 offen lds
  ds_read_b64_tr_b16 v[42:43], v80 offset:3168
  ds_read_b64_tr_b16 v[44:45], v78 offset:128
  ds_read_b64_tr_b16 v[46:47], v78 offset:3200
  ds_read_b64_tr_b16 v[48:49], v80 offset:160
  ds_read_b64_tr_b16 v[50:51], v80 offset:3232
  s_add_u32 s63, s63, s68
  s_add_u32 m0, s74, 20480
  s_nop 0
  buffer_load_dwordx4 v72, s[56:59], s64 offen lds
  s_add_u32 s64, s64, s69
  ds_read_b64_tr_b16 v[52:53], v82 offset:0
  ds_read_b64_tr_b16 v[54:55], v82 offset:3584
  ds_read_b64_tr_b16 v[56:57], v82 offset:32
  ds_read_b64_tr_b16 v[58:59], v82 offset:3616
  s_cmp_eq_u32 s75, 1
  s_cbranch_scc1 L_cpf1
  buffer_load_dword v6, v83, s[24:27], s28 offen
  s_add_u32 s28, s28, 256
  s_branch L_cpf1_d
L_cpf1:
  s_mul_i32 s16, s2, 28672
  s_add_u32 s16, s84, s16
  s_addc_u32 s17, s85, 0
  s_mov_b32 s18, 28672
  s_mov_b32 s19, 0x20000
  s_mov_b32 s20, 8192
  v_lshlrev_b32 v2, 7, v0
  buffer_load_dword v6, v2, s[16:19], s20 offen
L_cpf1_d:
  ds_read_b64_tr_b16 v[60:61], v82 offset:7168
  ds_read_b64_tr_b16 v[62:63], v82 offset:10752
  ds_read_b64_tr_b16 v[64:65], v82 offset:7200
  ds_read_b64_tr_b16 v[66:67], v82 offset:10784
  s_sub_u32 s12, s75, 5
  s_cmp_le_u32 s12, 1
  s_cbranch_scc0 L_X1_noclr1
  s_sub_u32 s12, 6, s75
  s_lshl_b32 s12, s12, 14
  v_lshlrev_b32 v1, 4, v0
  buffer_store_dwordx4 v[2:5], v1, s[88:91], s12 offen offset:1024 sc1
L_X1_noclr1:
  s_waitcnt lgkmcnt(0)
  s_barrier
  .p2align 3
  v_mfma_f32_16x16x32_bf16 v[92:95], v[40:43], v[24:27], v[92:95]
  v_mfma_f32_16x16x32_bf16 v[128:131], v[36:39], v[8:11], v[128:131]
  v_mfma_f32_16x16x32_bf16 v[132:135], v[36:39], v[12:15], v[132:135]
  v_mfma_f32_16x16x32_bf16 v[136:139], v[36:39], v[16:19], v[136:139]
  v_mfma_f32_16x16x32_bf16 v[140:143], v[36:39], v[20:23], v[140:143]
  v_mfma_f32_16x16x32_bf16 v[144:147], v[40:43], v[8:11], v[144:147]
  v_mfma_f32_16x16x32_bf16 v[148:151], v[40:43], v[12:15], v[148:151]
  v_mfma_f32_16x16x32_bf16 v[152:155], v[40:43], v[16:19], v[152:155]
  v_mfma_f32_16x16x32_bf16 v[156:159], v[40:43], v[20:23], v[156:159]
  v_mfma_f32_16x16x32_bf16 v[160:163], v[8:11], v[44:47], v[160:163]
  v_mfma_f32_16x16x32_bf16 v[164:167], v[12:15], v[44:47], v[164:167]
  v_mfma_f32_16x16x32_bf16 v[168:171], v[16:19], v[44:47], v[168:171]
  v_mfma_f32_16x16x32_bf16 v[172:175], v[20:23], v[44:47], v[172:175]
  v_mfma_f32_16x16x32_bf16 v[176:179], v[8:11], v[48:51], v[176:179]
  v_mfma_f32_16x16x32_bf16 v[180:183], v[12:15], v[48:51], v[180:183]
  v_mfma_f32_16x16x32_bf16 v[184:187], v[16:19], v[48:51], v[184:187]
  v_mfma_f32_16x16x32_bf16 v[188:191], v[20:23], v[48:51], v[188:191]
  v_mfma_f32_16x16x32_bf16 v[96:99], v[28:31], v[8:11], v[96:99]
  v_mfma_f32_16x16x32_bf16 v[100:103], v[28:31], v[12:15], v[100:103]
  v_mfma_f32_16x16x32_bf16 v[104:107], v[28:31], v[16:19], v[104:107]
  v_mfma_f32_16x16x32_bf16 v[84:87], v[32:35], v[24:27], v[84:87]
  v_mfma_f32_16x16x32_bf16 v[108:111], v[28:31], v[20:23], v[108:111]
  v_mfma_f32_16x16x32_bf16 v[112:115], v[32:35], v[8:11], v[112:115]
  v_mfma_f32_16x16x32_bf16 v[116:119], v[32:35], v[12:15], v[116:119]
  v_mfma_f32_16x16x32_bf16 v[120:123], v[32:35], v[16:19], v[120:123]
  v_mfma_f32_16x16x32_bf16 v[124:127], v[32:35], v[20:23], v[124:127]
  v_mfma_f32_16x16x32_bf16 v[192:195], v[52:55], v[8:11], v[192:195]
  v_mfma_f32_16x16x32_bf16 v[196:199], v[52:55], v[12:15], v[196:199]
  v_mfma_f32_16x16x32_bf16 v[200:203], v[52:55], v[16:19], v[200:203]
  v_mfma_f32_16x16x32_bf16 v[204:207], v[52:55], v[20:23], v[204:207]
  v_mfma_f32_16x16x32_bf16 v[208:211], v[56:59], v[8:11], v[208:211]
  v_mfma_f32_16x16x32_bf16 v[212:215], v[56:59], v[12:15], v[212:215]
  v_mfma_f32_16x16x32_bf16 v[216:219], v[56:59], v[16:19], v[216:219]
  v_mfma_f32_16x16x32_bf16 v[220:223], v[56:59], v[20:23], v[220:223]
  v_mfma_f32_16x16x32_bf16 v[224:227], v[60:63], v[8:11], v[224:227]
  v_mfma_f32_16x16x32_bf16 v[228:231], v[60:63], v[12:15], v[228:231]
  v_mfma_f32_16x16x32_bf16 v[232:235], v[60:63], v[16:19], v[232:235]
  v_mfma_f32_16x16x32_bf16 v[236:239], v[60:63], v[20:23], v[236:239]
  v_mfma_f32_16x16x32_bf16 v[240:243], v[64:67], v[8:11], v[240:243]
  v_mfma_f32_16x16x32_bf16 v[244:247], v[64:67], v[12:15], v[244:247]
  v_mfma_f32_16x16x32_bf16 v[248:251], v[64:67], v[16:19], v[248:251]
  v_mfma_f32_16x16x32_bf16 v[252:255], v[64:67], v[20:23], v[252:255]
  s_waitcnt vmcnt(11)
  s_barrier
  .p2align 3
  s_add_u32 m0, s70, 40960
  s_nop 0
  buffer_load_dwordx4 v68, s[40:43], s60 offen lds
  ds_read_b128 v[8:11], v74 offset:34816
  ds_read_b128 v[12:15], v74 offset:36864
  ds_read_b128 v[16:19], v74 offset:38912
  ds_read_b128 v[20:23], v74 offset:40960
  ds_read_b128 v[24:27], v76 offset:34816
  s_add_u32 s60, s60, s65
  s_add_u32 m0, s71, 40960
  s_nop 0
  buffer_load_dwordx4 v69, s[44:47], s61 offen lds
  ds_read_b64_tr_b16 v[28:29], v78 offset:20480
  ds_read_b64_tr_b16 v[30:31], v78 offset:23552
  ds_read_b64_tr_b16 v[32:33], v80 offset:20512
  ds_read_b64_tr_b16 v[34:35], v80 offset:23584
  ds_read_b64_tr_b16 v[36:37], v78 offset:20544
  s_add_u32 s61, s61, s66
  s_add_u32 m0, s72, 40960
  s_nop 0
  buffer_load_dwordx4 v70, s[48:51], s62 offen lds
  ds_read_b64_tr_b16 v[38:39], v78 offset:23616
  ds_read_b64_tr_b16 v[40:41], v80 offset:20576
  ds_read_b64_tr_b16 v[42:43], v80 offset:23648
  ds_read_b64_tr_b16 v[44:45], v78 offset:20608
  ds_read_b64_tr_b16 v[46:47], v78 offset:23680
  s_add_u32 s62, s62, s67
  s_add_u32 m0, s73, 40960
  s_nop 0
  buffer_load_dwordx4 v71, s[52:55], s63 offen lds
  ds_read_b64_tr_b16 v[48:49], v80 offset:20640
  ds_read_b64_tr_b16 v[50:51], v80 offset:23712
  ds_read_b64_tr_b16 v[52:53], v82 offset:20480
  ds_read_b64_tr_b16 v[54:55], v82 offset:24064
  ds_read_b64_tr_b16 v[56:57], v82 offset:20512
  s_add_u32 s63, s63, s68
  s_add_u32 m0, s74, 40960
  s_nop 0
  buffer_load_dwordx4 v72, s[56:59], s64 offen lds
  s_add_u32 s64, s64, s69
  ds_read_b64_tr_b16 v[58:59], v82 offset:24096
  ds_read_b64_tr_b16 v[60:61], v82 offset:27648
  ds_read_b64_tr_b16 v[62:63], v82 offset:31232
  ds_read_b64_tr_b16 v[64:65], v82 offset:27680
  ds_read_b64_tr_b16 v[66:67], v82 offset:31264
  s_sub_u32 s12, s75, 5
  s_cmp_le_u32 s12, 1
  s_cbranch_scc0 L_X1_noclr2
  s_sub_u32 s12, 6, s75
  s_lshl_b32 s12, s12, 14
  v_lshlrev_b32 v1, 4, v0
  buffer_store_dwordx4 v[2:5], v1, s[88:91], s12 offen offset:2048 sc1
L_X1_noclr2:
  s_waitcnt lgkmcnt(0)
  s_barrier
  .p2align 3
  v_mfma_f32_16x16x32_bf16 v[92:95], v[40:43], v[24:27], v[92:95]
  v_mfma_f32_16x16x32_bf16 v[128:131], v[36:39], v[8:11], v[128:131]
  v_mfma_f32_16x16x32_bf16 v[132:135], v[36:39], v[12:15], v[132:135]
  v_mfma_f32_16x16x32_bf16 v[136:139], v[36:39], v[16:19], v[136:139]
  v_mfma_f32_16x16x32_bf16 v[140:143], v[36:39], v[20:23], v[140:143]
  v_mfma_f32_16x16x32_bf16 v[144:147], v[40:43], v[8:11], v[144:147]
  v_mfma_f32_16x16x32_bf16 v[148:151], v[40:43], v[12:15], v[148:151]
  v_mfma_f32_16x16x32_bf16 v[152:155], v[40:43], v[16:19], v[152:155]
  v_mfma_f32_16x16x32_bf16 v[156:159], v[40:43], v[20:23], v[156:159]
  v_mfma_f32_16x16x32_bf16 v[160:163], v[8:11], v[44:47], v[160:163]
  v_mfma_f32_16x16x32_bf16 v[164:167], v[12:15], v[44:47], v[164:167]
  v_mfma_f32_16x16x32_bf16 v[168:171], v[16:19], v[44:47], v[168:171]
  v_mfma_f32_16x16x32_bf16 v[172:175], v[20:23], v[44:47], v[172:175]
  v_mfma_f32_16x16x32_bf16 v[176:179], v[8:11], v[48:51], v[176:179]
  v_mfma_f32_16x16x32_bf16 v[180:183], v[12:15], v[48:51], v[180:183]
  v_mfma_f32_16x16x32_bf16 v[184:187], v[16:19], v[48:51], v[184:187]
  v_mfma_f32_16x16x32_bf16 v[188:191], v[20:23], v[48:51], v[188:191]
  v_mfma_f32_16x16x32_bf16 v[96:99], v[28:31], v[8:11], v[96:99]
  v_mfma_f32_16x16x32_bf16 v[100:103], v[28:31], v[12:15], v[100:103]
  v_mfma_f32_16x16x32_bf16 v[104:107], v[28:31], v[16:19], v[104:107]
  v_mfma_f32_16x16x32_bf16 v[84:87], v[32:35], v[24:27], v[84:87]
  v_mfma_f32_16x16x32_bf16 v[108:111], v[28:31], v[20:23], v[108:111]
  v_mfma_f32_16x16x32_bf16 v[112:115], v[32:35], v[8:11], v[112:115]
  v_mfma_f32_16x16x32_bf16 v[116:119], v[32:35], v[12:15], v[116:119]
  v_mfma_f32_16x16x32_bf16 v[120:123], v[32:35], v[16:19], v[120:123]
  v_mfma_f32_16x16x32_bf16 v[124:127], v[32:35], v[20:23], v[124:127]
  v_mfma_f32_16x16x32_bf16 v[192:195], v[52:55], v[8:11], v[192:195]
  v_mfma_f32_16x16x32_bf16 v[196:199], v[52:55], v[12:15], v[196:199]
  v_mfma_f32_16x16x32_bf16 v[200:203], v[52:55], v[16:19], v[200:203]
  v_mfma_f32_16x16x32_bf16 v[204:207], v[52:55], v[20:23], v[204:207]
  v_mfma_f32_16x16x32_bf16 v[208:211], v[56:59], v[8:11], v[208:211]
  v_mfma_f32_16x16x32_bf16 v[212:215], v[56:59], v[12:15], v[212:215]
  v_mfma_f32_16x16x32_bf16 v[216:219], v[56:59], v[16:19], v[216:219]
  v_mfma_f32_16x16x32_bf16 v[220:223], v[56:59], v[20:23], v[220:223]
  v_mfma_f32_16x16x32_bf16 v[224:227], v[60:63], v[8:11], v[224:227]
  v_mfma_f32_16x16x32_bf16 v[228:231], v[60:63], v[12:15], v[228:231]
  v_mfma_f32_16x16x32_bf16 v[232:235], v[60:63], v[16:19], v[232:235]
  v_mfma_f32_16x16x32_bf16 v[236:239], v[60:63], v[20:23], v[236:239]
  v_mfma_f32_16x16x32_bf16 v[240:243], v[64:67], v[8:11], v[240:243]
  v_mfma_f32_16x16x32_bf16 v[244:247], v[64:67], v[12:15], v[244:247]
  v_mfma_f32_16x16x32_bf16 v[248:251], v[64:67], v[16:19], v[248:251]
  v_mfma_f32_16x16x32_bf16 v[252:255], v[64:67], v[20:23], v[252:255]
  s_waitcnt vmcnt(11)
  s_barrier
  .p2align 3
  s_add_u32 m0, s70, 61440
  s_nop 0
  buffer_load_dwordx4 v68, s[40:43], s60 offen lds
  ds_read_b128 v[8:11], v73 offset:0
  ds_read_b128 v[12:15], v73 offset:2048
  ds_read_b128 v[16:19], v73 offset:4096
  ds_read_b128 v[20:23], v73 offset:6144
  ds_read_b128 v[24:27], v75 offset:0
  s_add_u32 s60, s60, s65
  s_add_u32 m0, s71, 61440
  s_nop 0
  buffer_load_dwordx4 v69, s[44:47], s61 offen lds
  ds_read_b64_tr_b16 v[28:29], v77 offset:0
  ds_read_b64_tr_b16 v[30:31], v77 offset:3072
  ds_read_b64_tr_b16 v[32:33], v79 offset:32
  ds_read_b64_tr_b16 v[34:35], v79 offset:3104
  ds_read_b64_tr_b16 v[36:37], v77 offset:64
  s_add_u32 s61, s61, s66
  s_add_u32 m0, s72, 61440
  s_nop 0
  buffer_load_dwordx4 v70, s[48:51], s62 offen lds
  ds_read_b64_tr_b16 v[38:39], v77 offset:3136
  ds_read_b64_tr_b16 v[40:41], v79 offset:96
  ds_read_b64_tr_b16 v[42:43], v79 offset:3168
  ds_read_b64_tr_b16 v[44:45], v77 offset:128
  ds_read_b64_tr_b16 v[46:47], v77 offset:3200
  s_add_u32 s62, s62, s67
  s_add_u32 m0, s73, 61440
  s_nop 0
  buffer_load_dwordx4 v71, s[52:55], s63 offen lds
  ds_read_b64_tr_b16 v[48:49], v79 offset:160
  ds_read_b64_tr_b16 v[50:51], v79 offset:3232
  ds_read_b64_tr_b16 v[52:53], v81 offset:0
  ds_read_b64_tr_b16 v[54:55], v81 offset:3584
  ds_read_b64_tr_b16 v[56:57], v81 offset:32
  s_add_u32 s63, s63, s68
  s_add_u32 m0, s74, 61440
  s_nop 0
  buffer_load_dwordx4 v72, s[56:59], s64 offen lds
  s_add_u32 s64, s64, s69
  ds_read_b64_tr_b16 v[58:59], v81 offset:3616
  ds_read_b64_tr_b16 v[60:61], v81 offset:7168
  ds_read_b64_tr_b16 v[62:63], v81 offset:10752
  ds_read_b64_tr_b16 v[64:65], v81 offset:7200
  ds_read_b64_tr_b16 v[66:67], v81 offset:10784
  s_sub_u32 s12, s75, 5
  s_cmp_le_u32 s12, 1
  s_cbranch_scc0 L_X1_noclr3
  s_sub_u32 s12, 6, s75
  s_lshl_b32 s12, s12, 14
  v_lshlrev_b32 v1, 4, v0
  buffer_store_dwordx4 v[2:5], v1, s[88:91], s12 offen offset:3072 sc1
L_X1_noclr3:
  s_waitcnt lgkmcnt(0)
  s_barrier
  s_sub_u32 s75, s75, 1
  s_cmp_lg_u32 s75, 0
  s_cbranch_scc1 L_X1_loop
  s_load_dwordx2 s[24:25], s[0:1], 16
  s_load_dwordx2 s[26:27], s[0:1], 48
  .p2align 3
  v_mfma_f32_16x16x32_bf16 v[92:95], v[40:43], v[24:27], v[92:95]
  v_mfma_f32_16x16x32_bf16 v[128:131], v[36:39], v[8:11], v[128:131]
  v_mfma_f32_16x16x32_bf16 v[132:135], v[36:39], v[12:15], v[132:135]
  v_mfma_f32_16x16x32_bf16 v[136:139], v[36:39], v[16:19], v[136:139]
  v_mfma_f32_16x16x32_bf16 v[140:143], v[36:39], v[20:23], v[140:143]
  v_mfma_f32_16x16x32_bf16 v[144:147], v[40:43], v[8:11], v[144:147]
  v_mfma_f32_16x16x32_bf16 v[148:151], v[40:43], v[12:15], v[148:151]
  v_mfma_f32_16x16x32_bf16 v[152:155], v[40:43], v[16:19], v[152:155]
  v_mfma_f32_16x16x32_bf16 v[156:159], v[40:43], v[20:23], v[156:159]
  v_mfma_f32_16x16x32_bf16 v[160:163], v[8:11], v[44:47], v[160:163]
  v_mfma_f32_16x16x32_bf16 v[164:167], v[12:15], v[44:47], v[164:167]
  v_mfma_f32_16x16x32_bf16 v[168:171], v[16:19], v[44:47], v[168:171]
  v_mfma_f32_16x16x32_bf16 v[172:175], v[20:23], v[44:47], v[172:175]
  v_mfma_f32_16x16x32_bf16 v[176:179], v[8:11], v[48:51], v[176:179]
  v_mfma_f32_16x16x32_bf16 v[180:183], v[12:15], v[48:51], v[180:183]
  v_mfma_f32_16x16x32_bf16 v[184:187], v[16:19], v[48:51], v[184:187]
  v_mfma_f32_16x16x32_bf16 v[188:191], v[20:23], v[48:51], v[188:191]
  v_mfma_f32_16x16x32_bf16 v[96:99], v[28:31], v[8:11], v[96:99]
  v_mfma_f32_16x16x32_bf16 v[100:103], v[28:31], v[12:15], v[100:103]
  v_mfma_f32_16x16x32_bf16 v[104:107], v[28:31], v[16:19], v[104:107]
  v_mfma_f32_16x16x32_bf16 v[84:87], v[32:35], v[24:27], v[84:87]
  v_mfma_f32_16x16x32_bf16 v[108:111], v[28:31], v[20:23], v[108:111]
  v_mfma_f32_16x16x32_bf16 v[112:115], v[32:35], v[8:11], v[112:115]
  v_mfma_f32_16x16x32_bf16 v[116:119], v[32:35], v[12:15], v[116:119]
  v_mfma_f32_16x16x32_bf16 v[120:123], v[32:35], v[16:19], v[120:123]
  v_mfma_f32_16x16x32_bf16 v[124:127], v[32:35], v[20:23], v[124:127]
  v_mfma_f32_16x16x32_bf16 v[192:195], v[52:55], v[8:11], v[192:195]
  v_mfma_f32_16x16x32_bf16 v[196:199], v[52:55], v[12:15], v[196:199]
  v_mfma_f32_16x16x32_bf16 v[200:203], v[52:55], v[16:19], v[200:203]
  v_mfma_f32_16x16x32_bf16 v[204:207], v[52:55], v[20:23], v[204:207]
  v_mfma_f32_16x16x32_bf16 v[208:211], v[56:59], v[8:11], v[208:211]
  v_mfma_f32_16x16x32_bf16 v[212:215], v[56:59], v[12:15], v[212:215]
  v_mfma_f32_16x16x32_bf16 v[216:219], v[56:59], v[16:19], v[216:219]
  v_mfma_f32_16x16x32_bf16 v[220:223], v[56:59], v[20:23], v[220:223]
  v_mfma_f32_16x16x32_bf16 v[224:227], v[60:63], v[8:11], v[224:227]
  v_mfma_f32_16x16x32_bf16 v[228:231], v[60:63], v[12:15], v[228:231]
  v_mfma_f32_16x16x32_bf16 v[232:235], v[60:63], v[16:19], v[232:235]
  v_mfma_f32_16x16x32_bf16 v[236:239], v[60:63], v[20:23], v[236:239]
  v_mfma_f32_16x16x32_bf16 v[240:243], v[64:67], v[8:11], v[240:243]
  v_mfma_f32_16x16x32_bf16 v[244:247], v[64:67], v[12:15], v[244:247]
  v_mfma_f32_16x16x32_bf16 v[248:251], v[64:67], v[16:19], v[248:251]
  v_mfma_f32_16x16x32_bf16 v[252:255], v[64:67], v[20:23], v[252:255]
  s_waitcnt vmcnt(10)
  s_barrier
  ds_read_b128 v[8:11], v74 offset:0
  ds_read_b128 v[12:15], v74 offset:2048
  ds_read_b128 v[16:19], v74 offset:4096
  ds_read_b128 v[20:23], v74 offset:6144
  ds_read_b128 v[24:27], v76 offset:0
  ds_read_b64_tr_b16 v[28:29], v77 offset:20480
  ds_read_b64_tr_b16 v[30:31], v77 offset:23552
  ds_read_b64_tr_b16 v[32:33], v79 offset:20512
  ds_read_b64_tr_b16 v[34:35], v79 offset:23584
  ds_read_b64_tr_b16 v[36:37], v77 offset:20544
  ds_read_b64_tr_b16 v[38:39], v77 offset:23616
  ds_read_b64_tr_b16 v[40:41], v79 offset:20576
  ds_read_b64_tr_b16 v[42:43], v79 offset:23648
  ds_read_b64_tr_b16 v[44:45], v77 offset:20608
  ds_read_b64_tr_b16 v[46:47], v77 offset:23680
  ds_read_b64_tr_b16 v[48:49], v79 offset:20640
  ds_read_b64_tr_b16 v[50:51], v79 offset:23712
  ds_read_b64_tr_b16 v[52:53], v81 offset:20480
  ds_read_b64_tr_b16 v[54:55], v81 offset:24064
  ds_read_b64_tr_b16 v[56:57], v81 offset:20512
  ds_read_b64_tr_b16 v[58:59], v81 offset:24096
  ds_read_b64_tr_b16 v[60:61], v81 offset:27648
  ds_read_b64_tr_b16 v[62:63], v81 offset:31232
  ds_read_b64_tr_b16 v[64:65], v81 offset:27680
  ds_read_b64_tr_b16 v[66:67], v81 offset:31264
  s_waitcnt lgkmcnt(0)
  s_barrier
  .p2align 3
  v_mfma_f32_16x16x32_bf16 v[92:95], v[40:43], v[24:27], v[92:95]
  v_mfma_f32_16x16x32_bf16 v[128:131], v[36:39], v[8:11], v[128:131]
  v_mfma_f32_16x16x32_bf16 v[132:135], v[36:39], v[12:15], v[132:135]
  v_mfma_f32_16x16x32_bf16 v[136:139], v[36:39], v[16:19], v[136:139]
  v_mfma_f32_16x16x32_bf16 v[140:143], v[36:39], v[20:23], v[140:143]
  v_mfma_f32_16x16x32_bf16 v[144:147], v[40:43], v[8:11], v[144:147]
  v_mfma_f32_16x16x32_bf16 v[148:151], v[40:43], v[12:15], v[148:151]
  v_mfma_f32_16x16x32_bf16 v[152:155], v[40:43], v[16:19], v[152:155]
  v_mfma_f32_16x16x32_bf16 v[156:159], v[40:43], v[20:23], v[156:159]
  v_mfma_f32_16x16x32_bf16 v[160:163], v[8:11], v[44:47], v[160:163]
  v_mfma_f32_16x16x32_bf16 v[164:167], v[12:15], v[44:47], v[164:167]
  v_mfma_f32_16x16x32_bf16 v[168:171], v[16:19], v[44:47], v[168:171]
  v_mfma_f32_16x16x32_bf16 v[172:175], v[20:23], v[44:47], v[172:175]
  v_mfma_f32_16x16x32_bf16 v[176:179], v[8:11], v[48:51], v[176:179]
  v_mfma_f32_16x16x32_bf16 v[180:183], v[12:15], v[48:51], v[180:183]
  v_mfma_f32_16x16x32_bf16 v[184:187], v[16:19], v[48:51], v[184:187]
  v_mfma_f32_16x16x32_bf16 v[188:191], v[20:23], v[48:51], v[188:191]
  v_mfma_f32_16x16x32_bf16 v[96:99], v[28:31], v[8:11], v[96:99]
  v_mfma_f32_16x16x32_bf16 v[100:103], v[28:31], v[12:15], v[100:103]
  v_mfma_f32_16x16x32_bf16 v[104:107], v[28:31], v[16:19], v[104:107]
  v_mfma_f32_16x16x32_bf16 v[84:87], v[32:35], v[24:27], v[84:87]
  v_mfma_f32_16x16x32_bf16 v[108:111], v[28:31], v[20:23], v[108:111]
  v_mfma_f32_16x16x32_bf16 v[112:115], v[32:35], v[8:11], v[112:115]
  v_mfma_f32_16x16x32_bf16 v[116:119], v[32:35], v[12:15], v[116:119]
  v_mfma_f32_16x16x32_bf16 v[120:123], v[32:35], v[16:19], v[120:123]
  v_mfma_f32_16x16x32_bf16 v[124:127], v[32:35], v[20:23], v[124:127]
  v_mfma_f32_16x16x32_bf16 v[192:195], v[52:55], v[8:11], v[192:195]
  v_mfma_f32_16x16x32_bf16 v[196:199], v[52:55], v[12:15], v[196:199]
  v_mfma_f32_16x16x32_bf16 v[200:203], v[52:55], v[16:19], v[200:203]
  v_mfma_f32_16x16x32_bf16 v[204:207], v[52:55], v[20:23], v[204:207]
  v_mfma_f32_16x16x32_bf16 v[208:211], v[56:59], v[8:11], v[208:211]
  v_mfma_f32_16x16x32_bf16 v[212:215], v[56:59], v[12:15], v[212:215]
  v_mfma_f32_16x16x32_bf16 v[216:219], v[56:59], v[16:19], v[216:219]
  v_mfma_f32_16x16x32_bf16 v[220:223], v[56:59], v[20:23], v[220:223]
  v_mfma_f32_16x16x32_bf16 v[224:227], v[60:63], v[8:11], v[224:227]
  v_mfma_f32_16x16x32_bf16 v[228:231], v[60:63], v[12:15], v[228:231]
  v_mfma_f32_16x16x32_bf16 v[232:235], v[60:63], v[16:19], v[232:235]
  v_mfma_f32_16x16x32_bf16 v[236:239], v[60:63], v[20:23], v[236:239]
  v_mfma_f32_16x16x32_bf16 v[240:243], v[64:67], v[8:11], v[240:243]
  v_mfma_f32_16x16x32_bf16 v[244:247], v[64:67], v[12:15], v[244:247]
  v_mfma_f32_16x16x32_bf16 v[248:251], v[64:67], v[16:19], v[248:251]
  v_mfma_f32_16x16x32_bf16 v[252:255], v[64:67], v[20:23], v[252:255]
  s_waitcnt vmcnt(5)
  s_barrier
  ds_read_b128 v[8:11], v73 offset:34816
  ds_read_b128 v[12:15], v73 offset:36864
  ds_read_b128 v[16:19], v73 offset:38912
  ds_read_b128 v[20:23], v73 offset:40960
  ds_read_b128 v[24:27], v75 offset:34816
  ds_read_b64_tr_b16 v[28:29], v78 offset:0
  ds_read_b64_tr_b16 v[30:31], v78 offset:3072
  ds_read_b64_tr_b16 v[32:33], v80 offset:32
  ds_read_b64_tr_b16 v[34:35], v80 offset:3104
  ds_read_b64_tr_b16 v[36:37], v78 offset:64
  ds_read_b64_tr_b16 v[38:39], v78 offset:3136
  ds_read_b64_tr_b16 v[40:41], v80 offset:96
  ds_read_b64_tr_b16 v[42:43], v80 offset:3168
  ds_read_b64_tr_b16 v[44:45], v78 offset:128
  ds_read_b64_tr_b16 v[46:47], v78 offset:3200
  ds_read_b64_tr_b16 v[48:49], v80 offset:160
  ds_read_b64_tr_b16 v[50:51], v80 offset:3232
  ds_read_b64_tr_b16 v[52:53], v82 offset:0
  ds_read_b64_tr_b16 v[54:55], v82 offset:3584
  ds_read_b64_tr_b16 v[56:57], v82 offset:32
  ds_read_b64_tr_b16 v[58:59], v82 offset:3616
  ds_read_b64_tr_b16 v[60:61], v82 offset:7168
  ds_read_b64_tr_b16 v[62:63], v82 offset:10752
  ds_read_b64_tr_b16 v[64:65], v82 offset:7200
  ds_read_b64_tr_b16 v[66:67], v82 offset:10784
  s_waitcnt lgkmcnt(0)
  s_barrier
  .p2align 3
  v_mfma_f32_16x16x32_bf16 v[92:95], v[40:43], v[24:27], v[92:95]
  v_mfma_f32_16x16x32_bf16 v[128:131], v[36:39], v[8:11], v[128:131]
  v_mfma_f32_16x16x32_bf16 v[132:135], v[36:39], v[12:15], v[132:135]
  v_mfma_f32_16x16x32_bf16 v[136:139], v[36:39], v[16:19], v[136:139]
  v_mfma_f32_16x16x32_bf16 v[140:143], v[36:39], v[20:23], v[140:143]
  v_mfma_f32_16x16x32_bf16 v[144:147], v[40:43], v[8:11], v[144:147]
  v_mfma_f32_16x16x32_bf16 v[148:151], v[40:43], v[12:15], v[148:151]
  v_mfma_f32_16x16x32_bf16 v[152:155], v[40:43], v[16:19], v[152:155]
  v_mfma_f32_16x16x32_bf16 v[156:159], v[40:43], v[20:23], v[156:159]
  v_mfma_f32_16x16x32_bf16 v[160:163], v[8:11], v[44:47], v[160:163]
  v_mfma_f32_16x16x32_bf16 v[164:167], v[12:15], v[44:47], v[164:167]
  v_mfma_f32_16x16x32_bf16 v[168:171], v[16:19], v[44:47], v[168:171]
  v_mfma_f32_16x16x32_bf16 v[172:175], v[20:23], v[44:47], v[172:175]
  v_mfma_f32_16x16x32_bf16 v[176:179], v[8:11], v[48:51], v[176:179]
  v_mfma_f32_16x16x32_bf16 v[180:183], v[12:15], v[48:51], v[180:183]
  v_mfma_f32_16x16x32_bf16 v[184:187], v[16:19], v[48:51], v[184:187]
  v_mfma_f32_16x16x32_bf16 v[188:191], v[20:23], v[48:51], v[188:191]
  v_mfma_f32_16x16x32_bf16 v[96:99], v[28:31], v[8:11], v[96:99]
  v_mfma_f32_16x16x32_bf16 v[100:103], v[28:31], v[12:15], v[100:103]
  v_mfma_f32_16x16x32_bf16 v[104:107], v[28:31], v[16:19], v[104:107]
  v_mfma_f32_16x16x32_bf16 v[84:87], v[32:35], v[24:27], v[84:87]
  v_mfma_f32_16x16x32_bf16 v[108:111], v[28:31], v[20:23], v[108:111]
  v_mfma_f32_16x16x32_bf16 v[112:115], v[32:35], v[8:11], v[112:115]
  v_mfma_f32_16x16x32_bf16 v[116:119], v[32:35], v[12:15], v[116:119]
  v_mfma_f32_16x16x32_bf16 v[120:123], v[32:35], v[16:19], v[120:123]
  v_mfma_f32_16x16x32_bf16 v[124:127], v[32:35], v[20:23], v[124:127]
  v_mfma_f32_16x16x32_bf16 v[192:195], v[52:55], v[8:11], v[192:195]
  v_mfma_f32_16x16x32_bf16 v[196:199], v[52:55], v[12:15], v[196:199]
  v_mfma_f32_16x16x32_bf16 v[200:203], v[52:55], v[16:19], v[200:203]
  v_mfma_f32_16x16x32_bf16 v[204:207], v[52:55], v[20:23], v[204:207]
  v_mfma_f32_16x16x32_bf16 v[208:211], v[56:59], v[8:11], v[208:211]
  v_mfma_f32_16x16x32_bf16 v[212:215], v[56:59], v[12:15], v[212:215]
  v_mfma_f32_16x16x32_bf16 v[216:219], v[56:59], v[16:19], v[216:219]
  v_mfma_f32_16x16x32_bf16 v[220:223], v[56:59], v[20:23], v[220:223]
  v_mfma_f32_16x16x32_bf16 v[224:227], v[60:63], v[8:11], v[224:227]
  v_mfma_f32_16x16x32_bf16 v[228:231], v[60:63], v[12:15], v[228:231]
  v_mfma_f32_16x16x32_bf16 v[232:235], v[60:63], v[16:19], v[232:235]
  v_mfma_f32_16x16x32_bf16 v[236:239], v[60:63], v[20:23], v[236:239]
  v_mfma_f32_16x16x32_bf16 v[240:243], v[64:67], v[8:11], v[240:243]
  v_mfma_f32_16x16x32_bf16 v[244:247], v[64:67], v[12:15], v[244:247]
  v_mfma_f32_16x16x32_bf16 v[248:251], v[64:67], v[16:19], v[248:251]
  v_mfma_f32_16x16x32_bf16 v[252:255], v[64:67], v[20:23], v[252:255]
  s_waitcnt vmcnt(0)
  s_barrier
  ds_read_b128 v[8:11], v74 offset:34816
  ds_read_b128 v[12:15], v74 offset:36864
  ds_read_b128 v[16:19], v74 offset:38912
  ds_read_b128 v[20:23], v74 offset:40960
  ds_read_b128 v[24:27], v76 offset:34816
  ds_read_b64_tr_b16 v[28:29], v78 offset:20480
  ds_read_b64_tr_b16 v[30:31], v78 offset:23552
  ds_read_b64_tr_b16 v[32:33], v80 offset:20512
  ds_read_b64_tr_b16 v[34:35], v80 offset:23584
  ds_read_b64_tr_b16 v[36:37], v78 offset:20544
  ds_read_b64_tr_b16 v[38:39], v78 offset:23616
  ds_read_b64_tr_b16 v[40:41], v80 offset:20576
  ds_read_b64_tr_b16 v[42:43], v80 offset:23648
  ds_read_b64_tr_b16 v[44:45], v78 offset:20608
  ds_read_b64_tr_b16 v[46:47], v78 offset:23680
  ds_read_b64_tr_b16 v[48:49], v80 offset:20640
  ds_read_b64_tr_b16 v[50:51], v80 offset:23712
  ds_read_b64_tr_b16 v[52:53], v82 offset:20480
  ds_read_b64_tr_b16 v[54:55], v82 offset:24064
  ds_read_b64_tr_b16 v[56:57], v82 offset:20512
  ds_read_b64_tr_b16 v[58:59], v82 offset:24096
  ds_read_b64_tr_b16 v[60:61], v82 offset:27648
  ds_read_b64_tr_b16 v[62:63], v82 offset:31232
  ds_read_b64_tr_b16 v[64:65], v82 offset:27680
  ds_read_b64_tr_b16 v[66:67], v82 offset:31264
  s_and_b32 s3, s2, 7
  s_lshr_b32 s16, s2, 3
  s_and_b32 s20, s16, 1
  s_lshr_b32 s16, s16, 1
  s_lshr_b32 s17, s3, 1
  s_lshl_b32 s17, s17, 2
  s_and_b32 s18, s16, 3
  s_add_u32 s21, s17, s18
  s_and_b32 s17, s3, 1
  s_lshl_b32 s17, s17, 2
  s_lshr_b32 s18, s16, 2
  s_add_u32 s22, s17, s18
  s_lshl_b32 s23, s21, 3
  s_add_u32 s23, s23, s22
  s_lshr_b32 s19, s76, 2
  s_mov_b32 s64, s24
  s_mov_b32 s65, s25
  s_mov_b32 s66, 2097152
  s_mov_b32 s67, 0x20000
  s_lshl_b32 s16, s20, 4
  s_lshl_b32 s17, s19, 1
  s_add_u32 s16, s16, s17
  s_lshl_b32 s73, s16, 16
  s_mov_b32 s70, 262144
  s_mov_b32 s72, 65536
  s_mov_b32 s68, 4
  s_mov_b32 s69, 0
  s_mul_i32 s16, s20, 56
  s_mul_i32 s17, s19, 7
  s_add_u32 s18, s16, s17
  s_lshl_b32 s80, s18, 16
  s_mul_i32 s17, s19, 3
  s_add_u32 s18, s16, s17
  s_add_u32 s18, s18, 1
  s_lshl_b32 s81, s18, 16
  s_mul_i32 s17, s19, 14
  s_add_u32 s18, s16, s17
  s_add_u32 s18, s18, 6
  s_lshl_b32 s82, s18, 16
  s_mul_i32 s17, s19, 49152
  s_lshl_b32 s18, s77, 11
  s_add_u32 s74, s17, s18
  v_lshrrev_b32 v3, 4, v0
  v_lshlrev_b32 v4, 1, v3
  v_and_b32 v2, 15, v0
  v_xor_b32 v6, v4, v2
  v_xor_b32 v2, 8, v6
  s_lshl_b32 s17, s77, 3
  v_add_u32 v3, s17, v3
  v_lshlrev_b32 v3, 11, v3
  s_lshl_b32 s17, s22, 8
  v_add_u32 v3, s17, v3
  v_lshl_add_u32 v68, v6, 4, v3
  v_lshl_add_u32 v69, v2, 4, v3
  v_add_u32 v69, 8192, v69
  s_add_u32 m0, s74, 0
  s_add_u32 s75, s73, s72
  buffer_load_dwordx4 v68, s[64:67], s73 offen lds
  s_add_u32 m0, s74, 1024
  s_sub_u32 s68, s68, 1
  buffer_load_dwordx4 v69, s[64:67], s73 offen lds
  s_add_u32 m0, s74, 8192
  s_add_u32 s73, s73, s70
  buffer_load_dwordx4 v68, s[64:67], s75 offen lds
  s_add_u32 m0, s74, 9216
  s_cmp_eq_u32 s68, 0
  buffer_load_dwordx4 v69, s[64:67], s75 offen lds
  s_cbranch_scc0 L_bo3
  s_add_u32 s69, s69, 1
  s_mov_b32 s64, s26
  s_mov_b32 s65, s27
  s_mov_b32 s66, 7340032
  s_mov_b32 s73, s80
  s_mov_b32 s70, 917504
  s_mov_b32 s72, 196608
  s_mov_b32 s68, 4
  s_cmp_eq_u32 s69, 1
  s_cbranch_scc1 L_bo3
  s_mov_b32 s73, s81
  s_mov_b32 s70, 458752
  s_mov_b32 s72, 65536
  s_mov_b32 s68, 8
  s_cmp_eq_u32 s69, 2
  s_cbranch_scc1 L_bo3
  s_mov_b32 s73, s82
  s_mov_b32 s70, 1835008
  s_mov_b32 s72, 458752
  s_mov_b32 s68, 2
  s_cmp_eq_u32 s69, 3
  s_cbranch_scc1 L_bo3
  s_mov_b32 s66, 0
  s_mov_b32 s68, 64
L_bo3:
  s_add_u32 m0, s74, 16384
  s_add_u32 s75, s73, s72
  buffer_load_dwordx4 v68, s[64:67], s73 offen lds
  s_add_u32 m0, s74, 17408
  s_sub_u32 s68, s68, 1
  buffer_load_dwordx4 v69, s[64:67], s73 offen lds
  s_add_u32 m0, s74, 24576
  s_add_u32 s73, s73, s70
  buffer_load_dwordx4 v68, s[64:67], s75 offen lds
  s_add_u32 m0, s74, 25600
  s_cmp_eq_u32 s68, 0
  buffer_load_dwordx4 v69, s[64:67], s75 offen lds
  s_cbranch_scc0 L_bo4
  s_add_u32 s69, s69, 1
  s_mov_b32 s64, s26
  s_mov_b32 s65, s27
  s_mov_b32 s66, 7340032
  s_mov_b32 s73, s80
  s_mov_b32 s70, 917504
  s_mov_b32 s72, 196608
  s_mov_b32 s68, 4
  s_cmp_eq_u32 s69, 1
  s_cbranch_scc1 L_bo4
  s_mov_b32 s73, s81
  s_mov_b32 s70, 458752
  s_mov_b32 s72, 65536
  s_mov_b32 s68, 8
  s_cmp_eq_u32 s69, 2
  s_cbranch_scc1 L_bo4
  s_mov_b32 s73, s82
  s_mov_b32 s70, 1835008
  s_mov_b32 s72, 458752
  s_mov_b32 s68, 2
  s_cmp_eq_u32 s69, 3
  s_cbranch_scc1 L_bo4
  s_mov_b32 s66, 0
  s_mov_b32 s68, 64
L_bo4:
  s_waitcnt lgkmcnt(0)
  s_barrier
  .p2align 3
  v_mfma_f32_16x16x32_bf16 v[92:95], v[40:43], v[24:27], v[92:95]
  v_mfma_f32_16x16x32_bf16 v[128:131], v[36:39], v[8:11], v[128:131]
  v_mfma_f32_16x16x32_bf16 v[132:135], v[36:39], v[12:15], v[132:135]
  v_mfma_f32_16x16x32_bf16 v[136:139], v[36:39], v[16:19], v[136:139]
  v_mfma_f32_16x16x32_bf16 v[140:143], v[36:39], v[20:23], v[140:143]
  v_mfma_f32_16x16x32_bf16 v[144:147], v[40:43], v[8:11], v[144:147]
  v_mfma_f32_16x16x32_bf16 v[148:151], v[40:43], v[12:15], v[148:151]
  v_mfma_f32_16x16x32_bf16 v[152:155], v[40:43], v[16:19], v[152:155]
  v_mfma_f32_16x16x32_bf16 v[156:159], v[40:43], v[20:23], v[156:159]
  v_mfma_f32_16x16x32_bf16 v[160:163], v[8:11], v[44:47], v[160:163]
  v_mfma_f32_16x16x32_bf16 v[164:167], v[12:15], v[44:47], v[164:167]
  v_mfma_f32_16x16x32_bf16 v[168:171], v[16:19], v[44:47], v[168:171]
  v_mfma_f32_16x16x32_bf16 v[172:175], v[20:23], v[44:47], v[172:175]
  v_mfma_f32_16x16x32_bf16 v[176:179], v[8:11], v[48:51], v[176:179]
  v_mfma_f32_16x16x32_bf16 v[180:183], v[12:15], v[48:51], v[180:183]
  v_mfma_f32_16x16x32_bf16 v[184:187], v[16:19], v[48:51], v[184:187]
  v_mfma_f32_16x16x32_bf16 v[188:191], v[20:23], v[48:51], v[188:191]
  v_mfma_f32_16x16x32_bf16 v[96:99], v[28:31], v[8:11], v[96:99]
  v_mfma_f32_16x16x32_bf16 v[100:103], v[28:31], v[12:15], v[100:103]
  v_mfma_f32_16x16x32_bf16 v[104:107], v[28:31], v[16:19], v[104:107]
  v_mfma_f32_16x16x32_bf16 v[84:87], v[32:35], v[24:27], v[84:87]
  v_mfma_f32_16x16x32_bf16 v[108:111], v[28:31], v[20:23], v[108:111]
  v_mfma_f32_16x16x32_bf16 v[112:115], v[32:35], v[8:11], v[112:115]
  v_mfma_f32_16x16x32_bf16 v[116:119], v[32:35], v[12:15], v[116:119]
  v_mfma_f32_16x16x32_bf16 v[120:123], v[32:35], v[16:19], v[120:123]
  v_mfma_f32_16x16x32_bf16 v[124:127], v[32:35], v[20:23], v[124:127]
  v_mfma_f32_16x16x32_bf16 v[192:195], v[52:55], v[8:11], v[192:195]
  v_mfma_f32_16x16x32_bf16 v[196:199], v[52:55], v[12:15], v[196:199]
  v_mfma_f32_16x16x32_bf16 v[200:203], v[52:55], v[16:19], v[200:203]
  v_mfma_f32_16x16x32_bf16 v[204:207], v[52:55], v[20:23], v[204:207]
  v_mfma_f32_16x16x32_bf16 v[208:211], v[56:59], v[8:11], v[208:211]
  v_mfma_f32_16x16x32_bf16 v[212:215], v[56:59], v[12:15], v[212:215]
  v_mfma_f32_16x16x32_bf16 v[216:219], v[56:59], v[16:19], v[216:219]
  v_mfma_f32_16x16x32_bf16 v[220:223], v[56:59], v[20:23], v[220:223]
  v_mfma_f32_16x16x32_bf16 v[224:227], v[60:63], v[8:11], v[224:227]
  v_mfma_f32_16x16x32_bf16 v[228:231], v[60:63], v[12:15], v[228:231]
  v_mfma_f32_16x16x32_bf16 v[232:235], v[60:63], v[16:19], v[232:235]
  v_mfma_f32_16x16x32_bf16 v[236:239], v[60:63], v[20:23], v[236:239]
  v_mfma_f32_16x16x32_bf16 v[240:243], v[64:67], v[8:11], v[240:243]
  v_mfma_f32_16x16x32_bf16 v[244:247], v[64:67], v[12:15], v[244:247]
  v_mfma_f32_16x16x32_bf16 v[248:251], v[64:67], v[16:19], v[248:251]
  v_mfma_f32_16x16x32_bf16 v[252:255], v[64:67], v[20:23], v[252:255]
  s_barrier
  s_mov_b32 s39, 1
  s_branch L_xepi
L_X2:
  s_mov_b32 s40, s8
  s_mov_b32 s41, s9
  s_mov_b32 s42, 7340032
  s_mov_b32 s43, 0x20000
  s_mov_b32 s70, 79872
  s_mov_b32 s65, 229376
  s_mov_b32 s60, 0
  v_add_u32 v1, 256, v0
  v_mul_u32_u24 v2, 37450, v1
  v_lshrrev_b32 v2, 19, v2
  v_mul_u32_u24 v3, 14, v2
  v_sub_u32 v3, v1, v3
  v_lshlrev_b32 v4, 4, v3
  v_mov_b32 v6, s25
  v_mov_b32 v5, s26
  v_cmp_gt_u32 vcc, 12, v3
  s_nop 1
  v_cndmask_b32 v6, v5, v6, vcc
  v_add_u32 v4, v6, v4
  v_bfe_u32 v5, v2, 2, 2
  v_lshlrev_b32 v5, 3, v5
  v_lshrrev_b32 v6, 4, v2
  v_lshl_add_u32 v5, v6, 2, v5
  v_and_b32 v6, 3, v2
  v_add_u32 v5, v5, v6
  v_mul_u32_u24 v5, 7168, v5
  v_add_u32 v68, v5, v4
  s_mov_b32 s44, s8
  s_mov_b32 s45, s9
  s_mov_b32 s46, 7340032
  s_mov_b32 s47, 0x20000
  s_mov_b32 s71, 80896
  s_mov_b32 s66, 229376
  s_mov_b32 s61, 0
  v_add_u32 v1, 320, v0
  v_mul_u32_u24 v2, 37450, v1
  v_lshrrev_b32 v2, 19, v2
  v_mul_u32_u24 v3, 14, v2
  v_sub_u32 v3, v1, v3
  v_lshlrev_b32 v4, 4, v3
  v_mov_b32 v6, s25
  v_mov_b32 v5, s26
  v_cmp_gt_u32 vcc, 12, v3
  s_nop 1
  v_cndmask_b32 v6, v5, v6, vcc
  v_add_u32 v4, v6, v4
  v_bfe_u32 v5, v2, 2, 2
  v_lshlrev_b32 v5, 3, v5
  v_lshrrev_b32 v6, 4, v2
  v_lshl_add_u32 v5, v6, 2, v5
  v_and_b32 v6, 3, v2
  v_add_u32 v5, v5, v6
  v_mul_u32_u24 v5, 7168, v5
  v_add_u32 v69, v5, v4
  s_mov_b32 s48, s8
  s_mov_b32 s49, s9
  s_mov_b32 s50, 7340032
  s_mov_b32 s51, 0x20000
  s_mov_b32 s72, 81920
  s_mov_b32 s67, 229376
  s_mov_b32 s62, 0
  v_add_u32 v1, 384, v0
  v_mul_u32_u24 v2, 37450, v1
  v_lshrrev_b32 v2, 19, v2
  v_mul_u32_u24 v3, 14, v2
  v_sub_u32 v3, v1, v3
  v_lshlrev_b32 v4, 4, v3
  v_mov_b32 v6, s25
  v_mov_b32 v5, s26
  v_cmp_gt_u32 vcc, 12, v3
  s_nop 1
  v_cndmask_b32 v6, v5, v6, vcc
  v_add_u32 v4, v6, v4
  v_bfe_u32 v5, v2, 2, 2
  v_lshlrev_b32 v5, 3, v5
  v_lshrrev_b32 v6, 4, v2
  v_lshl_add_u32 v5, v6, 2, v5
  v_and_b32 v6, 3, v2
  v_add_u32 v5, v5, v6
  v_mul_u32_u24 v5, 7168, v5
  v_add_u32 v70, v5, v4
  s_mov_b32 s52, s10
  s_mov_b32 s53, s11
  s_mov_b32 s54, 7340032
  s_mov_b32 s55, 0x20000
  s_mov_b32 s73, 82944
  s_mov_b32 s68, 229376
  s_mov_b32 s63, 0
  v_add_u32 v1, 0, v0
  v_mul_u32_u24 v2, 37450, v1
  v_lshrrev_b32 v2, 19, v2
  v_mul_u32_u24 v3, 14, v2
  v_sub_u32 v3, v1, v3
  v_lshlrev_b32 v4, 4, v3
  v_mov_b32 v6, s25
  v_mov_b32 v5, s26
  v_cmp_gt_u32 vcc, 12, v3
  s_nop 1
  v_cndmask_b32 v6, v5, v6, vcc
  v_add_u32 v4, v6, v4
  v_bfe_u32 v5, v2, 2, 2
  v_lshlrev_b32 v5, 3, v5
  v_lshrrev_b32 v6, 4, v2
  v_lshl_add_u32 v5, v6, 2, v5
  v_and_b32 v6, 3, v2
  v_add_u32 v5, v5, v6
  v_mul_u32_u24 v5, 7168, v5
  v_add_u32 v71, v5, v4
  s_mov_b32 s56, s10
  s_mov_b32 s57, s11
  s_mov_b32 s58, 7340032
  s_mov_b32 s59, 0x20000
  s_mov_b32 s74, 83968
  s_mov_b32 s69, 229376
  s_mov_b32 s64, 0
  v_add_u32 v1, 64, v0
  v_mul_u32_u24 v2, 37450, v1
  v_lshrrev_b32 v2, 19, v2
  v_mul_u32_u24 v3, 14, v2
  v_sub_u32 v3, v1, v3
  v_lshlrev_b32 v4, 4, v3
  v_mov_b32 v6, s25
  v_mov_b32 v5, s26
  v_cmp_gt_u32 vcc, 12, v3
  s_nop 1
  v_cndmask_b32 v6, v5, v6, vcc
  v_add_u32 v4, v6, v4
  v_bfe_u32 v5, v2, 2, 2
  v_lshlrev_b32 v5, 3, v5
  v_lshrrev_b32 v6, 4, v2
  v_lshl_add_u32 v5, v6, 2, v5
  v_and_b32 v6, 3, v2
  v_add_u32 v5, v5, v6
  v_mul_u32_u24 v5, 7168, v5
  v_add_u32 v72, v5, v4
  s_mov_b32 s12, s79
  s_lshr_b32 s13, s12, 1
  s_and_b32 s14, s12, 1
  s_sub_u32 s15, s12, 2
  s_sub_u32 s16, s12, 7
  s_cmp_lt_u32 s12, 9
  s_cselect_b32 s15, s15, s16
  s_cselect_b32 s16, 0, 1
  s_cmp_lt_u32 s12, 4
  s_cselect_b32 s13, s13, s16
  s_cselect_b32 s14, s14, s15
  s_mul_i32 s13, s13, 7168
  s_lshl_b32 s14, s14, 5
  s_add_u32 s38, s13, s14
  s_add_u32 m0, s70, 0
  s_nop 0
  buffer_load_dwordx4 v68, s[40:43], s60 offen lds
  s_add_u32 s60, s60, s65
  s_add_u32 m0, s71, 0
  s_nop 0
  buffer_load_dwordx4 v69, s[44:47], s61 offen lds
  s_add_u32 s61, s61, s66
  s_add_u32 m0, s72, 0
  s_nop 0
  buffer_load_dwordx4 v70, s[48:51], s62 offen lds
  s_add_u32 s62, s62, s67
  s_add_u32 m0, s73, 0
  s_nop 0
  buffer_load_dwordx4 v71, s[52:55], s63 offen lds
  s_add_u32 s63, s63, s68
  s_add_u32 m0, s74, 0
  s_nop 0
  buffer_load_dwordx4 v72, s[56:59], s64 offen lds
  s_add_u32 s64, s64, s69
  s_add_u32 m0, s70, 20480
  s_nop 0
  buffer_load_dwordx4 v68, s[40:43], s60 offen lds
  s_add_u32 s60, s60, s65
  s_add_u32 m0, s71, 20480
  s_nop 0
  buffer_load_dwordx4 v69, s[44:47], s61 offen lds
  s_add_u32 s61, s61, s66
  s_add_u32 m0, s72, 20480
  s_nop 0
  buffer_load_dwordx4 v70, s[48:51], s62 offen lds
  s_add_u32 s62, s62, s67
  s_add_u32 m0, s73, 20480
  s_nop 0
  buffer_load_dwordx4 v71, s[52:55], s63 offen lds
  s_add_u32 s63, s63, s68
  s_add_u32 m0, s74, 20480
  s_nop 0
  buffer_load_dwordx4 v72, s[56:59], s64 offen lds
  s_add_u32 s64, s64, s69
  s_add_u32 m0, s70, 40960
  s_nop 0
  buffer_load_dwordx4 v68, s[40:43], s60 offen lds
  s_add_u32 s60, s60, s65
  s_add_u32 m0, s71, 40960
  s_nop 0
  buffer_load_dwordx4 v69, s[44:47], s61 offen lds
  s_add_u32 s61, s61, s66
  s_add_u32 m0, s72, 40960
  s_nop 0
  buffer_load_dwordx4 v70, s[48:51], s62 offen lds
  s_add_u32 s62, s62, s67
  s_add_u32 m0, s73, 40960
  s_nop 0
  buffer_load_dwordx4 v71, s[52:55], s63 offen lds
  s_add_u32 s63, s63, s68
  s_add_u32 m0, s74, 40960
  s_nop 0
  buffer_load_dwordx4 v72, s[56:59], s64 offen lds
  s_add_u32 s64, s64, s69
  s_mov_b32 s24, s36
  s_mov_b32 s25, s37
  s_mov_b32 s26, 4194304
  s_mov_b32 s27, 0x20000
  s_lshr_b32 s28, s2, 3
  s_lshl_b32 s28, s28, 6
  s_add_u32 s28, s28, 32
  v_add_u32 v83, s28, v0
  v_lshlrev_b32 v83, 11, v83
  v_add_u32 v83, 0, v83
  v_cmp_gt_u32 vcc, 32, v0
  v_mov_b32 v3, 0x7ffffff0
  s_nop 0
  v_cndmask_b32 v83, v3, v83, vcc
  s_mov_b32 s28, 256
  buffer_load_dword v6, v83, s[24:27], s28 offen
  s_add_u32 s28, s28, 256
  s_and_b32 s3, s2, 7
  s_lshr_b32 s16, s2, 3
  s_and_b32 s20, s16, 1
  s_lshr_b32 s16, s16, 1
  s_lshr_b32 s17, s3, 1
  s_lshl_b32 s17, s17, 2
  s_and_b32 s18, s16, 3
  s_add_u32 s21, s17, s18
  s_and_b32 s17, s3, 1
  s_lshl_b32 s17, s17, 2
  s_lshr_b32 s18, s16, 2
  s_add_u32 s22, s17, s18
  s_lshl_b32 s23, s21, 3
  s_add_u32 s23, s23, s22
  s_lshl_b32 s16, s23, 16
  s_lshl_b32 s17, s20, 15
  s_add_u32 s16, s16, s17
  s_lshl_b32 s17, s76, 12
  s_add_u32 s16, s16, s17
  s_add_u32 s16, s16, 67108864
  s_add_u32 s88, s6, s16
  s_addc_u32 s89, s7, 0
  s_mov_b32 s90, 20480
  s_mov_b32 s91, 0x20000
  s_waitcnt vmcnt(16)
  v_lshlrev_b32 v104, 16, v96
  v_and_b32 v105, 0xffff0000, v96
  v_lshlrev_b32 v106, 16, v97
  v_and_b32 v107, 0xffff0000, v97
  v_lshlrev_b32 v108, 16, v98
  v_and_b32 v109, 0xffff0000, v98
  v_lshlrev_b32 v110, 16, v99
  v_and_b32 v111, 0xffff0000, v99
  v_lshlrev_b32 v112, 16, v100
  v_and_b32 v113, 0xffff0000, v100
  v_lshlrev_b32 v114, 16, v101
  v_and_b32 v115, 0xffff0000, v101
  v_lshlrev_b32 v116, 16, v102
  v_and_b32 v117, 0xffff0000, v102
  v_lshlrev_b32 v118, 16, v103
  v_and_b32 v119, 0xffff0000, v103
  v_add_f32 v120, v104, v108
  v_add_f32 v124, v112, v116
  v_add_f32 v121, v105, v109
  v_add_f32 v125, v113, v117
  v_add_f32 v122, v106, v110
  v_add_f32 v126, v114, v118
  v_add_f32 v123, v107, v111
  v_add_f32 v127, v115, v119
  v_add_f32 v120, v120, v124
  v_add_f32 v121, v121, v125
  v_add_f32 v122, v122, v126
  v_add_f32 v123, v123, v127
  v_add_f32 v120, v120, v121
  v_add_f32 v122, v122, v123
  v_add_f32 v120, v120, v122
  s_nop 1
  v_add_f32_dpp v120, v120, v120 row_ror:8 row_mask:0xf bank_mask:0xf
  s_nop 1
  v_add_f32_dpp v120, v120, v120 row_ror:4 row_mask:0xf bank_mask:0xf
  s_nop 1
  v_add_f32_dpp v120, v120, v120 row_ror:2 row_mask:0xf bank_mask:0xf
  s_nop 1
  v_add_f32_dpp v120, v120, v120 row_ror:1 row_mask:0xf bank_mask:0xf
  v_mov_b32 v121, v120
  s_nop 1
  v_permlane16_swap_b32 v120, v121
  v_add_f32 v120, v120, v121
  v_mov_b32 v121, v120
  s_nop 1
  v_permlane32_swap_b32 v120, v121
  v_add_f32 v120, v120, v121
  v_mul_f32 v120, 0x3a800000, v120
  v_sub_f32 v104, v104, v120
  v_sub_f32 v105, v105, v120
  v_sub_f32 v106, v106, v120
  v_sub_f32 v107, v107, v120
  v_sub_f32 v108, v108, v120
  v_sub_f32 v109, v109, v120
  v_sub_f32 v110, v110, v120
  v_sub_f32 v111, v111, v120
  v_sub_f32 v112, v112, v120
  v_sub_f32 v113, v113, v120
  v_sub_f32 v114, v114, v120
  v_sub_f32 v115, v115, v120
  v_sub_f32 v116, v116, v120
  v_sub_f32 v117, v117, v120
  v_sub_f32 v118, v118, v120
  v_sub_f32 v119, v119, v120
  v_mul_f32 v124, v104, v104
  v_mul_f32 v125, v105, v105
  v_mul_f32 v126, v106, v106
  v_mul_f32 v127, v107, v107
  v_fmac_f32 v124, v108, v108
  v_fmac_f32 v125, v109, v109
  v_fmac_f32 v126, v110, v110
  v_fmac_f32 v127, v111, v111
  v_fmac_f32 v124, v112, v112
  v_fmac_f32 v125, v113, v113
  v_fmac_f32 v126, v114, v114
  v_fmac_f32 v127, v115, v115
  v_fmac_f32 v124, v116, v116
  v_fmac_f32 v125, v117, v117
  v_fmac_f32 v126, v118, v118
  v_fmac_f32 v127, v119, v119
  v_add_f32 v124, v124, v125
  v_add_f32 v126, v126, v127
  v_add_f32 v124, v124, v126
  s_nop 1
  v_add_f32_dpp v124, v124, v124 row_ror:8 row_mask:0xf bank_mask:0xf
  s_nop 1
  v_add_f32_dpp v124, v124, v124 row_ror:4 row_mask:0xf bank_mask:0xf
  s_nop 1
  v_add_f32_dpp v124, v124, v124 row_ror:2 row_mask:0xf bank_mask:0xf
  s_nop 1
  v_add_f32_dpp v124, v124, v124 row_ror:1 row_mask:0xf bank_mask:0xf
  v_mov_b32 v125, v124
  s_nop 1
  v_permlane16_swap_b32 v124, v125
  v_add_f32 v124, v124, v125
  v_mov_b32 v125, v124
  s_nop 1
  v_permlane32_swap_b32 v124, v125
  v_add_f32 v124, v124, v125
  v_mov_b32 v122, 0x3727c5ac
  v_fmac_f32 v122, 0x3a800000, v124
  v_rsq_f32 v121, v122
  v_mov_b32 v123, 0
  s_mov_b32 s16, s6
  s_mov_b32 s17, s7
  s_mov_b32 s18, 32768
  s_mov_b32 s19, 0x20000
  s_lshl_b32 s14, s2, 3
  s_add_u32 s14, s14, s76
  s_lshl_b32 s14, s14, 4
  v_mov_b32 v2, s14
  v_cmp_eq_u32 vcc, 0, v0
  s_and_saveexec_b64 s[20:21], vcc
  buffer_store_dwordx4 v[120:123], v2, s[16:19], 0 offen sc1
  s_mov_b64 exec, s[20:21]
  v_mov_b32 v84, 0
  v_mov_b32 v85, 0
  v_mov_b32 v86, 0
  v_mov_b32 v87, 0
  v_mov_b32 v88, 0
  v_mov_b32 v89, 0
  v_mov_b32 v90, 0
  v_mov_b32 v91, 0
  v_mov_b32 v92, 0
  v_mov_b32 v93, 0
  v_mov_b32 v94, 0
  v_mov_b32 v95, 0
  v_mov_b32 v96, 0
  v_mov_b32 v97, 0
  v_mov_b32 v98, 0
  v_mov_b32 v99, 0
  v_mov_b32 v100, 0
  v_mov_b32 v101, 0
  v_mov_b32 v102, 0
  v_mov_b32 v103, 0
  v_mov_b32 v104, 0
  v_mov_b32 v105, 0
  v_mov_b32 v106, 0
  v_mov_b32 v107, 0
  v_mov_b32 v108, 0
  v_mov_b32 v109, 0
  v_mov_b32 v110, 0
  v_mov_b32 v111, 0
  v_mov_b32 v112, 0
  v_mov_b32 v113, 0
  v_mov_b32 v114, 0
  v_mov_b32 v115, 0
  v_mov_b32 v116, 0
  v_mov_b32 v117, 0
  v_mov_b32 v118, 0
  v_mov_b32 v119, 0
  v_mov_b32 v120, 0
  v_mov_b32 v121, 0
  v_mov_b32 v122, 0
  v_mov_b32 v123, 0
  v_mov_b32 v124, 0
  v_mov_b32 v125, 0
  v_mov_b32 v126, 0
  v_mov_b32 v127, 0
  v_mov_b32 v128, 0
  v_mov_b32 v129, 0
  v_mov_b32 v130, 0
  v_mov_b32 v131, 0
  v_mov_b32 v132, 0
  v_mov_b32 v133, 0
  v_mov_b32 v134, 0
  v_mov_b32 v135, 0
  v_mov_b32 v136, 0
  v_mov_b32 v137, 0
  v_mov_b32 v138, 0
  v_mov_b32 v139, 0
  v_mov_b32 v140, 0
  v_mov_b32 v141, 0
  v_mov_b32 v142, 0
  v_mov_b32 v143, 0
  v_mov_b32 v144, 0
  v_mov_b32 v145, 0
  v_mov_b32 v146, 0
  v_mov_b32 v147, 0
  v_mov_b32 v148, 0
  v_mov_b32 v149, 0
  v_mov_b32 v150, 0
  v_mov_b32 v151, 0
  v_mov_b32 v152, 0
  v_mov_b32 v153, 0
  v_mov_b32 v154, 0
  v_mov_b32 v155, 0
  v_mov_b32 v156, 0
  v_mov_b32 v157, 0
  v_mov_b32 v158, 0
  v_mov_b32 v159, 0
  v_mov_b32 v160, 0
  v_mov_b32 v161, 0
  v_mov_b32 v162, 0
  v_mov_b32 v163, 0
  v_mov_b32 v164, 0
  v_mov_b32 v165, 0
  v_mov_b32 v166, 0
  v_mov_b32 v167, 0
  v_mov_b32 v168, 0
  v_mov_b32 v169, 0
  v_mov_b32 v170, 0
  v_mov_b32 v171, 0
  v_mov_b32 v172, 0
  v_mov_b32 v173, 0
  v_mov_b32 v174, 0
  v_mov_b32 v175, 0
  v_mov_b32 v176, 0
  v_mov_b32 v177, 0
  v_mov_b32 v178, 0
  v_mov_b32 v179, 0
  v_mov_b32 v180, 0
  v_mov_b32 v181, 0
  v_mov_b32 v182, 0
  v_mov_b32 v183, 0
  v_mov_b32 v184, 0
  v_mov_b32 v185, 0
  v_mov_b32 v186, 0
  v_mov_b32 v187, 0
  v_mov_b32 v188, 0
  v_mov_b32 v189, 0
  v_mov_b32 v190, 0
  v_mov_b32 v191, 0
  v_mov_b32 v192, 0
  v_mov_b32 v193, 0
  v_mov_b32 v194, 0
  v_mov_b32 v195, 0
  v_mov_b32 v196, 0
  v_mov_b32 v197, 0
  v_mov_b32 v198, 0
  v_mov_b32 v199, 0
  v_mov_b32 v200, 0
  v_mov_b32 v201, 0
  v_mov_b32 v202, 0
  v_mov_b32 v203, 0
  v_mov_b32 v204, 0
  v_mov_b32 v205, 0
  v_mov_b32 v206, 0
  v_mov_b32 v207, 0
  v_mov_b32 v208, 0
  v_mov_b32 v209, 0
  v_mov_b32 v210, 0
  v_mov_b32 v211, 0
  v_mov_b32 v212, 0
  v_mov_b32 v213, 0
  v_mov_b32 v214, 0
  v_mov_b32 v215, 0
  v_mov_b32 v216, 0
  v_mov_b32 v217, 0
  v_mov_b32 v218, 0
  v_mov_b32 v219, 0
  v_mov_b32 v220, 0
  v_mov_b32 v221, 0
  v_mov_b32 v222, 0
  v_mov_b32 v223, 0
  v_mov_b32 v224, 0
  v_mov_b32 v225, 0
  v_mov_b32 v226, 0
  v_mov_b32 v227, 0
  v_mov_b32 v228, 0
  v_mov_b32 v229, 0
  v_mov_b32 v230, 0
  v_mov_b32 v231, 0
  v_mov_b32 v232, 0
  v_mov_b32 v233, 0
  v_mov_b32 v234, 0
  v_mov_b32 v235, 0
  v_mov_b32 v236, 0
  v_mov_b32 v237, 0
  v_mov_b32 v238, 0
  v_mov_b32 v239, 0
  v_mov_b32 v240, 0
  v_mov_b32 v241, 0
  v_mov_b32 v242, 0
  v_mov_b32 v243, 0
  v_mov_b32 v244, 0
  v_mov_b32 v245, 0
  v_mov_b32 v246, 0
  v_mov_b32 v247, 0
  v_mov_b32 v248, 0
  v_mov_b32 v249, 0
  v_mov_b32 v250, 0
  v_mov_b32 v251, 0
  v_mov_b32 v252, 0
  v_mov_b32 v253, 0
  v_mov_b32 v254, 0
  v_mov_b32 v255, 0
  s_waitcnt vmcnt(12)
  s_barrier
  .p2align 3
  s_add_u32 m0, s70, 61440
  s_nop 0
  buffer_load_dwordx4 v68, s[40:43], s60 offen lds
  ds_read_b128 v[8:11], v73 offset:0
  ds_read_b128 v[12:15], v73 offset:2048
  ds_read_b128 v[16:19], v73 offset:4096
  ds_read_b128 v[20:23], v73 offset:6144
  ds_read_b128 v[24:27], v75 offset:0
  ds_read_b64_tr_b16 v[28:29], v77 offset:0
  s_add_u32 s60, s60, s65
  s_add_u32 m0, s71, 61440
  s_nop 0
  buffer_load_dwordx4 v69, s[44:47], s61 offen lds
  ds_read_b64_tr_b16 v[30:31], v77 offset:3072
  ds_read_b64_tr_b16 v[32:33], v79 offset:32
  ds_read_b64_tr_b16 v[34:35], v79 offset:3104
  ds_read_b64_tr_b16 v[36:37], v77 offset:64
  ds_read_b64_tr_b16 v[38:39], v77 offset:3136
  s_add_u32 s61, s61, s66
  s_add_u32 m0, s72, 61440
  s_nop 0
  buffer_load_dwordx4 v70, s[48:51], s62 offen lds
  ds_read_b64_tr_b16 v[40:41], v79 offset:96
  ds_read_b64_tr_b16 v[42:43], v79 offset:3168
  ds_read_b64_tr_b16 v[44:45], v77 offset:128
  ds_read_b64_tr_b16 v[46:47], v77 offset:3200
  ds_read_b64_tr_b16 v[48:49], v79 offset:160
  ds_read_b64_tr_b16 v[50:51], v79 offset:3232
  s_add_u32 s62, s62, s67
  s_add_u32 m0, s73, 61440
  s_nop 0
  buffer_load_dwordx4 v71, s[52:55], s63 offen lds
  ds_read_b64_tr_b16 v[52:53], v81 offset:0
  ds_read_b64_tr_b16 v[54:55], v81 offset:3584
  ds_read_b64_tr_b16 v[56:57], v81 offset:32
  ds_read_b64_tr_b16 v[58:59], v81 offset:3616
  ds_read_b64_tr_b16 v[60:61], v81 offset:7168
  s_add_u32 s63, s63, s68
  s_add_u32 m0, s74, 61440
  s_nop 0
  buffer_load_dwordx4 v72, s[56:59], s64 offen lds
  s_add_u32 s64, s64, s69
  ds_read_b64_tr_b16 v[62:63], v81 offset:10752
  ds_read_b64_tr_b16 v[64:65], v81 offset:7200
  ds_read_b64_tr_b16 v[66:67], v81 offset:10784
  v_add_u32 v1, s38, v81
  ds_read_b64_tr_b16 v[88:89], v1 offset:0
  ds_read_b64_tr_b16 v[90:91], v1 offset:3584
  s_waitcnt lgkmcnt(0)
  s_barrier
  s_mov_b32 s75, 7
  .p2align 6
L_X2_loop:
  .p2align 3
  v_mfma_f32_16x16x32_bf16 v[92:95], v[24:27], v[44:47], v[92:95]
  v_mfma_f32_16x16x32_bf16 v[128:131], v[36:39], v[8:11], v[128:131]
  v_mfma_f32_16x16x32_bf16 v[132:135], v[36:39], v[12:15], v[132:135]
  v_mfma_f32_16x16x32_bf16 v[136:139], v[36:39], v[16:19], v[136:139]
  v_mfma_f32_16x16x32_bf16 v[140:143], v[36:39], v[20:23], v[140:143]
  v_mfma_f32_16x16x32_bf16 v[144:147], v[40:43], v[8:11], v[144:147]
  v_mfma_f32_16x16x32_bf16 v[148:151], v[40:43], v[12:15], v[148:151]
  v_mfma_f32_16x16x32_bf16 v[152:155], v[40:43], v[16:19], v[152:155]
  v_mfma_f32_16x16x32_bf16 v[156:159], v[40:43], v[20:23], v[156:159]
  v_mfma_f32_16x16x32_bf16 v[160:163], v[8:11], v[44:47], v[160:163]
  v_mfma_f32_16x16x32_bf16 v[164:167], v[12:15], v[44:47], v[164:167]
  v_mfma_f32_16x16x32_bf16 v[168:171], v[16:19], v[44:47], v[168:171]
  v_mfma_f32_16x16x32_bf16 v[172:175], v[20:23], v[44:47], v[172:175]
  v_mfma_f32_16x16x32_bf16 v[176:179], v[8:11], v[48:51], v[176:179]
  v_mfma_f32_16x16x32_bf16 v[180:183], v[12:15], v[48:51], v[180:183]
  v_mfma_f32_16x16x32_bf16 v[184:187], v[16:19], v[48:51], v[184:187]
  v_mfma_f32_16x16x32_bf16 v[188:191], v[20:23], v[48:51], v[188:191]
  v_mfma_f32_16x16x32_bf16 v[96:99], v[28:31], v[8:11], v[96:99]
  v_mfma_f32_16x16x32_bf16 v[100:103], v[28:31], v[12:15], v[100:103]
  v_mfma_f32_16x16x32_bf16 v[104:107], v[28:31], v[16:19], v[104:107]
  v_mfma_f32_16x16x32_bf16 v[84:87], v[88:91], v[24:27], v[84:87]
  v_mfma_f32_16x16x32_bf16 v[108:111], v[28:31], v[20:23], v[108:111]
  v_mfma_f32_16x16x32_bf16 v[112:115], v[32:35], v[8:11], v[112:115]
  v_mfma_f32_16x16x32_bf16 v[116:119], v[32:35], v[12:15], v[116:119]
  v_mfma_f32_16x16x32_bf16 v[120:123], v[32:35], v[16:19], v[120:123]
  v_mfma_f32_16x16x32_bf16 v[124:127], v[32:35], v[20:23], v[124:127]
  v_mfma_f32_16x16x32_bf16 v[192:195], v[52:55], v[8:11], v[192:195]
  v_mfma_f32_16x16x32_bf16 v[196:199], v[52:55], v[12:15], v[196:199]
  v_mfma_f32_16x16x32_bf16 v[200:203], v[52:55], v[16:19], v[200:203]
  v_mfma_f32_16x16x32_bf16 v[204:207], v[52:55], v[20:23], v[204:207]
  v_mfma_f32_16x16x32_bf16 v[208:211], v[56:59], v[8:11], v[208:211]
  v_mfma_f32_16x16x32_bf16 v[212:215], v[56:59], v[12:15], v[212:215]
  v_mfma_f32_16x16x32_bf16 v[216:219], v[56:59], v[16:19], v[216:219]
  v_mfma_f32_16x16x32_bf16 v[220:223], v[56:59], v[20:23], v[220:223]
  v_mfma_f32_16x16x32_bf16 v[224:227], v[60:63], v[8:11], v[224:227]
  v_mfma_f32_16x16x32_bf16 v[228:231], v[60:63], v[12:15], v[228:231]
  v_mfma_f32_16x16x32_bf16 v[232:235], v[60:63], v[16:19], v[232:235]
  v_mfma_f32_16x16x32_bf16 v[236:239], v[60:63], v[20:23], v[236:239]
  v_mfma_f32_16x16x32_bf16 v[240:243], v[64:67], v[8:11], v[240:243]
  v_mfma_f32_16x16x32_bf16 v[244:247], v[64:67], v[12:15], v[244:247]
  v_mfma_f32_16x16x32_bf16 v[248:251], v[64:67], v[16:19], v[248:251]
  v_mfma_f32_16x16x32_bf16 v[252:255], v[64:67], v[20:23], v[252:255]
  s_waitcnt vmcnt(11)
  s_barrier
  .p2align 3
  s_add_u32 m0, s70, 0
  s_nop 0
  buffer_load_dwordx4 v68, s[40:43], s60 offen lds
  ds_read_b128 v[8:11], v74 offset:0
  ds_read_b128 v[12:15], v74 offset:2048
  ds_read_b128 v[16:19], v74 offset:4096
  ds_read_b128 v[20:23], v74 offset:6144
  ds_read_b128 v[24:27], v76 offset:0
  ds_read_b64_tr_b16 v[28:29], v77 offset:20480
  s_add_u32 s60, s60, s65
  s_add_u32 m0, s71, 0
  s_nop 0
  buffer_load_dwordx4 v69, s[44:47], s61 offen lds
  ds_read_b64_tr_b16 v[30:31], v77 offset:23552
  ds_read_b64_tr_b16 v[32:33], v79 offset:20512
  ds_read_b64_tr_b16 v[34:35], v79 offset:23584
  ds_read_b64_tr_b16 v[36:37], v77 offset:20544
  ds_read_b64_tr_b16 v[38:39], v77 offset:23616
  s_add_u32 s61, s61, s66
  s_add_u32 m0, s72, 0
  s_nop 0
  buffer_load_dwordx4 v70, s[48:51], s62 offen lds
  ds_read_b64_tr_b16 v[40:41], v79 offset:20576
  ds_read_b64_tr_b16 v[42:43], v79 offset:23648
  ds_read_b64_tr_b16 v[44:45], v77 offset:20608
  ds_read_b64_tr_b16 v[46:47], v77 offset:23680
  ds_read_b64_tr_b16 v[48:49], v79 offset:20640
  ds_read_b64_tr_b16 v[50:51], v79 offset:23712
  s_add_u32 s62, s62, s67
  s_add_u32 m0, s73, 0
  s_nop 0
  buffer_load_dwordx4 v71, s[52:55], s63 offen lds
  ds_read_b64_tr_b16 v[52:53], v81 offset:20480
  ds_read_b64_tr_b16 v[54:55], v81 offset:24064
  ds_read_b64_tr_b16 v[56:57], v81 offset:20512
  ds_read_b64_tr_b16 v[58:59], v81 offset:24096
  ds_read_b64_tr_b16 v[60:61], v81 offset:27648
  s_add_u32 s63, s63, s68
  s_add_u32 m0, s74, 0
  s_nop 0
  buffer_load_dwordx4 v72, s[56:59], s64 offen lds
  s_add_u32 s64, s64, s69
  ds_read_b64_tr_b16 v[62:63], v81 offset:31232
  ds_read_b64_tr_b16 v[64:65], v81 offset:27680
  ds_read_b64_tr_b16 v[66:67], v81 offset:31264
  v_add_u32 v1, s38, v81
  ds_read_b64_tr_b16 v[88:89], v1 offset:20480
  ds_read_b64_tr_b16 v[90:91], v1 offset:24064
  s_sub_u32 s12, s75, 5
  s_cmp_le_u32 s12, 1
  s_cbranch_scc0 L_X2_noclr0
  s_sub_u32 s12, 6, s75
  s_lshl_b32 s12, s12, 14
  v_mov_b32 v2, -1
  v_mov_b32 v3, -1
  v_mov_b32 v4, -1
  v_mov_b32 v5, -1
  v_lshlrev_b32 v1, 4, v0
  buffer_store_dwordx4 v[2:5], v1, s[88:91], s12 offen offset:0 sc1
L_X2_noclr0:
  s_waitcnt lgkmcnt(0)
  s_barrier
  .p2align 3
  v_mfma_f32_16x16x32_bf16 v[92:95], v[24:27], v[44:47], v[92:95]
  v_mfma_f32_16x16x32_bf16 v[128:131], v[36:39], v[8:11], v[128:131]
  v_mfma_f32_16x16x32_bf16 v[132:135], v[36:39], v[12:15], v[132:135]
  v_mfma_f32_16x16x32_bf16 v[136:139], v[36:39], v[16:19], v[136:139]
  v_mfma_f32_16x16x32_bf16 v[140:143], v[36:39], v[20:23], v[140:143]
  v_mfma_f32_16x16x32_bf16 v[144:147], v[40:43], v[8:11], v[144:147]
  v_mfma_f32_16x16x32_bf16 v[148:151], v[40:43], v[12:15], v[148:151]
  v_mfma_f32_16x16x32_bf16 v[152:155], v[40:43], v[16:19], v[152:155]
  v_mfma_f32_16x16x32_bf16 v[156:159], v[40:43], v[20:23], v[156:159]
  v_mfma_f32_16x16x32_bf16 v[160:163], v[8:11], v[44:47], v[160:163]
  v_mfma_f32_16x16x32_bf16 v[164:167], v[12:15], v[44:47], v[164:167]
  v_mfma_f32_16x16x32_bf16 v[168:171], v[16:19], v[44:47], v[168:171]
  v_mfma_f32_16x16x32_bf16 v[172:175], v[20:23], v[44:47], v[172:175]
  v_mfma_f32_16x16x32_bf16 v[176:179], v[8:11], v[48:51], v[176:179]
  v_mfma_f32_16x16x32_bf16 v[180:183], v[12:15], v[48:51], v[180:183]
  v_mfma_f32_16x16x32_bf16 v[184:187], v[16:19], v[48:51], v[184:187]
  v_mfma_f32_16x16x32_bf16 v[188:191], v[20:23], v[48:51], v[188:191]
  v_mfma_f32_16x16x32_bf16 v[96:99], v[28:31], v[8:11], v[96:99]
  v_mfma_f32_16x16x32_bf16 v[100:103], v[28:31], v[12:15], v[100:103]
  v_mfma_f32_16x16x32_bf16 v[104:107], v[28:31], v[16:19], v[104:107]
  v_mfma_f32_16x16x32_bf16 v[84:87], v[88:91], v[24:27], v[84:87]
  v_mfma_f32_16x16x32_bf16 v[108:111], v[28:31], v[20:23], v[108:111]
  v_mfma_f32_16x16x32_bf16 v[112:115], v[32:35], v[8:11], v[112:115]
  v_mfma_f32_16x16x32_bf16 v[116:119], v[32:35], v[12:15], v[116:119]
  v_mfma_f32_16x16x32_bf16 v[120:123], v[32:35], v[16:19], v[120:123]
  v_mfma_f32_16x16x32_bf16 v[124:127], v[32:35], v[20:23], v[124:127]
  v_mfma_f32_16x16x32_bf16 v[192:195], v[52:55], v[8:11], v[192:195]
  v_mfma_f32_16x16x32_bf16 v[196:199], v[52:55], v[12:15], v[196:199]
  v_mfma_f32_16x16x32_bf16 v[200:203], v[52:55], v[16:19], v[200:203]
  v_mfma_f32_16x16x32_bf16 v[204:207], v[52:55], v[20:23], v[204:207]
  v_mfma_f32_16x16x32_bf16 v[208:211], v[56:59], v[8:11], v[208:211]
  v_mfma_f32_16x16x32_bf16 v[212:215], v[56:59], v[12:15], v[212:215]
  v_mfma_f32_16x16x32_bf16 v[216:219], v[56:59], v[16:19], v[216:219]
  v_mfma_f32_16x16x32_bf16 v[220:223], v[56:59], v[20:23], v[220:223]
  v_mfma_f32_16x16x32_bf16 v[224:227], v[60:63], v[8:11], v[224:227]
  v_mfma_f32_16x16x32_bf16 v[228:231], v[60:63], v[12:15], v[228:231]
  v_mfma_f32_16x16x32_bf16 v[232:235], v[60:63], v[16:19], v[232:235]
  v_mfma_f32_16x16x32_bf16 v[236:239], v[60:63], v[20:23], v[236:239]
  v_mfma_f32_16x16x32_bf16 v[240:243], v[64:67], v[8:11], v[240:243]
  v_mfma_f32_16x16x32_bf16 v[244:247], v[64:67], v[12:15], v[244:247]
  v_mfma_f32_16x16x32_bf16 v[248:251], v[64:67], v[16:19], v[248:251]
  v_mfma_f32_16x16x32_bf16 v[252:255], v[64:67], v[20:23], v[252:255]
  s_waitcnt vmcnt(11)
  s_barrier
  .p2align 3
  s_add_u32 m0, s70, 20480
  s_nop 0
  buffer_load_dwordx4 v68, s[40:43], s60 offen lds
  ds_read_b128 v[8:11], v73 offset:34816
  ds_read_b128 v[12:15], v73 offset:36864
  ds_read_b128 v[16:19], v73 offset:38912
  ds_read_b128 v[20:23], v73 offset:40960
  ds_read_b128 v[24:27], v75 offset:34816
  ds_read_b64_tr_b16 v[28:29], v78 offset:0
  s_add_u32 s60, s60, s65
  s_add_u32 m0, s71, 20480
  s_nop 0
  buffer_load_dwordx4 v69, s[44:47], s61 offen lds
  ds_read_b64_tr_b16 v[30:31], v78 offset:3072
  ds_read_b64_tr_b16 v[32:33], v80 offset:32
  ds_read_b64_tr_b16 v[34:35], v80 offset:3104
  ds_read_b64_tr_b16 v[36:37], v78 offset:64
  ds_read_b64_tr_b16 v[38:39], v78 offset:3136
  s_add_u32 s61, s61, s66
  s_add_u32 m0, s72, 20480
  s_nop 0
  buffer_load_dwordx4 v70, s[48:51], s62 offen lds
  ds_read_b64_tr_b16 v[40:41], v80 offset:96
  ds_read_b64_tr_b16 v[42:43], v80 offset:3168
  ds_read_b64_tr_b16 v[44:45], v78 offset:128
  ds_read_b64_tr_b16 v[46:47], v78 offset:3200
  ds_read_b64_tr_b16 v[48:49], v80 offset:160
  ds_read_b64_tr_b16 v[50:51], v80 offset:3232
  s_add_u32 s62, s62, s67
  s_add_u32 m0, s73, 20480
  s_nop 0
  buffer_load_dwordx4 v71, s[52:55], s63 offen lds
  ds_read_b64_tr_b16 v[52:53], v82 offset:0
  ds_read_b64_tr_b16 v[54:55], v82 offset:3584
  ds_read_b64_tr_b16 v[56:57], v82 offset:32
  ds_read_b64_tr_b16 v[58:59], v82 offset:3616
  ds_read_b64_tr_b16 v[60:61], v82 offset:7168
  s_add_u32 s63, s63, s68
  s_add_u32 m0, s74, 20480
  s_nop 0
  buffer_load_dwordx4 v72, s[56:59], s64 offen lds
  s_add_u32 s64, s64, s69
  ds_read_b64_tr_b16 v[62:63], v82 offset:10752
  ds_read_b64_tr_b16 v[64:65], v82 offset:7200
  ds_read_b64_tr_b16 v[66:67], v82 offset:10784
  v_add_u32 v1, s38, v82
  ds_read_b64_tr_b16 v[88:89], v1 offset:0
  ds_read_b64_tr_b16 v[90:91], v1 offset:3584
  s_cmp_eq_u32 s75, 6
  s_cbranch_scc0 L_X2_nocs
  s_mov_b32 s12, s79
  s_lshl_b32 s13, s78, 4
  s_add_u32 s13, s13, s12
  s_lshl_b32 s13, s13, 6
  s_add_u32 s13, s13, 1048576
  s_add_u32 s16, s6, s13
  s_addc_u32 s17, s7, 0
  s_mov_b32 s18, 64
  s_mov_b32 s19, 0x20000
  v_lshlrev_b32 v1, 2, v0
  v_mov_b32 v2, -1
  buffer_store_dword v2, v1, s[16:19], 0 offen sc1
L_X2_nocs:
  s_sub_u32 s12, s75, 5
  s_cmp_le_u32 s12, 1
  s_cbranch_scc0 L_X2_noclr1
  s_sub_u32 s12, 6, s75
  s_lshl_b32 s12, s12, 14
  v_lshlrev_b32 v1, 4, v0
  buffer_store_dwordx4 v[2:5], v1, s[88:91], s12 offen offset:1024 sc1
L_X2_noclr1:
  s_waitcnt lgkmcnt(0)
  s_barrier
  .p2align 3
  v_mfma_f32_16x16x32_bf16 v[92:95], v[24:27], v[44:47], v[92:95]
  v_mfma_f32_16x16x32_bf16 v[128:131], v[36:39], v[8:11], v[128:131]
  v_mfma_f32_16x16x32_bf16 v[132:135], v[36:39], v[12:15], v[132:135]
  v_mfma_f32_16x16x32_bf16 v[136:139], v[36:39], v[16:19], v[136:139]
  v_mfma_f32_16x16x32_bf16 v[140:143], v[36:39], v[20:23], v[140:143]
  v_mfma_f32_16x16x32_bf16 v[144:147], v[40:43], v[8:11], v[144:147]
  v_mfma_f32_16x16x32_bf16 v[148:151], v[40:43], v[12:15], v[148:151]
  v_mfma_f32_16x16x32_bf16 v[152:155], v[40:43], v[16:19], v[152:155]
  v_mfma_f32_16x16x32_bf16 v[156:159], v[40:43], v[20:23], v[156:159]
  v_mfma_f32_16x16x32_bf16 v[160:163], v[8:11], v[44:47], v[160:163]
  v_mfma_f32_16x16x32_bf16 v[164:167], v[12:15], v[44:47], v[164:167]
  v_mfma_f32_16x16x32_bf16 v[168:171], v[16:19], v[44:47], v[168:171]
  v_mfma_f32_16x16x32_bf16 v[172:175], v[20:23], v[44:47], v[172:175]
  v_mfma_f32_16x16x32_bf16 v[176:179], v[8:11], v[48:51], v[176:179]
  v_mfma_f32_16x16x32_bf16 v[180:183], v[12:15], v[48:51], v[180:183]
  v_mfma_f32_16x16x32_bf16 v[184:187], v[16:19], v[48:51], v[184:187]
  v_mfma_f32_16x16x32_bf16 v[188:191], v[20:23], v[48:51], v[188:191]
  v_mfma_f32_16x16x32_bf16 v[96:99], v[28:31], v[8:11], v[96:99]
  v_mfma_f32_16x16x32_bf16 v[100:103], v[28:31], v[12:15], v[100:103]
  v_mfma_f32_16x16x32_bf16 v[104:107], v[28:31], v[16:19], v[104:107]
  v_mfma_f32_16x16x32_bf16 v[84:87], v[88:91], v[24:27], v[84:87]
  v_mfma_f32_16x16x32_bf16 v[108:111], v[28:31], v[20:23], v[108:111]
  v_mfma_f32_16x16x32_bf16 v[112:115], v[32:35], v[8:11], v[112:115]
  v_mfma_f32_16x16x32_bf16 v[116:119], v[32:35], v[12:15], v[116:119]
  v_mfma_f32_16x16x32_bf16 v[120:123], v[32:35], v[16:19], v[120:123]
  v_mfma_f32_16x16x32_bf16 v[124:127], v[32:35], v[20:23], v[124:127]
  v_mfma_f32_16x16x32_bf16 v[192:195], v[52:55], v[8:11], v[192:195]
  v_mfma_f32_16x16x32_bf16 v[196:199], v[52:55], v[12:15], v[196:199]
  v_mfma_f32_16x16x32_bf16 v[200:203], v[52:55], v[16:19], v[200:203]
  v_mfma_f32_16x16x32_bf16 v[204:207], v[52:55], v[20:23], v[204:207]
  v_mfma_f32_16x16x32_bf16 v[208:211], v[56:59], v[8:11], v[208:211]
  v_mfma_f32_16x16x32_bf16 v[212:215], v[56:59], v[12:15], v[212:215]
  v_mfma_f32_16x16x32_bf16 v[216:219], v[56:59], v[16:19], v[216:219]
  v_mfma_f32_16x16x32_bf16 v[220:223], v[56:59], v[20:23], v[220:223]
  v_mfma_f32_16x16x32_bf16 v[224:227], v[60:63], v[8:11], v[224:227]
  v_mfma_f32_16x16x32_bf16 v[228:231], v[60:63], v[12:15], v[228:231]
  v_mfma_f32_16x16x32_bf16 v[232:235], v[60:63], v[16:19], v[232:235]
  v_mfma_f32_16x16x32_bf16 v[236:239], v[60:63], v[20:23], v[236:239]
  v_mfma_f32_16x16x32_bf16 v[240:243], v[64:67], v[8:11], v[240:243]
  v_mfma_f32_16x16x32_bf16 v[244:247], v[64:67], v[12:15], v[244:247]
  v_mfma_f32_16x16x32_bf16 v[248:251], v[64:67], v[16:19], v[248:251]
  v_mfma_f32_16x16x32_bf16 v[252:255], v[64:67], v[20:23], v[252:255]
  s_waitcnt vmcnt(10)
  s_barrier
  .p2align 3
  s_add_u32 m0, s70, 40960
  s_nop 0
  buffer_load_dwordx4 v68, s[40:43], s60 offen lds
  ds_read_b128 v[8:11], v74 offset:34816
  ds_read_b128 v[12:15], v74 offset:36864
  ds_read_b128 v[16:19], v74 offset:38912
  ds_read_b128 v[20:23], v74 offset:40960
  ds_read_b128 v[24:27], v76 offset:34816
  s_add_u32 s60, s60, s65
  s_add_u32 m0, s71, 40960
  s_nop 0
  buffer_load_dwordx4 v69, s[44:47], s61 offen lds
  ds_read_b64_tr_b16 v[28:29], v78 offset:20480
  ds_read_b64_tr_b16 v[30:31], v78 offset:23552
  ds_read_b64_tr_b16 v[32:33], v80 offset:20512
  ds_read_b64_tr_b16 v[34:35], v80 offset:23584
  s_add_u32 s61, s61, s66
  s_add_u32 m0, s72, 40960
  s_nop 0
  buffer_load_dwordx4 v70, s[48:51], s62 offen lds
  ds_read_b64_tr_b16 v[36:37], v78 offset:20544
  ds_read_b64_tr_b16 v[38:39], v78 offset:23616
  ds_read_b64_tr_b16 v[40:41], v80 offset:20576
  ds_read_b64_tr_b16 v[42:43], v80 offset:23648
  ds_read_b64_tr_b16 v[44:45], v78 offset:20608
  s_add_u32 s62, s62, s67
  s_add_u32 m0, s73, 40960
  s_nop 0
  buffer_load_dwordx4 v71, s[52:55], s63 offen lds
  ds_read_b64_tr_b16 v[46:47], v78 offset:23680
  ds_read_b64_tr_b16 v[48:49], v80 offset:20640
  ds_read_b64_tr_b16 v[50:51], v80 offset:23712
  ds_read_b64_tr_b16 v[52:53], v82 offset:20480
  ds_read_b64_tr_b16 v[54:55], v82 offset:24064
  s_add_u32 s63, s63, s68
  s_add_u32 m0, s74, 40960
  s_nop 0
  buffer_load_dwordx4 v72, s[56:59], s64 offen lds
  s_add_u32 s64, s64, s69
  ds_read_b64_tr_b16 v[56:57], v82 offset:20512
  ds_read_b64_tr_b16 v[58:59], v82 offset:24096
  ds_read_b64_tr_b16 v[60:61], v82 offset:27648
  ds_read_b64_tr_b16 v[62:63], v82 offset:31232
  s_cmp_eq_u32 s75, 1
  s_cbranch_scc1 L_cpf2
  buffer_load_dword v6, v83, s[24:27], s28 offen
  s_add_u32 s28, s28, 256
  s_branch L_cpf2_d
L_cpf2:
  s_mul_i32 s16, s2, 28672
  s_add_u32 s16, s84, s16
  s_addc_u32 s17, s85, 0
  s_mov_b32 s18, 28672
  s_mov_b32 s19, 0x20000
  s_mov_b32 s20, 16384
  v_lshlrev_b32 v2, 7, v0
  buffer_load_dword v6, v2, s[16:19], s20 offen
L_cpf2_d:
  ds_read_b64_tr_b16 v[64:65], v82 offset:27680
  ds_read_b64_tr_b16 v[66:67], v82 offset:31264
  v_add_u32 v1, s38, v82
  ds_read_b64_tr_b16 v[88:89], v1 offset:20480
  ds_read_b64_tr_b16 v[90:91], v1 offset:24064
  s_sub_u32 s12, s75, 5
  s_cmp_le_u32 s12, 1
  s_cbranch_scc0 L_X2_noclr2
  s_sub_u32 s12, 6, s75
  s_lshl_b32 s12, s12, 14
  v_lshlrev_b32 v1, 4, v0
  buffer_store_dwordx4 v[2:5], v1, s[88:91], s12 offen offset:2048 sc1
L_X2_noclr2:
  s_waitcnt lgkmcnt(0)
  s_barrier
  .p2align 3
  v_mfma_f32_16x16x32_bf16 v[92:95], v[24:27], v[44:47], v[92:95]
  v_mfma_f32_16x16x32_bf16 v[128:131], v[36:39], v[8:11], v[128:131]
  v_mfma_f32_16x16x32_bf16 v[132:135], v[36:39], v[12:15], v[132:135]
  v_mfma_f32_16x16x32_bf16 v[136:139], v[36:39], v[16:19], v[136:139]
  v_mfma_f32_16x16x32_bf16 v[140:143], v[36:39], v[20:23], v[140:143]
  v_mfma_f32_16x16x32_bf16 v[144:147], v[40:43], v[8:11], v[144:147]
  v_mfma_f32_16x16x32_bf16 v[148:151], v[40:43], v[12:15], v[148:151]
  v_mfma_f32_16x16x32_bf16 v[152:155], v[40:43], v[16:19], v[152:155]
  v_mfma_f32_16x16x32_bf16 v[156:159], v[40:43], v[20:23], v[156:159]
  v_mfma_f32_16x16x32_bf16 v[160:163], v[8:11], v[44:47], v[160:163]
  v_mfma_f32_16x16x32_bf16 v[164:167], v[12:15], v[44:47], v[164:167]
  v_mfma_f32_16x16x32_bf16 v[168:171], v[16:19], v[44:47], v[168:171]
  v_mfma_f32_16x16x32_bf16 v[172:175], v[20:23], v[44:47], v[172:175]
  v_mfma_f32_16x16x32_bf16 v[176:179], v[8:11], v[48:51], v[176:179]
  v_mfma_f32_16x16x32_bf16 v[180:183], v[12:15], v[48:51], v[180:183]
  v_mfma_f32_16x16x32_bf16 v[184:187], v[16:19], v[48:51], v[184:187]
  v_mfma_f32_16x16x32_bf16 v[188:191], v[20:23], v[48:51], v[188:191]
  v_mfma_f32_16x16x32_bf16 v[96:99], v[28:31], v[8:11], v[96:99]
  v_mfma_f32_16x16x32_bf16 v[100:103], v[28:31], v[12:15], v[100:103]
  v_mfma_f32_16x16x32_bf16 v[104:107], v[28:31], v[16:19], v[104:107]
  v_mfma_f32_16x16x32_bf16 v[84:87], v[88:91], v[24:27], v[84:87]
  v_mfma_f32_16x16x32_bf16 v[108:111], v[28:31], v[20:23], v[108:111]
  v_mfma_f32_16x16x32_bf16 v[112:115], v[32:35], v[8:11], v[112:115]
  v_mfma_f32_16x16x32_bf16 v[116:119], v[32:35], v[12:15], v[116:119]
  v_mfma_f32_16x16x32_bf16 v[120:123], v[32:35], v[16:19], v[120:123]
  v_mfma_f32_16x16x32_bf16 v[124:127], v[32:35], v[20:23], v[124:127]
  v_mfma_f32_16x16x32_bf16 v[192:195], v[52:55], v[8:11], v[192:195]
  v_mfma_f32_16x16x32_bf16 v[196:199], v[52:55], v[12:15], v[196:199]
  v_mfma_f32_16x16x32_bf16 v[200:203], v[52:55], v[16:19], v[200:203]
  v_mfma_f32_16x16x32_bf16 v[204:207], v[52:55], v[20:23], v[204:207]
  v_mfma_f32_16x16x32_bf16 v[208:211], v[56:59], v[8:11], v[208:211]
  v_mfma_f32_16x16x32_bf16 v[212:215], v[56:59], v[12:15], v[212:215]
  v_mfma_f32_16x16x32_bf16 v[216:219], v[56:59], v[16:19], v[216:219]
  v_mfma_f32_16x16x32_bf16 v[220:223], v[56:59], v[20:23], v[220:223]
  v_mfma_f32_16x16x32_bf16 v[224:227], v[60:63], v[8:11], v[224:227]
  v_mfma_f32_16x16x32_bf16 v[228:231], v[60:63], v[12:15], v[228:231]
  v_mfma_f32_16x16x32_bf16 v[232:235], v[60:63], v[16:19], v[232:235]
  v_mfma_f32_16x16x32_bf16 v[236:239], v[60:63], v[20:23], v[236:239]
  v_mfma_f32_16x16x32_bf16 v[240:243], v[64:67], v[8:11], v[240:243]
  v_mfma_f32_16x16x32_bf16 v[244:247], v[64:67], v[12:15], v[244:247]
  v_mfma_f32_16x16x32_bf16 v[248:251], v[64:67], v[16:19], v[248:251]
  v_mfma_f32_16x16x32_bf16 v[252:255], v[64:67], v[20:23], v[252:255]
  s_waitcnt vmcnt(11)
  s_barrier
  .p2align 3
  s_add_u32 m0, s70, 61440
  s_nop 0
  buffer_load_dwordx4 v68, s[40:43], s60 offen lds
  ds_read_b128 v[8:11], v73 offset:0
  ds_read_b128 v[12:15], v73 offset:2048
  ds_read_b128 v[16:19], v73 offset:4096
  ds_read_b128 v[20:23], v73 offset:6144
  ds_read_b128 v[24:27], v75 offset:0
  ds_read_b64_tr_b16 v[28:29], v77 offset:0
  s_add_u32 s60, s60, s65
  s_add_u32 m0, s71, 61440
  s_nop 0
  buffer_load_dwordx4 v69, s[44:47], s61 offen lds
  ds_read_b64_tr_b16 v[30:31], v77 offset:3072
  ds_read_b64_tr_b16 v[32:33], v79 offset:32
  ds_read_b64_tr_b16 v[34:35], v79 offset:3104
  ds_read_b64_tr_b16 v[36:37], v77 offset:64
  ds_read_b64_tr_b16 v[38:39], v77 offset:3136
  s_add_u32 s61, s61, s66
  s_add_u32 m0, s72, 61440
  s_nop 0
  buffer_load_dwordx4 v70, s[48:51], s62 offen lds
  ds_read_b64_tr_b16 v[40:41], v79 offset:96
  ds_read_b64_tr_b16 v[42:43], v79 offset:3168
  ds_read_b64_tr_b16 v[44:45], v77 offset:128
  ds_read_b64_tr_b16 v[46:47], v77 offset:3200
  ds_read_b64_tr_b16 v[48:49], v79 offset:160
  ds_read_b64_tr_b16 v[50:51], v79 offset:3232
  s_add_u32 s62, s62, s67
  s_add_u32 m0, s73, 61440
  s_nop 0
  buffer_load_dwordx4 v71, s[52:55], s63 offen lds
  ds_read_b64_tr_b16 v[52:53], v81 offset:0
  ds_read_b64_tr_b16 v[54:55], v81 offset:3584
  ds_read_b64_tr_b16 v[56:57], v81 offset:32
  ds_read_b64_tr_b16 v[58:59], v81 offset:3616
  ds_read_b64_tr_b16 v[60:61], v81 offset:7168
  s_add_u32 s63, s63, s68
  s_add_u32 m0, s74, 61440
  s_nop 0
  buffer_load_dwordx4 v72, s[56:59], s64 offen lds
  s_add_u32 s64, s64, s69
  ds_read_b64_tr_b16 v[62:63], v81 offset:10752
  ds_read_b64_tr_b16 v[64:65], v81 offset:7200
  ds_read_b64_tr_b16 v[66:67], v81 offset:10784
  v_add_u32 v1, s38, v81
  ds_read_b64_tr_b16 v[88:89], v1 offset:0
  ds_read_b64_tr_b16 v[90:91], v1 offset:3584
  s_sub_u32 s12, s75, 5
  s_cmp_le_u32 s12, 1
  s_cbranch_scc0 L_X2_noclr3
  s_sub_u32 s12, 6, s75
  s_lshl_b32 s12, s12, 14
  v_lshlrev_b32 v1, 4, v0
  buffer_store_dwordx4 v[2:5], v1, s[88:91], s12 offen offset:3072 sc1
L_X2_noclr3:
  s_waitcnt lgkmcnt(0)
  s_barrier
  s_sub_u32 s75, s75, 1
  s_cmp_lg_u32 s75, 0
  s_cbranch_scc1 L_X2_loop
  s_load_dwordx2 s[24:25], s[0:1], 16
  s_load_dwordx2 s[26:27], s[0:1], 48
  .p2align 3
  v_mfma_f32_16x16x32_bf16 v[92:95], v[24:27], v[44:47], v[92:95]
  v_mfma_f32_16x16x32_bf16 v[128:131], v[36:39], v[8:11], v[128:131]
  v_mfma_f32_16x16x32_bf16 v[132:135], v[36:39], v[12:15], v[132:135]
  v_mfma_f32_16x16x32_bf16 v[136:139], v[36:39], v[16:19], v[136:139]
  v_mfma_f32_16x16x32_bf16 v[140:143], v[36:39], v[20:23], v[140:143]
  v_mfma_f32_16x16x32_bf16 v[144:147], v[40:43], v[8:11], v[144:147]
  v_mfma_f32_16x16x32_bf16 v[148:151], v[40:43], v[12:15], v[148:151]
  v_mfma_f32_16x16x32_bf16 v[152:155], v[40:43], v[16:19], v[152:155]
  v_mfma_f32_16x16x32_bf16 v[156:159], v[40:43], v[20:23], v[156:159]
  v_mfma_f32_16x16x32_bf16 v[160:163], v[8:11], v[44:47], v[160:163]
  v_mfma_f32_16x16x32_bf16 v[164:167], v[12:15], v[44:47], v[164:167]
  v_mfma_f32_16x16x32_bf16 v[168:171], v[16:19], v[44:47], v[168:171]
  v_mfma_f32_16x16x32_bf16 v[172:175], v[20:23], v[44:47], v[172:175]
  v_mfma_f32_16x16x32_bf16 v[176:179], v[8:11], v[48:51], v[176:179]
  v_mfma_f32_16x16x32_bf16 v[180:183], v[12:15], v[48:51], v[180:183]
  v_mfma_f32_16x16x32_bf16 v[184:187], v[16:19], v[48:51], v[184:187]
  v_mfma_f32_16x16x32_bf16 v[188:191], v[20:23], v[48:51], v[188:191]
  v_mfma_f32_16x16x32_bf16 v[96:99], v[28:31], v[8:11], v[96:99]
  v_mfma_f32_16x16x32_bf16 v[100:103], v[28:31], v[12:15], v[100:103]
  v_mfma_f32_16x16x32_bf16 v[104:107], v[28:31], v[16:19], v[104:107]
  v_mfma_f32_16x16x32_bf16 v[84:87], v[88:91], v[24:27], v[84:87]
  v_mfma_f32_16x16x32_bf16 v[108:111], v[28:31], v[20:23], v[108:111]
  v_mfma_f32_16x16x32_bf16 v[112:115], v[32:35], v[8:11], v[112:115]
  v_mfma_f32_16x16x32_bf16 v[116:119], v[32:35], v[12:15], v[116:119]
  v_mfma_f32_16x16x32_bf16 v[120:123], v[32:35], v[16:19], v[120:123]
  v_mfma_f32_16x16x32_bf16 v[124:127], v[32:35], v[20:23], v[124:127]
  v_mfma_f32_16x16x32_bf16 v[192:195], v[52:55], v[8:11], v[192:195]
  v_mfma_f32_16x16x32_bf16 v[196:199], v[52:55], v[12:15], v[196:199]
  v_mfma_f32_16x16x32_bf16 v[200:203], v[52:55], v[16:19], v[200:203]
  v_mfma_f32_16x16x32_bf16 v[204:207], v[52:55], v[20:23], v[204:207]
  v_mfma_f32_16x16x32_bf16 v[208:211], v[56:59], v[8:11], v[208:211]
  v_mfma_f32_16x16x32_bf16 v[212:215], v[56:59], v[12:15], v[212:215]
  v_mfma_f32_16x16x32_bf16 v[216:219], v[56:59], v[16:19], v[216:219]
  v_mfma_f32_16x16x32_bf16 v[220:223], v[56:59], v[20:23], v[220:223]
  v_mfma_f32_16x16x32_bf16 v[224:227], v[60:63], v[8:11], v[224:227]
  v_mfma_f32_16x16x32_bf16 v[228:231], v[60:63], v[12:15], v[228:231]
  v_mfma_f32_16x16x32_bf16 v[232:235], v[60:63], v[16:19], v[232:235]
  v_mfma_f32_16x16x32_bf16 v[236:239], v[60:63], v[20:23], v[236:239]
  v_mfma_f32_16x16x32_bf16 v[240:243], v[64:67], v[8:11], v[240:243]
  v_mfma_f32_16x16x32_bf16 v[244:247], v[64:67], v[12:15], v[244:247]
  v_mfma_f32_16x16x32_bf16 v[248:251], v[64:67], v[16:19], v[248:251]
  v_mfma_f32_16x16x32_bf16 v[252:255], v[64:67], v[20:23], v[252:255]
  s_waitcnt vmcnt(10)
  s_barrier
  ds_read_b128 v[8:11], v74 offset:0
  ds_read_b128 v[12:15], v74 offset:2048
  ds_read_b128 v[16:19], v74 offset:4096
  ds_read_b128 v[20:23], v74 offset:6144
  ds_read_b128 v[24:27], v76 offset:0
  ds_read_b64_tr_b16 v[28:29], v77 offset:20480
  ds_read_b64_tr_b16 v[30:31], v77 offset:23552
  ds_read_b64_tr_b16 v[32:33], v79 offset:20512
  ds_read_b64_tr_b16 v[34:35], v79 offset:23584
  ds_read_b64_tr_b16 v[36:37], v77 offset:20544
  ds_read_b64_tr_b16 v[38:39], v77 offset:23616
  ds_read_b64_tr_b16 v[40:41], v79 offset:20576
  ds_read_b64_tr_b16 v[42:43], v79 offset:23648
  ds_read_b64_tr_b16 v[44:45], v77 offset:20608
  ds_read_b64_tr_b16 v[46:47], v77 offset:23680
  ds_read_b64_tr_b16 v[48:49], v79 offset:20640
  ds_read_b64_tr_b16 v[50:51], v79 offset:23712
  ds_read_b64_tr_b16 v[52:53], v81 offset:20480
  ds_read_b64_tr_b16 v[54:55], v81 offset:24064
  ds_read_b64_tr_b16 v[56:57], v81 offset:20512
  ds_read_b64_tr_b16 v[58:59], v81 offset:24096
  ds_read_b64_tr_b16 v[60:61], v81 offset:27648
  ds_read_b64_tr_b16 v[62:63], v81 offset:31232
  ds_read_b64_tr_b16 v[64:65], v81 offset:27680
  ds_read_b64_tr_b16 v[66:67], v81 offset:31264
  v_add_u32 v1, s38, v81
  ds_read_b64_tr_b16 v[88:89], v1 offset:20480
  ds_read_b64_tr_b16 v[90:91], v1 offset:24064
  s_waitcnt lgkmcnt(0)
  s_barrier
  .p2align 3
  v_mfma_f32_16x16x32_bf16 v[92:95], v[24:27], v[44:47], v[92:95]
  v_mfma_f32_16x16x32_bf16 v[128:131], v[36:39], v[8:11], v[128:131]
  v_mfma_f32_16x16x32_bf16 v[132:135], v[36:39], v[12:15], v[132:135]
  v_mfma_f32_16x16x32_bf16 v[136:139], v[36:39], v[16:19], v[136:139]
  v_mfma_f32_16x16x32_bf16 v[140:143], v[36:39], v[20:23], v[140:143]
  v_mfma_f32_16x16x32_bf16 v[144:147], v[40:43], v[8:11], v[144:147]
  v_mfma_f32_16x16x32_bf16 v[148:151], v[40:43], v[12:15], v[148:151]
  v_mfma_f32_16x16x32_bf16 v[152:155], v[40:43], v[16:19], v[152:155]
  v_mfma_f32_16x16x32_bf16 v[156:159], v[40:43], v[20:23], v[156:159]
  v_mfma_f32_16x16x32_bf16 v[160:163], v[8:11], v[44:47], v[160:163]
  v_mfma_f32_16x16x32_bf16 v[164:167], v[12:15], v[44:47], v[164:167]
  v_mfma_f32_16x16x32_bf16 v[168:171], v[16:19], v[44:47], v[168:171]
  v_mfma_f32_16x16x32_bf16 v[172:175], v[20:23], v[44:47], v[172:175]
  v_mfma_f32_16x16x32_bf16 v[176:179], v[8:11], v[48:51], v[176:179]
  v_mfma_f32_16x16x32_bf16 v[180:183], v[12:15], v[48:51], v[180:183]
  v_mfma_f32_16x16x32_bf16 v[184:187], v[16:19], v[48:51], v[184:187]
  v_mfma_f32_16x16x32_bf16 v[188:191], v[20:23], v[48:51], v[188:191]
  v_mfma_f32_16x16x32_bf16 v[96:99], v[28:31], v[8:11], v[96:99]
  v_mfma_f32_16x16x32_bf16 v[100:103], v[28:31], v[12:15], v[100:103]
  v_mfma_f32_16x16x32_bf16 v[104:107], v[28:31], v[16:19], v[104:107]
  v_mfma_f32_16x16x32_bf16 v[84:87], v[88:91], v[24:27], v[84:87]
  v_mfma_f32_16x16x32_bf16 v[108:111], v[28:31], v[20:23], v[108:111]
  v_mfma_f32_16x16x32_bf16 v[112:115], v[32:35], v[8:11], v[112:115]
  v_mfma_f32_16x16x32_bf16 v[116:119], v[32:35], v[12:15], v[116:119]
  v_mfma_f32_16x16x32_bf16 v[120:123], v[32:35], v[16:19], v[120:123]
  v_mfma_f32_16x16x32_bf16 v[124:127], v[32:35], v[20:23], v[124:127]
  v_mfma_f32_16x16x32_bf16 v[192:195], v[52:55], v[8:11], v[192:195]
  v_mfma_f32_16x16x32_bf16 v[196:199], v[52:55], v[12:15], v[196:199]
  v_mfma_f32_16x16x32_bf16 v[200:203], v[52:55], v[16:19], v[200:203]
  v_mfma_f32_16x16x32_bf16 v[204:207], v[52:55], v[20:23], v[204:207]
  v_mfma_f32_16x16x32_bf16 v[208:211], v[56:59], v[8:11], v[208:211]
  v_mfma_f32_16x16x32_bf16 v[212:215], v[56:59], v[12:15], v[212:215]
  v_mfma_f32_16x16x32_bf16 v[216:219], v[56:59], v[16:19], v[216:219]
  v_mfma_f32_16x16x32_bf16 v[220:223], v[56:59], v[20:23], v[220:223]
  v_mfma_f32_16x16x32_bf16 v[224:227], v[60:63], v[8:11], v[224:227]
  v_mfma_f32_16x16x32_bf16 v[228:231], v[60:63], v[12:15], v[228:231]
  v_mfma_f32_16x16x32_bf16 v[232:235], v[60:63], v[16:19], v[232:235]
  v_mfma_f32_16x16x32_bf16 v[236:239], v[60:63], v[20:23], v[236:239]
  v_mfma_f32_16x16x32_bf16 v[240:243], v[64:67], v[8:11], v[240:243]
  v_mfma_f32_16x16x32_bf16 v[244:247], v[64:67], v[12:15], v[244:247]
  v_mfma_f32_16x16x32_bf16 v[248:251], v[64:67], v[16:19], v[248:251]
  v_mfma_f32_16x16x32_bf16 v[252:255], v[64:67], v[20:23], v[252:255]
  s_waitcnt vmcnt(5)
  s_barrier
  ds_read_b128 v[8:11], v73 offset:34816
  ds_read_b128 v[12:15], v73 offset:36864
  ds_read_b128 v[16:19], v73 offset:38912
  ds_read_b128 v[20:23], v73 offset:40960
  ds_read_b128 v[24:27], v75 offset:34816
  ds_read_b64_tr_b16 v[28:29], v78 offset:0
  ds_read_b64_tr_b16 v[30:31], v78 offset:3072
  ds_read_b64_tr_b16 v[32:33], v80 offset:32
  ds_read_b64_tr_b16 v[34:35], v80 offset:3104
  ds_read_b64_tr_b16 v[36:37], v78 offset:64
  ds_read_b64_tr_b16 v[38:39], v78 offset:3136
  ds_read_b64_tr_b16 v[40:41], v80 offset:96
  ds_read_b64_tr_b16 v[42:43], v80 offset:3168
  ds_read_b64_tr_b16 v[44:45], v78 offset:128
  ds_read_b64_tr_b16 v[46:47], v78 offset:3200
  ds_read_b64_tr_b16 v[48:49], v80 offset:160
  ds_read_b64_tr_b16 v[50:51], v80 offset:3232
  ds_read_b64_tr_b16 v[52:53], v82 offset:0
  ds_read_b64_tr_b16 v[54:55], v82 offset:3584
  ds_read_b64_tr_b16 v[56:57], v82 offset:32
  ds_read_b64_tr_b16 v[58:59], v82 offset:3616
  ds_read_b64_tr_b16 v[60:61], v82 offset:7168
  ds_read_b64_tr_b16 v[62:63], v82 offset:10752
  ds_read_b64_tr_b16 v[64:65], v82 offset:7200
  ds_read_b64_tr_b16 v[66:67], v82 offset:10784
  v_add_u32 v1, s38, v82
  ds_read_b64_tr_b16 v[88:89], v1 offset:0
  ds_read_b64_tr_b16 v[90:91], v1 offset:3584
  s_waitcnt lgkmcnt(0)
  s_barrier
  .p2align 3
  v_mfma_f32_16x16x32_bf16 v[92:95], v[24:27], v[44:47], v[92:95]
  v_mfma_f32_16x16x32_bf16 v[128:131], v[36:39], v[8:11], v[128:131]
  v_mfma_f32_16x16x32_bf16 v[132:135], v[36:39], v[12:15], v[132:135]
  v_mfma_f32_16x16x32_bf16 v[136:139], v[36:39], v[16:19], v[136:139]
  v_mfma_f32_16x16x32_bf16 v[140:143], v[36:39], v[20:23], v[140:143]
  v_mfma_f32_16x16x32_bf16 v[144:147], v[40:43], v[8:11], v[144:147]
  v_mfma_f32_16x16x32_bf16 v[148:151], v[40:43], v[12:15], v[148:151]
  v_mfma_f32_16x16x32_bf16 v[152:155], v[40:43], v[16:19], v[152:155]
  v_mfma_f32_16x16x32_bf16 v[156:159], v[40:43], v[20:23], v[156:159]
  v_mfma_f32_16x16x32_bf16 v[160:163], v[8:11], v[44:47], v[160:163]
  v_mfma_f32_16x16x32_bf16 v[164:167], v[12:15], v[44:47], v[164:167]
  v_mfma_f32_16x16x32_bf16 v[168:171], v[16:19], v[44:47], v[168:171]
  v_mfma_f32_16x16x32_bf16 v[172:175], v[20:23], v[44:47], v[172:175]
  v_mfma_f32_16x16x32_bf16 v[176:179], v[8:11], v[48:51], v[176:179]
  v_mfma_f32_16x16x32_bf16 v[180:183], v[12:15], v[48:51], v[180:183]
  v_mfma_f32_16x16x32_bf16 v[184:187], v[16:19], v[48:51], v[184:187]
  v_mfma_f32_16x16x32_bf16 v[188:191], v[20:23], v[48:51], v[188:191]
  v_mfma_f32_16x16x32_bf16 v[96:99], v[28:31], v[8:11], v[96:99]
  v_mfma_f32_16x16x32_bf16 v[100:103], v[28:31], v[12:15], v[100:103]
  v_mfma_f32_16x16x32_bf16 v[104:107], v[28:31], v[16:19], v[104:107]
  v_mfma_f32_16x16x32_bf16 v[84:87], v[88:91], v[24:27], v[84:87]
  v_mfma_f32_16x16x32_bf16 v[108:111], v[28:31], v[20:23], v[108:111]
  v_mfma_f32_16x16x32_bf16 v[112:115], v[32:35], v[8:11], v[112:115]
  v_mfma_f32_16x16x32_bf16 v[116:119], v[32:35], v[12:15], v[116:119]
  v_mfma_f32_16x16x32_bf16 v[120:123], v[32:35], v[16:19], v[120:123]
  v_mfma_f32_16x16x32_bf16 v[124:127], v[32:35], v[20:23], v[124:127]
  v_mfma_f32_16x16x32_bf16 v[192:195], v[52:55], v[8:11], v[192:195]
  v_mfma_f32_16x16x32_bf16 v[196:199], v[52:55], v[12:15], v[196:199]
  v_mfma_f32_16x16x32_bf16 v[200:203], v[52:55], v[16:19], v[200:203]
  v_mfma_f32_16x16x32_bf16 v[204:207], v[52:55], v[20:23], v[204:207]
  v_mfma_f32_16x16x32_bf16 v[208:211], v[56:59], v[8:11], v[208:211]
  v_mfma_f32_16x16x32_bf16 v[212:215], v[56:59], v[12:15], v[212:215]
  v_mfma_f32_16x16x32_bf16 v[216:219], v[56:59], v[16:19], v[216:219]
  v_mfma_f32_16x16x32_bf16 v[220:223], v[56:59], v[20:23], v[220:223]
  v_mfma_f32_16x16x32_bf16 v[224:227], v[60:63], v[8:11], v[224:227]
  v_mfma_f32_16x16x32_bf16 v[228:231], v[60:63], v[12:15], v[228:231]
  v_mfma_f32_16x16x32_bf16 v[232:235], v[60:63], v[16:19], v[232:235]
  v_mfma_f32_16x16x32_bf16 v[236:239], v[60:63], v[20:23], v[236:239]
  v_mfma_f32_16x16x32_bf16 v[240:243], v[64:67], v[8:11], v[240:243]
  v_mfma_f32_16x16x32_bf16 v[244:247], v[64:67], v[12:15], v[244:247]
  v_mfma_f32_16x16x32_bf16 v[248:251], v[64:67], v[16:19], v[248:251]
  v_mfma_f32_16x16x32_bf16 v[252:255], v[64:67], v[20:23], v[252:255]
  s_waitcnt vmcnt(0)
  s_barrier
  ds_read_b128 v[8:11], v74 offset:34816
  ds_read_b128 v[12:15], v74 offset:36864
  ds_read_b128 v[16:19], v74 offset:38912
  ds_read_b128 v[20:23], v74 offset:40960
  ds_read_b128 v[24:27], v76 offset:34816
  ds_read_b64_tr_b16 v[28:29], v78 offset:20480
  ds_read_b64_tr_b16 v[30:31], v78 offset:23552
  ds_read_b64_tr_b16 v[32:33], v80 offset:20512
  ds_read_b64_tr_b16 v[34:35], v80 offset:23584
  ds_read_b64_tr_b16 v[36:37], v78 offset:20544
  ds_read_b64_tr_b16 v[38:39], v78 offset:23616
  ds_read_b64_tr_b16 v[40:41], v80 offset:20576
  ds_read_b64_tr_b16 v[42:43], v80 offset:23648
  ds_read_b64_tr_b16 v[44:45], v78 offset:20608
  ds_read_b64_tr_b16 v[46:47], v78 offset:23680
  ds_read_b64_tr_b16 v[48:49], v80 offset:20640
  ds_read_b64_tr_b16 v[50:51], v80 offset:23712
  ds_read_b64_tr_b16 v[52:53], v82 offset:20480
  ds_read_b64_tr_b16 v[54:55], v82 offset:24064
  ds_read_b64_tr_b16 v[56:57], v82 offset:20512
  ds_read_b64_tr_b16 v[58:59], v82 offset:24096
  ds_read_b64_tr_b16 v[60:61], v82 offset:27648
  ds_read_b64_tr_b16 v[62:63], v82 offset:31232
  ds_read_b64_tr_b16 v[64:65], v82 offset:27680
  ds_read_b64_tr_b16 v[66:67], v82 offset:31264
  v_add_u32 v1, s38, v82
  ds_read_b64_tr_b16 v[88:89], v1 offset:20480
  ds_read_b64_tr_b16 v[90:91], v1 offset:24064
  s_waitcnt lgkmcnt(0)
  v_mfma_f32_16x16x32_bf16 v[84:87], v[88:91], v[24:27], v[84:87]
  s_mov_b32 s12, s79
  s_lshl_b32 s13, s78, 4
  s_add_u32 s13, s13, s12
  s_lshl_b32 s13, s13, 6
  s_add_u32 s13, s13, 1048576
  s_add_u32 s16, s6, s13
  s_addc_u32 s17, s7, 0
  s_mov_b32 s18, 64
  s_mov_b32 s19, 0x20000
  v_lshrrev_b32 v4, 4, v0
  v_lshlrev_b32 v4, 4, v4
  s_mov_b32 s12, 0x00010001
  s_mov_b32 s13, 0x00010001
  s_mov_b64 exec, s[12:13]
  buffer_store_dwordx4 v[84:87], v4, s[16:19], 0 offen sc1
  s_mov_b64 exec, -1
L_X2_nopub:
  s_and_b32 s3, s2, 7
  s_lshr_b32 s16, s2, 3
  s_and_b32 s20, s16, 1
  s_lshr_b32 s16, s16, 1
  s_lshr_b32 s17, s3, 1
  s_lshl_b32 s17, s17, 2
  s_and_b32 s18, s16, 3
  s_add_u32 s21, s17, s18
  s_and_b32 s17, s3, 1
  s_lshl_b32 s17, s17, 2
  s_lshr_b32 s18, s16, 2
  s_add_u32 s22, s17, s18
  s_lshl_b32 s23, s21, 3
  s_add_u32 s23, s23, s22
  s_lshr_b32 s19, s76, 2
  s_mov_b32 s64, s24
  s_mov_b32 s65, s25
  s_mov_b32 s66, 2097152
  s_mov_b32 s67, 0x20000
  s_lshl_b32 s16, s20, 4
  s_lshl_b32 s17, s19, 1
  s_add_u32 s16, s16, s17
  s_lshl_b32 s73, s16, 16
  s_mov_b32 s70, 262144
  s_mov_b32 s72, 65536
  s_mov_b32 s68, 4
  s_mov_b32 s69, 0
  s_mul_i32 s16, s20, 56
  s_mul_i32 s17, s19, 7
  s_add_u32 s18, s16, s17
  s_lshl_b32 s80, s18, 16
  s_mul_i32 s17, s19, 3
  s_add_u32 s18, s16, s17
  s_add_u32 s18, s18, 1
  s_lshl_b32 s81, s18, 16
  s_mul_i32 s17, s19, 14
  s_add_u32 s18, s16, s17
  s_add_u32 s18, s18, 6
  s_lshl_b32 s82, s18, 16
  s_mul_i32 s17, s19, 49152
  s_lshl_b32 s18, s77, 11
  s_add_u32 s74, s17, s18
  v_lshrrev_b32 v3, 4, v0
  v_lshlrev_b32 v4, 1, v3
  v_and_b32 v2, 15, v0
  v_xor_b32 v6, v4, v2
  v_xor_b32 v2, 8, v6
  s_lshl_b32 s17, s77, 3
  v_add_u32 v3, s17, v3
  v_lshlrev_b32 v3, 11, v3
  s_lshl_b32 s17, s22, 8
  v_add_u32 v3, s17, v3
  v_lshl_add_u32 v68, v6, 4, v3
  v_lshl_add_u32 v69, v2, 4, v3
  v_add_u32 v69, 8192, v69
  s_add_u32 m0, s74, 0
  s_add_u32 s75, s73, s72
  buffer_load_dwordx4 v68, s[64:67], s73 offen lds
  s_add_u32 m0, s74, 1024
  s_sub_u32 s68, s68, 1
  buffer_load_dwordx4 v69, s[64:67], s73 offen lds
  s_add_u32 m0, s74, 8192
  s_add_u32 s73, s73, s70
  buffer_load_dwordx4 v68, s[64:67], s75 offen lds
  s_add_u32 m0, s74, 9216
  s_cmp_eq_u32 s68, 0
  buffer_load_dwordx4 v69, s[64:67], s75 offen lds
  s_cbranch_scc0 L_bo5
  s_add_u32 s69, s69, 1
  s_mov_b32 s64, s26
  s_mov_b32 s65, s27
  s_mov_b32 s66, 7340032
  s_mov_b32 s73, s80
  s_mov_b32 s70, 917504
  s_mov_b32 s72, 196608
  s_mov_b32 s68, 4
  s_cmp_eq_u32 s69, 1
  s_cbranch_scc1 L_bo5
  s_mov_b32 s73, s81
  s_mov_b32 s70, 458752
  s_mov_b32 s72, 65536
  s_mov_b32 s68, 8
  s_cmp_eq_u32 s69, 2
  s_cbranch_scc1 L_bo5
  s_mov_b32 s73, s82
  s_mov_b32 s70, 1835008
  s_mov_b32 s72, 458752
  s_mov_b32 s68, 2
  s_cmp_eq_u32 s69, 3
  s_cbranch_scc1 L_bo5
  s_mov_b32 s66, 0
  s_mov_b32 s68, 64
L_bo5:
  s_add_u32 m0, s74, 16384
  s_add_u32 s75, s73, s72
  buffer_load_dwordx4 v68, s[64:67], s73 offen lds
  s_add_u32 m0, s74, 17408
  s_sub_u32 s68, s68, 1
  buffer_load_dwordx4 v69, s[64:67], s73 offen lds
  s_add_u32 m0, s74, 24576
  s_add_u32 s73, s73, s70
  buffer_load_dwordx4 v68, s[64:67], s75 offen lds
  s_add_u32 m0, s74, 25600
  s_cmp_eq_u32 s68, 0
  buffer_load_dwordx4 v69, s[64:67], s75 offen lds
  s_cbranch_scc0 L_bo6
  s_add_u32 s69, s69, 1
  s_mov_b32 s64, s26
  s_mov_b32 s65, s27
  s_mov_b32 s66, 7340032
  s_mov_b32 s73, s80
  s_mov_b32 s70, 917504
  s_mov_b32 s72, 196608
  s_mov_b32 s68, 4
  s_cmp_eq_u32 s69, 1
  s_cbranch_scc1 L_bo6
  s_mov_b32 s73, s81
  s_mov_b32 s70, 458752
  s_mov_b32 s72, 65536
  s_mov_b32 s68, 8
  s_cmp_eq_u32 s69, 2
  s_cbranch_scc1 L_bo6
  s_mov_b32 s73, s82
  s_mov_b32 s70, 1835008
  s_mov_b32 s72, 458752
  s_mov_b32 s68, 2
  s_cmp_eq_u32 s69, 3
  s_cbranch_scc1 L_bo6
  s_mov_b32 s66, 0
  s_mov_b32 s68, 64
L_bo6:
  s_waitcnt lgkmcnt(0)
  s_barrier
  .p2align 3
  v_mfma_f32_16x16x32_bf16 v[92:95], v[24:27], v[44:47], v[92:95]
  v_mfma_f32_16x16x32_bf16 v[128:131], v[36:39], v[8:11], v[128:131]
  v_mfma_f32_16x16x32_bf16 v[132:135], v[36:39], v[12:15], v[132:135]
  v_mfma_f32_16x16x32_bf16 v[136:139], v[36:39], v[16:19], v[136:139]
  v_mfma_f32_16x16x32_bf16 v[140:143], v[36:39], v[20:23], v[140:143]
  v_mfma_f32_16x16x32_bf16 v[144:147], v[40:43], v[8:11], v[144:147]
  v_mfma_f32_16x16x32_bf16 v[148:151], v[40:43], v[12:15], v[148:151]
  v_mfma_f32_16x16x32_bf16 v[152:155], v[40:43], v[16:19], v[152:155]
  v_mfma_f32_16x16x32_bf16 v[156:159], v[40:43], v[20:23], v[156:159]
  v_mfma_f32_16x16x32_bf16 v[160:163], v[8:11], v[44:47], v[160:163]
  v_mfma_f32_16x16x32_bf16 v[164:167], v[12:15], v[44:47], v[164:167]
  v_mfma_f32_16x16x32_bf16 v[168:171], v[16:19], v[44:47], v[168:171]
  v_mfma_f32_16x16x32_bf16 v[172:175], v[20:23], v[44:47], v[172:175]
  v_mfma_f32_16x16x32_bf16 v[176:179], v[8:11], v[48:51], v[176:179]
  v_mfma_f32_16x16x32_bf16 v[180:183], v[12:15], v[48:51], v[180:183]
  v_mfma_f32_16x16x32_bf16 v[184:187], v[16:19], v[48:51], v[184:187]
  v_mfma_f32_16x16x32_bf16 v[188:191], v[20:23], v[48:51], v[188:191]
  v_mfma_f32_16x16x32_bf16 v[96:99], v[28:31], v[8:11], v[96:99]
  v_mfma_f32_16x16x32_bf16 v[100:103], v[28:31], v[12:15], v[100:103]
  v_mfma_f32_16x16x32_bf16 v[104:107], v[28:31], v[16:19], v[104:107]
  v_mfma_f32_16x16x32_bf16 v[108:111], v[28:31], v[20:23], v[108:111]
  v_mfma_f32_16x16x32_bf16 v[112:115], v[32:35], v[8:11], v[112:115]
  v_mfma_f32_16x16x32_bf16 v[116:119], v[32:35], v[12:15], v[116:119]
  v_mfma_f32_16x16x32_bf16 v[120:123], v[32:35], v[16:19], v[120:123]
  v_mfma_f32_16x16x32_bf16 v[124:127], v[32:35], v[20:23], v[124:127]
  v_mfma_f32_16x16x32_bf16 v[192:195], v[52:55], v[8:11], v[192:195]
  v_mfma_f32_16x16x32_bf16 v[196:199], v[52:55], v[12:15], v[196:199]
  v_mfma_f32_16x16x32_bf16 v[200:203], v[52:55], v[16:19], v[200:203]
  v_mfma_f32_16x16x32_bf16 v[204:207], v[52:55], v[20:23], v[204:207]
  v_mfma_f32_16x16x32_bf16 v[208:211], v[56:59], v[8:11], v[208:211]
  v_mfma_f32_16x16x32_bf16 v[212:215], v[56:59], v[12:15], v[212:215]
  v_mfma_f32_16x16x32_bf16 v[216:219], v[56:59], v[16:19], v[216:219]
  v_mfma_f32_16x16x32_bf16 v[220:223], v[56:59], v[20:23], v[220:223]
  v_mfma_f32_16x16x32_bf16 v[224:227], v[60:63], v[8:11], v[224:227]
  v_mfma_f32_16x16x32_bf16 v[228:231], v[60:63], v[12:15], v[228:231]
  v_mfma_f32_16x16x32_bf16 v[232:235], v[60:63], v[16:19], v[232:235]
  v_mfma_f32_16x16x32_bf16 v[236:239], v[60:63], v[20:23], v[236:239]
  v_mfma_f32_16x16x32_bf16 v[240:243], v[64:67], v[8:11], v[240:243]
  v_mfma_f32_16x16x32_bf16 v[244:247], v[64:67], v[12:15], v[244:247]
  v_mfma_f32_16x16x32_bf16 v[248:251], v[64:67], v[16:19], v[248:251]
  v_mfma_f32_16x16x32_bf16 v[252:255], v[64:67], v[20:23], v[252:255]
  s_barrier
  s_mov_b32 s39, 2
  s_branch L_xepi
L_X3:
  s_mov_b32 s40, s10
  s_mov_b32 s41, s11
  s_mov_b32 s42, 7340032
  s_mov_b32 s43, 0x20000
  s_mov_b32 s70, 84992
  s_mov_b32 s65, 229376
  s_mov_b32 s60, 0
  v_add_u32 v1, 128, v0
  v_mul_u32_u24 v2, 37450, v1
  v_lshrrev_b32 v2, 19, v2
  v_mul_u32_u24 v3, 14, v2
  v_sub_u32 v3, v1, v3
  v_lshlrev_b32 v4, 4, v3
  v_mov_b32 v6, s25
  v_mov_b32 v5, s26
  v_cmp_gt_u32 vcc, 12, v3
  s_nop 1
  v_cndmask_b32 v6, v5, v6, vcc
  v_add_u32 v4, v6, v4
  v_bfe_u32 v5, v2, 2, 2
  v_lshlrev_b32 v5, 3, v5
  v_lshrrev_b32 v6, 4, v2
  v_lshl_add_u32 v5, v6, 2, v5
  v_and_b32 v6, 3, v2
  v_add_u32 v5, v5, v6
  v_mul_u32_u24 v5, 7168, v5
  v_add_u32 v68, v5, v4
  s_mov_b32 s44, s10
  s_mov_b32 s45, s11
  s_mov_b32 s46, 7340032
  s_mov_b32 s47, 0x20000
  s_mov_b32 s71, 86016
  s_mov_b32 s66, 229376
  s_mov_b32 s61, 0
  v_add_u32 v1, 192, v0
  v_mul_u32_u24 v2, 37450, v1
  v_lshrrev_b32 v2, 19, v2
  v_mul_u32_u24 v3, 14, v2
  v_sub_u32 v3, v1, v3
  v_lshlrev_b32 v4, 4, v3
  v_mov_b32 v6, s25
  v_mov_b32 v5, s26
  v_cmp_gt_u32 vcc, 12, v3
  s_nop 1
  v_cndmask_b32 v6, v5, v6, vcc
  v_add_u32 v4, v6, v4
  v_bfe_u32 v5, v2, 2, 2
  v_lshlrev_b32 v5, 3, v5
  v_lshrrev_b32 v6, 4, v2
  v_lshl_add_u32 v5, v6, 2, v5
  v_and_b32 v6, 3, v2
  v_add_u32 v5, v5, v6
  v_mul_u32_u24 v5, 7168, v5
  v_add_u32 v69, v5, v4
  s_mov_b32 s48, s10
  s_mov_b32 s49, s11
  s_mov_b32 s50, 7340032
  s_mov_b32 s51, 0x20000
  s_mov_b32 s72, 87040
  s_mov_b32 s67, 229376
  s_mov_b32 s62, 0
  v_add_u32 v1, 256, v0
  v_mul_u32_u24 v2, 37450, v1
  v_lshrrev_b32 v2, 19, v2
  v_mul_u32_u24 v3, 14, v2
  v_sub_u32 v3, v1, v3
  v_lshlrev_b32 v4, 4, v3
  v_mov_b32 v6, s25
  v_mov_b32 v5, s26
  v_cmp_gt_u32 vcc, 12, v3
  s_nop 1
  v_cndmask_b32 v6, v5, v6, vcc
  v_add_u32 v4, v6, v4
  v_bfe_u32 v5, v2, 2, 2
  v_lshlrev_b32 v5, 3, v5
  v_lshrrev_b32 v6, 4, v2
  v_lshl_add_u32 v5, v6, 2, v5
  v_and_b32 v6, 3, v2
  v_add_u32 v5, v5, v6
  v_mul_u32_u24 v5, 7168, v5
  v_add_u32 v70, v5, v4
  s_mov_b32 s52, s10
  s_mov_b32 s53, s11
  s_mov_b32 s54, 7340032
  s_mov_b32 s55, 0x20000
  s_mov_b32 s73, 88064
  s_mov_b32 s68, 229376
  s_mov_b32 s63, 0
  v_add_u32 v1, 320, v0
  v_mul_u32_u24 v2, 37450, v1
  v_lshrrev_b32 v2, 19, v2
  v_mul_u32_u24 v3, 14, v2
  v_sub_u32 v3, v1, v3
  v_lshlrev_b32 v4, 4, v3
  v_mov_b32 v6, s25
  v_mov_b32 v5, s26
  v_cmp_gt_u32 vcc, 12, v3
  s_nop 1
  v_cndmask_b32 v6, v5, v6, vcc
  v_add_u32 v4, v6, v4
  v_bfe_u32 v5, v2, 2, 2
  v_lshlrev_b32 v5, 3, v5
  v_lshrrev_b32 v6, 4, v2
  v_lshl_add_u32 v5, v6, 2, v5
  v_and_b32 v6, 3, v2
  v_add_u32 v5, v5, v6
  v_mul_u32_u24 v5, 7168, v5
  v_add_u32 v71, v5, v4
  s_mov_b32 s56, s10
  s_mov_b32 s57, s11
  s_mov_b32 s58, 7340032
  s_mov_b32 s59, 0x20000
  s_mov_b32 s74, 89088
  s_mov_b32 s69, 229376
  s_mov_b32 s64, 0
  v_add_u32 v1, 384, v0
  v_mul_u32_u24 v2, 37450, v1
  v_lshrrev_b32 v2, 19, v2
  v_mul_u32_u24 v3, 14, v2
  v_sub_u32 v3, v1, v3
  v_lshlrev_b32 v4, 4, v3
  v_mov_b32 v6, s25
  v_mov_b32 v5, s26
  v_cmp_gt_u32 vcc, 12, v3
  s_nop 1
  v_cndmask_b32 v6, v5, v6, vcc
  v_add_u32 v4, v6, v4
  v_bfe_u32 v5, v2, 2, 2
  v_lshlrev_b32 v5, 3, v5
  v_lshrrev_b32 v6, 4, v2
  v_lshl_add_u32 v5, v6, 2, v5
  v_and_b32 v6, 3, v2
  v_add_u32 v5, v5, v6
  v_mul_u32_u24 v5, 7168, v5
  v_add_u32 v72, v5, v4
  s_add_u32 s12, s79, 8
  s_min_u32 s12, s12, 13
  s_lshr_b32 s13, s12, 1
  s_and_b32 s14, s12, 1
  s_sub_u32 s15, s12, 2
  s_sub_u32 s16, s12, 7
  s_cmp_lt_u32 s12, 9
  s_cselect_b32 s15, s15, s16
  s_cselect_b32 s16, 0, 1
  s_cmp_lt_u32 s12, 4
  s_cselect_b32 s13, s13, s16
  s_cselect_b32 s14, s14, s15
  s_mul_i32 s13, s13, 7168
  s_lshl_b32 s14, s14, 5
  s_add_u32 s38, s13, s14
  s_add_u32 m0, s70, 0
  s_nop 0
  buffer_load_dwordx4 v68, s[40:43], s60 offen lds
  s_add_u32 s60, s60, s65
  s_add_u32 m0, s71, 0
  s_nop 0
  buffer_load_dwordx4 v69, s[44:47], s61 offen lds
  s_add_u32 s61, s61, s66
  s_add_u32 m0, s72, 0
  s_nop 0
  buffer_load_dwordx4 v70, s[48:51], s62 offen lds
  s_add_u32 s62, s62, s67
  s_add_u32 m0, s73, 0
  s_nop 0
  buffer_load_dwordx4 v71, s[52:55], s63 offen lds
  s_add_u32 s63, s63, s68
  s_add_u32 m0, s74, 0
  s_nop 0
  buffer_load_dwordx4 v72, s[56:59], s64 offen lds
  s_add_u32 s64, s64, s69
  s_add_u32 m0, s70, 20480
  s_nop 0
  buffer_load_dwordx4 v68, s[40:43], s60 offen lds
  s_add_u32 s60, s60, s65
  s_add_u32 m0, s71, 20480
  s_nop 0
  buffer_load_dwordx4 v69, s[44:47], s61 offen lds
  s_add_u32 s61, s61, s66
  s_add_u32 m0, s72, 20480
  s_nop 0
  buffer_load_dwordx4 v70, s[48:51], s62 offen lds
  s_add_u32 s62, s62, s67
  s_add_u32 m0, s73, 20480
  s_nop 0
  buffer_load_dwordx4 v71, s[52:55], s63 offen lds
  s_add_u32 s63, s63, s68
  s_add_u32 m0, s74, 20480
  s_nop 0
  buffer_load_dwordx4 v72, s[56:59], s64 offen lds
  s_add_u32 s64, s64, s69
  s_add_u32 m0, s70, 40960
  s_nop 0
  buffer_load_dwordx4 v68, s[40:43], s60 offen lds
  s_add_u32 s60, s60, s65
  s_add_u32 m0, s71, 40960
  s_nop 0
  buffer_load_dwordx4 v69, s[44:47], s61 offen lds
  s_add_u32 s61, s61, s66
  s_add_u32 m0, s72, 40960
  s_nop 0
  buffer_load_dwordx4 v70, s[48:51], s62 offen lds
  s_add_u32 s62, s62, s67
  s_add_u32 m0, s73, 40960
  s_nop 0
  buffer_load_dwordx4 v71, s[52:55], s63 offen lds
  s_add_u32 s63, s63, s68
  s_add_u32 m0, s74, 40960
  s_nop 0
  buffer_load_dwordx4 v72, s[56:59], s64 offen lds
  s_add_u32 s64, s64, s69
  s_mov_b32 s24, s36
  s_mov_b32 s25, s37
  s_mov_b32 s26, 4194304
  s_mov_b32 s27, 0x20000
  s_lshr_b32 s28, s2, 3
  s_lshl_b32 s28, s28, 6
  s_add_u32 s28, s28, 32
  v_add_u32 v83, s28, v0
  v_lshlrev_b32 v83, 11, v83
  v_add_u32 v83, 128, v83
  v_cmp_gt_u32 vcc, 32, v0
  v_mov_b32 v3, 0x7ffffff0
  s_nop 0
  v_cndmask_b32 v83, v3, v83, vcc
  s_mov_b32 s28, 256
  buffer_load_dword v6, v83, s[24:27], s28 offen
  s_add_u32 s28, s28, 256
  s_and_b32 s3, s2, 7
  s_lshr_b32 s16, s2, 3
  s_and_b32 s20, s16, 1
  s_lshr_b32 s16, s16, 1
  s_lshr_b32 s17, s3, 1
  s_lshl_b32 s17, s17, 2
  s_and_b32 s18, s16, 3
  s_add_u32 s21, s17, s18
  s_and_b32 s17, s3, 1
  s_lshl_b32 s17, s17, 2
  s_lshr_b32 s18, s16, 2
  s_add_u32 s22, s17, s18
  s_lshl_b32 s23, s21, 3
  s_add_u32 s23, s23, s22
  s_lshl_b32 s16, s23, 16
  s_lshl_b32 s17, s20, 15
  s_add_u32 s16, s16, s17
  s_lshl_b32 s17, s76, 12
  s_add_u32 s16, s16, s17
  s_add_u32 s16, s16, 67108864
  s_add_u32 s88, s6, s16
  s_addc_u32 s89, s7, 0
  s_mov_b32 s90, 20480
  s_mov_b32 s91, 0x20000
  s_waitcnt vmcnt(16)
  v_lshlrev_b32 v104, 16, v96
  v_and_b32 v105, 0xffff0000, v96
  v_lshlrev_b32 v106, 16, v97
  v_and_b32 v107, 0xffff0000, v97
  v_lshlrev_b32 v108, 16, v98
  v_and_b32 v109, 0xffff0000, v98
  v_lshlrev_b32 v110, 16, v99
  v_and_b32 v111, 0xffff0000, v99
  v_lshlrev_b32 v112, 16, v100
  v_and_b32 v113, 0xffff0000, v100
  v_lshlrev_b32 v114, 16, v101
  v_and_b32 v115, 0xffff0000, v101
  v_lshlrev_b32 v116, 16, v102
  v_and_b32 v117, 0xffff0000, v102
  v_lshlrev_b32 v118, 16, v103
  v_and_b32 v119, 0xffff0000, v103
  v_add_f32 v120, v104, v108
  v_add_f32 v124, v112, v116
  v_add_f32 v121, v105, v109
  v_add_f32 v125, v113, v117
  v_add_f32 v122, v106, v110
  v_add_f32 v126, v114, v118
  v_add_f32 v123, v107, v111
  v_add_f32 v127, v115, v119
  v_add_f32 v120, v120, v124
  v_add_f32 v121, v121, v125
  v_add_f32 v122, v122, v126
  v_add_f32 v123, v123, v127
  v_add_f32 v120, v120, v121
  v_add_f32 v122, v122, v123
  v_add_f32 v120, v120, v122
  s_nop 1
  v_add_f32_dpp v120, v120, v120 row_ror:8 row_mask:0xf bank_mask:0xf
  s_nop 1
  v_add_f32_dpp v120, v120, v120 row_ror:4 row_mask:0xf bank_mask:0xf
  s_nop 1
  v_add_f32_dpp v120, v120, v120 row_ror:2 row_mask:0xf bank_mask:0xf
  s_nop 1
  v_add_f32_dpp v120, v120, v120 row_ror:1 row_mask:0xf bank_mask:0xf
  v_mov_b32 v121, v120
  s_nop 1
  v_permlane16_swap_b32 v120, v121
  v_add_f32 v120, v120, v121
  v_mov_b32 v121, v120
  s_nop 1
  v_permlane32_swap_b32 v120, v121
  v_add_f32 v120, v120, v121
  v_mul_f32 v120, 0x3a800000, v120
  v_sub_f32 v104, v104, v120
  v_sub_f32 v105, v105, v120
  v_sub_f32 v106, v106, v120
  v_sub_f32 v107, v107, v120
  v_sub_f32 v108, v108, v120
  v_sub_f32 v109, v109, v120
  v_sub_f32 v110, v110, v120
  v_sub_f32 v111, v111, v120
  v_sub_f32 v112, v112, v120
  v_sub_f32 v113, v113, v120
  v_sub_f32 v114, v114, v120
  v_sub_f32 v115, v115, v120
  v_sub_f32 v116, v116, v120
  v_sub_f32 v117, v117, v120
  v_sub_f32 v118, v118, v120
  v_sub_f32 v119, v119, v120
  v_mul_f32 v124, v104, v104
  v_mul_f32 v125, v105, v105
  v_mul_f32 v126, v106, v106
  v_mul_f32 v127, v107, v107
  v_fmac_f32 v124, v108, v108
  v_fmac_f32 v125, v109, v109
  v_fmac_f32 v126, v110, v110
  v_fmac_f32 v127, v111, v111
  v_fmac_f32 v124, v112, v112
  v_fmac_f32 v125, v113, v113
  v_fmac_f32 v126, v114, v114
  v_fmac_f32 v127, v115, v115
  v_fmac_f32 v124, v116, v116
  v_fmac_f32 v125, v117, v117
  v_fmac_f32 v126, v118, v118
  v_fmac_f32 v127, v119, v119
  v_add_f32 v124, v124, v125
  v_add_f32 v126, v126, v127
  v_add_f32 v124, v124, v126
  s_nop 1
  v_add_f32_dpp v124, v124, v124 row_ror:8 row_mask:0xf bank_mask:0xf
  s_nop 1
  v_add_f32_dpp v124, v124, v124 row_ror:4 row_mask:0xf bank_mask:0xf
  s_nop 1
  v_add_f32_dpp v124, v124, v124 row_ror:2 row_mask:0xf bank_mask:0xf
  s_nop 1
  v_add_f32_dpp v124, v124, v124 row_ror:1 row_mask:0xf bank_mask:0xf
  v_mov_b32 v125, v124
  s_nop 1
  v_permlane16_swap_b32 v124, v125
  v_add_f32 v124, v124, v125
  v_mov_b32 v125, v124
  s_nop 1
  v_permlane32_swap_b32 v124, v125
  v_add_f32 v124, v124, v125
  v_mov_b32 v122, 0x3727c5ac
  v_fmac_f32 v122, 0x3a800000, v124
  v_rsq_f32 v121, v122
  v_mov_b32 v123, 0
  s_mov_b32 s16, s6
  s_mov_b32 s17, s7
  s_mov_b32 s18, 32768
  s_mov_b32 s19, 0x20000
  s_lshl_b32 s14, s2, 3
  s_add_u32 s14, s14, s76
  s_lshl_b32 s14, s14, 4
  v_mov_b32 v2, s14
  v_cmp_eq_u32 vcc, 0, v0
  s_and_saveexec_b64 s[20:21], vcc
  buffer_store_dwordx4 v[120:123], v2, s[16:19], 0 offen sc1
  s_mov_b64 exec, s[20:21]
  v_mov_b32 v84, 0
  v_mov_b32 v85, 0
  v_mov_b32 v86, 0
  v_mov_b32 v87, 0
  v_mov_b32 v88, 0
  v_mov_b32 v89, 0
  v_mov_b32 v90, 0
  v_mov_b32 v91, 0
  v_mov_b32 v92, 0
  v_mov_b32 v93, 0
  v_mov_b32 v94, 0
  v_mov_b32 v95, 0
  v_mov_b32 v96, 0
  v_mov_b32 v97, 0
  v_mov_b32 v98, 0
  v_mov_b32 v99, 0
  v_mov_b32 v100, 0
  v_mov_b32 v101, 0
  v_mov_b32 v102, 0
  v_mov_b32 v103, 0
  v_mov_b32 v104, 0
  v_mov_b32 v105, 0
  v_mov_b32 v106, 0
  v_mov_b32 v107, 0
  v_mov_b32 v108, 0
  v_mov_b32 v109, 0
  v_mov_b32 v110, 0
  v_mov_b32 v111, 0
  v_mov_b32 v112, 0
  v_mov_b32 v113, 0
  v_mov_b32 v114, 0
  v_mov_b32 v115, 0
  v_mov_b32 v116, 0
  v_mov_b32 v117, 0
  v_mov_b32 v118, 0
  v_mov_b32 v119, 0
  v_mov_b32 v120, 0
  v_mov_b32 v121, 0
  v_mov_b32 v122, 0
  v_mov_b32 v123, 0
  v_mov_b32 v124, 0
  v_mov_b32 v125, 0
  v_mov_b32 v126, 0
  v_mov_b32 v127, 0
  v_mov_b32 v128, 0
  v_mov_b32 v129, 0
  v_mov_b32 v130, 0
  v_mov_b32 v131, 0
  v_mov_b32 v132, 0
  v_mov_b32 v133, 0
  v_mov_b32 v134, 0
  v_mov_b32 v135, 0
  v_mov_b32 v136, 0
  v_mov_b32 v137, 0
  v_mov_b32 v138, 0
  v_mov_b32 v139, 0
  v_mov_b32 v140, 0
  v_mov_b32 v141, 0
  v_mov_b32 v142, 0
  v_mov_b32 v143, 0
  v_mov_b32 v144, 0
  v_mov_b32 v145, 0
  v_mov_b32 v146, 0
  v_mov_b32 v147, 0
  v_mov_b32 v148, 0
  v_mov_b32 v149, 0
  v_mov_b32 v150, 0
  v_mov_b32 v151, 0
  v_mov_b32 v152, 0
  v_mov_b32 v153, 0
  v_mov_b32 v154, 0
  v_mov_b32 v155, 0
  v_mov_b32 v156, 0
  v_mov_b32 v157, 0
  v_mov_b32 v158, 0
  v_mov_b32 v159, 0
  v_mov_b32 v160, 0
  v_mov_b32 v161, 0
  v_mov_b32 v162, 0
  v_mov_b32 v163, 0
  v_mov_b32 v164, 0
  v_mov_b32 v165, 0
  v_mov_b32 v166, 0
  v_mov_b32 v167, 0
  v_mov_b32 v168, 0
  v_mov_b32 v169, 0
  v_mov_b32 v170, 0
  v_mov_b32 v171, 0
  v_mov_b32 v172, 0
  v_mov_b32 v173, 0
  v_mov_b32 v174, 0
  v_mov_b32 v175, 0
  v_mov_b32 v176, 0
  v_mov_b32 v177, 0
  v_mov_b32 v178, 0
  v_mov_b32 v179, 0
  v_mov_b32 v180, 0
  v_mov_b32 v181, 0
  v_mov_b32 v182, 0
  v_mov_b32 v183, 0
  v_mov_b32 v184, 0
  v_mov_b32 v185, 0
  v_mov_b32 v186, 0
  v_mov_b32 v187, 0
  v_mov_b32 v188, 0
  v_mov_b32 v189, 0
  v_mov_b32 v190, 0
  v_mov_b32 v191, 0
  v_mov_b32 v192, 0
  v_mov_b32 v193, 0
  v_mov_b32 v194, 0
  v_mov_b32 v195, 0
  v_mov_b32 v196, 0
  v_mov_b32 v197, 0
  v_mov_b32 v198, 0
  v_mov_b32 v199, 0
  v_mov_b32 v200, 0
  v_mov_b32 v201, 0
  v_mov_b32 v202, 0
  v_mov_b32 v203, 0
  v_mov_b32 v204, 0
  v_mov_b32 v205, 0
  v_mov_b32 v206, 0
  v_mov_b32 v207, 0
  v_mov_b32 v208, 0
  v_mov_b32 v209, 0
  v_mov_b32 v210, 0
  v_mov_b32 v211, 0
  v_mov_b32 v212, 0
  v_mov_b32 v213, 0
  v_mov_b32 v214, 0
  v_mov_b32 v215, 0
  v_mov_b32 v216, 0
  v_mov_b32 v217, 0
  v_mov_b32 v218, 0
  v_mov_b32 v219, 0
  v_mov_b32 v220, 0
  v_mov_b32 v221, 0
  v_mov_b32 v222, 0
  v_mov_b32 v223, 0
  v_mov_b32 v224, 0
  v_mov_b32 v225, 0
  v_mov_b32 v226, 0
  v_mov_b32 v227, 0
  v_mov_b32 v228, 0
  v_mov_b32 v229, 0
  v_mov_b32 v230, 0
  v_mov_b32 v231, 0
  v_mov_b32 v232, 0
  v_mov_b32 v233, 0
  v_mov_b32 v234, 0
  v_mov_b32 v235, 0
  v_mov_b32 v236, 0
  v_mov_b32 v237, 0
  v_mov_b32 v238, 0
  v_mov_b32 v239, 0
  v_mov_b32 v240, 0
  v_mov_b32 v241, 0
  v_mov_b32 v242, 0
  v_mov_b32 v243, 0
  v_mov_b32 v244, 0
  v_mov_b32 v245, 0
  v_mov_b32 v246, 0
  v_mov_b32 v247, 0
  v_mov_b32 v248, 0
  v_mov_b32 v249, 0
  v_mov_b32 v250, 0
  v_mov_b32 v251, 0
  v_mov_b32 v252, 0
  v_mov_b32 v253, 0
  v_mov_b32 v254, 0
  v_mov_b32 v255, 0
  s_waitcnt vmcnt(12)
  s_barrier
  .p2align 3
  s_add_u32 m0, s70, 61440
  s_nop 0
  buffer_load_dwordx4 v68, s[40:43], s60 offen lds
  ds_read_b128 v[8:11], v73 offset:0
  ds_read_b128 v[12:15], v73 offset:2048
  ds_read_b128 v[16:19], v73 offset:4096
  ds_read_b128 v[20:23], v73 offset:6144
  ds_read_b128 v[24:27], v75 offset:0
  ds_read_b64_tr_b16 v[28:29], v77 offset:0
  s_add_u32 s60, s60, s65
  s_add_u32 m0, s71, 61440
  s_nop 0
  buffer_load_dwordx4 v69, s[44:47], s61 offen lds
  ds_read_b64_tr_b16 v[30:31], v77 offset:3072
  ds_read_b64_tr_b16 v[32:33], v79 offset:32
  ds_read_b64_tr_b16 v[34:35], v79 offset:3104
  ds_read_b64_tr_b16 v[36:37], v77 offset:64
  ds_read_b64_tr_b16 v[38:39], v77 offset:3136
  s_add_u32 s61, s61, s66
  s_add_u32 m0, s72, 61440
  s_nop 0
  buffer_load_dwordx4 v70, s[48:51], s62 offen lds
  ds_read_b64_tr_b16 v[40:41], v79 offset:96
  ds_read_b64_tr_b16 v[42:43], v79 offset:3168
  ds_read_b64_tr_b16 v[44:45], v77 offset:128
  ds_read_b64_tr_b16 v[46:47], v77 offset:3200
  ds_read_b64_tr_b16 v[48:49], v79 offset:160
  ds_read_b64_tr_b16 v[50:51], v79 offset:3232
  s_add_u32 s62, s62, s67
  s_add_u32 m0, s73, 61440
  s_nop 0
  buffer_load_dwordx4 v71, s[52:55], s63 offen lds
  ds_read_b64_tr_b16 v[52:53], v81 offset:0
  ds_read_b64_tr_b16 v[54:55], v81 offset:3584
  ds_read_b64_tr_b16 v[56:57], v81 offset:32
  ds_read_b64_tr_b16 v[58:59], v81 offset:3616
  ds_read_b64_tr_b16 v[60:61], v81 offset:7168
  s_add_u32 s63, s63, s68
  s_add_u32 m0, s74, 61440
  s_nop 0
  buffer_load_dwordx4 v72, s[56:59], s64 offen lds
  s_add_u32 s64, s64, s69
  ds_read_b64_tr_b16 v[62:63], v81 offset:10752
  ds_read_b64_tr_b16 v[64:65], v81 offset:7200
  ds_read_b64_tr_b16 v[66:67], v81 offset:10784
  v_add_u32 v1, s38, v81
  ds_read_b64_tr_b16 v[88:89], v1 offset:0
  ds_read_b64_tr_b16 v[90:91], v1 offset:3584
  s_waitcnt lgkmcnt(0)
  s_barrier
  s_mov_b32 s75, 7
  .p2align 6
L_X3_loop:
  .p2align 3
  v_mfma_f32_16x16x32_bf16 v[92:95], v[24:27], v[48:51], v[92:95]
  v_mfma_f32_16x16x32_bf16 v[128:131], v[36:39], v[8:11], v[128:131]
  v_mfma_f32_16x16x32_bf16 v[132:135], v[36:39], v[12:15], v[132:135]
  v_mfma_f32_16x16x32_bf16 v[136:139], v[36:39], v[16:19], v[136:139]
  v_mfma_f32_16x16x32_bf16 v[140:143], v[36:39], v[20:23], v[140:143]
  v_mfma_f32_16x16x32_bf16 v[144:147], v[40:43], v[8:11], v[144:147]
  v_mfma_f32_16x16x32_bf16 v[148:151], v[40:43], v[12:15], v[148:151]
  v_mfma_f32_16x16x32_bf16 v[152:155], v[40:43], v[16:19], v[152:155]
  v_mfma_f32_16x16x32_bf16 v[156:159], v[40:43], v[20:23], v[156:159]
  v_mfma_f32_16x16x32_bf16 v[160:163], v[8:11], v[44:47], v[160:163]
  v_mfma_f32_16x16x32_bf16 v[164:167], v[12:15], v[44:47], v[164:167]
  v_mfma_f32_16x16x32_bf16 v[168:171], v[16:19], v[44:47], v[168:171]
  v_mfma_f32_16x16x32_bf16 v[172:175], v[20:23], v[44:47], v[172:175]
  v_mfma_f32_16x16x32_bf16 v[176:179], v[8:11], v[48:51], v[176:179]
  v_mfma_f32_16x16x32_bf16 v[180:183], v[12:15], v[48:51], v[180:183]
  v_mfma_f32_16x16x32_bf16 v[184:187], v[16:19], v[48:51], v[184:187]
  v_mfma_f32_16x16x32_bf16 v[188:191], v[20:23], v[48:51], v[188:191]
  v_mfma_f32_16x16x32_bf16 v[96:99], v[28:31], v[8:11], v[96:99]
  v_mfma_f32_16x16x32_bf16 v[100:103], v[28:31], v[12:15], v[100:103]
  v_mfma_f32_16x16x32_bf16 v[104:107], v[28:31], v[16:19], v[104:107]
  v_mfma_f32_16x16x32_bf16 v[84:87], v[88:91], v[24:27], v[84:87]
  v_mfma_f32_16x16x32_bf16 v[108:111], v[28:31], v[20:23], v[108:111]
  v_mfma_f32_16x16x32_bf16 v[112:115], v[32:35], v[8:11], v[112:115]
  v_mfma_f32_16x16x32_bf16 v[116:119], v[32:35], v[12:15], v[116:119]
  v_mfma_f32_16x16x32_bf16 v[120:123], v[32:35], v[16:19], v[120:123]
  v_mfma_f32_16x16x32_bf16 v[124:127], v[32:35], v[20:23], v[124:127]
  v_mfma_f32_16x16x32_bf16 v[192:195], v[52:55], v[8:11], v[192:195]
  v_mfma_f32_16x16x32_bf16 v[196:199], v[52:55], v[12:15], v[196:199]
  v_mfma_f32_16x16x32_bf16 v[200:203], v[52:55], v[16:19], v[200:203]
  v_mfma_f32_16x16x32_bf16 v[204:207], v[52:55], v[20:23], v[204:207]
  v_mfma_f32_16x16x32_bf16 v[208:211], v[56:59], v[8:11], v[208:211]
  v_mfma_f32_16x16x32_bf16 v[212:215], v[56:59], v[12:15], v[212:215]
  v_mfma_f32_16x16x32_bf16 v[216:219], v[56:59], v[16:19], v[216:219]
  v_mfma_f32_16x16x32_bf16 v[220:223], v[56:59], v[20:23], v[220:223]
  v_mfma_f32_16x16x32_bf16 v[224:227], v[60:63], v[8:11], v[224:227]
  v_mfma_f32_16x16x32_bf16 v[228:231], v[60:63], v[12:15], v[228:231]
  v_mfma_f32_16x16x32_bf16 v[232:235], v[60:63], v[16:19], v[232:235]
  v_mfma_f32_16x16x32_bf16 v[236:239], v[60:63], v[20:23], v[236:239]
  v_mfma_f32_16x16x32_bf16 v[240:243], v[64:67], v[8:11], v[240:243]
  v_mfma_f32_16x16x32_bf16 v[244:247], v[64:67], v[12:15], v[244:247]
  v_mfma_f32_16x16x32_bf16 v[248:251], v[64:67], v[16:19], v[248:251]
  v_mfma_f32_16x16x32_bf16 v[252:255], v[64:67], v[20:23], v[252:255]
  s_waitcnt vmcnt(11)
  s_barrier
  .p2align 3
  s_add_u32 m0, s70, 0
  s_nop 0
  buffer_load_dwordx4 v68, s[40:43], s60 offen lds
  ds_read_b128 v[8:11], v74 offset:0
  ds_read_b128 v[12:15], v74 offset:2048
  ds_read_b128 v[16:19], v74 offset:4096
  ds_read_b128 v[20:23], v74 offset:6144
  ds_read_b128 v[24:27], v76 offset:0
  ds_read_b64_tr_b16 v[28:29], v77 offset:20480
  s_add_u32 s60, s60, s65
  s_add_u32 m0, s71, 0
  s_nop 0
  buffer_load_dwordx4 v69, s[44:47], s61 offen lds
  ds_read_b64_tr_b16 v[30:31], v77 offset:23552
  ds_read_b64_tr_b16 v[32:33], v79 offset:20512
  ds_read_b64_tr_b16 v[34:35], v79 offset:23584
  ds_read_b64_tr_b16 v[36:37], v77 offset:20544
  ds_read_b64_tr_b16 v[38:39], v77 offset:23616
  s_add_u32 s61, s61, s66
  s_add_u32 m0, s72, 0
  s_nop 0
  buffer_load_dwordx4 v70, s[48:51], s62 offen lds
  ds_read_b64_tr_b16 v[40:41], v79 offset:20576
  ds_read_b64_tr_b16 v[42:43], v79 offset:23648
  ds_read_b64_tr_b16 v[44:45], v77 offset:20608
  ds_read_b64_tr_b16 v[46:47], v77 offset:23680
  ds_read_b64_tr_b16 v[48:49], v79 offset:20640
  ds_read_b64_tr_b16 v[50:51], v79 offset:23712
  s_add_u32 s62, s62, s67
  s_add_u32 m0, s73, 0
  s_nop 0
  buffer_load_dwordx4 v71, s[52:55], s63 offen lds
  ds_read_b64_tr_b16 v[52:53], v81 offset:20480
  ds_read_b64_tr_b16 v[54:55], v81 offset:24064
  ds_read_b64_tr_b16 v[56:57], v81 offset:20512
  ds_read_b64_tr_b16 v[58:59], v81 offset:24096
  ds_read_b64_tr_b16 v[60:61], v81 offset:27648
  s_add_u32 s63, s63, s68
  s_add_u32 m0, s74, 0
  s_nop 0
  buffer_load_dwordx4 v72, s[56:59], s64 offen lds
  s_add_u32 s64, s64, s69
  ds_read_b64_tr_b16 v[62:63], v81 offset:31232
  ds_read_b64_tr_b16 v[64:65], v81 offset:27680
  ds_read_b64_tr_b16 v[66:67], v81 offset:31264
  v_add_u32 v1, s38, v81
  ds_read_b64_tr_b16 v[88:89], v1 offset:20480
  ds_read_b64_tr_b16 v[90:91], v1 offset:24064
  s_sub_u32 s12, s75, 5
  s_cmp_le_u32 s12, 1
  s_cbranch_scc0 L_X3_noclr0
  s_sub_u32 s12, 6, s75
  s_lshl_b32 s12, s12, 14
  v_mov_b32 v2, -1
  v_mov_b32 v3, -1
  v_mov_b32 v4, -1
  v_mov_b32 v5, -1
  v_lshlrev_b32 v1, 4, v0
  buffer_store_dwordx4 v[2:5], v1, s[88:91], s12 offen offset:0 sc1
L_X3_noclr0:
  s_waitcnt lgkmcnt(0)
  s_barrier
  .p2align 3
  v_mfma_f32_16x16x32_bf16 v[92:95], v[24:27], v[48:51], v[92:95]
  v_mfma_f32_16x16x32_bf16 v[128:131], v[36:39], v[8:11], v[128:131]
  v_mfma_f32_16x16x32_bf16 v[132:135], v[36:39], v[12:15], v[132:135]
  v_mfma_f32_16x16x32_bf16 v[136:139], v[36:39], v[16:19], v[136:139]
  v_mfma_f32_16x16x32_bf16 v[140:143], v[36:39], v[20:23], v[140:143]
  v_mfma_f32_16x16x32_bf16 v[144:147], v[40:43], v[8:11], v[144:147]
  v_mfma_f32_16x16x32_bf16 v[148:151], v[40:43], v[12:15], v[148:151]
  v_mfma_f32_16x16x32_bf16 v[152:155], v[40:43], v[16:19], v[152:155]
  v_mfma_f32_16x16x32_bf16 v[156:159], v[40:43], v[20:23], v[156:159]
  v_mfma_f32_16x16x32_bf16 v[160:163], v[8:11], v[44:47], v[160:163]
  v_mfma_f32_16x16x32_bf16 v[164:167], v[12:15], v[44:47], v[164:167]
  v_mfma_f32_16x16x32_bf16 v[168:171], v[16:19], v[44:47], v[168:171]
  v_mfma_f32_16x16x32_bf16 v[172:175], v[20:23], v[44:47], v[172:175]
  v_mfma_f32_16x16x32_bf16 v[176:179], v[8:11], v[48:51], v[176:179]
  v_mfma_f32_16x16x32_bf16 v[180:183], v[12:15], v[48:51], v[180:183]
  v_mfma_f32_16x16x32_bf16 v[184:187], v[16:19], v[48:51], v[184:187]
  v_mfma_f32_16x16x32_bf16 v[188:191], v[20:23], v[48:51], v[188:191]
  v_mfma_f32_16x16x32_bf16 v[96:99], v[28:31], v[8:11], v[96:99]
  v_mfma_f32_16x16x32_bf16 v[100:103], v[28:31], v[12:15], v[100:103]
  v_mfma_f32_16x16x32_bf16 v[104:107], v[28:31], v[16:19], v[104:107]
  v_mfma_f32_16x16x32_bf16 v[84:87], v[88:91], v[24:27], v[84:87]
  v_mfma_f32_16x16x32_bf16 v[108:111], v[28:31], v[20:23], v[108:111]
  v_mfma_f32_16x16x32_bf16 v[112:115], v[32:35], v[8:11], v[112:115]
  v_mfma_f32_16x16x32_bf16 v[116:119], v[32:35], v[12:15], v[116:119]
  v_mfma_f32_16x16x32_bf16 v[120:123], v[32:35], v[16:19], v[120:123]
  v_mfma_f32_16x16x32_bf16 v[124:127], v[32:35], v[20:23], v[124:127]
  v_mfma_f32_16x16x32_bf16 v[192:195], v[52:55], v[8:11], v[192:195]
  v_mfma_f32_16x16x32_bf16 v[196:199], v[52:55], v[12:15], v[196:199]
  v_mfma_f32_16x16x32_bf16 v[200:203], v[52:55], v[16:19], v[200:203]
  v_mfma_f32_16x16x32_bf16 v[204:207], v[52:55], v[20:23], v[204:207]
  v_mfma_f32_16x16x32_bf16 v[208:211], v[56:59], v[8:11], v[208:211]
  v_mfma_f32_16x16x32_bf16 v[212:215], v[56:59], v[12:15], v[212:215]
  v_mfma_f32_16x16x32_bf16 v[216:219], v[56:59], v[16:19], v[216:219]
  v_mfma_f32_16x16x32_bf16 v[220:223], v[56:59], v[20:23], v[220:223]
  v_mfma_f32_16x16x32_bf16 v[224:227], v[60:63], v[8:11], v[224:227]
  v_mfma_f32_16x16x32_bf16 v[228:231], v[60:63], v[12:15], v[228:231]
  v_mfma_f32_16x16x32_bf16 v[232:235], v[60:63], v[16:19], v[232:235]
  v_mfma_f32_16x16x32_bf16 v[236:239], v[60:63], v[20:23], v[236:239]
  v_mfma_f32_16x16x32_bf16 v[240:243], v[64:67], v[8:11], v[240:243]
  v_mfma_f32_16x16x32_bf16 v[244:247], v[64:67], v[12:15], v[244:247]
  v_mfma_f32_16x16x32_bf16 v[248:251], v[64:67], v[16:19], v[248:251]
  v_mfma_f32_16x16x32_bf16 v[252:255], v[64:67], v[20:23], v[252:255]
  s_waitcnt vmcnt(11)
  s_barrier
  .p2align 3
  s_add_u32 m0, s70, 20480
  s_nop 0
  buffer_load_dwordx4 v68, s[40:43], s60 offen lds
  ds_read_b128 v[8:11], v73 offset:34816
  ds_read_b128 v[12:15], v73 offset:36864
  ds_read_b128 v[16:19], v73 offset:38912
  ds_read_b128 v[20:23], v73 offset:40960
  ds_read_b128 v[24:27], v75 offset:34816
  ds_read_b64_tr_b16 v[28:29], v78 offset:0
  s_add_u32 s60, s60, s65
  s_add_u32 m0, s71, 20480
  s_nop 0
  buffer_load_dwordx4 v69, s[44:47], s61 offen lds
  ds_read_b64_tr_b16 v[30:31], v78 offset:3072
  ds_read_b64_tr_b16 v[32:33], v80 offset:32
  ds_read_b64_tr_b16 v[34:35], v80 offset:3104
  ds_read_b64_tr_b16 v[36:37], v78 offset:64
  ds_read_b64_tr_b16 v[38:39], v78 offset:3136
  s_add_u32 s61, s61, s66
  s_add_u32 m0, s72, 20480
  s_nop 0
  buffer_load_dwordx4 v70, s[48:51], s62 offen lds
  ds_read_b64_tr_b16 v[40:41], v80 offset:96
  ds_read_b64_tr_b16 v[42:43], v80 offset:3168
  ds_read_b64_tr_b16 v[44:45], v78 offset:128
  ds_read_b64_tr_b16 v[46:47], v78 offset:3200
  ds_read_b64_tr_b16 v[48:49], v80 offset:160
  ds_read_b64_tr_b16 v[50:51], v80 offset:3232
  s_add_u32 s62, s62, s67
  s_add_u32 m0, s73, 20480
  s_nop 0
  buffer_load_dwordx4 v71, s[52:55], s63 offen lds
  ds_read_b64_tr_b16 v[52:53], v82 offset:0
  ds_read_b64_tr_b16 v[54:55], v82 offset:3584
  ds_read_b64_tr_b16 v[56:57], v82 offset:32
  ds_read_b64_tr_b16 v[58:59], v82 offset:3616
  ds_read_b64_tr_b16 v[60:61], v82 offset:7168
  s_add_u32 s63, s63, s68
  s_add_u32 m0, s74, 20480
  s_nop 0
  buffer_load_dwordx4 v72, s[56:59], s64 offen lds
  s_add_u32 s64, s64, s69
  ds_read_b64_tr_b16 v[62:63], v82 offset:10752
  ds_read_b64_tr_b16 v[64:65], v82 offset:7200
  ds_read_b64_tr_b16 v[66:67], v82 offset:10784
  v_add_u32 v1, s38, v82
  ds_read_b64_tr_b16 v[88:89], v1 offset:0
  ds_read_b64_tr_b16 v[90:91], v1 offset:3584
  s_cmp_eq_u32 s75, 6
  s_cbranch_scc0 L_X3_nocs
  s_cmp_ge_u32 s79, 6
  s_cbranch_scc1 L_X3_nocs
  s_add_u32 s12, s79, 8
  s_min_u32 s12, s12, 13
  s_lshl_b32 s13, s78, 4
  s_add_u32 s13, s13, s12
  s_lshl_b32 s13, s13, 6
  s_add_u32 s13, s13, 1048576
  s_add_u32 s16, s6, s13
  s_addc_u32 s17, s7, 0
  s_mov_b32 s18, 64
  s_mov_b32 s19, 0x20000
  v_lshlrev_b32 v1, 2, v0
  v_mov_b32 v2, -1
  buffer_store_dword v2, v1, s[16:19], 0 offen sc1
L_X3_nocs:
  s_sub_u32 s12, s75, 5
  s_cmp_le_u32 s12, 1
  s_cbranch_scc0 L_X3_noclr1
  s_sub_u32 s12, 6, s75
  s_lshl_b32 s12, s12, 14
  v_lshlrev_b32 v1, 4, v0
  buffer_store_dwordx4 v[2:5], v1, s[88:91], s12 offen offset:1024 sc1
L_X3_noclr1:
  s_waitcnt lgkmcnt(0)
  s_barrier
  .p2align 3
  v_mfma_f32_16x16x32_bf16 v[92:95], v[24:27], v[48:51], v[92:95]
  v_mfma_f32_16x16x32_bf16 v[128:131], v[36:39], v[8:11], v[128:131]
  v_mfma_f32_16x16x32_bf16 v[132:135], v[36:39], v[12:15], v[132:135]
  v_mfma_f32_16x16x32_bf16 v[136:139], v[36:39], v[16:19], v[136:139]
  v_mfma_f32_16x16x32_bf16 v[140:143], v[36:39], v[20:23], v[140:143]
  v_mfma_f32_16x16x32_bf16 v[144:147], v[40:43], v[8:11], v[144:147]
  v_mfma_f32_16x16x32_bf16 v[148:151], v[40:43], v[12:15], v[148:151]
  v_mfma_f32_16x16x32_bf16 v[152:155], v[40:43], v[16:19], v[152:155]
  v_mfma_f32_16x16x32_bf16 v[156:159], v[40:43], v[20:23], v[156:159]
  v_mfma_f32_16x16x32_bf16 v[160:163], v[8:11], v[44:47], v[160:163]
  v_mfma_f32_16x16x32_bf16 v[164:167], v[12:15], v[44:47], v[164:167]
  v_mfma_f32_16x16x32_bf16 v[168:171], v[16:19], v[44:47], v[168:171]
  v_mfma_f32_16x16x32_bf16 v[172:175], v[20:23], v[44:47], v[172:175]
  v_mfma_f32_16x16x32_bf16 v[176:179], v[8:11], v[48:51], v[176:179]
  v_mfma_f32_16x16x32_bf16 v[180:183], v[12:15], v[48:51], v[180:183]
  v_mfma_f32_16x16x32_bf16 v[184:187], v[16:19], v[48:51], v[184:187]
  v_mfma_f32_16x16x32_bf16 v[188:191], v[20:23], v[48:51], v[188:191]
  v_mfma_f32_16x16x32_bf16 v[96:99], v[28:31], v[8:11], v[96:99]
  v_mfma_f32_16x16x32_bf16 v[100:103], v[28:31], v[12:15], v[100:103]
  v_mfma_f32_16x16x32_bf16 v[104:107], v[28:31], v[16:19], v[104:107]
  v_mfma_f32_16x16x32_bf16 v[84:87], v[88:91], v[24:27], v[84:87]
  v_mfma_f32_16x16x32_bf16 v[108:111], v[28:31], v[20:23], v[108:111]
  v_mfma_f32_16x16x32_bf16 v[112:115], v[32:35], v[8:11], v[112:115]
  v_mfma_f32_16x16x32_bf16 v[116:119], v[32:35], v[12:15], v[116:119]
  v_mfma_f32_16x16x32_bf16 v[120:123], v[32:35], v[16:19], v[120:123]
  v_mfma_f32_16x16x32_bf16 v[124:127], v[32:35], v[20:23], v[124:127]
  v_mfma_f32_16x16x32_bf16 v[192:195], v[52:55], v[8:11], v[192:195]
  v_mfma_f32_16x16x32_bf16 v[196:199], v[52:55], v[12:15], v[196:199]
  v_mfma_f32_16x16x32_bf16 v[200:203], v[52:55], v[16:19], v[200:203]
  v_mfma_f32_16x16x32_bf16 v[204:207], v[52:55], v[20:23], v[204:207]
  v_mfma_f32_16x16x32_bf16 v[208:211], v[56:59], v[8:11], v[208:211]
  v_mfma_f32_16x16x32_bf16 v[212:215], v[56:59], v[12:15], v[212:215]
  v_mfma_f32_16x16x32_bf16 v[216:219], v[56:59], v[16:19], v[216:219]
  v_mfma_f32_16x16x32_bf16 v[220:223], v[56:59], v[20:23], v[220:223]
  v_mfma_f32_16x16x32_bf16 v[224:227], v[60:63], v[8:11], v[224:227]
  v_mfma_f32_16x16x32_bf16 v[228:231], v[60:63], v[12:15], v[228:231]
  v_mfma_f32_16x16x32_bf16 v[232:235], v[60:63], v[16:19], v[232:235]
  v_mfma_f32_16x16x32_bf16 v[236:239], v[60:63], v[20:23], v[236:239]
  v_mfma_f32_16x16x32_bf16 v[240:243], v[64:67], v[8:11], v[240:243]
  v_mfma_f32_16x16x32_bf16 v[244:247], v[64:67], v[12:15], v[244:247]
  v_mfma_f32_16x16x32_bf16 v[248:251], v[64:67], v[16:19], v[248:251]
  v_mfma_f32_16x16x32_bf16 v[252:255], v[64:67], v[20:23], v[252:255]
  s_waitcnt vmcnt(11)
  s_barrier
  .p2align 3
  s_add_u32 m0, s70, 40960
  s_nop 0
  buffer_load_dwordx4 v68, s[40:43], s60 offen lds
  ds_read_b128 v[8:11], v74 offset:34816
  ds_read_b128 v[12:15], v74 offset:36864
  ds_read_b128 v[16:19], v74 offset:38912
  ds_read_b128 v[20:23], v74 offset:40960
  ds_read_b128 v[24:27], v76 offset:34816
  ds_read_b64_tr_b16 v[28:29], v78 offset:20480
  s_add_u32 s60, s60, s65
  s_add_u32 m0, s71, 40960
  s_nop 0
  buffer_load_dwordx4 v69, s[44:47], s61 offen lds
  ds_read_b64_tr_b16 v[30:31], v78 offset:23552
  ds_read_b64_tr_b16 v[32:33], v80 offset:20512
  ds_read_b64_tr_b16 v[34:35], v80 offset:23584
  ds_read_b64_tr_b16 v[36:37], v78 offset:20544
  ds_read_b64_tr_b16 v[38:39], v78 offset:23616
  s_add_u32 s61, s61, s66
  s_add_u32 m0, s72, 40960
  s_nop 0
  buffer_load_dwordx4 v70, s[48:51], s62 offen lds
  ds_read_b64_tr_b16 v[40:41], v80 offset:20576
  ds_read_b64_tr_b16 v[42:43], v80 offset:23648
  ds_read_b64_tr_b16 v[44:45], v78 offset:20608
  ds_read_b64_tr_b16 v[46:47], v78 offset:23680
  ds_read_b64_tr_b16 v[48:49], v80 offset:20640
  ds_read_b64_tr_b16 v[50:51], v80 offset:23712
  s_add_u32 s62, s62, s67
  s_add_u32 m0, s73, 40960
  s_nop 0
  buffer_load_dwordx4 v71, s[52:55], s63 offen lds
  ds_read_b64_tr_b16 v[52:53], v82 offset:20480
  ds_read_b64_tr_b16 v[54:55], v82 offset:24064
  ds_read_b64_tr_b16 v[56:57], v82 offset:20512
  ds_read_b64_tr_b16 v[58:59], v82 offset:24096
  ds_read_b64_tr_b16 v[60:61], v82 offset:27648
  s_add_u32 s63, s63, s68
  s_add_u32 m0, s74, 40960
  s_nop 0
  buffer_load_dwordx4 v72, s[56:59], s64 offen lds
  s_add_u32 s64, s64, s69
  ds_read_b64_tr_b16 v[62:63], v82 offset:31232
  ds_read_b64_tr_b16 v[64:65], v82 offset:27680
  ds_read_b64_tr_b16 v[66:67], v82 offset:31264
  v_add_u32 v1, s38, v82
  ds_read_b64_tr_b16 v[88:89], v1 offset:20480
  ds_read_b64_tr_b16 v[90:91], v1 offset:24064
  s_sub_u32 s12, s75, 5
  s_cmp_le_u32 s12, 1
  s_cbranch_scc0 L_X3_noclr2
  s_sub_u32 s12, 6, s75
  s_lshl_b32 s12, s12, 14
  v_lshlrev_b32 v1, 4, v0
  buffer_store_dwordx4 v[2:5], v1, s[88:91], s12 offen offset:2048 sc1
L_X3_noclr2:
  s_waitcnt lgkmcnt(0)
  s_barrier
  .p2align 3
  v_mfma_f32_16x16x32_bf16 v[92:95], v[24:27], v[48:51], v[92:95]
  v_mfma_f32_16x16x32_bf16 v[128:131], v[36:39], v[8:11], v[128:131]
  v_mfma_f32_16x16x32_bf16 v[132:135], v[36:39], v[12:15], v[132:135]
  v_mfma_f32_16x16x32_bf16 v[136:139], v[36:39], v[16:19], v[136:139]
  v_mfma_f32_16x16x32_bf16 v[140:143], v[36:39], v[20:23], v[140:143]
  v_mfma_f32_16x16x32_bf16 v[144:147], v[40:43], v[8:11], v[144:147]
  v_mfma_f32_16x16x32_bf16 v[148:151], v[40:43], v[12:15], v[148:151]
  v_mfma_f32_16x16x32_bf16 v[152:155], v[40:43], v[16:19], v[152:155]
  v_mfma_f32_16x16x32_bf16 v[156:159], v[40:43], v[20:23], v[156:159]
  v_mfma_f32_16x16x32_bf16 v[160:163], v[8:11], v[44:47], v[160:163]
  v_mfma_f32_16x16x32_bf16 v[164:167], v[12:15], v[44:47], v[164:167]
  v_mfma_f32_16x16x32_bf16 v[168:171], v[16:19], v[44:47], v[168:171]
  v_mfma_f32_16x16x32_bf16 v[172:175], v[20:23], v[44:47], v[172:175]
  v_mfma_f32_16x16x32_bf16 v[176:179], v[8:11], v[48:51], v[176:179]
  v_mfma_f32_16x16x32_bf16 v[180:183], v[12:15], v[48:51], v[180:183]
  v_mfma_f32_16x16x32_bf16 v[184:187], v[16:19], v[48:51], v[184:187]
  v_mfma_f32_16x16x32_bf16 v[188:191], v[20:23], v[48:51], v[188:191]
  v_mfma_f32_16x16x32_bf16 v[96:99], v[28:31], v[8:11], v[96:99]
  v_mfma_f32_16x16x32_bf16 v[100:103], v[28:31], v[12:15], v[100:103]
  v_mfma_f32_16x16x32_bf16 v[104:107], v[28:31], v[16:19], v[104:107]
  v_mfma_f32_16x16x32_bf16 v[84:87], v[88:91], v[24:27], v[84:87]
  v_mfma_f32_16x16x32_bf16 v[108:111], v[28:31], v[20:23], v[108:111]
  v_mfma_f32_16x16x32_bf16 v[112:115], v[32:35], v[8:11], v[112:115]
  v_mfma_f32_16x16x32_bf16 v[116:119], v[32:35], v[12:15], v[116:119]
  v_mfma_f32_16x16x32_bf16 v[120:123], v[32:35], v[16:19], v[120:123]
  v_mfma_f32_16x16x32_bf16 v[124:127], v[32:35], v[20:23], v[124:127]
  v_mfma_f32_16x16x32_bf16 v[192:195], v[52:55], v[8:11], v[192:195]
  v_mfma_f32_16x16x32_bf16 v[196:199], v[52:55], v[12:15], v[196:199]
  v_mfma_f32_16x16x32_bf16 v[200:203], v[52:55], v[16:19], v[200:203]
  v_mfma_f32_16x16x32_bf16 v[204:207], v[52:55], v[20:23], v[204:207]
  v_mfma_f32_16x16x32_bf16 v[208:211], v[56:59], v[8:11], v[208:211]
  v_mfma_f32_16x16x32_bf16 v[212:215], v[56:59], v[12:15], v[212:215]
  v_mfma_f32_16x16x32_bf16 v[216:219], v[56:59], v[16:19], v[216:219]
  v_mfma_f32_16x16x32_bf16 v[220:223], v[56:59], v[20:23], v[220:223]
  v_mfma_f32_16x16x32_bf16 v[224:227], v[60:63], v[8:11], v[224:227]
  v_mfma_f32_16x16x32_bf16 v[228:231], v[60:63], v[12:15], v[228:231]
  v_mfma_f32_16x16x32_bf16 v[232:235], v[60:63], v[16:19], v[232:235]
  v_mfma_f32_16x16x32_bf16 v[236:239], v[60:63], v[20:23], v[236:239]
  v_mfma_f32_16x16x32_bf16 v[240:243], v[64:67], v[8:11], v[240:243]
  v_mfma_f32_16x16x32_bf16 v[244:247], v[64:67], v[12:15], v[244:247]
  v_mfma_f32_16x16x32_bf16 v[248:251], v[64:67], v[16:19], v[248:251]
  v_mfma_f32_16x16x32_bf16 v[252:255], v[64:67], v[20:23], v[252:255]
  s_waitcnt vmcnt(10)
  s_barrier
  .p2align 3
  s_add_u32 m0, s70, 61440
  s_nop 0
  buffer_load_dwordx4 v68, s[40:43], s60 offen lds
  ds_read_b128 v[8:11], v73 offset:0
  ds_read_b128 v[12:15], v73 offset:2048
  ds_read_b128 v[16:19], v73 offset:4096
  ds_read_b128 v[20:23], v73 offset:6144
  ds_read_b128 v[24:27], v75 offset:0
  s_add_u32 s60, s60, s65
  s_add_u32 m0, s71, 61440
  s_nop 0
  buffer_load_dwordx4 v69, s[44:47], s61 offen lds
  ds_read_b64_tr_b16 v[28:29], v77 offset:0
  ds_read_b64_tr_b16 v[30:31], v77 offset:3072
  ds_read_b64_tr_b16 v[32:33], v79 offset:32
  ds_read_b64_tr_b16 v[34:35], v79 offset:3104
  s_add_u32 s61, s61, s66
  s_add_u32 m0, s72, 61440
  s_nop 0
  buffer_load_dwordx4 v70, s[48:51], s62 offen lds
  ds_read_b64_tr_b16 v[36:37], v77 offset:64
  ds_read_b64_tr_b16 v[38:39], v77 offset:3136
  ds_read_b64_tr_b16 v[40:41], v79 offset:96
  ds_read_b64_tr_b16 v[42:43], v79 offset:3168
  ds_read_b64_tr_b16 v[44:45], v77 offset:128
  s_add_u32 s62, s62, s67
  s_add_u32 m0, s73, 61440
  s_nop 0
  buffer_load_dwordx4 v71, s[52:55], s63 offen lds
  ds_read_b64_tr_b16 v[46:47], v77 offset:3200
  ds_read_b64_tr_b16 v[48:49], v79 offset:160
  ds_read_b64_tr_b16 v[50:51], v79 offset:3232
  ds_read_b64_tr_b16 v[52:53], v81 offset:0
  ds_read_b64_tr_b16 v[54:55], v81 offset:3584
  s_add_u32 s63, s63, s68
  s_add_u32 m0, s74, 61440
  s_nop 0
  buffer_load_dwordx4 v72, s[56:59], s64 offen lds
  s_add_u32 s64, s64, s69
  ds_read_b64_tr_b16 v[56:57], v81 offset:32
  ds_read_b64_tr_b16 v[58:59], v81 offset:3616
  ds_read_b64_tr_b16 v[60:61], v81 offset:7168
  ds_read_b64_tr_b16 v[62:63], v81 offset:10752
  s_cmp_eq_u32 s75, 1
  s_cbranch_scc1 L_cpf3
  buffer_load_dword v6, v83, s[24:27], s28 offen
  s_add_u32 s28, s28, 256
  s_branch L_cpf3_d
L_cpf3:
  s_mul_i32 s16, s2, 28672
  s_add_u32 s16, s84, s16
  s_addc_u32 s17, s85, 0
  s_mov_b32 s18, 28672
  s_mov_b32 s19, 0x20000
  s_mov_b32 s20, 24576
  v_lshlrev_b32 v2, 7, v0
  buffer_load_dword v6, v2, s[16:19], s20 offen
L_cpf3_d:
  ds_read_b64_tr_b16 v[64:65], v81 offset:7200
  ds_read_b64_tr_b16 v[66:67], v81 offset:10784
  v_add_u32 v1, s38, v81
  ds_read_b64_tr_b16 v[88:89], v1 offset:0
  ds_read_b64_tr_b16 v[90:91], v1 offset:3584
  s_sub_u32 s12, s75, 5
  s_cmp_le_u32 s12, 1
  s_cbranch_scc0 L_X3_noclr3
  s_sub_u32 s12, 6, s75
  s_lshl_b32 s12, s12, 14
  v_lshlrev_b32 v1, 4, v0
  buffer_store_dwordx4 v[2:5], v1, s[88:91], s12 offen offset:3072 sc1
L_X3_noclr3:
  s_waitcnt lgkmcnt(0)
  s_barrier
  s_sub_u32 s75, s75, 1
  s_cmp_lg_u32 s75, 0
  s_cbranch_scc1 L_X3_loop
  s_load_dwordx2 s[24:25], s[0:1], 16
  s_load_dwordx2 s[26:27], s[0:1], 48
  .p2align 3
  v_mfma_f32_16x16x32_bf16 v[92:95], v[24:27], v[48:51], v[92:95]
  v_mfma_f32_16x16x32_bf16 v[128:131], v[36:39], v[8:11], v[128:131]
  v_mfma_f32_16x16x32_bf16 v[132:135], v[36:39], v[12:15], v[132:135]
  v_mfma_f32_16x16x32_bf16 v[136:139], v[36:39], v[16:19], v[136:139]
  v_mfma_f32_16x16x32_bf16 v[140:143], v[36:39], v[20:23], v[140:143]
  v_mfma_f32_16x16x32_bf16 v[144:147], v[40:43], v[8:11], v[144:147]
  v_mfma_f32_16x16x32_bf16 v[148:151], v[40:43], v[12:15], v[148:151]
  v_mfma_f32_16x16x32_bf16 v[152:155], v[40:43], v[16:19], v[152:155]
  v_mfma_f32_16x16x32_bf16 v[156:159], v[40:43], v[20:23], v[156:159]
  v_mfma_f32_16x16x32_bf16 v[160:163], v[8:11], v[44:47], v[160:163]
  v_mfma_f32_16x16x32_bf16 v[164:167], v[12:15], v[44:47], v[164:167]
  v_mfma_f32_16x16x32_bf16 v[168:171], v[16:19], v[44:47], v[168:171]
  v_mfma_f32_16x16x32_bf16 v[172:175], v[20:23], v[44:47], v[172:175]
  v_mfma_f32_16x16x32_bf16 v[176:179], v[8:11], v[48:51], v[176:179]
  v_mfma_f32_16x16x32_bf16 v[180:183], v[12:15], v[48:51], v[180:183]
  v_mfma_f32_16x16x32_bf16 v[184:187], v[16:19], v[48:51], v[184:187]
  v_mfma_f32_16x16x32_bf16 v[188:191], v[20:23], v[48:51], v[188:191]
  v_mfma_f32_16x16x32_bf16 v[96:99], v[28:31], v[8:11], v[96:99]
  v_mfma_f32_16x16x32_bf16 v[100:103], v[28:31], v[12:15], v[100:103]
  v_mfma_f32_16x16x32_bf16 v[104:107], v[28:31], v[16:19], v[104:107]
  v_mfma_f32_16x16x32_bf16 v[84:87], v[88:91], v[24:27], v[84:87]
  v_mfma_f32_16x16x32_bf16 v[108:111], v[28:31], v[20:23], v[108:111]
  v_mfma_f32_16x16x32_bf16 v[112:115], v[32:35], v[8:11], v[112:115]
  v_mfma_f32_16x16x32_bf16 v[116:119], v[32:35], v[12:15], v[116:119]
  v_mfma_f32_16x16x32_bf16 v[120:123], v[32:35], v[16:19], v[120:123]
  v_mfma_f32_16x16x32_bf16 v[124:127], v[32:35], v[20:23], v[124:127]
  v_mfma_f32_16x16x32_bf16 v[192:195], v[52:55], v[8:11], v[192:195]
  v_mfma_f32_16x16x32_bf16 v[196:199], v[52:55], v[12:15], v[196:199]
  v_mfma_f32_16x16x32_bf16 v[200:203], v[52:55], v[16:19], v[200:203]
  v_mfma_f32_16x16x32_bf16 v[204:207], v[52:55], v[20:23], v[204:207]
  v_mfma_f32_16x16x32_bf16 v[208:211], v[56:59], v[8:11], v[208:211]
  v_mfma_f32_16x16x32_bf16 v[212:215], v[56:59], v[12:15], v[212:215]
  v_mfma_f32_16x16x32_bf16 v[216:219], v[56:59], v[16:19], v[216:219]
  v_mfma_f32_16x16x32_bf16 v[220:223], v[56:59], v[20:23], v[220:223]
  v_mfma_f32_16x16x32_bf16 v[224:227], v[60:63], v[8:11], v[224:227]
  v_mfma_f32_16x16x32_bf16 v[228:231], v[60:63], v[12:15], v[228:231]
  v_mfma_f32_16x16x32_bf16 v[232:235], v[60:63], v[16:19], v[232:235]
  v_mfma_f32_16x16x32_bf16 v[236:239], v[60:63], v[20:23], v[236:239]
  v_mfma_f32_16x16x32_bf16 v[240:243], v[64:67], v[8:11], v[240:243]
  v_mfma_f32_16x16x32_bf16 v[244:247], v[64:67], v[12:15], v[244:247]
  v_mfma_f32_16x16x32_bf16 v[248:251], v[64:67], v[16:19], v[248:251]
  v_mfma_f32_16x16x32_bf16 v[252:255], v[64:67], v[20:23], v[252:255]
  s_waitcnt vmcnt(10)
  s_barrier
  ds_read_b128 v[8:11], v74 offset:0
  ds_read_b128 v[12:15], v74 offset:2048
  ds_read_b128 v[16:19], v74 offset:4096
  ds_read_b128 v[20:23], v74 offset:6144
  ds_read_b128 v[24:27], v76 offset:0
  ds_read_b64_tr_b16 v[28:29], v77 offset:20480
  ds_read_b64_tr_b16 v[30:31], v77 offset:23552
  ds_read_b64_tr_b16 v[32:33], v79 offset:20512
  ds_read_b64_tr_b16 v[34:35], v79 offset:23584
  ds_read_b64_tr_b16 v[36:37], v77 offset:20544
  ds_read_b64_tr_b16 v[38:39], v77 offset:23616
  ds_read_b64_tr_b16 v[40:41], v79 offset:20576
  ds_read_b64_tr_b16 v[42:43], v79 offset:23648
  ds_read_b64_tr_b16 v[44:45], v77 offset:20608
  ds_read_b64_tr_b16 v[46:47], v77 offset:23680
  ds_read_b64_tr_b16 v[48:49], v79 offset:20640
  ds_read_b64_tr_b16 v[50:51], v79 offset:23712
  ds_read_b64_tr_b16 v[52:53], v81 offset:20480
  ds_read_b64_tr_b16 v[54:55], v81 offset:24064
  ds_read_b64_tr_b16 v[56:57], v81 offset:20512
  ds_read_b64_tr_b16 v[58:59], v81 offset:24096
  ds_read_b64_tr_b16 v[60:61], v81 offset:27648
  ds_read_b64_tr_b16 v[62:63], v81 offset:31232
  ds_read_b64_tr_b16 v[64:65], v81 offset:27680
  ds_read_b64_tr_b16 v[66:67], v81 offset:31264
  v_add_u32 v1, s38, v81
  ds_read_b64_tr_b16 v[88:89], v1 offset:20480
  ds_read_b64_tr_b16 v[90:91], v1 offset:24064
  s_waitcnt lgkmcnt(0)
  s_barrier
  .p2align 3
  v_mfma_f32_16x16x32_bf16 v[92:95], v[24:27], v[48:51], v[92:95]
  v_mfma_f32_16x16x32_bf16 v[128:131], v[36:39], v[8:11], v[128:131]
  v_mfma_f32_16x16x32_bf16 v[132:135], v[36:39], v[12:15], v[132:135]
  v_mfma_f32_16x16x32_bf16 v[136:139], v[36:39], v[16:19], v[136:139]
  v_mfma_f32_16x16x32_bf16 v[140:143], v[36:39], v[20:23], v[140:143]
  v_mfma_f32_16x16x32_bf16 v[144:147], v[40:43], v[8:11], v[144:147]
  v_mfma_f32_16x16x32_bf16 v[148:151], v[40:43], v[12:15], v[148:151]
  v_mfma_f32_16x16x32_bf16 v[152:155], v[40:43], v[16:19], v[152:155]
  v_mfma_f32_16x16x32_bf16 v[156:159], v[40:43], v[20:23], v[156:159]
  v_mfma_f32_16x16x32_bf16 v[160:163], v[8:11], v[44:47], v[160:163]
  v_mfma_f32_16x16x32_bf16 v[164:167], v[12:15], v[44:47], v[164:167]
  v_mfma_f32_16x16x32_bf16 v[168:171], v[16:19], v[44:47], v[168:171]
  v_mfma_f32_16x16x32_bf16 v[172:175], v[20:23], v[44:47], v[172:175]
  v_mfma_f32_16x16x32_bf16 v[176:179], v[8:11], v[48:51], v[176:179]
  v_mfma_f32_16x16x32_bf16 v[180:183], v[12:15], v[48:51], v[180:183]
  v_mfma_f32_16x16x32_bf16 v[184:187], v[16:19], v[48:51], v[184:187]
  v_mfma_f32_16x16x32_bf16 v[188:191], v[20:23], v[48:51], v[188:191]
  v_mfma_f32_16x16x32_bf16 v[96:99], v[28:31], v[8:11], v[96:99]
  v_mfma_f32_16x16x32_bf16 v[100:103], v[28:31], v[12:15], v[100:103]
  v_mfma_f32_16x16x32_bf16 v[104:107], v[28:31], v[16:19], v[104:107]
  v_mfma_f32_16x16x32_bf16 v[84:87], v[88:91], v[24:27], v[84:87]
  v_mfma_f32_16x16x32_bf16 v[108:111], v[28:31], v[20:23], v[108:111]
  v_mfma_f32_16x16x32_bf16 v[112:115], v[32:35], v[8:11], v[112:115]
  v_mfma_f32_16x16x32_bf16 v[116:119], v[32:35], v[12:15], v[116:119]
  v_mfma_f32_16x16x32_bf16 v[120:123], v[32:35], v[16:19], v[120:123]
  v_mfma_f32_16x16x32_bf16 v[124:127], v[32:35], v[20:23], v[124:127]
  v_mfma_f32_16x16x32_bf16 v[192:195], v[52:55], v[8:11], v[192:195]
  v_mfma_f32_16x16x32_bf16 v[196:199], v[52:55], v[12:15], v[196:199]
  v_mfma_f32_16x16x32_bf16 v[200:203], v[52:55], v[16:19], v[200:203]
  v_mfma_f32_16x16x32_bf16 v[204:207], v[52:55], v[20:23], v[204:207]
  v_mfma_f32_16x16x32_bf16 v[208:211], v[56:59], v[8:11], v[208:211]
  v_mfma_f32_16x16x32_bf16 v[212:215], v[56:59], v[12:15], v[212:215]
  v_mfma_f32_16x16x32_bf16 v[216:219], v[56:59], v[16:19], v[216:219]
  v_mfma_f32_16x16x32_bf16 v[220:223], v[56:59], v[20:23], v[220:223]
  v_mfma_f32_16x16x32_bf16 v[224:227], v[60:63], v[8:11], v[224:227]
  v_mfma_f32_16x16x32_bf16 v[228:231], v[60:63], v[12:15], v[228:231]
  v_mfma_f32_16x16x32_bf16 v[232:235], v[60:63], v[16:19], v[232:235]
  v_mfma_f32_16x16x32_bf16 v[236:239], v[60:63], v[20:23], v[236:239]
  v_mfma_f32_16x16x32_bf16 v[240:243], v[64:67], v[8:11], v[240:243]
  v_mfma_f32_16x16x32_bf16 v[244:247], v[64:67], v[12:15], v[244:247]
  v_mfma_f32_16x16x32_bf16 v[248:251], v[64:67], v[16:19], v[248:251]
  v_mfma_f32_16x16x32_bf16 v[252:255], v[64:67], v[20:23], v[252:255]
  s_waitcnt vmcnt(5)
  s_barrier
  ds_read_b128 v[8:11], v73 offset:34816
  ds_read_b128 v[12:15], v73 offset:36864
  ds_read_b128 v[16:19], v73 offset:38912
  ds_read_b128 v[20:23], v73 offset:40960
  ds_read_b128 v[24:27], v75 offset:34816
  ds_read_b64_tr_b16 v[28:29], v78 offset:0
  ds_read_b64_tr_b16 v[30:31], v78 offset:3072
  ds_read_b64_tr_b16 v[32:33], v80 offset:32
  ds_read_b64_tr_b16 v[34:35], v80 offset:3104
  ds_read_b64_tr_b16 v[36:37], v78 offset:64
  ds_read_b64_tr_b16 v[38:39], v78 offset:3136
  ds_read_b64_tr_b16 v[40:41], v80 offset:96
  ds_read_b64_tr_b16 v[42:43], v80 offset:3168
  ds_read_b64_tr_b16 v[44:45], v78 offset:128
  ds_read_b64_tr_b16 v[46:47], v78 offset:3200
  ds_read_b64_tr_b16 v[48:49], v80 offset:160
  ds_read_b64_tr_b16 v[50:51], v80 offset:3232
  ds_read_b64_tr_b16 v[52:53], v82 offset:0
  ds_read_b64_tr_b16 v[54:55], v82 offset:3584
  ds_read_b64_tr_b16 v[56:57], v82 offset:32
  ds_read_b64_tr_b16 v[58:59], v82 offset:3616
  ds_read_b64_tr_b16 v[60:61], v82 offset:7168
  ds_read_b64_tr_b16 v[62:63], v82 offset:10752
  ds_read_b64_tr_b16 v[64:65], v82 offset:7200
  ds_read_b64_tr_b16 v[66:67], v82 offset:10784
  v_add_u32 v1, s38, v82
  ds_read_b64_tr_b16 v[88:89], v1 offset:0
  ds_read_b64_tr_b16 v[90:91], v1 offset:3584
  s_waitcnt lgkmcnt(0)
  s_barrier
  .p2align 3
  v_mfma_f32_16x16x32_bf16 v[92:95], v[24:27], v[48:51], v[92:95]
  v_mfma_f32_16x16x32_bf16 v[128:131], v[36:39], v[8:11], v[128:131]
  v_mfma_f32_16x16x32_bf16 v[132:135], v[36:39], v[12:15], v[132:135]
  v_mfma_f32_16x16x32_bf16 v[136:139], v[36:39], v[16:19], v[136:139]
  v_mfma_f32_16x16x32_bf16 v[140:143], v[36:39], v[20:23], v[140:143]
  v_mfma_f32_16x16x32_bf16 v[144:147], v[40:43], v[8:11], v[144:147]
  v_mfma_f32_16x16x32_bf16 v[148:151], v[40:43], v[12:15], v[148:151]
  v_mfma_f32_16x16x32_bf16 v[152:155], v[40:43], v[16:19], v[152:155]
  v_mfma_f32_16x16x32_bf16 v[156:159], v[40:43], v[20:23], v[156:159]
  v_mfma_f32_16x16x32_bf16 v[160:163], v[8:11], v[44:47], v[160:163]
  v_mfma_f32_16x16x32_bf16 v[164:167], v[12:15], v[44:47], v[164:167]
  v_mfma_f32_16x16x32_bf16 v[168:171], v[16:19], v[44:47], v[168:171]
  v_mfma_f32_16x16x32_bf16 v[172:175], v[20:23], v[44:47], v[172:175]
  v_mfma_f32_16x16x32_bf16 v[176:179], v[8:11], v[48:51], v[176:179]
  v_mfma_f32_16x16x32_bf16 v[180:183], v[12:15], v[48:51], v[180:183]
  v_mfma_f32_16x16x32_bf16 v[184:187], v[16:19], v[48:51], v[184:187]
  v_mfma_f32_16x16x32_bf16 v[188:191], v[20:23], v[48:51], v[188:191]
  v_mfma_f32_16x16x32_bf16 v[96:99], v[28:31], v[8:11], v[96:99]
  v_mfma_f32_16x16x32_bf16 v[100:103], v[28:31], v[12:15], v[100:103]
  v_mfma_f32_16x16x32_bf16 v[104:107], v[28:31], v[16:19], v[104:107]
  v_mfma_f32_16x16x32_bf16 v[84:87], v[88:91], v[24:27], v[84:87]
  v_mfma_f32_16x16x32_bf16 v[108:111], v[28:31], v[20:23], v[108:111]
  v_mfma_f32_16x16x32_bf16 v[112:115], v[32:35], v[8:11], v[112:115]
  v_mfma_f32_16x16x32_bf16 v[116:119], v[32:35], v[12:15], v[116:119]
  v_mfma_f32_16x16x32_bf16 v[120:123], v[32:35], v[16:19], v[120:123]
  v_mfma_f32_16x16x32_bf16 v[124:127], v[32:35], v[20:23], v[124:127]
  v_mfma_f32_16x16x32_bf16 v[192:195], v[52:55], v[8:11], v[192:195]
  v_mfma_f32_16x16x32_bf16 v[196:199], v[52:55], v[12:15], v[196:199]
  v_mfma_f32_16x16x32_bf16 v[200:203], v[52:55], v[16:19], v[200:203]
  v_mfma_f32_16x16x32_bf16 v[204:207], v[52:55], v[20:23], v[204:207]
  v_mfma_f32_16x16x32_bf16 v[208:211], v[56:59], v[8:11], v[208:211]
  v_mfma_f32_16x16x32_bf16 v[212:215], v[56:59], v[12:15], v[212:215]
  v_mfma_f32_16x16x32_bf16 v[216:219], v[56:59], v[16:19], v[216:219]
  v_mfma_f32_16x16x32_bf16 v[220:223], v[56:59], v[20:23], v[220:223]
  v_mfma_f32_16x16x32_bf16 v[224:227], v[60:63], v[8:11], v[224:227]
  v_mfma_f32_16x16x32_bf16 v[228:231], v[60:63], v[12:15], v[228:231]
  v_mfma_f32_16x16x32_bf16 v[232:235], v[60:63], v[16:19], v[232:235]
  v_mfma_f32_16x16x32_bf16 v[236:239], v[60:63], v[20:23], v[236:239]
  v_mfma_f32_16x16x32_bf16 v[240:243], v[64:67], v[8:11], v[240:243]
  v_mfma_f32_16x16x32_bf16 v[244:247], v[64:67], v[12:15], v[244:247]
  v_mfma_f32_16x16x32_bf16 v[248:251], v[64:67], v[16:19], v[248:251]
  v_mfma_f32_16x16x32_bf16 v[252:255], v[64:67], v[20:23], v[252:255]
  s_waitcnt vmcnt(0)
  s_barrier
  ds_read_b128 v[8:11], v74 offset:34816
  ds_read_b128 v[12:15], v74 offset:36864
  ds_read_b128 v[16:19], v74 offset:38912
  ds_read_b128 v[20:23], v74 offset:40960
  ds_read_b128 v[24:27], v76 offset:34816
  ds_read_b64_tr_b16 v[28:29], v78 offset:20480
  ds_read_b64_tr_b16 v[30:31], v78 offset:23552
  ds_read_b64_tr_b16 v[32:33], v80 offset:20512
  ds_read_b64_tr_b16 v[34:35], v80 offset:23584
  ds_read_b64_tr_b16 v[36:37], v78 offset:20544
  ds_read_b64_tr_b16 v[38:39], v78 offset:23616
  ds_read_b64_tr_b16 v[40:41], v80 offset:20576
  ds_read_b64_tr_b16 v[42:43], v80 offset:23648
  ds_read_b64_tr_b16 v[44:45], v78 offset:20608
  ds_read_b64_tr_b16 v[46:47], v78 offset:23680
  ds_read_b64_tr_b16 v[48:49], v80 offset:20640
  ds_read_b64_tr_b16 v[50:51], v80 offset:23712
  ds_read_b64_tr_b16 v[52:53], v82 offset:20480
  ds_read_b64_tr_b16 v[54:55], v82 offset:24064
  ds_read_b64_tr_b16 v[56:57], v82 offset:20512
  ds_read_b64_tr_b16 v[58:59], v82 offset:24096
  ds_read_b64_tr_b16 v[60:61], v82 offset:27648
  ds_read_b64_tr_b16 v[62:63], v82 offset:31232
  ds_read_b64_tr_b16 v[64:65], v82 offset:27680
  ds_read_b64_tr_b16 v[66:67], v82 offset:31264
  v_add_u32 v1, s38, v82
  ds_read_b64_tr_b16 v[88:89], v1 offset:20480
  ds_read_b64_tr_b16 v[90:91], v1 offset:24064
  s_waitcnt lgkmcnt(0)
  v_mfma_f32_16x16x32_bf16 v[84:87], v[88:91], v[24:27], v[84:87]
  s_cmp_ge_u32 s79, 6
  s_cbranch_scc1 L_X3_nopub
  s_add_u32 s12, s79, 8
  s_min_u32 s12, s12, 13
  s_lshl_b32 s13, s78, 4
  s_add_u32 s13, s13, s12
  s_lshl_b32 s13, s13, 6
  s_add_u32 s13, s13, 1048576
  s_add_u32 s16, s6, s13
  s_addc_u32 s17, s7, 0
  s_mov_b32 s18, 64
  s_mov_b32 s19, 0x20000
  v_lshrrev_b32 v4, 4, v0
  v_lshlrev_b32 v4, 4, v4
  s_mov_b32 s12, 0x00010001
  s_mov_b32 s13, 0x00010001
  s_mov_b64 exec, s[12:13]
  buffer_store_dwordx4 v[84:87], v4, s[16:19], 0 offen sc1
  s_mov_b64 exec, -1
L_X3_nopub:
  s_and_b32 s3, s2, 7
  s_lshr_b32 s16, s2, 3
  s_and_b32 s20, s16, 1
  s_lshr_b32 s16, s16, 1
  s_lshr_b32 s17, s3, 1
  s_lshl_b32 s17, s17, 2
  s_and_b32 s18, s16, 3
  s_add_u32 s21, s17, s18
  s_and_b32 s17, s3, 1
  s_lshl_b32 s17, s17, 2
  s_lshr_b32 s18, s16, 2
  s_add_u32 s22, s17, s18
  s_lshl_b32 s23, s21, 3
  s_add_u32 s23, s23, s22
  s_lshr_b32 s19, s76, 2
  s_mov_b32 s64, s24
  s_mov_b32 s65, s25
  s_mov_b32 s66, 2097152
  s_mov_b32 s67, 0x20000
  s_lshl_b32 s16, s20, 4
  s_lshl_b32 s17, s19, 1
  s_add_u32 s16, s16, s17
  s_lshl_b32 s73, s16, 16
  s_mov_b32 s70, 262144
  s_mov_b32 s72, 65536
  s_mov_b32 s68, 4
  s_mov_b32 s69, 0
  s_mul_i32 s16, s20, 56
  s_mul_i32 s17, s19, 7
  s_add_u32 s18, s16, s17
  s_lshl_b32 s80, s18, 16
  s_mul_i32 s17, s19, 3
  s_add_u32 s18, s16, s17
  s_add_u32 s18, s18, 1
  s_lshl_b32 s81, s18, 16
  s_mul_i32 s17, s19, 14
  s_add_u32 s18, s16, s17
  s_add_u32 s18, s18, 6
  s_lshl_b32 s82, s18, 16
  s_mul_i32 s17, s19, 49152
  s_lshl_b32 s18, s77, 11
  s_add_u32 s74, s17, s18
  v_lshrrev_b32 v3, 4, v0
  v_lshlrev_b32 v4, 1, v3
  v_and_b32 v2, 15, v0
  v_xor_b32 v6, v4, v2
  v_xor_b32 v2, 8, v6
  s_lshl_b32 s17, s77, 3
  v_add_u32 v3, s17, v3
  v_lshlrev_b32 v3, 11, v3
  s_lshl_b32 s17, s22, 8
  v_add_u32 v3, s17, v3
  v_lshl_add_u32 v68, v6, 4, v3
  v_lshl_add_u32 v69, v2, 4, v3
  v_add_u32 v69, 8192, v69
  s_add_u32 m0, s74, 0
  s_add_u32 s75, s73, s72
  buffer_load_dwordx4 v68, s[64:67], s73 offen lds
  s_add_u32 m0, s74, 1024
  s_sub_u32 s68, s68, 1
  buffer_load_dwordx4 v69, s[64:67], s73 offen lds
  s_add_u32 m0, s74, 8192
  s_add_u32 s73, s73, s70
  buffer_load_dwordx4 v68, s[64:67], s75 offen lds
  s_add_u32 m0, s74, 9216
  s_cmp_eq_u32 s68, 0
  buffer_load_dwordx4 v69, s[64:67], s75 offen lds
  s_cbranch_scc0 L_bo7
  s_add_u32 s69, s69, 1
  s_mov_b32 s64, s26
  s_mov_b32 s65, s27
  s_mov_b32 s66, 7340032
  s_mov_b32 s73, s80
  s_mov_b32 s70, 917504
  s_mov_b32 s72, 196608
  s_mov_b32 s68, 4
  s_cmp_eq_u32 s69, 1
  s_cbranch_scc1 L_bo7
  s_mov_b32 s73, s81
  s_mov_b32 s70, 458752
  s_mov_b32 s72, 65536
  s_mov_b32 s68, 8
  s_cmp_eq_u32 s69, 2
  s_cbranch_scc1 L_bo7
  s_mov_b32 s73, s82
  s_mov_b32 s70, 1835008
  s_mov_b32 s72, 458752
  s_mov_b32 s68, 2
  s_cmp_eq_u32 s69, 3
  s_cbranch_scc1 L_bo7
  s_mov_b32 s66, 0
  s_mov_b32 s68, 64
L_bo7:
  s_add_u32 m0, s74, 16384
  s_add_u32 s75, s73, s72
  buffer_load_dwordx4 v68, s[64:67], s73 offen lds
  s_add_u32 m0, s74, 17408
  s_sub_u32 s68, s68, 1
  buffer_load_dwordx4 v69, s[64:67], s73 offen lds
  s_add_u32 m0, s74, 24576
  s_add_u32 s73, s73, s70
  buffer_load_dwordx4 v68, s[64:67], s75 offen lds
  s_add_u32 m0, s74, 25600
  s_cmp_eq_u32 s68, 0
  buffer_load_dwordx4 v69, s[64:67], s75 offen lds
  s_cbranch_scc0 L_bo8
  s_add_u32 s69, s69, 1
  s_mov_b32 s64, s26
  s_mov_b32 s65, s27
  s_mov_b32 s66, 7340032
  s_mov_b32 s73, s80
  s_mov_b32 s70, 917504
  s_mov_b32 s72, 196608
  s_mov_b32 s68, 4
  s_cmp_eq_u32 s69, 1
  s_cbranch_scc1 L_bo8
  s_mov_b32 s73, s81
  s_mov_b32 s70, 458752
  s_mov_b32 s72, 65536
  s_mov_b32 s68, 8
  s_cmp_eq_u32 s69, 2
  s_cbranch_scc1 L_bo8
  s_mov_b32 s73, s82
  s_mov_b32 s70, 1835008
  s_mov_b32 s72, 458752
  s_mov_b32 s68, 2
  s_cmp_eq_u32 s69, 3
  s_cbranch_scc1 L_bo8
  s_mov_b32 s66, 0
  s_mov_b32 s68, 64
L_bo8:
  s_waitcnt lgkmcnt(0)
  s_barrier
  .p2align 3
  v_mfma_f32_16x16x32_bf16 v[92:95], v[24:27], v[48:51], v[92:95]
  v_mfma_f32_16x16x32_bf16 v[128:131], v[36:39], v[8:11], v[128:131]
  v_mfma_f32_16x16x32_bf16 v[132:135], v[36:39], v[12:15], v[132:135]
  v_mfma_f32_16x16x32_bf16 v[136:139], v[36:39], v[16:19], v[136:139]
  v_mfma_f32_16x16x32_bf16 v[140:143], v[36:39], v[20:23], v[140:143]
  v_mfma_f32_16x16x32_bf16 v[144:147], v[40:43], v[8:11], v[144:147]
  v_mfma_f32_16x16x32_bf16 v[148:151], v[40:43], v[12:15], v[148:151]
  v_mfma_f32_16x16x32_bf16 v[152:155], v[40:43], v[16:19], v[152:155]
  v_mfma_f32_16x16x32_bf16 v[156:159], v[40:43], v[20:23], v[156:159]
  v_mfma_f32_16x16x32_bf16 v[160:163], v[8:11], v[44:47], v[160:163]
  v_mfma_f32_16x16x32_bf16 v[164:167], v[12:15], v[44:47], v[164:167]
  v_mfma_f32_16x16x32_bf16 v[168:171], v[16:19], v[44:47], v[168:171]
  v_mfma_f32_16x16x32_bf16 v[172:175], v[20:23], v[44:47], v[172:175]
  v_mfma_f32_16x16x32_bf16 v[176:179], v[8:11], v[48:51], v[176:179]
  v_mfma_f32_16x16x32_bf16 v[180:183], v[12:15], v[48:51], v[180:183]
  v_mfma_f32_16x16x32_bf16 v[184:187], v[16:19], v[48:51], v[184:187]
  v_mfma_f32_16x16x32_bf16 v[188:191], v[20:23], v[48:51], v[188:191]
  v_mfma_f32_16x16x32_bf16 v[96:99], v[28:31], v[8:11], v[96:99]
  v_mfma_f32_16x16x32_bf16 v[100:103], v[28:31], v[12:15], v[100:103]
  v_mfma_f32_16x16x32_bf16 v[104:107], v[28:31], v[16:19], v[104:107]
  v_mfma_f32_16x16x32_bf16 v[108:111], v[28:31], v[20:23], v[108:111]
  v_mfma_f32_16x16x32_bf16 v[112:115], v[32:35], v[8:11], v[112:115]
  v_mfma_f32_16x16x32_bf16 v[116:119], v[32:35], v[12:15], v[116:119]
  v_mfma_f32_16x16x32_bf16 v[120:123], v[32:35], v[16:19], v[120:123]
  v_mfma_f32_16x16x32_bf16 v[124:127], v[32:35], v[20:23], v[124:127]
  v_mfma_f32_16x16x32_bf16 v[192:195], v[52:55], v[8:11], v[192:195]
  v_mfma_f32_16x16x32_bf16 v[196:199], v[52:55], v[12:15], v[196:199]
  v_mfma_f32_16x16x32_bf16 v[200:203], v[52:55], v[16:19], v[200:203]
  v_mfma_f32_16x16x32_bf16 v[204:207], v[52:55], v[20:23], v[204:207]
  v_mfma_f32_16x16x32_bf16 v[208:211], v[56:59], v[8:11], v[208:211]
  v_mfma_f32_16x16x32_bf16 v[212:215], v[56:59], v[12:15], v[212:215]
  v_mfma_f32_16x16x32_bf16 v[216:219], v[56:59], v[16:19], v[216:219]
  v_mfma_f32_16x16x32_bf16 v[220:223], v[56:59], v[20:23], v[220:223]
  v_mfma_f32_16x16x32_bf16 v[224:227], v[60:63], v[8:11], v[224:227]
  v_mfma_f32_16x16x32_bf16 v[228:231], v[60:63], v[12:15], v[228:231]
  v_mfma_f32_16x16x32_bf16 v[232:235], v[60:63], v[16:19], v[232:235]
  v_mfma_f32_16x16x32_bf16 v[236:239], v[60:63], v[20:23], v[236:239]
  v_mfma_f32_16x16x32_bf16 v[240:243], v[64:67], v[8:11], v[240:243]
  v_mfma_f32_16x16x32_bf16 v[244:247], v[64:67], v[12:15], v[244:247]
  v_mfma_f32_16x16x32_bf16 v[248:251], v[64:67], v[16:19], v[248:251]
  v_mfma_f32_16x16x32_bf16 v[252:255], v[64:67], v[20:23], v[252:255]
  s_barrier
  s_mov_b32 s39, 3
  s_branch L_xepi
L_Y:
  s_add_u32 m0, s70, 0
  s_add_u32 s61, s60, 0
  buffer_load_dwordx4 v68, s[40:43], s61 offen lds
  s_add_u32 m0, s70, 1024
  s_add_u32 s61, s60, 16384
  buffer_load_dwordx4 v69, s[40:43], s61 offen lds
  s_add_u32 m0, s70, 2048
  s_add_u32 s61, s60, 32768
  buffer_load_dwordx4 v68, s[40:43], s61 offen lds
  s_add_u32 m0, s70, 3072
  s_add_u32 s61, s60, 49152
  buffer_load_dwordx4 v69, s[40:43], s61 offen lds
  s_add_u32 m0, s70, 4096
  s_add_u32 s61, s60, 65536
  buffer_load_dwordx4 v68, s[40:43], s61 offen lds
  s_add_u32 m0, s70, 5120
  s_add_u32 s61, s60, 81920
  buffer_load_dwordx4 v69, s[40:43], s61 offen lds
  s_add_u32 m0, s70, 6144
  s_add_u32 s61, s60, 98304
  buffer_load_dwordx4 v68, s[40:43], s61 offen lds
  s_add_u32 m0, s70, 7168
  s_add_u32 s61, s60, 114688
  buffer_load_dwordx4 v69, s[40:43], s61 offen lds
  s_add_u32 m0, s71, 0
  s_mov_b64 exec, s[62:63]
  buffer_load_dwordx4 v70, s[40:43], s60 offen lds
  s_mov_b64 exec, -1
  s_add_u32 s60, s60, 128
  buffer_load_dword v6, v83, s[48:51], s52 offen
  s_add_u32 s52, s52, s53
  buffer_load_dword v6, v83, s[48:51], s52 offen
  s_add_u32 s52, s52, s53
  s_cmp_eq_u32 s77, 0
  s_cbranch_scc0 L_Y_noones
  v_lshlrev_b32 v2, 2, v0
  v_mov_b32 v3, 0x3f803f80
  ds_write_b32 v2, v3 offset:32768
  v_add_u32 v2, 34816, v2
  ds_write_b32 v2, v3 offset:32768
  v_mov_b32 v2, 157184
  v_mov_b32 v3, 0
  ds_write_b32 v2, v3
L_Y_noones:
  s_waitcnt vmcnt(11)
  v_lshlrev_b32 v104, 16, v96
  v_and_b32 v105, 0xffff0000, v96
  v_lshlrev_b32 v106, 16, v97
  v_and_b32 v107, 0xffff0000, v97
  v_lshlrev_b32 v108, 16, v98
  v_and_b32 v109, 0xffff0000, v98
  v_lshlrev_b32 v110, 16, v99
  v_and_b32 v111, 0xffff0000, v99
  v_lshlrev_b32 v112, 16, v100
  v_and_b32 v113, 0xffff0000, v100
  v_lshlrev_b32 v114, 16, v101
  v_and_b32 v115, 0xffff0000, v101
  v_lshlrev_b32 v116, 16, v102
  v_and_b32 v117, 0xffff0000, v102
  v_lshlrev_b32 v118, 16, v103
  v_and_b32 v119, 0xffff0000, v103
  v_add_f32 v120, v104, v108
  v_add_f32 v124, v112, v116
  v_add_f32 v121, v105, v109
  v_add_f32 v125, v113, v117
  v_add_f32 v122, v106, v110
  v_add_f32 v126, v114, v118
  v_add_f32 v123, v107, v111
  v_add_f32 v127, v115, v119
  v_add_f32 v120, v120, v124
  v_add_f32 v121, v121, v125
  v_add_f32 v122, v122, v126
  v_add_f32 v123, v123, v127
  v_add_f32 v120, v120, v121
  v_add_f32 v122, v122, v123
  v_add_f32 v120, v120, v122
  s_nop 1
  v_add_f32_dpp v120, v120, v120 row_ror:8 row_mask:0xf bank_mask:0xf
  s_nop 1
  v_add_f32_dpp v120, v120, v120 row_ror:4 row_mask:0xf bank_mask:0xf
  s_nop 1
  v_add_f32_dpp v120, v120, v120 row_ror:2 row_mask:0xf bank_mask:0xf
  s_nop 1
  v_add_f32_dpp v120, v120, v120 row_ror:1 row_mask:0xf bank_mask:0xf
  v_mov_b32 v121, v120
  s_nop 1
  v_permlane16_swap_b32 v120, v121
  v_add_f32 v120, v120, v121
  v_mov_b32 v121, v120
  s_nop 1
  v_permlane32_swap_b32 v120, v121
  v_add_f32 v120, v120, v121
  v_mul_f32 v120, 0x3a800000, v120
  v_sub_f32 v104, v104, v120
  v_sub_f32 v105, v105, v120
  v_sub_f32 v106, v106, v120
  v_sub_f32 v107, v107, v120
  v_sub_f32 v108, v108, v120
  v_sub_f32 v109, v109, v120
  v_sub_f32 v110, v110, v120
  v_sub_f32 v111, v111, v120
  v_sub_f32 v112, v112, v120
  v_sub_f32 v113, v113, v120
  v_sub_f32 v114, v114, v120
  v_sub_f32 v115, v115, v120
  v_sub_f32 v116, v116, v120
  v_sub_f32 v117, v117, v120
  v_sub_f32 v118, v118, v120
  v_sub_f32 v119, v119, v120
  v_mul_f32 v124, v104, v104
  v_mul_f32 v125, v105, v105
  v_mul_f32 v126, v106, v106
  v_mul_f32 v127, v107, v107
  v_fmac_f32 v124, v108, v108
  v_fmac_f32 v125, v109, v109
  v_fmac_f32 v126, v110, v110
  v_fmac_f32 v127, v111, v111
  v_fmac_f32 v124, v112, v112
  v_fmac_f32 v125, v113, v113
  v_fmac_f32 v126, v114, v114
  v_fmac_f32 v127, v115, v115
  v_fmac_f32 v124, v116, v116
  v_fmac_f32 v125, v117, v117
  v_fmac_f32 v126, v118, v118
  v_fmac_f32 v127, v119, v119
  v_add_f32 v124, v124, v125
  v_add_f32 v126, v126, v127
  v_add_f32 v124, v124, v126
  s_nop 1
  v_add_f32_dpp v124, v124, v124 row_ror:8 row_mask:0xf bank_mask:0xf
  s_nop 1
  v_add_f32_dpp v124, v124, v124 row_ror:4 row_mask:0xf bank_mask:0xf
  s_nop 1
  v_add_f32_dpp v124, v124, v124 row_ror:2 row_mask:0xf bank_mask:0xf
  s_nop 1
  v_add_f32_dpp v124, v124, v124 row_ror:1 row_mask:0xf bank_mask:0xf
  v_mov_b32 v125, v124
  s_nop 1
  v_permlane16_swap_b32 v124, v125
  v_add_f32 v124, v124, v125
  v_mov_b32 v125, v124
  s_nop 1
  v_permlane32_swap_b32 v124, v125
  v_add_f32 v124, v124, v125
  v_mov_b32 v122, 0x3727c5ac
  v_fmac_f32 v122, 0x3a800000, v124
  v_rsq_f32 v121, v122
  v_mov_b32 v123, 0
  s_mov_b32 s16, s6
  s_mov_b32 s17, s7
  s_mov_b32 s18, 32768
  s_mov_b32 s19, 0x20000
  s_lshl_b32 s14, s2, 3
  s_add_u32 s14, s14, s76
  s_lshl_b32 s14, s14, 4
  v_mov_b32 v2, s14
  v_cmp_eq_u32 vcc, 0, v0
  s_and_saveexec_b64 s[20:21], vcc
  buffer_store_dwordx4 v[120:123], v2, s[16:19], 0 offen sc1
  s_mov_b64 exec, s[20:21]
  v_mov_b32 v96, 0
  v_mov_b32 v97, 0
  v_mov_b32 v98, 0
  v_mov_b32 v99, 0
  v_mov_b32 v100, 0
  v_mov_b32 v101, 0
  v_mov_b32 v102, 0
  v_mov_b32 v103, 0
  v_mov_b32 v104, 0
  v_mov_b32 v105, 0
  v_mov_b32 v106, 0
  v_mov_b32 v107, 0
  v_mov_b32 v108, 0
  v_mov_b32 v109, 0
  v_mov_b32 v110, 0
  v_mov_b32 v111, 0
  v_mov_b32 v112, 0
  v_mov_b32 v113, 0
  v_mov_b32 v114, 0
  v_mov_b32 v115, 0
  v_mov_b32 v116, 0
  v_mov_b32 v117, 0
  v_mov_b32 v118, 0
  v_mov_b32 v119, 0
  v_mov_b32 v120, 0
  v_mov_b32 v121, 0
  v_mov_b32 v122, 0
  v_mov_b32 v123, 0
  v_mov_b32 v124, 0
  v_mov_b32 v125, 0
  v_mov_b32 v126, 0
  v_mov_b32 v127, 0
  v_mov_b32 v128, 0
  v_mov_b32 v129, 0
  v_mov_b32 v130, 0
  v_mov_b32 v131, 0
  v_mov_b32 v132, 0
  v_mov_b32 v133, 0
  v_mov_b32 v134, 0
  v_mov_b32 v135, 0
  v_mov_b32 v136, 0
  v_mov_b32 v137, 0
  v_mov_b32 v138, 0
  v_mov_b32 v139, 0
  v_mov_b32 v140, 0
  v_mov_b32 v141, 0
  v_mov_b32 v142, 0
  v_mov_b32 v143, 0
  v_mov_b32 v144, 0
  v_mov_b32 v145, 0
  v_mov_b32 v146, 0
  v_mov_b32 v147, 0
  v_mov_b32 v148, 0
  v_mov_b32 v149, 0
  v_mov_b32 v150, 0
  v_mov_b32 v151, 0
  v_mov_b32 v152, 0
  v_mov_b32 v153, 0
  v_mov_b32 v154, 0
  v_mov_b32 v155, 0
  v_mov_b32 v156, 0
  v_mov_b32 v157, 0
  v_mov_b32 v158, 0
  v_mov_b32 v159, 0
  v_mov_b32 v160, 0
  v_mov_b32 v161, 0
  v_mov_b32 v162, 0
  v_mov_b32 v163, 0
  v_mov_b32 v164, 0
  v_mov_b32 v165, 0
  v_mov_b32 v166, 0
  v_mov_b32 v167, 0
  v_mov_b32 v168, 0
  v_mov_b32 v169, 0
  v_mov_b32 v170, 0
  v_mov_b32 v171, 0
  v_mov_b32 v172, 0
  v_mov_b32 v173, 0
  v_mov_b32 v174, 0
  v_mov_b32 v175, 0
  v_mov_b32 v176, 0
  v_mov_b32 v177, 0
  v_mov_b32 v178, 0
  v_mov_b32 v179, 0
  v_mov_b32 v180, 0
  v_mov_b32 v181, 0
  v_mov_b32 v182, 0
  v_mov_b32 v183, 0
  v_mov_b32 v184, 0
  v_mov_b32 v185, 0
  v_mov_b32 v186, 0
  v_mov_b32 v187, 0
  v_mov_b32 v188, 0
  v_mov_b32 v189, 0
  v_mov_b32 v190, 0
  v_mov_b32 v191, 0
  v_mov_b32 v192, 0
  v_mov_b32 v193, 0
  v_mov_b32 v194, 0
  v_mov_b32 v195, 0
  v_mov_b32 v196, 0
  v_mov_b32 v197, 0
  v_mov_b32 v198, 0
  v_mov_b32 v199, 0
  v_mov_b32 v200, 0
  v_mov_b32 v201, 0
  v_mov_b32 v202, 0
  v_mov_b32 v203, 0
  v_mov_b32 v204, 0
  v_mov_b32 v205, 0
  v_mov_b32 v206, 0
  v_mov_b32 v207, 0
  v_mov_b32 v208, 0
  v_mov_b32 v209, 0
  v_mov_b32 v210, 0
  v_mov_b32 v211, 0
  v_mov_b32 v212, 0
  v_mov_b32 v213, 0
  v_mov_b32 v214, 0
  v_mov_b32 v215, 0
  v_mov_b32 v216, 0
  v_mov_b32 v217, 0
  v_mov_b32 v218, 0
  v_mov_b32 v219, 0
  v_mov_b32 v220, 0
  v_mov_b32 v221, 0
  v_mov_b32 v222, 0
  v_mov_b32 v223, 0
  v_mov_b32 v224, 0
  v_mov_b32 v225, 0
  v_mov_b32 v226, 0
  v_mov_b32 v227, 0
  v_mov_b32 v228, 0
  v_mov_b32 v229, 0
  v_mov_b32 v230, 0
  v_mov_b32 v231, 0
  v_mov_b32 v232, 0
  v_mov_b32 v233, 0
  v_mov_b32 v234, 0
  v_mov_b32 v235, 0
  v_mov_b32 v236, 0
  v_mov_b32 v237, 0
  v_mov_b32 v238, 0
  v_mov_b32 v239, 0
  v_mov_b32 v240, 0
  v_mov_b32 v241, 0
  v_mov_b32 v242, 0
  v_mov_b32 v243, 0
  v_mov_b32 v244, 0
  v_mov_b32 v245, 0
  v_mov_b32 v246, 0
  v_mov_b32 v247, 0
  v_mov_b32 v248, 0
  v_mov_b32 v249, 0
  v_mov_b32 v250, 0
  v_mov_b32 v251, 0
  v_mov_b32 v252, 0
  v_mov_b32 v253, 0
  v_mov_b32 v254, 0
  v_mov_b32 v255, 0
  s_waitcnt vmcnt(3) lgkmcnt(0)
  s_barrier
  s_barrier
  s_mov_b32 s75, 7
  .p2align 6
L_Y_loop:
  .p2align 3
  s_add_u32 m0, s70, 34816
  s_add_u32 s61, s60, 0
  buffer_load_dwordx4 v68, s[40:43], s61 offen lds
  ds_read_b128 v[8:11], v73 offset:0
  ds_read_b128 v[12:15], v73 offset:2048
  s_add_u32 m0, s70, 35840
  s_add_u32 s61, s60, 16384
  buffer_load_dwordx4 v69, s[40:43], s61 offen lds
  ds_read_b128 v[16:19], v73 offset:4096
  ds_read_b128 v[20:23], v73 offset:6144
  ds_read_b64_tr_b16 v[28:29], v81 offset:64
  s_add_u32 m0, s70, 36864
  s_add_u32 s61, s60, 32768
  buffer_load_dwordx4 v68, s[40:43], s61 offen lds
  ds_read_b64_tr_b16 v[30:31], v81 offset:3648
  ds_read_b64_tr_b16 v[32:33], v81 offset:96
  s_add_u32 m0, s70, 37888
  s_add_u32 s61, s60, 49152
  buffer_load_dwordx4 v69, s[40:43], s61 offen lds
  ds_read_b64_tr_b16 v[34:35], v81 offset:3680
  ds_read_b64_tr_b16 v[36:37], v81 offset:128
  ds_read_b64_tr_b16 v[38:39], v81 offset:3712
  s_add_u32 m0, s70, 38912
  s_add_u32 s61, s60, 65536
  buffer_load_dwordx4 v68, s[40:43], s61 offen lds
  ds_read_b64_tr_b16 v[40:41], v81 offset:160
  ds_read_b64_tr_b16 v[42:43], v81 offset:3744
  s_add_u32 m0, s70, 39936
  s_add_u32 s61, s60, 81920
  buffer_load_dwordx4 v69, s[40:43], s61 offen lds
  ds_read_b64_tr_b16 v[44:45], v81 offset:192
  ds_read_b64_tr_b16 v[46:47], v81 offset:3776
  s_add_u32 m0, s70, 40960
  s_add_u32 s61, s60, 98304
  buffer_load_dwordx4 v68, s[40:43], s61 offen lds
  ds_read_b64_tr_b16 v[48:49], v81 offset:7232
  ds_read_b64_tr_b16 v[50:51], v81 offset:10816
  ds_read_b64_tr_b16 v[52:53], v81 offset:7264
  s_add_u32 m0, s70, 41984
  s_add_u32 s61, s60, 114688
  buffer_load_dwordx4 v69, s[40:43], s61 offen lds
  ds_read_b64_tr_b16 v[54:55], v81 offset:10848
  ds_read_b64_tr_b16 v[56:57], v81 offset:7296
  s_add_u32 m0, s71, 34816
  s_mov_b64 exec, s[62:63]
  buffer_load_dwordx4 v70, s[40:43], s60 offen lds
  s_mov_b64 exec, -1
  s_add_u32 s60, s60, 128
  ds_read_b64_tr_b16 v[58:59], v81 offset:10880
  ds_read_b64_tr_b16 v[60:61], v81 offset:7328
  ds_read_b64_tr_b16 v[62:63], v81 offset:10912
  buffer_load_dword v6, v83, s[48:51], s52 offen
  s_add_u32 s52, s52, s53
  ds_read_b64_tr_b16 v[64:65], v81 offset:7360
  ds_read_b64_tr_b16 v[66:67], v81 offset:10944
  s_waitcnt lgkmcnt(0)
  s_barrier
  .p2align 3
  v_mfma_f32_16x16x32_bf16 v[96:99], v[28:31], v[8:11], v[96:99]
  v_mfma_f32_16x16x32_bf16 v[100:103], v[28:31], v[12:15], v[100:103]
  v_mfma_f32_16x16x32_bf16 v[104:107], v[28:31], v[16:19], v[104:107]
  v_mfma_f32_16x16x32_bf16 v[108:111], v[28:31], v[20:23], v[108:111]
  v_mfma_f32_16x16x32_bf16 v[112:115], v[32:35], v[8:11], v[112:115]
  v_mfma_f32_16x16x32_bf16 v[116:119], v[32:35], v[12:15], v[116:119]
  v_mfma_f32_16x16x32_bf16 v[120:123], v[32:35], v[16:19], v[120:123]
  v_mfma_f32_16x16x32_bf16 v[124:127], v[32:35], v[20:23], v[124:127]
  v_mfma_f32_16x16x32_bf16 v[128:131], v[36:39], v[8:11], v[128:131]
  v_mfma_f32_16x16x32_bf16 v[132:135], v[36:39], v[12:15], v[132:135]
  v_mfma_f32_16x16x32_bf16 v[136:139], v[36:39], v[16:19], v[136:139]
  v_mfma_f32_16x16x32_bf16 v[140:143], v[36:39], v[20:23], v[140:143]
  v_mfma_f32_16x16x32_bf16 v[144:147], v[40:43], v[8:11], v[144:147]
  v_mfma_f32_16x16x32_bf16 v[148:151], v[40:43], v[12:15], v[148:151]
  v_mfma_f32_16x16x32_bf16 v[152:155], v[40:43], v[16:19], v[152:155]
  v_mfma_f32_16x16x32_bf16 v[156:159], v[40:43], v[20:23], v[156:159]
  v_mfma_f32_16x16x32_bf16 v[160:163], v[44:47], v[8:11], v[160:163]
  v_mfma_f32_16x16x32_bf16 v[164:167], v[44:47], v[12:15], v[164:167]
  v_mfma_f32_16x16x32_bf16 v[168:171], v[44:47], v[16:19], v[168:171]
  v_mfma_f32_16x16x32_bf16 v[172:175], v[44:47], v[20:23], v[172:175]
  v_mfma_f32_16x16x32_bf16 v[176:179], v[48:51], v[8:11], v[176:179]
  v_mfma_f32_16x16x32_bf16 v[180:183], v[48:51], v[12:15], v[180:183]
  v_mfma_f32_16x16x32_bf16 v[184:187], v[48:51], v[16:19], v[184:187]
  v_mfma_f32_16x16x32_bf16 v[188:191], v[48:51], v[20:23], v[188:191]
  v_mfma_f32_16x16x32_bf16 v[192:195], v[52:55], v[8:11], v[192:195]
  v_mfma_f32_16x16x32_bf16 v[196:199], v[52:55], v[12:15], v[196:199]
  v_mfma_f32_16x16x32_bf16 v[200:203], v[52:55], v[16:19], v[200:203]
  v_mfma_f32_16x16x32_bf16 v[204:207], v[52:55], v[20:23], v[204:207]
  v_mfma_f32_16x16x32_bf16 v[208:211], v[56:59], v[8:11], v[208:211]
  v_mfma_f32_16x16x32_bf16 v[212:215], v[56:59], v[12:15], v[212:215]
  v_mfma_f32_16x16x32_bf16 v[216:219], v[56:59], v[16:19], v[216:219]
  v_mfma_f32_16x16x32_bf16 v[220:223], v[56:59], v[20:23], v[220:223]
  v_mfma_f32_16x16x32_bf16 v[224:227], v[60:63], v[8:11], v[224:227]
  v_mfma_f32_16x16x32_bf16 v[228:231], v[60:63], v[12:15], v[228:231]
  v_mfma_f32_16x16x32_bf16 v[232:235], v[60:63], v[16:19], v[232:235]
  v_mfma_f32_16x16x32_bf16 v[236:239], v[60:63], v[20:23], v[236:239]
  v_mfma_f32_16x16x32_bf16 v[240:243], v[64:67], v[8:11], v[240:243]
  v_mfma_f32_16x16x32_bf16 v[244:247], v[64:67], v[12:15], v[244:247]
  v_mfma_f32_16x16x32_bf16 v[248:251], v[64:67], v[16:19], v[248:251]
  v_mfma_f32_16x16x32_bf16 v[252:255], v[64:67], v[20:23], v[252:255]
  s_barrier
  .p2align 3
  ds_read_b128 v[8:11], v74 offset:0
  ds_read_b128 v[12:15], v74 offset:2048
  ds_read_b128 v[16:19], v74 offset:4096
  ds_read_b128 v[20:23], v74 offset:6144
  ds_read_b64_tr_b16 v[28:29], v81 offset:20544
  ds_read_b64_tr_b16 v[30:31], v81 offset:24128
  ds_read_b64_tr_b16 v[32:33], v81 offset:20576
  ds_read_b64_tr_b16 v[34:35], v81 offset:24160
  ds_read_b64_tr_b16 v[36:37], v81 offset:20608
  ds_read_b64_tr_b16 v[38:39], v81 offset:24192
  ds_read_b64_tr_b16 v[40:41], v81 offset:20640
  ds_read_b64_tr_b16 v[42:43], v81 offset:24224
  ds_read_b64_tr_b16 v[44:45], v81 offset:20672
  ds_read_b64_tr_b16 v[46:47], v81 offset:24256
  ds_read_b64_tr_b16 v[48:49], v81 offset:27712
  ds_read_b64_tr_b16 v[50:51], v81 offset:31296
  ds_read_b64_tr_b16 v[52:53], v81 offset:27744
  ds_read_b64_tr_b16 v[54:55], v81 offset:31328
  ds_read_b64_tr_b16 v[56:57], v81 offset:27776
  ds_read_b64_tr_b16 v[58:59], v81 offset:31360
  ds_read_b64_tr_b16 v[60:61], v81 offset:27808
  ds_read_b64_tr_b16 v[62:63], v81 offset:31392
  ds_read_b64_tr_b16 v[64:65], v81 offset:27840
  ds_read_b64_tr_b16 v[66:67], v81 offset:31424
  s_waitcnt lgkmcnt(0)
  s_waitcnt vmcnt(1)
  s_barrier
  .p2align 3
  v_mfma_f32_16x16x32_bf16 v[96:99], v[28:31], v[8:11], v[96:99]
  v_mfma_f32_16x16x32_bf16 v[100:103], v[28:31], v[12:15], v[100:103]
  v_mfma_f32_16x16x32_bf16 v[104:107], v[28:31], v[16:19], v[104:107]
  v_mfma_f32_16x16x32_bf16 v[108:111], v[28:31], v[20:23], v[108:111]
  v_mfma_f32_16x16x32_bf16 v[112:115], v[32:35], v[8:11], v[112:115]
  v_mfma_f32_16x16x32_bf16 v[116:119], v[32:35], v[12:15], v[116:119]
  v_mfma_f32_16x16x32_bf16 v[120:123], v[32:35], v[16:19], v[120:123]
  v_mfma_f32_16x16x32_bf16 v[124:127], v[32:35], v[20:23], v[124:127]
  v_mfma_f32_16x16x32_bf16 v[128:131], v[36:39], v[8:11], v[128:131]
  v_mfma_f32_16x16x32_bf16 v[132:135], v[36:39], v[12:15], v[132:135]
  v_mfma_f32_16x16x32_bf16 v[136:139], v[36:39], v[16:19], v[136:139]
  v_mfma_f32_16x16x32_bf16 v[140:143], v[36:39], v[20:23], v[140:143]
  v_mfma_f32_16x16x32_bf16 v[144:147], v[40:43], v[8:11], v[144:147]
  v_mfma_f32_16x16x32_bf16 v[148:151], v[40:43], v[12:15], v[148:151]
  v_mfma_f32_16x16x32_bf16 v[152:155], v[40:43], v[16:19], v[152:155]
  v_mfma_f32_16x16x32_bf16 v[156:159], v[40:43], v[20:23], v[156:159]
  v_mfma_f32_16x16x32_bf16 v[160:163], v[44:47], v[8:11], v[160:163]
  v_mfma_f32_16x16x32_bf16 v[164:167], v[44:47], v[12:15], v[164:167]
  v_mfma_f32_16x16x32_bf16 v[168:171], v[44:47], v[16:19], v[168:171]
  v_mfma_f32_16x16x32_bf16 v[172:175], v[44:47], v[20:23], v[172:175]
  v_mfma_f32_16x16x32_bf16 v[176:179], v[48:51], v[8:11], v[176:179]
  v_mfma_f32_16x16x32_bf16 v[180:183], v[48:51], v[12:15], v[180:183]
  v_mfma_f32_16x16x32_bf16 v[184:187], v[48:51], v[16:19], v[184:187]
  v_mfma_f32_16x16x32_bf16 v[188:191], v[48:51], v[20:23], v[188:191]
  v_mfma_f32_16x16x32_bf16 v[192:195], v[52:55], v[8:11], v[192:195]
  v_mfma_f32_16x16x32_bf16 v[196:199], v[52:55], v[12:15], v[196:199]
  v_mfma_f32_16x16x32_bf16 v[200:203], v[52:55], v[16:19], v[200:203]
  v_mfma_f32_16x16x32_bf16 v[204:207], v[52:55], v[20:23], v[204:207]
  v_mfma_f32_16x16x32_bf16 v[208:211], v[56:59], v[8:11], v[208:211]
  v_mfma_f32_16x16x32_bf16 v[212:215], v[56:59], v[12:15], v[212:215]
  v_mfma_f32_16x16x32_bf16 v[216:219], v[56:59], v[16:19], v[216:219]
  v_mfma_f32_16x16x32_bf16 v[220:223], v[56:59], v[20:23], v[220:223]
  v_mfma_f32_16x16x32_bf16 v[224:227], v[60:63], v[8:11], v[224:227]
  v_mfma_f32_16x16x32_bf16 v[228:231], v[60:63], v[12:15], v[228:231]
  v_mfma_f32_16x16x32_bf16 v[232:235], v[60:63], v[16:19], v[232:235]
  v_mfma_f32_16x16x32_bf16 v[236:239], v[60:63], v[20:23], v[236:239]
  v_mfma_f32_16x16x32_bf16 v[240:243], v[64:67], v[8:11], v[240:243]
  v_mfma_f32_16x16x32_bf16 v[244:247], v[64:67], v[12:15], v[244:247]
  v_mfma_f32_16x16x32_bf16 v[248:251], v[64:67], v[16:19], v[248:251]
  v_mfma_f32_16x16x32_bf16 v[252:255], v[64:67], v[20:23], v[252:255]
  s_barrier
  .p2align 3
  s_add_u32 m0, s70, 0
  s_add_u32 s61, s60, 0
  buffer_load_dwordx4 v68, s[40:43], s61 offen lds
  ds_read_b128 v[8:11], v73 offset:34816
  ds_read_b128 v[12:15], v73 offset:36864
  ds_read_b128 v[16:19], v73 offset:38912
  s_add_u32 m0, s70, 1024
  s_add_u32 s61, s60, 16384
  buffer_load_dwordx4 v69, s[40:43], s61 offen lds
  ds_read_b128 v[20:23], v73 offset:40960
  ds_read_b64_tr_b16 v[28:29], v82 offset:64
  s_add_u32 m0, s70, 2048
  s_add_u32 s61, s60, 32768
  buffer_load_dwordx4 v68, s[40:43], s61 offen lds
  ds_read_b64_tr_b16 v[30:31], v82 offset:3648
  ds_read_b64_tr_b16 v[32:33], v82 offset:96
  ds_read_b64_tr_b16 v[34:35], v82 offset:3680
  s_add_u32 m0, s70, 3072
  s_add_u32 s61, s60, 49152
  buffer_load_dwordx4 v69, s[40:43], s61 offen lds
  ds_read_b64_tr_b16 v[36:37], v82 offset:128
  ds_read_b64_tr_b16 v[38:39], v82 offset:3712
  ds_read_b64_tr_b16 v[40:41], v82 offset:160
  s_add_u32 m0, s70, 4096
  s_add_u32 s61, s60, 65536
  buffer_load_dwordx4 v68, s[40:43], s61 offen lds
  ds_read_b64_tr_b16 v[42:43], v82 offset:3744
  ds_read_b64_tr_b16 v[44:45], v82 offset:192
  s_add_u32 m0, s70, 5120
  s_add_u32 s61, s60, 81920
  buffer_load_dwordx4 v69, s[40:43], s61 offen lds
  ds_read_b64_tr_b16 v[46:47], v82 offset:3776
  ds_read_b64_tr_b16 v[48:49], v82 offset:7232
  ds_read_b64_tr_b16 v[50:51], v82 offset:10816
  s_add_u32 m0, s70, 6144
  s_add_u32 s61, s60, 98304
  buffer_load_dwordx4 v68, s[40:43], s61 offen lds
  ds_read_b64_tr_b16 v[52:53], v82 offset:7264
  ds_read_b64_tr_b16 v[54:55], v82 offset:10848
  ds_read_b64_tr_b16 v[56:57], v82 offset:7296
  s_add_u32 m0, s70, 7168
  s_add_u32 s61, s60, 114688
  buffer_load_dwordx4 v69, s[40:43], s61 offen lds
  ds_read_b64_tr_b16 v[58:59], v82 offset:10880
  ds_read_b64_tr_b16 v[60:61], v82 offset:7328
  s_add_u32 m0, s71, 0
  s_mov_b64 exec, s[62:63]
  buffer_load_dwordx4 v70, s[40:43], s60 offen lds
  s_mov_b64 exec, -1
  s_add_u32 s60, s60, 128
  ds_read_b64_tr_b16 v[62:63], v82 offset:10912
  ds_read_b64_tr_b16 v[64:65], v82 offset:7360
  ds_read_b64_tr_b16 v[66:67], v82 offset:10944
  s_waitcnt lgkmcnt(0)
  s_barrier
  .p2align 3
  v_mfma_f32_16x16x32_bf16 v[96:99], v[28:31], v[8:11], v[96:99]
  v_mfma_f32_16x16x32_bf16 v[100:103], v[28:31], v[12:15], v[100:103]
  v_mfma_f32_16x16x32_bf16 v[104:107], v[28:31], v[16:19], v[104:107]
  v_mfma_f32_16x16x32_bf16 v[108:111], v[28:31], v[20:23], v[108:111]
  v_mfma_f32_16x16x32_bf16 v[112:115], v[32:35], v[8:11], v[112:115]
  v_mfma_f32_16x16x32_bf16 v[116:119], v[32:35], v[12:15], v[116:119]
  v_mfma_f32_16x16x32_bf16 v[120:123], v[32:35], v[16:19], v[120:123]
  v_mfma_f32_16x16x32_bf16 v[124:127], v[32:35], v[20:23], v[124:127]
  v_mfma_f32_16x16x32_bf16 v[128:131], v[36:39], v[8:11], v[128:131]
  v_mfma_f32_16x16x32_bf16 v[132:135], v[36:39], v[12:15], v[132:135]
  v_mfma_f32_16x16x32_bf16 v[136:139], v[36:39], v[16:19], v[136:139]
  v_mfma_f32_16x16x32_bf16 v[140:143], v[36:39], v[20:23], v[140:143]
  v_mfma_f32_16x16x32_bf16 v[144:147], v[40:43], v[8:11], v[144:147]
  v_mfma_f32_16x16x32_bf16 v[148:151], v[40:43], v[12:15], v[148:151]
  v_mfma_f32_16x16x32_bf16 v[152:155], v[40:43], v[16:19], v[152:155]
  v_mfma_f32_16x16x32_bf16 v[156:159], v[40:43], v[20:23], v[156:159]
  v_mfma_f32_16x16x32_bf16 v[160:163], v[44:47], v[8:11], v[160:163]
  v_mfma_f32_16x16x32_bf16 v[164:167], v[44:47], v[12:15], v[164:167]
  v_mfma_f32_16x16x32_bf16 v[168:171], v[44:47], v[16:19], v[168:171]
  v_mfma_f32_16x16x32_bf16 v[172:175], v[44:47], v[20:23], v[172:175]
  v_mfma_f32_16x16x32_bf16 v[176:179], v[48:51], v[8:11], v[176:179]
  v_mfma_f32_16x16x32_bf16 v[180:183], v[48:51], v[12:15], v[180:183]
  v_mfma_f32_16x16x32_bf16 v[184:187], v[48:51], v[16:19], v[184:187]
  v_mfma_f32_16x16x32_bf16 v[188:191], v[48:51], v[20:23], v[188:191]
  v_mfma_f32_16x16x32_bf16 v[192:195], v[52:55], v[8:11], v[192:195]
  v_mfma_f32_16x16x32_bf16 v[196:199], v[52:55], v[12:15], v[196:199]
  v_mfma_f32_16x16x32_bf16 v[200:203], v[52:55], v[16:19], v[200:203]
  v_mfma_f32_16x16x32_bf16 v[204:207], v[52:55], v[20:23], v[204:207]
  v_mfma_f32_16x16x32_bf16 v[208:211], v[56:59], v[8:11], v[208:211]
  v_mfma_f32_16x16x32_bf16 v[212:215], v[56:59], v[12:15], v[212:215]
  v_mfma_f32_16x16x32_bf16 v[216:219], v[56:59], v[16:19], v[216:219]
  v_mfma_f32_16x16x32_bf16 v[220:223], v[56:59], v[20:23], v[220:223]
  v_mfma_f32_16x16x32_bf16 v[224:227], v[60:63], v[8:11], v[224:227]
  v_mfma_f32_16x16x32_bf16 v[228:231], v[60:63], v[12:15], v[228:231]
  v_mfma_f32_16x16x32_bf16 v[232:235], v[60:63], v[16:19], v[232:235]
  v_mfma_f32_16x16x32_bf16 v[236:239], v[60:63], v[20:23], v[236:239]
  v_mfma_f32_16x16x32_bf16 v[240:243], v[64:67], v[8:11], v[240:243]
  v_mfma_f32_16x16x32_bf16 v[244:247], v[64:67], v[12:15], v[244:247]
  v_mfma_f32_16x16x32_bf16 v[248:251], v[64:67], v[16:19], v[248:251]
  v_mfma_f32_16x16x32_bf16 v[252:255], v[64:67], v[20:23], v[252:255]
  s_barrier
  .p2align 3
  ds_read_b128 v[8:11], v74 offset:34816
  ds_read_b128 v[12:15], v74 offset:36864
  ds_read_b128 v[16:19], v74 offset:38912
  ds_read_b128 v[20:23], v74 offset:40960
  ds_read_b64_tr_b16 v[28:29], v82 offset:20544
  ds_read_b64_tr_b16 v[30:31], v82 offset:24128
  ds_read_b64_tr_b16 v[32:33], v82 offset:20576
  ds_read_b64_tr_b16 v[34:35], v82 offset:24160
  ds_read_b64_tr_b16 v[36:37], v82 offset:20608
  ds_read_b64_tr_b16 v[38:39], v82 offset:24192
  ds_read_b64_tr_b16 v[40:41], v82 offset:20640
  ds_read_b64_tr_b16 v[42:43], v82 offset:24224
  ds_read_b64_tr_b16 v[44:45], v82 offset:20672
  ds_read_b64_tr_b16 v[46:47], v82 offset:24256
  ds_read_b64_tr_b16 v[48:49], v82 offset:27712
  ds_read_b64_tr_b16 v[50:51], v82 offset:31296
  ds_read_b64_tr_b16 v[52:53], v82 offset:27744
  ds_read_b64_tr_b16 v[54:55], v82 offset:31328
  ds_read_b64_tr_b16 v[56:57], v82 offset:27776
  ds_read_b64_tr_b16 v[58:59], v82 offset:31360
  ds_read_b64_tr_b16 v[60:61], v82 offset:27808
  ds_read_b64_tr_b16 v[62:63], v82 offset:31392
  ds_read_b64_tr_b16 v[64:65], v82 offset:27840
  ds_read_b64_tr_b16 v[66:67], v82 offset:31424
  s_waitcnt lgkmcnt(0)
  s_waitcnt vmcnt(0)
  s_barrier
  .p2align 3
  v_mfma_f32_16x16x32_bf16 v[96:99], v[28:31], v[8:11], v[96:99]
  v_mfma_f32_16x16x32_bf16 v[100:103], v[28:31], v[12:15], v[100:103]
  v_mfma_f32_16x16x32_bf16 v[104:107], v[28:31], v[16:19], v[104:107]
  v_mfma_f32_16x16x32_bf16 v[108:111], v[28:31], v[20:23], v[108:111]
  v_mfma_f32_16x16x32_bf16 v[112:115], v[32:35], v[8:11], v[112:115]
  v_mfma_f32_16x16x32_bf16 v[116:119], v[32:35], v[12:15], v[116:119]
  v_mfma_f32_16x16x32_bf16 v[120:123], v[32:35], v[16:19], v[120:123]
  v_mfma_f32_16x16x32_bf16 v[124:127], v[32:35], v[20:23], v[124:127]
  v_mfma_f32_16x16x32_bf16 v[128:131], v[36:39], v[8:11], v[128:131]
  v_mfma_f32_16x16x32_bf16 v[132:135], v[36:39], v[12:15], v[132:135]
  v_mfma_f32_16x16x32_bf16 v[136:139], v[36:39], v[16:19], v[136:139]
  v_mfma_f32_16x16x32_bf16 v[140:143], v[36:39], v[20:23], v[140:143]
  v_mfma_f32_16x16x32_bf16 v[144:147], v[40:43], v[8:11], v[144:147]
  v_mfma_f32_16x16x32_bf16 v[148:151], v[40:43], v[12:15], v[148:151]
  v_mfma_f32_16x16x32_bf16 v[152:155], v[40:43], v[16:19], v[152:155]
  v_mfma_f32_16x16x32_bf16 v[156:159], v[40:43], v[20:23], v[156:159]
  v_mfma_f32_16x16x32_bf16 v[160:163], v[44:47], v[8:11], v[160:163]
  v_mfma_f32_16x16x32_bf16 v[164:167], v[44:47], v[12:15], v[164:167]
  v_mfma_f32_16x16x32_bf16 v[168:171], v[44:47], v[16:19], v[168:171]
  v_mfma_f32_16x16x32_bf16 v[172:175], v[44:47], v[20:23], v[172:175]
  v_mfma_f32_16x16x32_bf16 v[176:179], v[48:51], v[8:11], v[176:179]
  v_mfma_f32_16x16x32_bf16 v[180:183], v[48:51], v[12:15], v[180:183]
  v_mfma_f32_16x16x32_bf16 v[184:187], v[48:51], v[16:19], v[184:187]
  v_mfma_f32_16x16x32_bf16 v[188:191], v[48:51], v[20:23], v[188:191]
  v_mfma_f32_16x16x32_bf16 v[192:195], v[52:55], v[8:11], v[192:195]
  v_mfma_f32_16x16x32_bf16 v[196:199], v[52:55], v[12:15], v[196:199]
  v_mfma_f32_16x16x32_bf16 v[200:203], v[52:55], v[16:19], v[200:203]
  v_mfma_f32_16x16x32_bf16 v[204:207], v[52:55], v[20:23], v[204:207]
  v_mfma_f32_16x16x32_bf16 v[208:211], v[56:59], v[8:11], v[208:211]
  v_mfma_f32_16x16x32_bf16 v[212:215], v[56:59], v[12:15], v[212:215]
  v_mfma_f32_16x16x32_bf16 v[216:219], v[56:59], v[16:19], v[216:219]
  v_mfma_f32_16x16x32_bf16 v[220:223], v[56:59], v[20:23], v[220:223]
  v_mfma_f32_16x16x32_bf16 v[224:227], v[60:63], v[8:11], v[224:227]
  v_mfma_f32_16x16x32_bf16 v[228:231], v[60:63], v[12:15], v[228:231]
  v_mfma_f32_16x16x32_bf16 v[232:235], v[60:63], v[16:19], v[232:235]
  v_mfma_f32_16x16x32_bf16 v[236:239], v[60:63], v[20:23], v[236:239]
  v_mfma_f32_16x16x32_bf16 v[240:243], v[64:67], v[8:11], v[240:243]
  v_mfma_f32_16x16x32_bf16 v[244:247], v[64:67], v[12:15], v[244:247]
  v_mfma_f32_16x16x32_bf16 v[248:251], v[64:67], v[16:19], v[248:251]
  v_mfma_f32_16x16x32_bf16 v[252:255], v[64:67], v[20:23], v[252:255]
  s_barrier
  s_sub_u32 s75, s75, 1
  s_cmp_lg_u32 s75, 0
  s_cbranch_scc1 L_Y_loop
  s_load_dwordx2 s[24:25], s[0:1], 16
  s_load_dwordx2 s[26:27], s[0:1], 48
  .p2align 3
  s_add_u32 m0, s70, 34816
  s_add_u32 s61, s60, 0
  buffer_load_dwordx4 v68, s[40:43], s61 offen lds
  ds_read_b128 v[8:11], v73 offset:0
  ds_read_b128 v[12:15], v73 offset:2048
  ds_read_b128 v[16:19], v73 offset:4096
  s_add_u32 m0, s70, 35840
  s_add_u32 s61, s60, 16384
  buffer_load_dwordx4 v69, s[40:43], s61 offen lds
  ds_read_b128 v[20:23], v73 offset:6144
  ds_read_b64_tr_b16 v[28:29], v81 offset:64
  s_add_u32 m0, s70, 36864
  s_add_u32 s61, s60, 32768
  buffer_load_dwordx4 v68, s[40:43], s61 offen lds
  ds_read_b64_tr_b16 v[30:31], v81 offset:3648
  ds_read_b64_tr_b16 v[32:33], v81 offset:96
  ds_read_b64_tr_b16 v[34:35], v81 offset:3680
  s_add_u32 m0, s70, 37888
  s_add_u32 s61, s60, 49152
  buffer_load_dwordx4 v69, s[40:43], s61 offen lds
  ds_read_b64_tr_b16 v[36:37], v81 offset:128
  ds_read_b64_tr_b16 v[38:39], v81 offset:3712
  ds_read_b64_tr_b16 v[40:41], v81 offset:160
  s_add_u32 m0, s70, 38912
  s_add_u32 s61, s60, 65536
  buffer_load_dwordx4 v68, s[40:43], s61 offen lds
  ds_read_b64_tr_b16 v[42:43], v81 offset:3744
  ds_read_b64_tr_b16 v[44:45], v81 offset:192
  s_add_u32 m0, s70, 39936
  s_add_u32 s61, s60, 81920
  buffer_load_dwordx4 v69, s[40:43], s61 offen lds
  ds_read_b64_tr_b16 v[46:47], v81 offset:3776
  ds_read_b64_tr_b16 v[48:49], v81 offset:7232
  ds_read_b64_tr_b16 v[50:51], v81 offset:10816
  s_add_u32 m0, s70, 40960
  s_add_u32 s61, s60, 98304
  buffer_load_dwordx4 v68, s[40:43], s61 offen lds
  ds_read_b64_tr_b16 v[52:53], v81 offset:7264
  ds_read_b64_tr_b16 v[54:55], v81 offset:10848
  ds_read_b64_tr_b16 v[56:57], v81 offset:7296
  s_add_u32 m0, s70, 41984
  s_add_u32 s61, s60, 114688
  buffer_load_dwordx4 v69, s[40:43], s61 offen lds
  ds_read_b64_tr_b16 v[58:59], v81 offset:10880
  ds_read_b64_tr_b16 v[60:61], v81 offset:7328
  s_add_u32 m0, s71, 34816
  s_mov_b64 exec, s[62:63]
  buffer_load_dwordx4 v70, s[40:43], s60 offen lds
  s_mov_b64 exec, -1
  s_add_u32 s60, s60, 128
  ds_read_b64_tr_b16 v[62:63], v81 offset:10912
  ds_read_b64_tr_b16 v[64:65], v81 offset:7360
  ds_read_b64_tr_b16 v[66:67], v81 offset:10944
  s_waitcnt lgkmcnt(0)
  s_barrier
  .p2align 3
  v_mfma_f32_16x16x32_bf16 v[96:99], v[28:31], v[8:11], v[96:99]
  v_mfma_f32_16x16x32_bf16 v[100:103], v[28:31], v[12:15], v[100:103]
  v_mfma_f32_16x16x32_bf16 v[104:107], v[28:31], v[16:19], v[104:107]
  v_mfma_f32_16x16x32_bf16 v[108:111], v[28:31], v[20:23], v[108:111]
  v_mfma_f32_16x16x32_bf16 v[112:115], v[32:35], v[8:11], v[112:115]
  v_mfma_f32_16x16x32_bf16 v[116:119], v[32:35], v[12:15], v[116:119]
  v_mfma_f32_16x16x32_bf16 v[120:123], v[32:35], v[16:19], v[120:123]
  v_mfma_f32_16x16x32_bf16 v[124:127], v[32:35], v[20:23], v[124:127]
  v_mfma_f32_16x16x32_bf16 v[128:131], v[36:39], v[8:11], v[128:131]
  v_mfma_f32_16x16x32_bf16 v[132:135], v[36:39], v[12:15], v[132:135]
  v_mfma_f32_16x16x32_bf16 v[136:139], v[36:39], v[16:19], v[136:139]
  v_mfma_f32_16x16x32_bf16 v[140:143], v[36:39], v[20:23], v[140:143]
  v_mfma_f32_16x16x32_bf16 v[144:147], v[40:43], v[8:11], v[144:147]
  v_mfma_f32_16x16x32_bf16 v[148:151], v[40:43], v[12:15], v[148:151]
  v_mfma_f32_16x16x32_bf16 v[152:155], v[40:43], v[16:19], v[152:155]
  v_mfma_f32_16x16x32_bf16 v[156:159], v[40:43], v[20:23], v[156:159]
  v_mfma_f32_16x16x32_bf16 v[160:163], v[44:47], v[8:11], v[160:163]
  v_mfma_f32_16x16x32_bf16 v[164:167], v[44:47], v[12:15], v[164:167]
  v_mfma_f32_16x16x32_bf16 v[168:171], v[44:47], v[16:19], v[168:171]
  v_mfma_f32_16x16x32_bf16 v[172:175], v[44:47], v[20:23], v[172:175]
  v_mfma_f32_16x16x32_bf16 v[176:179], v[48:51], v[8:11], v[176:179]
  v_mfma_f32_16x16x32_bf16 v[180:183], v[48:51], v[12:15], v[180:183]
  v_mfma_f32_16x16x32_bf16 v[184:187], v[48:51], v[16:19], v[184:187]
  v_mfma_f32_16x16x32_bf16 v[188:191], v[48:51], v[20:23], v[188:191]
  v_mfma_f32_16x16x32_bf16 v[192:195], v[52:55], v[8:11], v[192:195]
  v_mfma_f32_16x16x32_bf16 v[196:199], v[52:55], v[12:15], v[196:199]
  v_mfma_f32_16x16x32_bf16 v[200:203], v[52:55], v[16:19], v[200:203]
  v_mfma_f32_16x16x32_bf16 v[204:207], v[52:55], v[20:23], v[204:207]
  v_mfma_f32_16x16x32_bf16 v[208:211], v[56:59], v[8:11], v[208:211]
  v_mfma_f32_16x16x32_bf16 v[212:215], v[56:59], v[12:15], v[212:215]
  v_mfma_f32_16x16x32_bf16 v[216:219], v[56:59], v[16:19], v[216:219]
  v_mfma_f32_16x16x32_bf16 v[220:223], v[56:59], v[20:23], v[220:223]
  v_mfma_f32_16x16x32_bf16 v[224:227], v[60:63], v[8:11], v[224:227]
  v_mfma_f32_16x16x32_bf16 v[228:231], v[60:63], v[12:15], v[228:231]
  v_mfma_f32_16x16x32_bf16 v[232:235], v[60:63], v[16:19], v[232:235]
  v_mfma_f32_16x16x32_bf16 v[236:239], v[60:63], v[20:23], v[236:239]
  v_mfma_f32_16x16x32_bf16 v[240:243], v[64:67], v[8:11], v[240:243]
  v_mfma_f32_16x16x32_bf16 v[244:247], v[64:67], v[12:15], v[244:247]
  v_mfma_f32_16x16x32_bf16 v[248:251], v[64:67], v[16:19], v[248:251]
  v_mfma_f32_16x16x32_bf16 v[252:255], v[64:67], v[20:23], v[252:255]
  s_barrier
  .p2align 3
  ds_read_b128 v[8:11], v74 offset:0
  ds_read_b128 v[12:15], v74 offset:2048
  ds_read_b128 v[16:19], v74 offset:4096
  ds_read_b128 v[20:23], v74 offset:6144
  ds_read_b64_tr_b16 v[28:29], v81 offset:20544
  ds_read_b64_tr_b16 v[30:31], v81 offset:24128
  ds_read_b64_tr_b16 v[32:33], v81 offset:20576
  ds_read_b64_tr_b16 v[34:35], v81 offset:24160
  ds_read_b64_tr_b16 v[36:37], v81 offset:20608
  ds_read_b64_tr_b16 v[38:39], v81 offset:24192
  ds_read_b64_tr_b16 v[40:41], v81 offset:20640
  ds_read_b64_tr_b16 v[42:43], v81 offset:24224
  ds_read_b64_tr_b16 v[44:45], v81 offset:20672
  ds_read_b64_tr_b16 v[46:47], v81 offset:24256
  ds_read_b64_tr_b16 v[48:49], v81 offset:27712
  ds_read_b64_tr_b16 v[50:51], v81 offset:31296
  ds_read_b64_tr_b16 v[52:53], v81 offset:27744
  ds_read_b64_tr_b16 v[54:55], v81 offset:31328
  ds_read_b64_tr_b16 v[56:57], v81 offset:27776
  ds_read_b64_tr_b16 v[58:59], v81 offset:31360
  ds_read_b64_tr_b16 v[60:61], v81 offset:27808
  ds_read_b64_tr_b16 v[62:63], v81 offset:31392
  ds_read_b64_tr_b16 v[64:65], v81 offset:27840
  ds_read_b64_tr_b16 v[66:67], v81 offset:31424
  s_waitcnt lgkmcnt(0)
  s_waitcnt vmcnt(0)
  s_barrier
  .p2align 3
  v_mfma_f32_16x16x32_bf16 v[96:99], v[28:31], v[8:11], v[96:99]
  v_mfma_f32_16x16x32_bf16 v[100:103], v[28:31], v[12:15], v[100:103]
  v_mfma_f32_16x16x32_bf16 v[104:107], v[28:31], v[16:19], v[104:107]
  v_mfma_f32_16x16x32_bf16 v[108:111], v[28:31], v[20:23], v[108:111]
  v_mfma_f32_16x16x32_bf16 v[112:115], v[32:35], v[8:11], v[112:115]
  v_mfma_f32_16x16x32_bf16 v[116:119], v[32:35], v[12:15], v[116:119]
  v_mfma_f32_16x16x32_bf16 v[120:123], v[32:35], v[16:19], v[120:123]
  v_mfma_f32_16x16x32_bf16 v[124:127], v[32:35], v[20:23], v[124:127]
  v_mfma_f32_16x16x32_bf16 v[128:131], v[36:39], v[8:11], v[128:131]
  v_mfma_f32_16x16x32_bf16 v[132:135], v[36:39], v[12:15], v[132:135]
  v_mfma_f32_16x16x32_bf16 v[136:139], v[36:39], v[16:19], v[136:139]
  v_mfma_f32_16x16x32_bf16 v[140:143], v[36:39], v[20:23], v[140:143]
  v_mfma_f32_16x16x32_bf16 v[144:147], v[40:43], v[8:11], v[144:147]
  v_mfma_f32_16x16x32_bf16 v[148:151], v[40:43], v[12:15], v[148:151]
  v_mfma_f32_16x16x32_bf16 v[152:155], v[40:43], v[16:19], v[152:155]
  v_mfma_f32_16x16x32_bf16 v[156:159], v[40:43], v[20:23], v[156:159]
  v_mfma_f32_16x16x32_bf16 v[160:163], v[44:47], v[8:11], v[160:163]
  v_mfma_f32_16x16x32_bf16 v[164:167], v[44:47], v[12:15], v[164:167]
  v_mfma_f32_16x16x32_bf16 v[168:171], v[44:47], v[16:19], v[168:171]
  v_mfma_f32_16x16x32_bf16 v[172:175], v[44:47], v[20:23], v[172:175]
  v_mfma_f32_16x16x32_bf16 v[176:179], v[48:51], v[8:11], v[176:179]
  v_mfma_f32_16x16x32_bf16 v[180:183], v[48:51], v[12:15], v[180:183]
  v_mfma_f32_16x16x32_bf16 v[184:187], v[48:51], v[16:19], v[184:187]
  v_mfma_f32_16x16x32_bf16 v[188:191], v[48:51], v[20:23], v[188:191]
  v_mfma_f32_16x16x32_bf16 v[192:195], v[52:55], v[8:11], v[192:195]
  v_mfma_f32_16x16x32_bf16 v[196:199], v[52:55], v[12:15], v[196:199]
  v_mfma_f32_16x16x32_bf16 v[200:203], v[52:55], v[16:19], v[200:203]
  v_mfma_f32_16x16x32_bf16 v[204:207], v[52:55], v[20:23], v[204:207]
  v_mfma_f32_16x16x32_bf16 v[208:211], v[56:59], v[8:11], v[208:211]
  v_mfma_f32_16x16x32_bf16 v[212:215], v[56:59], v[12:15], v[212:215]
  v_mfma_f32_16x16x32_bf16 v[216:219], v[56:59], v[16:19], v[216:219]
  v_mfma_f32_16x16x32_bf16 v[220:223], v[56:59], v[20:23], v[220:223]
  v_mfma_f32_16x16x32_bf16 v[224:227], v[60:63], v[8:11], v[224:227]
  v_mfma_f32_16x16x32_bf16 v[228:231], v[60:63], v[12:15], v[228:231]
  v_mfma_f32_16x16x32_bf16 v[232:235], v[60:63], v[16:19], v[232:235]
  v_mfma_f32_16x16x32_bf16 v[236:239], v[60:63], v[20:23], v[236:239]
  v_mfma_f32_16x16x32_bf16 v[240:243], v[64:67], v[8:11], v[240:243]
  v_mfma_f32_16x16x32_bf16 v[244:247], v[64:67], v[12:15], v[244:247]
  v_mfma_f32_16x16x32_bf16 v[248:251], v[64:67], v[16:19], v[248:251]
  v_mfma_f32_16x16x32_bf16 v[252:255], v[64:67], v[20:23], v[252:255]
  s_barrier
  .p2align 3
  ds_read_b128 v[8:11], v73 offset:34816
  ds_read_b128 v[12:15], v73 offset:36864
  ds_read_b128 v[16:19], v73 offset:38912
  ds_read_b128 v[20:23], v73 offset:40960
  ds_read_b64_tr_b16 v[28:29], v82 offset:64
  ds_read_b64_tr_b16 v[30:31], v82 offset:3648
  ds_read_b64_tr_b16 v[32:33], v82 offset:96
  ds_read_b64_tr_b16 v[34:35], v82 offset:3680
  ds_read_b64_tr_b16 v[36:37], v82 offset:128
  ds_read_b64_tr_b16 v[38:39], v82 offset:3712
  ds_read_b64_tr_b16 v[40:41], v82 offset:160
  ds_read_b64_tr_b16 v[42:43], v82 offset:3744
  ds_read_b64_tr_b16 v[44:45], v82 offset:192
  ds_read_b64_tr_b16 v[46:47], v82 offset:3776
  ds_read_b64_tr_b16 v[48:49], v82 offset:7232
  ds_read_b64_tr_b16 v[50:51], v82 offset:10816
  ds_read_b64_tr_b16 v[52:53], v82 offset:7264
  ds_read_b64_tr_b16 v[54:55], v82 offset:10848
  ds_read_b64_tr_b16 v[56:57], v82 offset:7296
  ds_read_b64_tr_b16 v[58:59], v82 offset:10880
  ds_read_b64_tr_b16 v[60:61], v82 offset:7328
  ds_read_b64_tr_b16 v[62:63], v82 offset:10912
  ds_read_b64_tr_b16 v[64:65], v82 offset:7360
  ds_read_b64_tr_b16 v[66:67], v82 offset:10944
  s_waitcnt lgkmcnt(0)
  s_barrier
  .p2align 3
  v_mfma_f32_16x16x32_bf16 v[96:99], v[28:31], v[8:11], v[96:99]
  v_mfma_f32_16x16x32_bf16 v[100:103], v[28:31], v[12:15], v[100:103]
  v_mfma_f32_16x16x32_bf16 v[104:107], v[28:31], v[16:19], v[104:107]
  v_mfma_f32_16x16x32_bf16 v[108:111], v[28:31], v[20:23], v[108:111]
  v_mfma_f32_16x16x32_bf16 v[112:115], v[32:35], v[8:11], v[112:115]
  v_mfma_f32_16x16x32_bf16 v[116:119], v[32:35], v[12:15], v[116:119]
  v_mfma_f32_16x16x32_bf16 v[120:123], v[32:35], v[16:19], v[120:123]
  v_mfma_f32_16x16x32_bf16 v[124:127], v[32:35], v[20:23], v[124:127]
  v_mfma_f32_16x16x32_bf16 v[128:131], v[36:39], v[8:11], v[128:131]
  v_mfma_f32_16x16x32_bf16 v[132:135], v[36:39], v[12:15], v[132:135]
  v_mfma_f32_16x16x32_bf16 v[136:139], v[36:39], v[16:19], v[136:139]
  v_mfma_f32_16x16x32_bf16 v[140:143], v[36:39], v[20:23], v[140:143]
  v_mfma_f32_16x16x32_bf16 v[144:147], v[40:43], v[8:11], v[144:147]
  v_mfma_f32_16x16x32_bf16 v[148:151], v[40:43], v[12:15], v[148:151]
  v_mfma_f32_16x16x32_bf16 v[152:155], v[40:43], v[16:19], v[152:155]
  v_mfma_f32_16x16x32_bf16 v[156:159], v[40:43], v[20:23], v[156:159]
  v_mfma_f32_16x16x32_bf16 v[160:163], v[44:47], v[8:11], v[160:163]
  v_mfma_f32_16x16x32_bf16 v[164:167], v[44:47], v[12:15], v[164:167]
  v_mfma_f32_16x16x32_bf16 v[168:171], v[44:47], v[16:19], v[168:171]
  v_mfma_f32_16x16x32_bf16 v[172:175], v[44:47], v[20:23], v[172:175]
  v_mfma_f32_16x16x32_bf16 v[176:179], v[48:51], v[8:11], v[176:179]
  v_mfma_f32_16x16x32_bf16 v[180:183], v[48:51], v[12:15], v[180:183]
  v_mfma_f32_16x16x32_bf16 v[184:187], v[48:51], v[16:19], v[184:187]
  v_mfma_f32_16x16x32_bf16 v[188:191], v[48:51], v[20:23], v[188:191]
  v_mfma_f32_16x16x32_bf16 v[192:195], v[52:55], v[8:11], v[192:195]
  v_mfma_f32_16x16x32_bf16 v[196:199], v[52:55], v[12:15], v[196:199]
  v_mfma_f32_16x16x32_bf16 v[200:203], v[52:55], v[16:19], v[200:203]
  v_mfma_f32_16x16x32_bf16 v[204:207], v[52:55], v[20:23], v[204:207]
  v_mfma_f32_16x16x32_bf16 v[208:211], v[56:59], v[8:11], v[208:211]
  v_mfma_f32_16x16x32_bf16 v[212:215], v[56:59], v[12:15], v[212:215]
  v_mfma_f32_16x16x32_bf16 v[216:219], v[56:59], v[16:19], v[216:219]
  v_mfma_f32_16x16x32_bf16 v[220:223], v[56:59], v[20:23], v[220:223]
  v_mfma_f32_16x16x32_bf16 v[224:227], v[60:63], v[8:11], v[224:227]
  v_mfma_f32_16x16x32_bf16 v[228:231], v[60:63], v[12:15], v[228:231]
  v_mfma_f32_16x16x32_bf16 v[232:235], v[60:63], v[16:19], v[232:235]
  v_mfma_f32_16x16x32_bf16 v[236:239], v[60:63], v[20:23], v[236:239]
  v_mfma_f32_16x16x32_bf16 v[240:243], v[64:67], v[8:11], v[240:243]
  v_mfma_f32_16x16x32_bf16 v[244:247], v[64:67], v[12:15], v[244:247]
  v_mfma_f32_16x16x32_bf16 v[248:251], v[64:67], v[16:19], v[248:251]
  v_mfma_f32_16x16x32_bf16 v[252:255], v[64:67], v[20:23], v[252:255]
  s_barrier
  .p2align 3
  ds_read_b128 v[8:11], v74 offset:34816
  ds_read_b128 v[12:15], v74 offset:36864
  ds_read_b128 v[16:19], v74 offset:38912
  ds_read_b128 v[20:23], v74 offset:40960
  ds_read_b64_tr_b16 v[28:29], v82 offset:20544
  ds_read_b64_tr_b16 v[30:31], v82 offset:24128
  ds_read_b64_tr_b16 v[32:33], v82 offset:20576
  ds_read_b64_tr_b16 v[34:35], v82 offset:24160
  ds_read_b64_tr_b16 v[36:37], v82 offset:20608
  ds_read_b64_tr_b16 v[38:39], v82 offset:24192
  ds_read_b64_tr_b16 v[40:41], v82 offset:20640
  ds_read_b64_tr_b16 v[42:43], v82 offset:24224
  ds_read_b64_tr_b16 v[44:45], v82 offset:20672
  ds_read_b64_tr_b16 v[46:47], v82 offset:24256
  ds_read_b64_tr_b16 v[48:49], v82 offset:27712
  ds_read_b64_tr_b16 v[50:51], v82 offset:31296
  ds_read_b64_tr_b16 v[52:53], v82 offset:27744
  ds_read_b64_tr_b16 v[54:55], v82 offset:31328
  ds_read_b64_tr_b16 v[56:57], v82 offset:27776
  ds_read_b64_tr_b16 v[58:59], v82 offset:31360
  ds_read_b64_tr_b16 v[60:61], v82 offset:27808
  ds_read_b64_tr_b16 v[62:63], v82 offset:31392
  ds_read_b64_tr_b16 v[64:65], v82 offset:27840
  ds_read_b64_tr_b16 v[66:67], v82 offset:31424
  s_waitcnt lgkmcnt(0)
  s_barrier
  s_lshl_b32 s20, s78, 10
  s_add_u32 s20, s20, 1048832
  s_add_u32 s20, s6, s20
  s_addc_u32 s21, s7, 0
  s_mov_b32 s22, 640
  s_mov_b32 s23, 0x20000
  v_lshrrev_b32 v2, 4, v0
  v_lshlrev_b32 v2, 4, v2
  v_mfma_f32_16x16x32_bf16 v[96:99], v[28:31], v[8:11], v[96:99]
  v_mfma_f32_16x16x32_bf16 v[100:103], v[28:31], v[12:15], v[100:103]
  v_mfma_f32_16x16x32_bf16 v[104:107], v[28:31], v[16:19], v[104:107]
  v_mfma_f32_16x16x32_bf16 v[108:111], v[28:31], v[20:23], v[108:111]
  buffer_load_dwordx4 v[28:31], v2, s[20:23], 0 offen offset:0 sc1
  v_mfma_f32_16x16x32_bf16 v[112:115], v[32:35], v[8:11], v[112:115]
  v_mfma_f32_16x16x32_bf16 v[116:119], v[32:35], v[12:15], v[116:119]
  v_mfma_f32_16x16x32_bf16 v[120:123], v[32:35], v[16:19], v[120:123]
  v_mfma_f32_16x16x32_bf16 v[124:127], v[32:35], v[20:23], v[124:127]
  buffer_load_dwordx4 v[32:35], v2, s[20:23], 0 offen offset:64 sc1
  v_mfma_f32_16x16x32_bf16 v[128:131], v[36:39], v[8:11], v[128:131]
  v_mfma_f32_16x16x32_bf16 v[132:135], v[36:39], v[12:15], v[132:135]
  v_mfma_f32_16x16x32_bf16 v[136:139], v[36:39], v[16:19], v[136:139]
  v_mfma_f32_16x16x32_bf16 v[140:143], v[36:39], v[20:23], v[140:143]
  buffer_load_dwordx4 v[36:39], v2, s[20:23], 0 offen offset:128 sc1
  v_mfma_f32_16x16x32_bf16 v[144:147], v[40:43], v[8:11], v[144:147]
  v_mfma_f32_16x16x32_bf16 v[148:151], v[40:43], v[12:15], v[148:151]
  v_mfma_f32_16x16x32_bf16 v[152:155], v[40:43], v[16:19], v[152:155]
  v_mfma_f32_16x16x32_bf16 v[156:159], v[40:43], v[20:23], v[156:159]
  buffer_load_dwordx4 v[40:43], v2, s[20:23], 0 offen offset:192 sc1
  v_mfma_f32_16x16x32_bf16 v[160:163], v[44:47], v[8:11], v[160:163]
  v_mfma_f32_16x16x32_bf16 v[164:167], v[44:47], v[12:15], v[164:167]
  v_mfma_f32_16x16x32_bf16 v[168:171], v[44:47], v[16:19], v[168:171]
  v_mfma_f32_16x16x32_bf16 v[172:175], v[44:47], v[20:23], v[172:175]
  buffer_load_dwordx4 v[44:47], v2, s[20:23], 0 offen offset:256 sc1
  v_mfma_f32_16x16x32_bf16 v[176:179], v[48:51], v[8:11], v[176:179]
  v_mfma_f32_16x16x32_bf16 v[180:183], v[48:51], v[12:15], v[180:183]
  v_mfma_f32_16x16x32_bf16 v[184:187], v[48:51], v[16:19], v[184:187]
  v_mfma_f32_16x16x32_bf16 v[188:191], v[48:51], v[20:23], v[188:191]
  buffer_load_dwordx4 v[48:51], v2, s[20:23], 0 offen offset:320 sc1
  v_mfma_f32_16x16x32_bf16 v[192:195], v[52:55], v[8:11], v[192:195]
  v_mfma_f32_16x16x32_bf16 v[196:199], v[52:55], v[12:15], v[196:199]
  v_mfma_f32_16x16x32_bf16 v[200:203], v[52:55], v[16:19], v[200:203]
  v_mfma_f32_16x16x32_bf16 v[204:207], v[52:55], v[20:23], v[204:207]
  buffer_load_dwordx4 v[52:55], v2, s[20:23], 0 offen offset:384 sc1
  v_mfma_f32_16x16x32_bf16 v[208:211], v[56:59], v[8:11], v[208:211]
  v_mfma_f32_16x16x32_bf16 v[212:215], v[56:59], v[12:15], v[212:215]
  v_mfma_f32_16x16x32_bf16 v[216:219], v[56:59], v[16:19], v[216:219]
  v_mfma_f32_16x16x32_bf16 v[220:223], v[56:59], v[20:23], v[220:223]
  buffer_load_dwordx4 v[56:59], v2, s[20:23], 0 offen offset:448 sc1
  v_mfma_f32_16x16x32_bf16 v[224:227], v[60:63], v[8:11], v[224:227]
  v_mfma_f32_16x16x32_bf16 v[228:231], v[60:63], v[12:15], v[228:231]
  v_mfma_f32_16x16x32_bf16 v[232:235], v[60:63], v[16:19], v[232:235]
  v_mfma_f32_16x16x32_bf16 v[236:239], v[60:63], v[20:23], v[236:239]
  buffer_load_dwordx4 v[60:63], v2, s[20:23], 0 offen offset:512 sc1
  v_mfma_f32_16x16x32_bf16 v[240:243], v[64:67], v[8:11], v[240:243]
  v_mfma_f32_16x16x32_bf16 v[244:247], v[64:67], v[12:15], v[244:247]
  v_mfma_f32_16x16x32_bf16 v[248:251], v[64:67], v[16:19], v[248:251]
  v_mfma_f32_16x16x32_bf16 v[252:255], v[64:67], v[20:23], v[252:255]
  buffer_load_dwordx4 v[64:67], v2, s[20:23], 0 offen offset:576 sc1
  s_barrier
  s_branch L_yepi
L_xepi:
  s_mul_i32 s12, s77, 5120
  v_lshlrev_b32 v2, 4, v0
  s_add_u32 s12, s12, 98304
  v_add_u32 v3, s12, v2
  s_sub_u32 s13, s12, 5120
  s_add_u32 s14, s13, 1024
  ds_write_b128 v3, v[140:143]
  s_add_u32 s15, s13, 2048
  ds_write_b128 v3, v[156:159] offset:1024
  s_add_u32 s22, s13, 3072
  ds_write_b128 v3, v[172:175] offset:2048
  s_mov_b32 s20, 102400
  s_mov_b32 s21, 107520
  s_mov_b32 s23, 112640
  s_mov_b32 s29, 117760
  s_cmp_eq_u32 s77, 0
  ds_write_b128 v3, v[188:191] offset:3072
  s_cselect_b32 s20, s20, s13
  s_cselect_b32 s21, s21, s14
  s_cselect_b32 s15, s23, s15
  s_cselect_b32 s22, s29, s22
  ds_write_b128 v3, v[92:95] offset:4096
  v_add_u32 v80, s20, v2
  v_add_u32 v81, s21, v2
  v_add_u32 v82, s15, v2
  v_add_u32 v83, s22, v2
  s_cmp_eq_u32 s39, 0
  s_cbranch_scc0 L_xcs0
  v_lshrrev_b32 v2, 4, v0
  s_mov_b32 s12, 0x00010001
  v_lshlrev_b32 v2, 4, v2
  s_mov_b32 s13, 0x00010001
  v_add_u32 v2, 155904, v2
  s_mov_b64 exec, s[12:13]
  ds_write_b128 v2, v[84:87] offset:0
  ds_write_b128 v2, v[92:95] offset:128
  s_mov_b64 exec, -1
  s_waitcnt vmcnt(8)
  v_readfirstlane_b32 s12, v5
  s_getreg_b32 s13, hwreg(HW_REG_XCC_ID)
  s_and_b32 s13, s13, 15
  s_cmp_eq_u32 s12, s13
  s_cselect_b32 s12, 1, 0
  v_mov_b32 v4, 157188
  v_mov_b32 v5, s12
  ds_write_b32 v4, v5
L_xcs0:
  s_cmp_eq_u32 s39, 1
  s_cbranch_scc0 L_xcs1
  v_lshrrev_b32 v2, 4, v0
  s_mov_b32 s12, 0x00010001
  v_lshlrev_b32 v2, 4, v2
  s_mov_b32 s13, 0x00010001
  v_add_u32 v2, 155904, v2
  s_mov_b64 exec, s[12:13]
  ds_write_b128 v2, v[84:87] offset:64
  ds_write_b128 v2, v[92:95] offset:192
  s_mov_b64 exec, -1
L_xcs1:
  s_cmp_eq_u32 s39, 2
  s_cbranch_scc0 L_xcs2
  v_lshlrev_b32 v4, 2, v0
  v_add_u32 v4, 156160, v4
  s_mov_b64 exec, 0xffff
  ds_write_b32 v4, v92
  s_mov_b64 exec, -1
L_xcs2:
  s_cmp_eq_u32 s39, 3
  s_cbranch_scc0 L_xcs3
  v_lshlrev_b32 v4, 2, v0
  v_add_u32 v4, 156224, v4
  s_mov_b64 exec, 0xffff
  ds_write_b32 v4, v92
  s_mov_b64 exec, -1
L_xcs3:
  s_add_u32 s16, s6, 4194304
  s_addc_u32 s17, s7, 0
  s_lshl_b32 s12, s79, 2
  s_add_u32 s12, s12, s77
  v_lshlrev_b32 v1, 4, v0
  s_mul_i32 s12, s12, 589824
  v_add_u32 v1, s12, v1
  s_lshr_b32 s12, s78, 4
  s_mul_i32 s12, s12, 72
  s_and_b32 s13, s78, 15
  s_add_u32 s14, s12, s13
  s_lshl_b32 s36, s14, 12
  s_add_u32 s14, s14, 16
  s_lshl_b32 s34, s14, 12
  s_lshl_b32 s14, s13, 1
  s_add_u32 s14, s14, s12
  s_add_u32 s14, s14, 32
  s_lshl_b32 s37, s14, 12
  s_lshr_b32 s14, s13, 1
  s_add_u32 s14, s14, s12
  s_add_u32 s14, s14, 64
  s_lshl_b32 s35, s14, 12
  s_and_b32 s13, s13, 1
  s_lshl_b32 s13, s13, 10
  s_add_u32 s35, s35, s13
  v_lshrrev_b32 v67, 4, v0
  v_and_b32 v66, 15, v0
  s_lshl_b32 s12, s77, 10
  v_lshlrev_b32 v67, 2, v67
  s_add_u32 s12, s12, 151552
  v_lshl_add_u32 v4, v66, 4, s12
  v_lshlrev_b32 v93, 2, v66
  v_sub_u32 v66, v66, v67
  v_lshl_add_u32 v6, v67, 4, s12
  v_subrev_u32 v68, 0, v66
  v_lshlrev_b32 v92, 2, v67
  v_and_b32 v69, 0xfffffff1, v68
  v_add_u32 v68, 16, v68
  v_cmp_eq_u32 s[44:45], 0, v69
  v_and_b32 v69, 0xfffffff1, v68
  v_subrev_u32 v68, 1, v66
  v_cmp_eq_u32 s[52:53], 0, v69
  v_and_b32 v69, 0xfffffff1, v68
  v_add_u32 v68, 16, v68
  v_cmp_eq_u32 s[46:47], 0, v69
  v_and_b32 v69, 0xfffffff1, v68
  v_subrev_u32 v68, 2, v66
  v_cmp_eq_u32 s[54:55], 0, v69
  v_and_b32 v69, 0xfffffff1, v68
  v_add_u32 v68, 16, v68
  v_cmp_eq_u32 s[48:49], 0, v69
  v_and_b32 v69, 0xfffffff1, v68
  v_subrev_u32 v68, 3, v66
  v_cmp_eq_u32 s[56:57], 0, v69
  v_and_b32 v69, 0xfffffff1, v68
  v_add_u32 v68, 16, v68
  v_cmp_eq_u32 s[50:51], 0, v69
  v_and_b32 v69, 0xfffffff1, v68
  s_or_b32 s12, s79, s77
  s_cmp_eq_u32 s12, 0
  s_mov_b32 s18, 18874368
  s_mov_b32 s19, 0x20000
  v_add_u32 v92, 155904, v92
  v_add_u32 v93, 155904, v93
  v_cmp_eq_u32 s[58:59], 0, v69
  s_cselect_b64 s[60:61], 0, -1
  s_waitcnt lgkmcnt(0)
  s_barrier
  ds_read_b128 v[64:67], v80
  ds_read_b128 v[68:71], v81
  ds_read_b128 v[72:75], v82
  ds_read_b128 v[76:79], v83
  ds_read_b128 v[84:87], v92 offset:128
  ds_read_b128 v[88:91], v92 offset:192
  ds_read_b32 v2, v93 offset:256
  ds_read_b32 v3, v93 offset:320
  ds_read_b128 v[80:83], v4
  ds_read_b64 v[8:9], v6 offset:0
  ds_read_b64 v[10:11], v6 offset:16
  ds_read_b64 v[12:13], v6 offset:32
  ds_read_b64 v[14:15], v6 offset:48
  ds_read_b64 v[16:17], v6 offset:256
  ds_read_b64 v[18:19], v6 offset:272
  ds_read_b64 v[20:21], v6 offset:288
  ds_read_b64 v[22:23], v6 offset:304
  s_waitcnt lgkmcnt(8)
  v_pk_fma_f32 v[64:65], v[84:85], v[80:81], v[64:65] op_sel_hi:[1,0,1] neg_lo:[0,1,0] neg_hi:[0,1,0]
  v_pk_fma_f32 v[66:67], v[86:87], v[80:81], v[66:67] op_sel_hi:[1,0,1] neg_lo:[0,1,0] neg_hi:[0,1,0]
  v_pk_fma_f32 v[68:69], v[88:89], v[80:81], v[68:69] op_sel_hi:[1,0,1] neg_lo:[0,1,0] neg_hi:[0,1,0]
  v_pk_fma_f32 v[70:71], v[90:91], v[80:81], v[70:71] op_sel_hi:[1,0,1] neg_lo:[0,1,0] neg_hi:[0,1,0]
  v_pk_mul_f32 v[64:65], v[64:65], v[80:81] op_sel:[0,1] op_sel_hi:[1,1]
  v_pk_mul_f32 v[66:67], v[66:67], v[80:81] op_sel:[0,1] op_sel_hi:[1,1]
  v_pk_mul_f32 v[68:69], v[68:69], v[80:81] op_sel:[0,1] op_sel_hi:[1,1]
  v_pk_mul_f32 v[70:71], v[70:71], v[80:81] op_sel:[0,1] op_sel_hi:[1,1]
  v_cvt_pk_bf16_f32 v24, v64, v65
  v_cvt_pk_bf16_f32 v25, v66, v67
  v_cvt_pk_bf16_f32 v26, v68, v69
  v_cvt_pk_bf16_f32 v27, v70, v71
  s_waitcnt lgkmcnt(4)
  v_fma_f32 v72, -v8, v2, v72
  v_fma_f32 v73, -v10, v2, v73
  v_fma_f32 v74, -v12, v2, v74
  v_fma_f32 v75, -v14, v2, v75
  v_fma_f32 v76, -v8, v3, v76
  v_fma_f32 v77, -v10, v3, v77
  v_fma_f32 v78, -v12, v3, v78
  v_fma_f32 v79, -v14, v3, v79
  v_mul_f32 v72, v72, v9
  v_mul_f32 v73, v73, v11
  v_mul_f32 v74, v74, v13
  v_mul_f32 v75, v75, v15
  v_mul_f32 v76, v76, v9
  v_mul_f32 v77, v77, v11
  v_mul_f32 v78, v78, v13
  v_mul_f32 v79, v79, v15
  ds_read_b128 v[64:67], v4 offset:256
  v_cvt_pk_bf16_f32 v44, v72, v73
  v_cvt_pk_bf16_f32 v45, v74, v75
  ds_read_b128 v[68:71], v4 offset:512
  v_cvt_pk_bf16_f32 v54, v76, v77
  v_cvt_pk_bf16_f32 v55, v78, v79
  ds_read_b128 v[72:75], v4 offset:768
  ds_read_b128 v[76:79], v4 offset:1024
  ds_read_b64 v[8:9], v6 offset:512
  ds_read_b64 v[10:11], v6 offset:528
  ds_read_b64 v[12:13], v6 offset:544
  ds_read_b64 v[14:15], v6 offset:560
  s_waitcnt lgkmcnt(8)
  v_fma_f32 v160, -v16, v2, v160
  v_fma_f32 v176, -v16, v3, v176
  v_fma_f32 v161, -v18, v2, v161
  v_fma_f32 v177, -v18, v3, v177
  v_fma_f32 v162, -v20, v2, v162
  v_fma_f32 v163, -v22, v2, v163
  v_mul_f32 v160, v160, v17
  v_fma_f32 v178, -v20, v3, v178
  v_fma_f32 v179, -v22, v3, v179
  v_mul_f32 v176, v176, v17
  v_mul_f32 v161, v161, v19
  v_mul_f32 v177, v177, v19
  ds_read_b64 v[16:17], v6 offset:768
  v_mul_f32 v162, v162, v21
  v_mul_f32 v163, v163, v23
  v_mul_f32 v178, v178, v21
  v_mul_f32 v179, v179, v23
  ds_read_b64 v[18:19], v6 offset:784
  ds_read_b64 v[20:21], v6 offset:800
  ds_read_b64 v[22:23], v6 offset:816
  v_cvt_pk_bf16_f32 v46, v160, v161
  v_cvt_pk_bf16_f32 v47, v162, v163
  v_cvt_pk_bf16_f32 v56, v176, v177
  v_cvt_pk_bf16_f32 v57, v178, v179
  s_waitcnt lgkmcnt(4)
  v_fma_f32 v164, -v8, v2, v164
  v_fma_f32 v180, -v8, v3, v180
  v_fma_f32 v165, -v10, v2, v165
  v_fma_f32 v181, -v10, v3, v181
  v_fma_f32 v166, -v12, v2, v166
  v_mul_f32 v164, v164, v9
  v_fma_f32 v182, -v12, v3, v182
  v_mul_f32 v180, v180, v9
  v_pk_fma_f32 v[128:129], v[84:85], v[64:65], v[128:129] op_sel_hi:[1,0,1] neg_lo:[0,1,0] neg_hi:[0,1,0]
  v_pk_fma_f32 v[130:131], v[86:87], v[64:65], v[130:131] op_sel_hi:[1,0,1] neg_lo:[0,1,0] neg_hi:[0,1,0]
  v_pk_fma_f32 v[144:145], v[88:89], v[64:65], v[144:145] op_sel_hi:[1,0,1] neg_lo:[0,1,0] neg_hi:[0,1,0]
  v_pk_fma_f32 v[146:147], v[90:91], v[64:65], v[146:147] op_sel_hi:[1,0,1] neg_lo:[0,1,0] neg_hi:[0,1,0]
  v_pk_fma_f32 v[132:133], v[84:85], v[68:69], v[132:133] op_sel_hi:[1,0,1] neg_lo:[0,1,0] neg_hi:[0,1,0]
  v_pk_fma_f32 v[134:135], v[86:87], v[68:69], v[134:135] op_sel_hi:[1,0,1] neg_lo:[0,1,0] neg_hi:[0,1,0]
  v_pk_fma_f32 v[148:149], v[88:89], v[68:69], v[148:149] op_sel_hi:[1,0,1] neg_lo:[0,1,0] neg_hi:[0,1,0]
  v_pk_fma_f32 v[150:151], v[90:91], v[68:69], v[150:151] op_sel_hi:[1,0,1] neg_lo:[0,1,0] neg_hi:[0,1,0]
  v_pk_fma_f32 v[136:137], v[84:85], v[72:73], v[136:137] op_sel_hi:[1,0,1] neg_lo:[0,1,0] neg_hi:[0,1,0]
  v_pk_fma_f32 v[138:139], v[86:87], v[72:73], v[138:139] op_sel_hi:[1,0,1] neg_lo:[0,1,0] neg_hi:[0,1,0]
  v_pk_fma_f32 v[152:153], v[88:89], v[72:73], v[152:153] op_sel_hi:[1,0,1] neg_lo:[0,1,0] neg_hi:[0,1,0]
  v_pk_fma_f32 v[154:155], v[90:91], v[72:73], v[154:155] op_sel_hi:[1,0,1] neg_lo:[0,1,0] neg_hi:[0,1,0]
  v_pk_fma_f32 v[140:141], v[84:85], v[76:77], v[140:141] op_sel_hi:[1,0,1] neg_lo:[0,1,0] neg_hi:[0,1,0]
  v_pk_fma_f32 v[142:143], v[86:87], v[76:77], v[142:143] op_sel_hi:[1,0,1] neg_lo:[0,1,0] neg_hi:[0,1,0]
  v_pk_fma_f32 v[156:157], v[88:89], v[76:77], v[156:157] op_sel_hi:[1,0,1] neg_lo:[0,1,0] neg_hi:[0,1,0]
  v_pk_fma_f32 v[158:159], v[90:91], v[76:77], v[158:159] op_sel_hi:[1,0,1] neg_lo:[0,1,0] neg_hi:[0,1,0]
  v_fma_f32 v167, -v14, v2, v167
  v_mul_f32 v165, v165, v11
  v_fma_f32 v183, -v14, v3, v183
  v_mul_f32 v181, v181, v11
  ds_read_b64 v[8:9], v6 offset:1024
  v_mul_f32 v166, v166, v13
  v_mul_f32 v182, v182, v13
  ds_read_b64 v[10:11], v6 offset:1040
  v_mul_f32 v167, v167, v15
  v_mul_f32 v183, v183, v15
  ds_read_b64 v[12:13], v6 offset:1056
  v_pk_mul_f32 v[128:129], v[128:129], v[64:65] op_sel:[0,1] op_sel_hi:[1,1]
  v_pk_mul_f32 v[130:131], v[130:131], v[64:65] op_sel:[0,1] op_sel_hi:[1,1]
  v_pk_mul_f32 v[144:145], v[144:145], v[64:65] op_sel:[0,1] op_sel_hi:[1,1]
  v_pk_mul_f32 v[146:147], v[146:147], v[64:65] op_sel:[0,1] op_sel_hi:[1,1]
  v_pk_mul_f32 v[132:133], v[132:133], v[68:69] op_sel:[0,1] op_sel_hi:[1,1]
  v_pk_mul_f32 v[134:135], v[134:135], v[68:69] op_sel:[0,1] op_sel_hi:[1,1]
  v_pk_mul_f32 v[148:149], v[148:149], v[68:69] op_sel:[0,1] op_sel_hi:[1,1]
  v_pk_mul_f32 v[150:151], v[150:151], v[68:69] op_sel:[0,1] op_sel_hi:[1,1]
  v_pk_mul_f32 v[136:137], v[136:137], v[72:73] op_sel:[0,1] op_sel_hi:[1,1]
  v_pk_mul_f32 v[138:139], v[138:139], v[72:73] op_sel:[0,1] op_sel_hi:[1,1]
  v_pk_mul_f32 v[152:153], v[152:153], v[72:73] op_sel:[0,1] op_sel_hi:[1,1]
  v_pk_mul_f32 v[154:155], v[154:155], v[72:73] op_sel:[0,1] op_sel_hi:[1,1]
  v_pk_mul_f32 v[140:141], v[140:141], v[76:77] op_sel:[0,1] op_sel_hi:[1,1]
  v_pk_mul_f32 v[142:143], v[142:143], v[76:77] op_sel:[0,1] op_sel_hi:[1,1]
  v_pk_mul_f32 v[156:157], v[156:157], v[76:77] op_sel:[0,1] op_sel_hi:[1,1]
  v_pk_mul_f32 v[158:159], v[158:159], v[76:77] op_sel:[0,1] op_sel_hi:[1,1]
  ds_read_b64 v[14:15], v6 offset:1072
  ds_read_b128 v[84:87], v92 offset:0
  v_cvt_pk_bf16_f32 v48, v164, v165
  v_cvt_pk_bf16_f32 v49, v166, v167
  v_cvt_pk_bf16_f32 v58, v180, v181
  v_cvt_pk_bf16_f32 v59, v182, v183
  v_cvt_pk_bf16_f32 v28, v128, v129
  v_cvt_pk_bf16_f32 v29, v130, v131
  v_cvt_pk_bf16_f32 v30, v144, v145
  v_cvt_pk_bf16_f32 v31, v146, v147
  v_cvt_pk_bf16_f32 v32, v132, v133
  v_cvt_pk_bf16_f32 v33, v134, v135
  v_cvt_pk_bf16_f32 v34, v148, v149
  v_cvt_pk_bf16_f32 v35, v150, v151
  v_cvt_pk_bf16_f32 v36, v136, v137
  v_cvt_pk_bf16_f32 v37, v138, v139
  v_cvt_pk_bf16_f32 v38, v152, v153
  v_cvt_pk_bf16_f32 v39, v154, v155
  v_cvt_pk_bf16_f32 v40, v140, v141
  v_cvt_pk_bf16_f32 v41, v142, v143
  v_cvt_pk_bf16_f32 v42, v156, v157
  v_cvt_pk_bf16_f32 v43, v158, v159
  ds_read_b128 v[88:91], v92 offset:64
  s_waitcnt lgkmcnt(6)
  v_fma_f32 v168, -v16, v2, v168
  v_fma_f32 v169, -v18, v2, v169
  v_fma_f32 v170, -v20, v2, v170
  v_fma_f32 v171, -v22, v2, v171
  v_fma_f32 v184, -v16, v3, v184
  v_fma_f32 v185, -v18, v3, v185
  v_fma_f32 v186, -v20, v3, v186
  v_fma_f32 v187, -v22, v3, v187
  v_mul_f32 v168, v168, v17
  v_mul_f32 v169, v169, v19
  v_mul_f32 v170, v170, v21
  v_mul_f32 v171, v171, v23
  v_mul_f32 v184, v184, v17
  v_mul_f32 v185, v185, v19
  v_mul_f32 v186, v186, v21
  v_mul_f32 v187, v187, v23
  v_cvt_pk_bf16_f32 v50, v168, v169
  v_cvt_pk_bf16_f32 v51, v170, v171
  v_cvt_pk_bf16_f32 v60, v184, v185
  v_cvt_pk_bf16_f32 v61, v186, v187
  s_waitcnt lgkmcnt(2)
  v_fma_f32 v172, -v8, v2, v172
  v_fma_f32 v173, -v10, v2, v173
  v_fma_f32 v174, -v12, v2, v174
  v_fma_f32 v175, -v14, v2, v175
  v_fma_f32 v188, -v8, v3, v188
  v_fma_f32 v189, -v10, v3, v189
  v_fma_f32 v190, -v12, v3, v190
  v_fma_f32 v191, -v14, v3, v191
  v_mul_f32 v172, v172, v9
  v_mul_f32 v173, v173, v11
  v_mul_f32 v174, v174, v13
  v_mul_f32 v175, v175, v15
  v_mul_f32 v188, v188, v9
  v_mul_f32 v189, v189, v11
  v_mul_f32 v190, v190, v13
  v_mul_f32 v191, v191, v15
  v_cvt_pk_bf16_f32 v52, v172, v173
  v_cvt_pk_bf16_f32 v53, v174, v175
  v_cvt_pk_bf16_f32 v62, v188, v189
  v_cvt_pk_bf16_f32 v63, v190, v191
  s_waitcnt lgkmcnt(0)
  s_lshl_b32 s20, s78, 10
  v_lshrrev_b32 v2, 4, v0
  s_add_u32 s20, s20, 1048576
  s_add_u32 s20, s6, s20
  v_lshlrev_b32 v2, 4, v2
  s_addc_u32 s21, s7, 0
  s_mov_b32 s22, 256
  s_mov_b32 s23, 0x20000
  v_pk_fma_f32 v[96:97], v[84:85], v[64:65], v[96:97] op_sel_hi:[1,0,1] neg_lo:[0,1,0] neg_hi:[0,1,0]
  v_pk_fma_f32 v[98:99], v[86:87], v[64:65], v[98:99] op_sel_hi:[1,0,1] neg_lo:[0,1,0] neg_hi:[0,1,0]
  v_pk_fma_f32 v[112:113], v[88:89], v[64:65], v[112:113] op_sel_hi:[1,0,1] neg_lo:[0,1,0] neg_hi:[0,1,0]
  v_pk_fma_f32 v[114:115], v[90:91], v[64:65], v[114:115] op_sel_hi:[1,0,1] neg_lo:[0,1,0] neg_hi:[0,1,0]
  v_pk_fma_f32 v[100:101], v[84:85], v[68:69], v[100:101] op_sel_hi:[1,0,1] neg_lo:[0,1,0] neg_hi:[0,1,0]
  v_pk_fma_f32 v[102:103], v[86:87], v[68:69], v[102:103] op_sel_hi:[1,0,1] neg_lo:[0,1,0] neg_hi:[0,1,0]
  v_pk_fma_f32 v[116:117], v[88:89], v[68:69], v[116:117] op_sel_hi:[1,0,1] neg_lo:[0,1,0] neg_hi:[0,1,0]
  v_pk_fma_f32 v[118:119], v[90:91], v[68:69], v[118:119] op_sel_hi:[1,0,1] neg_lo:[0,1,0] neg_hi:[0,1,0]
  v_pk_fma_f32 v[104:105], v[84:85], v[72:73], v[104:105] op_sel_hi:[1,0,1] neg_lo:[0,1,0] neg_hi:[0,1,0]
  v_pk_fma_f32 v[106:107], v[86:87], v[72:73], v[106:107] op_sel_hi:[1,0,1] neg_lo:[0,1,0] neg_hi:[0,1,0]
  v_pk_fma_f32 v[120:121], v[88:89], v[72:73], v[120:121] op_sel_hi:[1,0,1] neg_lo:[0,1,0] neg_hi:[0,1,0]
  v_pk_fma_f32 v[122:123], v[90:91], v[72:73], v[122:123] op_sel_hi:[1,0,1] neg_lo:[0,1,0] neg_hi:[0,1,0]
  v_pk_fma_f32 v[108:109], v[84:85], v[76:77], v[108:109] op_sel_hi:[1,0,1] neg_lo:[0,1,0] neg_hi:[0,1,0]
  v_pk_fma_f32 v[110:111], v[86:87], v[76:77], v[110:111] op_sel_hi:[1,0,1] neg_lo:[0,1,0] neg_hi:[0,1,0]
  v_pk_fma_f32 v[124:125], v[88:89], v[76:77], v[124:125] op_sel_hi:[1,0,1] neg_lo:[0,1,0] neg_hi:[0,1,0]
  v_pk_fma_f32 v[126:127], v[90:91], v[76:77], v[126:127] op_sel_hi:[1,0,1] neg_lo:[0,1,0] neg_hi:[0,1,0]
  buffer_load_dwordx4 v[160:163], v2, s[20:23], 0 offen offset:0 sc1
  buffer_load_dwordx4 v[164:167], v2, s[20:23], 0 offen offset:64 sc1
  buffer_load_dwordx4 v[168:171], v2, s[20:23], 0 offen offset:128 sc1
  v_cvt_pk_bf16_f32 v8, v96, v97
  v_cvt_pk_bf16_f32 v9, v98, v99
  v_cvt_pk_bf16_f32 v10, v112, v113
  v_cvt_pk_bf16_f32 v11, v114, v115
  v_cvt_pk_bf16_f32 v12, v100, v101
  v_cvt_pk_bf16_f32 v13, v102, v103
  v_cvt_pk_bf16_f32 v14, v116, v117
  v_cvt_pk_bf16_f32 v15, v118, v119
  v_cvt_pk_bf16_f32 v16, v104, v105
  v_cvt_pk_bf16_f32 v17, v106, v107
  v_cvt_pk_bf16_f32 v18, v120, v121
  v_cvt_pk_bf16_f32 v19, v122, v123
  v_cvt_pk_bf16_f32 v20, v108, v109
  v_cvt_pk_bf16_f32 v21, v110, v111
  v_cvt_pk_bf16_f32 v22, v124, v125
  v_cvt_pk_bf16_f32 v23, v126, v127
  v_mul_f32 v84, 0x3e8293ee, v65
  v_mul_f32 v85, 0x3e8293ee, v69
  v_mul_f32 v86, 0x3e8293ee, v73
  v_mul_f32 v87, 0x3e8293ee, v77
  buffer_load_dwordx4 v[172:175], v2, s[20:23], 0 offen offset:192 sc1
  s_mov_b32 s29, 0x40000
L_xcsg:
  s_waitcnt vmcnt(0)
  v_max3_u32 v3, v160, v161, v162
  v_max3_u32 v3, v3, v163, v164
  v_max3_u32 v3, v3, v165, v166
  v_max3_u32 v3, v3, v167, v168
  v_max3_u32 v3, v3, v169, v170
  v_max3_u32 v3, v3, v171, v172
  v_max3_u32 v3, v3, v173, v174
  v_max_u32 v3, v3, v175
  v_cmp_eq_u32 vcc, -1, v3
  s_cmp_eq_u64 vcc, 0
  s_cbranch_scc1 L_xcsg_ok
  s_sub_u32 s29, s29, 1
  s_cmp_eq_u32 s29, 0
  s_cbranch_scc1 L_xcsg_ok
  buffer_load_dwordx4 v[160:163], v2, s[20:23], 0 offen offset:0 sc1
  buffer_load_dwordx4 v[164:167], v2, s[20:23], 0 offen offset:64 sc1
  buffer_load_dwordx4 v[168:171], v2, s[20:23], 0 offen offset:128 sc1
  buffer_load_dwordx4 v[172:175], v2, s[20:23], 0 offen offset:192 sc1
  s_branch L_xcsg
L_xcsg_ok:
  v_mfma_f32_16x16x32_bf16 v[68:71], v[28:31], v[12:15], 0
  v_mfma_f32_16x16x32_bf16 v[72:75], v[32:35], v[12:15], 0
  v_mov_b32 v88, 0xf149f2ca
  s_and_b64 s[62:63], s[52:53], s[60:61]
  s_nop 4
  v_cndmask_b32 v68, v88, v68, s[52:53]
  v_cndmask_b32 v69, v88, v69, s[54:55]
  v_cndmask_b32 v70, v88, v70, s[56:57]
  v_cndmask_b32 v71, v88, v71, s[58:59]
  v_cndmask_b32 v72, v88, v72, s[44:45]
  v_max3_f32 v76, v68, v69, v70
  v_cndmask_b32 v73, v88, v73, s[46:47]
  v_cndmask_b32 v74, v88, v74, s[48:49]
  v_max3_f32 v76, v76, v71, v72
  v_cndmask_b32 v75, v88, v75, s[50:51]
  v_max3_f32 v76, v76, v73, v74
  v_max_f32 v76, v76, v75
  v_mov_b32 v77, v76
  s_nop 1
  v_permlane16_swap_b32 v76, v77
  v_max_f32 v76, v76, v77
  v_mov_b32 v77, v76
  s_nop 1
  v_permlane32_swap_b32 v76, v77
  v_max_f32 v76, v76, v77
  v_mul_f32 v76, v85, v76
  v_fma_f32 v68, v68, v85, -v76
  v_fma_f32 v69, v69, v85, -v76
  v_fma_f32 v70, v70, v85, -v76
  v_fma_f32 v71, v71, v85, -v76
  v_fma_f32 v72, v72, v85, -v76
  v_fma_f32 v73, v73, v85, -v76
  v_fma_f32 v74, v74, v85, -v76
  v_fma_f32 v75, v75, v85, -v76
  v_exp_f32 v68, v68
  v_exp_f32 v69, v69
  v_exp_f32 v70, v70
  v_exp_f32 v71, v71
  v_exp_f32 v72, v72
  v_exp_f32 v73, v73
  v_exp_f32 v74, v74
  v_exp_f32 v75, v75
  v_add_f32 v76, v68, v69
  v_add_f32 v77, v70, v71
  v_add_f32 v78, v72, v73
  v_add_f32 v79, v74, v75
  v_add_f32 v76, v76, v77
  v_add_f32 v78, v78, v79
  v_cvt_pk_bf16_f32 v80, v68, v69
  v_add_f32 v76, v76, v78
  v_cvt_pk_bf16_f32 v81, v70, v71
  v_mov_b32 v77, v76
  v_cvt_pk_bf16_f32 v82, v72, v73
  v_cvt_pk_bf16_f32 v83, v74, v75
  v_permlane16_swap_b32 v76, v77
  v_mfma_f32_16x16x32_bf16 v[68:71], v[32:35], v[16:19], 0
  v_add_f32 v76, v76, v77
  v_mfma_f32_16x16x32_bf16 v[100:103], v[46:49], v[80:83], 0
  v_mov_b32 v77, v76
  v_mfma_f32_16x16x32_bf16 v[116:119], v[56:59], v[80:83], 0
  v_mfma_f32_16x16x32_bf16 v[72:75], v[36:39], v[16:19], 0
  v_permlane32_swap_b32 v76, v77
  v_add_f32 v76, v76, v77
  s_nop 0
  v_cndmask_b32 v68, v88, v68, s[52:53]
  v_rcp_f32 v76, v76
  v_cndmask_b32 v69, v88, v69, s[54:55]
  v_cndmask_b32 v70, v88, v70, s[56:57]
  v_mul_f32 v100, v100, v76
  v_mul_f32 v101, v101, v76
  v_mul_f32 v102, v102, v76
  v_mul_f32 v103, v103, v76
  v_mul_f32 v116, v116, v76
  v_mul_f32 v117, v117, v76
  v_mul_f32 v118, v118, v76
  v_mul_f32 v119, v119, v76
  v_cndmask_b32 v71, v88, v71, s[58:59]
  v_cndmask_b32 v72, v88, v72, s[44:45]
  v_max3_f32 v76, v68, v69, v70
  v_cndmask_b32 v73, v88, v73, s[46:47]
  v_cndmask_b32 v74, v88, v74, s[48:49]
  v_max3_f32 v76, v76, v71, v72
  v_cndmask_b32 v75, v88, v75, s[50:51]
  v_max3_f32 v76, v76, v73, v74
  v_cvt_pk_bf16_f32 v132, v100, v101
  v_max_f32 v76, v76, v75
  v_cvt_pk_bf16_f32 v133, v102, v103
  v_mov_b32 v77, v76
  v_cvt_pk_bf16_f32 v134, v116, v117
  v_cvt_pk_bf16_f32 v135, v118, v119
  v_permlane16_swap_b32 v76, v77
  buffer_store_dwordx4 v[132:135], v1, s[16:19], s36 offen offset:1024 sc1
  v_max_f32 v76, v76, v77
  v_mov_b32 v77, v76
  s_nop 1
  v_permlane32_swap_b32 v76, v77
  v_max_f32 v76, v76, v77
  v_mul_f32 v76, v86, v76
  v_fma_f32 v68, v68, v86, -v76
  v_fma_f32 v69, v69, v86, -v76
  v_fma_f32 v70, v70, v86, -v76
  v_fma_f32 v71, v71, v86, -v76
  v_fma_f32 v72, v72, v86, -v76
  v_fma_f32 v73, v73, v86, -v76
  v_fma_f32 v74, v74, v86, -v76
  v_fma_f32 v75, v75, v86, -v76
  v_exp_f32 v68, v68
  v_exp_f32 v69, v69
  v_exp_f32 v70, v70
  v_exp_f32 v71, v71
  v_exp_f32 v72, v72
  v_exp_f32 v73, v73
  v_exp_f32 v74, v74
  v_exp_f32 v75, v75
  v_add_f32 v76, v68, v69
  v_add_f32 v77, v70, v71
  v_add_f32 v78, v72, v73
  v_add_f32 v79, v74, v75
  v_add_f32 v76, v76, v77
  v_add_f32 v78, v78, v79
  v_cvt_pk_bf16_f32 v80, v68, v69
  v_add_f32 v76, v76, v78
  v_cvt_pk_bf16_f32 v81, v70, v71
  v_mov_b32 v77, v76
  v_cvt_pk_bf16_f32 v82, v72, v73
  v_cvt_pk_bf16_f32 v83, v74, v75
  v_permlane16_swap_b32 v76, v77
  v_mfma_f32_16x16x32_bf16 v[68:71], v[36:39], v[20:23], 0
  v_add_f32 v76, v76, v77
  v_mfma_f32_16x16x32_bf16 v[104:107], v[48:51], v[80:83], 0
  v_mov_b32 v77, v76
  v_mfma_f32_16x16x32_bf16 v[120:123], v[58:61], v[80:83], 0
  v_mfma_f32_16x16x32_bf16 v[72:75], v[40:43], v[20:23], 0
  v_permlane32_swap_b32 v76, v77
  v_add_f32 v76, v76, v77
  s_nop 0
  v_cndmask_b32 v68, v88, v68, s[52:53]
  v_rcp_f32 v76, v76
  v_cndmask_b32 v69, v88, v69, s[54:55]
  v_cndmask_b32 v70, v88, v70, s[56:57]
  v_mul_f32 v104, v104, v76
  v_mul_f32 v105, v105, v76
  v_mul_f32 v106, v106, v76
  v_mul_f32 v107, v107, v76
  v_mul_f32 v120, v120, v76
  v_mul_f32 v121, v121, v76
  v_mul_f32 v122, v122, v76
  v_mul_f32 v123, v123, v76
  v_cndmask_b32 v71, v88, v71, s[58:59]
  v_cndmask_b32 v72, v88, v72, s[44:45]
  v_max3_f32 v76, v68, v69, v70
  v_cndmask_b32 v73, v88, v73, s[46:47]
  v_cndmask_b32 v74, v88, v74, s[48:49]
  v_max3_f32 v76, v76, v71, v72
  v_cndmask_b32 v75, v88, v75, s[50:51]
  v_max3_f32 v76, v76, v73, v74
  v_cvt_pk_bf16_f32 v136, v104, v105
  v_max_f32 v76, v76, v75
  v_cvt_pk_bf16_f32 v137, v106, v107
  v_mov_b32 v77, v76
  v_cvt_pk_bf16_f32 v138, v120, v121
  v_cvt_pk_bf16_f32 v139, v122, v123
  v_permlane16_swap_b32 v76, v77
  buffer_store_dwordx4 v[136:139], v1, s[16:19], s36 offen offset:2048 sc1
  v_max_f32 v76, v76, v77
  v_mov_b32 v77, v76
  s_nop 1
  v_permlane32_swap_b32 v76, v77
  v_max_f32 v76, v76, v77
  v_mul_f32 v76, v87, v76
  v_fma_f32 v68, v68, v87, -v76
  v_fma_f32 v69, v69, v87, -v76
  v_fma_f32 v70, v70, v87, -v76
  v_fma_f32 v71, v71, v87, -v76
  v_fma_f32 v72, v72, v87, -v76
  v_fma_f32 v73, v73, v87, -v76
  v_fma_f32 v74, v74, v87, -v76
  v_fma_f32 v75, v75, v87, -v76
  v_exp_f32 v68, v68
  v_exp_f32 v69, v69
  v_exp_f32 v70, v70
  v_exp_f32 v71, v71
  v_exp_f32 v72, v72
  v_exp_f32 v73, v73
  v_exp_f32 v74, v74
  v_exp_f32 v75, v75
  v_add_f32 v76, v68, v69
  v_add_f32 v77, v70, v71
  v_add_f32 v78, v72, v73
  v_add_f32 v79, v74, v75
  v_add_f32 v76, v76, v77
  v_add_f32 v78, v78, v79
  v_cvt_pk_bf16_f32 v80, v68, v69
  v_add_f32 v76, v76, v78
  v_cvt_pk_bf16_f32 v81, v70, v71
  v_mov_b32 v77, v76
  v_mfma_f32_16x16x32_bf16 v[68:71], v[24:27], v[8:11], 0
  v_cvt_pk_bf16_f32 v82, v72, v73
  v_permlane16_swap_b32 v76, v77
  v_cvt_pk_bf16_f32 v83, v74, v75
  v_add_f32 v76, v76, v77
  v_mfma_f32_16x16x32_bf16 v[72:75], v[28:31], v[8:11], 0
  v_mov_b32 v77, v76
  v_mfma_f32_16x16x32_bf16 v[108:111], v[50:53], v[80:83], 0
  v_mfma_f32_16x16x32_bf16 v[124:127], v[60:63], v[80:83], 0
  v_permlane32_swap_b32 v76, v77
  v_cndmask_b32 v68, v88, v68, s[62:63]
  v_add_f32 v76, v76, v77
  s_and_b64 s[62:63], s[54:55], s[60:61]
  v_rcp_f32 v76, v76
  v_cndmask_b32 v69, v88, v69, s[62:63]
  s_and_b64 s[62:63], s[56:57], s[60:61]
  v_cndmask_b32 v70, v88, v70, s[62:63]
  v_mul_f32 v108, v108, v76
  v_mul_f32 v109, v109, v76
  v_mul_f32 v110, v110, v76
  v_mul_f32 v111, v111, v76
  v_mul_f32 v124, v124, v76
  v_mul_f32 v125, v125, v76
  v_mul_f32 v126, v126, v76
  v_mul_f32 v127, v127, v76
  s_and_b64 s[62:63], s[58:59], s[60:61]
  v_cndmask_b32 v71, v88, v71, s[62:63]
  v_cndmask_b32 v72, v88, v72, s[44:45]
  v_max3_f32 v76, v68, v69, v70
  v_cndmask_b32 v73, v88, v73, s[46:47]
  v_cndmask_b32 v74, v88, v74, s[48:49]
  v_max3_f32 v76, v76, v71, v72
  v_cndmask_b32 v75, v88, v75, s[50:51]
  v_max3_f32 v76, v76, v73, v74
  v_cvt_pk_bf16_f32 v140, v108, v109
  v_max_f32 v76, v76, v75
  v_cvt_pk_bf16_f32 v141, v110, v111
  v_mov_b32 v77, v76
  v_cvt_pk_bf16_f32 v142, v124, v125
  v_cvt_pk_bf16_f32 v143, v126, v127
  v_permlane16_swap_b32 v76, v77
  ds_read_b128 v[24:27], v4 offset:256
  v_max_f32 v76, v76, v77
  ds_read_b128 v[28:31], v4 offset:512
  v_mov_b32 v77, v76
  buffer_store_dwordx4 v[140:143], v1, s[16:19], s36 offen offset:3072 sc1
  ds_read_b128 v[32:35], v4 offset:768
  v_permlane32_swap_b32 v76, v77
  ds_read_b128 v[36:39], v4 offset:1024
  v_max_f32 v76, v76, v77
  v_mul_f32 v76, v84, v76
  v_fma_f32 v68, v68, v84, -v76
  v_fma_f32 v69, v69, v84, -v76
  v_fma_f32 v70, v70, v84, -v76
  v_fma_f32 v71, v71, v84, -v76
  v_fma_f32 v72, v72, v84, -v76
  v_fma_f32 v73, v73, v84, -v76
  v_fma_f32 v74, v74, v84, -v76
  v_fma_f32 v75, v75, v84, -v76
  v_exp_f32 v68, v68
  v_exp_f32 v69, v69
  v_exp_f32 v70, v70
  v_exp_f32 v71, v71
  v_exp_f32 v72, v72
  v_exp_f32 v73, v73
  v_exp_f32 v74, v74
  v_exp_f32 v75, v75
  v_add_f32 v76, v68, v69
  v_add_f32 v77, v70, v71
  v_add_f32 v78, v72, v73
  v_add_f32 v79, v74, v75
  v_add_f32 v76, v76, v77
  v_add_f32 v78, v78, v79
  v_cvt_pk_bf16_f32 v80, v68, v69
  v_add_f32 v76, v76, v78
  v_cvt_pk_bf16_f32 v81, v70, v71
  v_mov_b32 v77, v76
  v_cvt_pk_bf16_f32 v82, v72, v73
  v_cvt_pk_bf16_f32 v83, v74, v75
  v_permlane16_swap_b32 v76, v77
  v_add_f32 v76, v76, v77
  v_mfma_f32_16x16x32_bf16 v[96:99], v[44:47], v[80:83], 0
  v_mov_b32 v77, v76
  v_mfma_f32_16x16x32_bf16 v[112:115], v[54:57], v[80:83], 0
  s_nop 0
  v_permlane32_swap_b32 v76, v77
  v_add_f32 v76, v76, v77
  v_rcp_f32 v76, v76
  s_nop 1
  v_mul_f32 v96, v96, v76
  v_mul_f32 v97, v97, v76
  v_mul_f32 v98, v98, v76
  v_mul_f32 v99, v99, v76
  v_mul_f32 v112, v112, v76
  v_mul_f32 v113, v113, v76
  v_mul_f32 v114, v114, v76
  v_mul_f32 v115, v115, v76
  v_cvt_pk_bf16_f32 v128, v96, v97
  v_cvt_pk_bf16_f32 v129, v98, v99
  v_cvt_pk_bf16_f32 v130, v112, v113
  v_cvt_pk_bf16_f32 v131, v114, v115
  buffer_store_dwordx4 v[128:131], v1, s[16:19], s36 offen offset:0 sc1
  s_waitcnt lgkmcnt(0)
  v_mul_f32 v27, v25, v25
  v_mul_f32 v25, 0xc0135761, v25
  v_mul_f32 v31, v29, v29
  v_mul_f32 v29, 0xc0135761, v29
  v_pk_fma_f32 v[192:193], v[160:161], v[24:25], v[192:193] op_sel_hi:[1,0,1] neg_lo:[0,1,0] neg_hi:[0,1,0]
  v_pk_fma_f32 v[194:195], v[162:163], v[24:25], v[194:195] op_sel_hi:[1,0,1] neg_lo:[0,1,0] neg_hi:[0,1,0]
  v_pk_fma_f32 v[208:209], v[164:165], v[24:25], v[208:209] op_sel_hi:[1,0,1] neg_lo:[0,1,0] neg_hi:[0,1,0]
  v_pk_fma_f32 v[210:211], v[166:167], v[24:25], v[210:211] op_sel_hi:[1,0,1] neg_lo:[0,1,0] neg_hi:[0,1,0]
  v_pk_fma_f32 v[196:197], v[160:161], v[28:29], v[196:197] op_sel_hi:[1,0,1] neg_lo:[0,1,0] neg_hi:[0,1,0]
  v_pk_fma_f32 v[198:199], v[162:163], v[28:29], v[198:199] op_sel_hi:[1,0,1] neg_lo:[0,1,0] neg_hi:[0,1,0]
  v_pk_fma_f32 v[212:213], v[164:165], v[28:29], v[212:213] op_sel_hi:[1,0,1] neg_lo:[0,1,0] neg_hi:[0,1,0]
  v_pk_fma_f32 v[214:215], v[166:167], v[28:29], v[214:215] op_sel_hi:[1,0,1] neg_lo:[0,1,0] neg_hi:[0,1,0]
  v_mul_f32 v27, v27, v25
  v_mul_f32 v31, v31, v29
  v_pk_mul_f32 v[40:41], v[192:193], v[192:193]
  v_pk_mul_f32 v[42:43], v[194:195], v[194:195]
  v_pk_mul_f32 v[48:49], v[208:209], v[208:209]
  v_pk_mul_f32 v[50:51], v[210:211], v[210:211]
  v_mul_f32 v27, 0x3d372713, v27
  v_pk_mul_f32 v[56:57], v[196:197], v[196:197]
  v_pk_mul_f32 v[58:59], v[198:199], v[198:199]
  v_pk_mul_f32 v[64:65], v[212:213], v[212:213]
  v_pk_mul_f32 v[66:67], v[214:215], v[214:215]
  v_mul_f32 v31, 0x3d372713, v31
  v_pk_fma_f32 v[40:41], v[40:41], v[26:27], v[24:25] op_sel:[0,1,1] op_sel_hi:[1,1,1]
  v_pk_fma_f32 v[42:43], v[42:43], v[26:27], v[24:25] op_sel:[0,1,1] op_sel_hi:[1,1,1]
  v_pk_fma_f32 v[48:49], v[48:49], v[26:27], v[24:25] op_sel:[0,1,1] op_sel_hi:[1,1,1]
  v_pk_fma_f32 v[50:51], v[50:51], v[26:27], v[24:25] op_sel:[0,1,1] op_sel_hi:[1,1,1]
  v_pk_fma_f32 v[56:57], v[56:57], v[30:31], v[28:29] op_sel:[0,1,1] op_sel_hi:[1,1,1]
  v_pk_fma_f32 v[58:59], v[58:59], v[30:31], v[28:29] op_sel:[0,1,1] op_sel_hi:[1,1,1]
  v_pk_fma_f32 v[64:65], v[64:65], v[30:31], v[28:29] op_sel:[0,1,1] op_sel_hi:[1,1,1]
  v_pk_fma_f32 v[66:67], v[66:67], v[30:31], v[28:29] op_sel:[0,1,1] op_sel_hi:[1,1,1]
  v_pk_mul_f32 v[40:41], v[40:41], v[192:193]
  v_pk_mul_f32 v[42:43], v[42:43], v[194:195]
  v_pk_mul_f32 v[48:49], v[48:49], v[208:209]
  v_pk_mul_f32 v[50:51], v[50:51], v[210:211]
  v_pk_mul_f32 v[56:57], v[56:57], v[196:197]
  v_pk_mul_f32 v[58:59], v[58:59], v[198:199]
  v_pk_mul_f32 v[64:65], v[64:65], v[212:213]
  v_pk_mul_f32 v[66:67], v[66:67], v[214:215]
  v_exp_f32 v40, v40
  v_exp_f32 v41, v41
  v_exp_f32 v42, v42
  v_exp_f32 v43, v43
  v_exp_f32 v48, v48
  v_exp_f32 v49, v49
  v_exp_f32 v50, v50
  v_exp_f32 v51, v51
  v_exp_f32 v56, v56
  v_exp_f32 v57, v57
  v_exp_f32 v58, v58
  v_exp_f32 v59, v59
  v_exp_f32 v64, v64
  v_exp_f32 v65, v65
  v_exp_f32 v66, v66
  v_exp_f32 v67, v67
  v_pk_fma_f32 v[40:41], v[40:41], v[26:27], v[26:27] op_sel_hi:[1,0,0]
  v_pk_fma_f32 v[42:43], v[42:43], v[26:27], v[26:27] op_sel_hi:[1,0,0]
  v_pk_fma_f32 v[48:49], v[48:49], v[26:27], v[26:27] op_sel_hi:[1,0,0]
  v_pk_fma_f32 v[50:51], v[50:51], v[26:27], v[26:27] op_sel_hi:[1,0,0]
  v_pk_fma_f32 v[224:225], v[168:169], v[24:25], v[224:225] op_sel_hi:[1,0,1] neg_lo:[0,1,0] neg_hi:[0,1,0]
  v_pk_fma_f32 v[226:227], v[170:171], v[24:25], v[226:227] op_sel_hi:[1,0,1] neg_lo:[0,1,0] neg_hi:[0,1,0]
  v_pk_fma_f32 v[240:241], v[172:173], v[24:25], v[240:241] op_sel_hi:[1,0,1] neg_lo:[0,1,0] neg_hi:[0,1,0]
  v_pk_fma_f32 v[242:243], v[174:175], v[24:25], v[242:243] op_sel_hi:[1,0,1] neg_lo:[0,1,0] neg_hi:[0,1,0]
  v_pk_fma_f32 v[56:57], v[56:57], v[30:31], v[30:31] op_sel_hi:[1,0,0]
  v_pk_fma_f32 v[58:59], v[58:59], v[30:31], v[30:31] op_sel_hi:[1,0,0]
  v_pk_fma_f32 v[64:65], v[64:65], v[30:31], v[30:31] op_sel_hi:[1,0,0]
  v_pk_fma_f32 v[66:67], v[66:67], v[30:31], v[30:31] op_sel_hi:[1,0,0]
  v_pk_fma_f32 v[228:229], v[168:169], v[28:29], v[228:229] op_sel_hi:[1,0,1] neg_lo:[0,1,0] neg_hi:[0,1,0]
  v_pk_fma_f32 v[230:231], v[170:171], v[28:29], v[230:231] op_sel_hi:[1,0,1] neg_lo:[0,1,0] neg_hi:[0,1,0]
  v_pk_fma_f32 v[244:245], v[172:173], v[28:29], v[244:245] op_sel_hi:[1,0,1] neg_lo:[0,1,0] neg_hi:[0,1,0]
  v_pk_fma_f32 v[246:247], v[174:175], v[28:29], v[246:247] op_sel_hi:[1,0,1] neg_lo:[0,1,0] neg_hi:[0,1,0]
  v_rcp_f32 v40, v40
  v_rcp_f32 v41, v41
  v_rcp_f32 v42, v42
  v_rcp_f32 v43, v43
  v_rcp_f32 v48, v48
  v_rcp_f32 v49, v49
  v_rcp_f32 v50, v50
  v_rcp_f32 v51, v51
  v_pk_mul_f32 v[44:45], v[192:193], v[224:225]
  v_pk_mul_f32 v[46:47], v[194:195], v[226:227]
  v_pk_mul_f32 v[52:53], v[208:209], v[240:241]
  v_pk_mul_f32 v[54:55], v[210:211], v[242:243]
  v_rcp_f32 v56, v56
  v_rcp_f32 v57, v57
  v_rcp_f32 v58, v58
  v_rcp_f32 v59, v59
  v_rcp_f32 v64, v64
  v_rcp_f32 v65, v65
  v_rcp_f32 v66, v66
  v_rcp_f32 v67, v67
  v_pk_mul_f32 v[60:61], v[196:197], v[228:229]
  v_pk_mul_f32 v[62:63], v[198:199], v[230:231]
  v_pk_mul_f32 v[68:69], v[212:213], v[244:245]
  v_pk_mul_f32 v[70:71], v[214:215], v[246:247]
  v_pk_mul_f32 v[44:45], v[44:45], v[40:41]
  v_pk_mul_f32 v[46:47], v[46:47], v[42:43]
  v_pk_mul_f32 v[52:53], v[52:53], v[48:49]
  v_pk_mul_f32 v[54:55], v[54:55], v[50:51]
  v_mul_f32 v35, v33, v33
  v_mul_f32 v39, v37, v37
  v_pk_mul_f32 v[60:61], v[60:61], v[56:57]
  v_pk_mul_f32 v[62:63], v[62:63], v[58:59]
  v_pk_mul_f32 v[68:69], v[68:69], v[64:65]
  v_pk_mul_f32 v[70:71], v[70:71], v[66:67]
  v_mul_f32 v33, 0xc0135761, v33
  v_mul_f32 v37, 0xc0135761, v37
  v_cvt_pk_bf16_f32 v192, v44, v45
  v_cvt_pk_bf16_f32 v193, v46, v47
  v_cvt_pk_bf16_f32 v194, v52, v53
  v_cvt_pk_bf16_f32 v195, v54, v55
  v_mul_f32 v35, v35, v33
  v_mul_f32 v39, v39, v37
  v_cvt_pk_bf16_f32 v196, v60, v61
  v_cvt_pk_bf16_f32 v197, v62, v63
  v_cvt_pk_bf16_f32 v198, v68, v69
  v_cvt_pk_bf16_f32 v199, v70, v71
  buffer_store_dwordx4 v[192:195], v1, s[16:19], s34 offen offset:0 sc1
  v_mul_f32 v35, 0x3d372713, v35
  v_mul_f32 v39, 0x3d372713, v39
  buffer_store_dwordx4 v[196:199], v1, s[16:19], s34 offen offset:1024 sc1
  s_waitcnt vmcnt(2)
  v_mov_b32 v2, 157184
  v_mov_b32 v3, 1
  s_mov_b64 exec, 1
  ds_add_rtn_u32 v3, v2, v3
  s_waitcnt lgkmcnt(0)
  v_readfirstlane_b32 s12, v3
  s_mov_b64 exec, -1
  s_cmp_eq_u32 s12, 3
  s_cbranch_scc0 L_osig_done
  s_lshl_b32 s12, s79, 7
  s_lshl_b32 s13, s78, 2
  s_add_u32 s12, s12, s13
  s_add_u32 s12, s12, 17408
  s_add_u32 s20, s6, 104857600
  s_addc_u32 s21, s7, 0
  s_mov_b32 s22, 21504
  s_mov_b32 s23, 0x20000
  v_mov_b32 v2, s12
  v_mov_b32 v3, 1
  s_mov_b64 exec, 1
  buffer_store_dword v3, v2, s[20:23], 0 offen sc1
  s_mov_b64 exec, -1
L_osig_done:
  v_pk_fma_f32 v[200:201], v[160:161], v[32:33], v[200:201] op_sel_hi:[1,0,1] neg_lo:[0,1,0] neg_hi:[0,1,0]
  v_pk_fma_f32 v[202:203], v[162:163], v[32:33], v[202:203] op_sel_hi:[1,0,1] neg_lo:[0,1,0] neg_hi:[0,1,0]
  v_pk_fma_f32 v[216:217], v[164:165], v[32:33], v[216:217] op_sel_hi:[1,0,1] neg_lo:[0,1,0] neg_hi:[0,1,0]
  v_pk_fma_f32 v[218:219], v[166:167], v[32:33], v[218:219] op_sel_hi:[1,0,1] neg_lo:[0,1,0] neg_hi:[0,1,0]
  v_pk_fma_f32 v[204:205], v[160:161], v[36:37], v[204:205] op_sel_hi:[1,0,1] neg_lo:[0,1,0] neg_hi:[0,1,0]
  v_pk_fma_f32 v[206:207], v[162:163], v[36:37], v[206:207] op_sel_hi:[1,0,1] neg_lo:[0,1,0] neg_hi:[0,1,0]
  v_pk_fma_f32 v[220:221], v[164:165], v[36:37], v[220:221] op_sel_hi:[1,0,1] neg_lo:[0,1,0] neg_hi:[0,1,0]
  v_pk_fma_f32 v[222:223], v[166:167], v[36:37], v[222:223] op_sel_hi:[1,0,1] neg_lo:[0,1,0] neg_hi:[0,1,0]
  v_pk_mul_f32 v[40:41], v[200:201], v[200:201]
  v_pk_mul_f32 v[42:43], v[202:203], v[202:203]
  v_pk_mul_f32 v[48:49], v[216:217], v[216:217]
  v_pk_mul_f32 v[50:51], v[218:219], v[218:219]
  v_pk_mul_f32 v[56:57], v[204:205], v[204:205]
  v_pk_mul_f32 v[58:59], v[206:207], v[206:207]
  v_pk_mul_f32 v[64:65], v[220:221], v[220:221]
  v_pk_mul_f32 v[66:67], v[222:223], v[222:223]
  v_pk_fma_f32 v[40:41], v[40:41], v[34:35], v[32:33] op_sel:[0,1,1] op_sel_hi:[1,1,1]
  v_pk_fma_f32 v[42:43], v[42:43], v[34:35], v[32:33] op_sel:[0,1,1] op_sel_hi:[1,1,1]
  v_pk_fma_f32 v[48:49], v[48:49], v[34:35], v[32:33] op_sel:[0,1,1] op_sel_hi:[1,1,1]
  v_pk_fma_f32 v[50:51], v[50:51], v[34:35], v[32:33] op_sel:[0,1,1] op_sel_hi:[1,1,1]
  v_pk_fma_f32 v[56:57], v[56:57], v[38:39], v[36:37] op_sel:[0,1,1] op_sel_hi:[1,1,1]
  v_pk_fma_f32 v[58:59], v[58:59], v[38:39], v[36:37] op_sel:[0,1,1] op_sel_hi:[1,1,1]
  v_pk_fma_f32 v[64:65], v[64:65], v[38:39], v[36:37] op_sel:[0,1,1] op_sel_hi:[1,1,1]
  v_pk_fma_f32 v[66:67], v[66:67], v[38:39], v[36:37] op_sel:[0,1,1] op_sel_hi:[1,1,1]
  v_pk_mul_f32 v[40:41], v[40:41], v[200:201]
  v_pk_mul_f32 v[42:43], v[42:43], v[202:203]
  v_pk_mul_f32 v[48:49], v[48:49], v[216:217]
  v_pk_mul_f32 v[50:51], v[50:51], v[218:219]
  v_pk_mul_f32 v[56:57], v[56:57], v[204:205]
  v_pk_mul_f32 v[58:59], v[58:59], v[206:207]
  v_pk_mul_f32 v[64:65], v[64:65], v[220:221]
  v_pk_mul_f32 v[66:67], v[66:67], v[222:223]
  v_exp_f32 v40, v40
  v_exp_f32 v41, v41
  v_exp_f32 v42, v42
  v_exp_f32 v43, v43
  v_exp_f32 v48, v48
  v_exp_f32 v49, v49
  v_exp_f32 v50, v50
  v_exp_f32 v51, v51
  v_exp_f32 v56, v56
  v_exp_f32 v57, v57
  v_exp_f32 v58, v58
  v_exp_f32 v59, v59
  v_exp_f32 v64, v64
  v_exp_f32 v65, v65
  v_exp_f32 v66, v66
  v_exp_f32 v67, v67
  v_pk_fma_f32 v[40:41], v[40:41], v[34:35], v[34:35] op_sel_hi:[1,0,0]
  v_pk_fma_f32 v[42:43], v[42:43], v[34:35], v[34:35] op_sel_hi:[1,0,0]
  v_pk_fma_f32 v[48:49], v[48:49], v[34:35], v[34:35] op_sel_hi:[1,0,0]
  v_pk_fma_f32 v[50:51], v[50:51], v[34:35], v[34:35] op_sel_hi:[1,0,0]
  v_pk_fma_f32 v[232:233], v[168:169], v[32:33], v[232:233] op_sel_hi:[1,0,1] neg_lo:[0,1,0] neg_hi:[0,1,0]
  v_pk_fma_f32 v[234:235], v[170:171], v[32:33], v[234:235] op_sel_hi:[1,0,1] neg_lo:[0,1,0] neg_hi:[0,1,0]
  v_pk_fma_f32 v[248:249], v[172:173], v[32:33], v[248:249] op_sel_hi:[1,0,1] neg_lo:[0,1,0] neg_hi:[0,1,0]
  v_pk_fma_f32 v[250:251], v[174:175], v[32:33], v[250:251] op_sel_hi:[1,0,1] neg_lo:[0,1,0] neg_hi:[0,1,0]
  v_pk_fma_f32 v[56:57], v[56:57], v[38:39], v[38:39] op_sel_hi:[1,0,0]
  v_pk_fma_f32 v[58:59], v[58:59], v[38:39], v[38:39] op_sel_hi:[1,0,0]
  v_pk_fma_f32 v[64:65], v[64:65], v[38:39], v[38:39] op_sel_hi:[1,0,0]
  v_pk_fma_f32 v[66:67], v[66:67], v[38:39], v[38:39] op_sel_hi:[1,0,0]
  v_pk_fma_f32 v[236:237], v[168:169], v[36:37], v[236:237] op_sel_hi:[1,0,1] neg_lo:[0,1,0] neg_hi:[0,1,0]
  v_pk_fma_f32 v[238:239], v[170:171], v[36:37], v[238:239] op_sel_hi:[1,0,1] neg_lo:[0,1,0] neg_hi:[0,1,0]
  v_pk_fma_f32 v[252:253], v[172:173], v[36:37], v[252:253] op_sel_hi:[1,0,1] neg_lo:[0,1,0] neg_hi:[0,1,0]
  v_pk_fma_f32 v[254:255], v[174:175], v[36:37], v[254:255] op_sel_hi:[1,0,1] neg_lo:[0,1,0] neg_hi:[0,1,0]
  v_rcp_f32 v40, v40
  v_rcp_f32 v41, v41
  v_rcp_f32 v42, v42
  v_rcp_f32 v43, v43
  v_rcp_f32 v48, v48
  v_rcp_f32 v49, v49
  v_rcp_f32 v50, v50
  v_rcp_f32 v51, v51
  v_pk_mul_f32 v[44:45], v[200:201], v[232:233]
  v_pk_mul_f32 v[46:47], v[202:203], v[234:235]
  v_pk_mul_f32 v[52:53], v[216:217], v[248:249]
  v_pk_mul_f32 v[54:55], v[218:219], v[250:251]
  v_rcp_f32 v56, v56
  v_rcp_f32 v57, v57
  v_rcp_f32 v58, v58
  v_rcp_f32 v59, v59
  v_rcp_f32 v64, v64
  v_rcp_f32 v65, v65
  v_rcp_f32 v66, v66
  v_rcp_f32 v67, v67
  v_pk_mul_f32 v[60:61], v[204:205], v[236:237]
  v_pk_mul_f32 v[62:63], v[206:207], v[238:239]
  v_pk_mul_f32 v[68:69], v[220:221], v[252:253]
  v_pk_mul_f32 v[70:71], v[222:223], v[254:255]
  v_pk_mul_f32 v[44:45], v[44:45], v[40:41]
  v_pk_mul_f32 v[46:47], v[46:47], v[42:43]
  v_pk_mul_f32 v[52:53], v[52:53], v[48:49]
  v_pk_mul_f32 v[54:55], v[54:55], v[50:51]
  v_pk_mul_f32 v[60:61], v[60:61], v[56:57]
  v_pk_mul_f32 v[62:63], v[62:63], v[58:59]
  v_pk_mul_f32 v[68:69], v[68:69], v[64:65]
  v_pk_mul_f32 v[70:71], v[70:71], v[66:67]
  v_cvt_pk_bf16_f32 v200, v44, v45
  v_cvt_pk_bf16_f32 v201, v46, v47
  v_cvt_pk_bf16_f32 v202, v52, v53
  v_cvt_pk_bf16_f32 v203, v54, v55
  v_cvt_pk_bf16_f32 v204, v60, v61
  v_cvt_pk_bf16_f32 v205, v62, v63
  v_cvt_pk_bf16_f32 v206, v68, v69
  v_cvt_pk_bf16_f32 v207, v70, v71
  buffer_store_dwordx4 v[200:203], v1, s[16:19], s34 offen offset:2048 sc1
  buffer_store_dwordx4 v[204:207], v1, s[16:19], s34 offen offset:3072 sc1
  s_branch L_g2_entry
L_yepi:
  v_and_b32 v24, 15, v0
  s_lshl_b32 s12, s77, 10
  s_add_u32 s12, s12, 151808
  v_lshl_add_u32 v4, v24, 4, s12
  s_mov_b32 s29, 0x40000
  ds_read_b128 v[8:11], v4 offset:0
  ds_read_b128 v[12:15], v4 offset:256
  ds_read_b128 v[16:19], v4 offset:512
  ds_read_b128 v[20:23], v4 offset:768
L_ycsg:
  s_waitcnt vmcnt(0)
  v_max3_u32 v3, v28, v29, v30
  v_max3_u32 v3, v3, v31, v32
  v_max3_u32 v3, v3, v33, v34
  v_max3_u32 v3, v3, v35, v36
  v_max3_u32 v3, v3, v37, v38
  v_max3_u32 v3, v3, v39, v40
  v_max3_u32 v3, v3, v41, v42
  v_max3_u32 v3, v3, v43, v44
  v_max3_u32 v3, v3, v45, v46
  v_max3_u32 v3, v3, v47, v48
  v_max3_u32 v3, v3, v49, v50
  v_max3_u32 v3, v3, v51, v52
  v_max3_u32 v3, v3, v53, v54
  v_max3_u32 v3, v3, v55, v56
  v_max3_u32 v3, v3, v57, v58
  v_max3_u32 v3, v3, v59, v60
  v_max3_u32 v3, v3, v61, v62
  v_max3_u32 v3, v3, v63, v64
  v_max3_u32 v3, v3, v65, v66
  v_max_u32 v3, v3, v67
  v_cmp_eq_u32 vcc, -1, v3
  s_cmp_eq_u64 vcc, 0
  s_cbranch_scc1 L_ycsg_ok
  s_sub_u32 s29, s29, 1
  s_cmp_eq_u32 s29, 0
  s_cbranch_scc1 L_ycsg_ok
  buffer_load_dwordx4 v[28:31], v2, s[20:23], 0 offen offset:0 sc1
  buffer_load_dwordx4 v[32:35], v2, s[20:23], 0 offen offset:64 sc1
  buffer_load_dwordx4 v[36:39], v2, s[20:23], 0 offen offset:128 sc1
  buffer_load_dwordx4 v[40:43], v2, s[20:23], 0 offen offset:192 sc1
  buffer_load_dwordx4 v[44:47], v2, s[20:23], 0 offen offset:256 sc1
  buffer_load_dwordx4 v[48:51], v2, s[20:23], 0 offen offset:320 sc1
  buffer_load_dwordx4 v[52:55], v2, s[20:23], 0 offen offset:384 sc1
  buffer_load_dwordx4 v[56:59], v2, s[20:23], 0 offen offset:448 sc1
  buffer_load_dwordx4 v[60:63], v2, s[20:23], 0 offen offset:512 sc1
  buffer_load_dwordx4 v[64:67], v2, s[20:23], 0 offen offset:576 sc1
  s_branch L_ycsg
L_ycsg_ok:
  s_and_b32 s3, s2, 7
  s_lshr_b32 s16, s2, 3
  s_and_b32 s20, s16, 1
  s_lshr_b32 s16, s16, 1
  s_lshr_b32 s17, s3, 1
  s_lshl_b32 s17, s17, 2
  s_and_b32 s18, s16, 3
  s_add_u32 s21, s17, s18
  s_and_b32 s17, s3, 1
  s_lshl_b32 s17, s17, 2
  s_lshr_b32 s18, s16, 2
  s_add_u32 s22, s17, s18
  s_lshl_b32 s23, s21, 3
  s_add_u32 s23, s23, s22
  s_lshr_b32 s19, s76, 2
  s_lshl_b32 s16, s20, 4
  s_lshl_b32 s17, s19, 1
  s_add_u32 s16, s16, s17
  s_lshl_b32 s73, s16, 16
  s_mul_i32 s16, s20, 56
  s_mul_i32 s17, s19, 7
  s_add_u32 s18, s16, s17
  s_lshl_b32 s80, s18, 16
  s_mul_i32 s17, s19, 3
  s_add_u32 s18, s16, s17
  s_add_u32 s18, s18, 1
  s_lshl_b32 s81, s18, 16
  s_mul_i32 s17, s19, 14
  s_add_u32 s18, s16, s17
  s_add_u32 s18, s18, 6
  s_lshl_b32 s82, s18, 16
  s_mul_i32 s17, s19, 49152
  s_lshl_b32 s18, s77, 11
  v_lshrrev_b32 v3, 4, v0
  s_add_u32 s74, s17, s18
  v_lshlrev_b32 v4, 1, v3
  s_lshl_b32 s17, s77, 3
  v_and_b32 v2, 15, v0
  v_add_u32 v3, s17, v3
  v_xor_b32 v6, v4, v2
  v_lshlrev_b32 v3, 11, v3
  s_lshl_b32 s17, s22, 8
  v_xor_b32 v2, 8, v6
  v_add_u32 v3, s17, v3
  s_mov_b32 s64, s24
  v_lshl_add_u32 v68, v6, 4, v3
  v_lshl_add_u32 v69, v2, 4, v3
  s_mov_b32 s65, s25
  s_mov_b32 s66, 2097152
  s_mov_b32 s67, 0x20000
  s_mov_b32 s72, 65536
  s_add_u32 m0, s74, 0
  v_add_u32 v69, 8192, v69
  s_add_u32 s75, s73, s72
  buffer_load_dwordx4 v68, s[64:67], s73 offen lds
  s_mov_b32 s68, 4
  s_add_u32 m0, s74, 1024
  s_sub_u32 s68, s68, 1
  buffer_load_dwordx4 v69, s[64:67], s73 offen lds
  s_mov_b32 s70, 262144
  s_add_u32 m0, s74, 8192
  s_add_u32 s73, s73, s70
  buffer_load_dwordx4 v68, s[64:67], s75 offen lds
  s_add_u32 m0, s74, 9216
  s_mov_b32 s69, 0
  s_cmp_eq_u32 s68, 0
  buffer_load_dwordx4 v69, s[64:67], s75 offen lds
  s_cbranch_scc0 L_bo9
  s_add_u32 s69, s69, 1
  s_mov_b32 s64, s26
  s_mov_b32 s65, s27
  s_mov_b32 s66, 7340032
  s_mov_b32 s73, s80
  s_mov_b32 s70, 917504
  s_mov_b32 s72, 196608
  s_mov_b32 s68, 4
  s_cmp_eq_u32 s69, 1
  s_cbranch_scc1 L_bo9
  s_mov_b32 s73, s81
  s_mov_b32 s70, 458752
  s_mov_b32 s72, 65536
  s_mov_b32 s68, 8
  s_cmp_eq_u32 s69, 2
  s_cbranch_scc1 L_bo9
  s_mov_b32 s73, s82
  s_mov_b32 s70, 1835008
  s_mov_b32 s72, 458752
  s_mov_b32 s68, 2
  s_cmp_eq_u32 s69, 3
  s_cbranch_scc1 L_bo9
  s_mov_b32 s66, 0
  s_mov_b32 s68, 64
L_bo9:
  s_add_u32 m0, s74, 16384
  s_add_u32 s75, s73, s72
  buffer_load_dwordx4 v68, s[64:67], s73 offen lds
  s_add_u32 m0, s74, 17408
  s_sub_u32 s68, s68, 1
  buffer_load_dwordx4 v69, s[64:67], s73 offen lds
  s_add_u32 m0, s74, 24576
  s_add_u32 s73, s73, s70
  buffer_load_dwordx4 v68, s[64:67], s75 offen lds
  s_add_u32 m0, s74, 25600
  s_cmp_eq_u32 s68, 0
  buffer_load_dwordx4 v69, s[64:67], s75 offen lds
  s_cbranch_scc0 L_bo10
  s_add_u32 s69, s69, 1
  s_mov_b32 s64, s26
  s_mov_b32 s65, s27
  s_mov_b32 s66, 7340032
  s_mov_b32 s73, s80
  s_mov_b32 s70, 917504
  s_mov_b32 s72, 196608
  s_mov_b32 s68, 4
  s_cmp_eq_u32 s69, 1
  s_cbranch_scc1 L_bo10
  s_mov_b32 s73, s81
  s_mov_b32 s70, 458752
  s_mov_b32 s72, 65536
  s_mov_b32 s68, 8
  s_cmp_eq_u32 s69, 2
  s_cbranch_scc1 L_bo10
  s_mov_b32 s73, s82
  s_mov_b32 s70, 1835008
  s_mov_b32 s72, 458752
  s_mov_b32 s68, 2
  s_cmp_eq_u32 s69, 3
  s_cbranch_scc1 L_bo10
  s_mov_b32 s66, 0
  s_mov_b32 s68, 64
L_bo10:
  s_add_u32 s16, s6, 4194304
  s_addc_u32 s17, s7, 0
  s_lshl_b32 s12, s79, 2
  s_add_u32 s12, s12, s77
  v_lshlrev_b32 v1, 4, v0
  s_mul_i32 s12, s12, 589824
  v_add_u32 v1, s12, v1
  s_lshr_b32 s12, s78, 4
  s_mul_i32 s12, s12, 72
  s_and_b32 s13, s78, 15
  s_add_u32 s14, s12, s13
  s_lshl_b32 s36, s14, 12
  s_add_u32 s14, s14, 16
  s_lshl_b32 s34, s14, 12
  s_lshl_b32 s14, s13, 1
  s_add_u32 s14, s14, s12
  s_add_u32 s14, s14, 32
  s_lshl_b32 s37, s14, 12
  s_lshr_b32 s14, s13, 1
  s_add_u32 s14, s14, s12
  s_add_u32 s14, s14, 64
  s_lshl_b32 s35, s14, 12
  s_and_b32 s13, s13, 1
  s_lshl_b32 s13, s13, 10
  s_add_u32 s35, s35, s13
  s_mov_b32 s18, 18874368
  s_mov_b32 s19, 0x20000
  s_mov_b32 s14, s37
  s_add_u32 s15, s37, 4096
  s_waitcnt lgkmcnt(0)
  v_mul_f32 v11, v9, v9
  v_mul_f32 v9, 0xc0135761, v9
  v_mul_f32 v15, v13, v13
  v_pk_fma_f32 v[96:97], v[28:29], v[8:9], v[96:97] op_sel_hi:[1,0,1] neg_lo:[0,1,0] neg_hi:[0,1,0]
  v_pk_fma_f32 v[98:99], v[30:31], v[8:9], v[98:99] op_sel_hi:[1,0,1] neg_lo:[0,1,0] neg_hi:[0,1,0]
  v_pk_fma_f32 v[112:113], v[32:33], v[8:9], v[112:113] op_sel_hi:[1,0,1] neg_lo:[0,1,0] neg_hi:[0,1,0]
  v_pk_fma_f32 v[114:115], v[34:35], v[8:9], v[114:115] op_sel_hi:[1,0,1] neg_lo:[0,1,0] neg_hi:[0,1,0]
  v_mul_f32 v11, v11, v9
  v_pk_mul_f32 v[76:77], v[96:97], v[96:97]
  v_pk_mul_f32 v[78:79], v[98:99], v[98:99]
  v_pk_mul_f32 v[84:85], v[112:113], v[112:113]
  v_pk_mul_f32 v[86:87], v[114:115], v[114:115]
  v_mul_f32 v11, 0x3d372713, v11
  v_pk_fma_f32 v[176:177], v[48:49], v[8:9], v[176:177] op_sel_hi:[1,0,1] neg_lo:[0,1,0] neg_hi:[0,1,0]
  v_pk_fma_f32 v[76:77], v[76:77], v[10:11], v[8:9] op_sel:[0,1,1] op_sel_hi:[1,1,1]
  v_pk_fma_f32 v[78:79], v[78:79], v[10:11], v[8:9] op_sel:[0,1,1] op_sel_hi:[1,1,1]
  v_pk_fma_f32 v[84:85], v[84:85], v[10:11], v[8:9] op_sel:[0,1,1] op_sel_hi:[1,1,1]
  v_pk_fma_f32 v[86:87], v[86:87], v[10:11], v[8:9] op_sel:[0,1,1] op_sel_hi:[1,1,1]
  v_pk_mul_f32 v[76:77], v[76:77], v[96:97]
  v_pk_mul_f32 v[78:79], v[78:79], v[98:99]
  v_pk_mul_f32 v[84:85], v[84:85], v[112:113]
  v_pk_mul_f32 v[86:87], v[86:87], v[114:115]
  v_exp_f32 v76, v76
  v_exp_f32 v77, v77
  v_exp_f32 v78, v78
  v_exp_f32 v79, v79
  v_exp_f32 v84, v84
  v_exp_f32 v85, v85
  v_exp_f32 v86, v86
  v_exp_f32 v87, v87
  v_pk_fma_f32 v[76:77], v[76:77], v[10:11], v[10:11] op_sel_hi:[1,0,0]
  v_pk_fma_f32 v[78:79], v[78:79], v[10:11], v[10:11] op_sel_hi:[1,0,0]
  v_pk_fma_f32 v[84:85], v[84:85], v[10:11], v[10:11] op_sel_hi:[1,0,0]
  v_pk_fma_f32 v[86:87], v[86:87], v[10:11], v[10:11] op_sel_hi:[1,0,0]
  v_pk_fma_f32 v[178:179], v[50:51], v[8:9], v[178:179] op_sel_hi:[1,0,1] neg_lo:[0,1,0] neg_hi:[0,1,0]
  v_pk_fma_f32 v[192:193], v[52:53], v[8:9], v[192:193] op_sel_hi:[1,0,1] neg_lo:[0,1,0] neg_hi:[0,1,0]
  v_pk_fma_f32 v[194:195], v[54:55], v[8:9], v[194:195] op_sel_hi:[1,0,1] neg_lo:[0,1,0] neg_hi:[0,1,0]
  v_mul_f32 v13, 0xc0135761, v13
  v_rcp_f32 v76, v76
  v_rcp_f32 v77, v77
  v_rcp_f32 v78, v78
  v_rcp_f32 v79, v79
  v_rcp_f32 v84, v84
  v_rcp_f32 v85, v85
  v_rcp_f32 v86, v86
  v_rcp_f32 v87, v87
  v_pk_mul_f32 v[80:81], v[96:97], v[176:177]
  v_pk_mul_f32 v[82:83], v[98:99], v[178:179]
  v_pk_mul_f32 v[88:89], v[112:113], v[192:193]
  v_pk_mul_f32 v[90:91], v[114:115], v[194:195]
  v_pk_fma_f32 v[128:129], v[36:37], v[8:9], v[128:129] op_sel_hi:[1,0,1] neg_lo:[0,1,0] neg_hi:[0,1,0]
  v_pk_fma_f32 v[130:131], v[38:39], v[8:9], v[130:131] op_sel_hi:[1,0,1] neg_lo:[0,1,0] neg_hi:[0,1,0]
  v_pk_fma_f32 v[144:145], v[40:41], v[8:9], v[144:145] op_sel_hi:[1,0,1] neg_lo:[0,1,0] neg_hi:[0,1,0]
  v_pk_fma_f32 v[146:147], v[42:43], v[8:9], v[146:147] op_sel_hi:[1,0,1] neg_lo:[0,1,0] neg_hi:[0,1,0]
  v_pk_fma_f32 v[100:101], v[28:29], v[12:13], v[100:101] op_sel_hi:[1,0,1] neg_lo:[0,1,0] neg_hi:[0,1,0]
  v_pk_fma_f32 v[102:103], v[30:31], v[12:13], v[102:103] op_sel_hi:[1,0,1] neg_lo:[0,1,0] neg_hi:[0,1,0]
  v_mul_f32 v15, v15, v13
  v_pk_mul_f32 v[80:81], v[80:81], v[76:77]
  v_pk_mul_f32 v[82:83], v[82:83], v[78:79]
  v_pk_mul_f32 v[88:89], v[88:89], v[84:85]
  v_pk_mul_f32 v[90:91], v[90:91], v[86:87]
  v_pk_mul_f32 v[68:69], v[128:129], v[128:129]
  v_pk_mul_f32 v[70:71], v[130:131], v[130:131]
  v_pk_mul_f32 v[76:77], v[144:145], v[144:145]
  v_pk_mul_f32 v[78:79], v[146:147], v[146:147]
  v_pk_mul_f32 v[84:85], v[100:101], v[100:101]
  v_pk_mul_f32 v[86:87], v[102:103], v[102:103]
  v_mul_f32 v15, 0x3d372713, v15
  v_pk_fma_f32 v[68:69], v[68:69], v[10:11], v[8:9] op_sel:[0,1,1] op_sel_hi:[1,1,1]
  v_pk_fma_f32 v[70:71], v[70:71], v[10:11], v[8:9] op_sel:[0,1,1] op_sel_hi:[1,1,1]
  v_pk_fma_f32 v[76:77], v[76:77], v[10:11], v[8:9] op_sel:[0,1,1] op_sel_hi:[1,1,1]
  v_pk_fma_f32 v[78:79], v[78:79], v[10:11], v[8:9] op_sel:[0,1,1] op_sel_hi:[1,1,1]
  v_pk_fma_f32 v[84:85], v[84:85], v[14:15], v[12:13] op_sel:[0,1,1] op_sel_hi:[1,1,1]
  v_pk_fma_f32 v[86:87], v[86:87], v[14:15], v[12:13] op_sel:[0,1,1] op_sel_hi:[1,1,1]
  v_pk_mul_f32 v[68:69], v[68:69], v[128:129]
  v_pk_mul_f32 v[70:71], v[70:71], v[130:131]
  v_pk_mul_f32 v[76:77], v[76:77], v[144:145]
  v_pk_mul_f32 v[78:79], v[78:79], v[146:147]
  v_pk_mul_f32 v[84:85], v[84:85], v[100:101]
  v_pk_mul_f32 v[86:87], v[86:87], v[102:103]
  v_exp_f32 v68, v68
  v_exp_f32 v69, v69
  v_exp_f32 v70, v70
  v_exp_f32 v71, v71
  v_exp_f32 v76, v76
  v_exp_f32 v77, v77
  v_exp_f32 v78, v78
  v_exp_f32 v79, v79
  v_exp_f32 v84, v84
  v_exp_f32 v85, v85
  v_exp_f32 v86, v86
  v_exp_f32 v87, v87
  v_pk_fma_f32 v[68:69], v[68:69], v[10:11], v[10:11] op_sel_hi:[1,0,0]
  v_pk_fma_f32 v[70:71], v[70:71], v[10:11], v[10:11] op_sel_hi:[1,0,0]
  v_pk_fma_f32 v[208:209], v[56:57], v[8:9], v[208:209] op_sel_hi:[1,0,1] neg_lo:[0,1,0] neg_hi:[0,1,0]
  v_pk_fma_f32 v[210:211], v[58:59], v[8:9], v[210:211] op_sel_hi:[1,0,1] neg_lo:[0,1,0] neg_hi:[0,1,0]
  v_pk_fma_f32 v[76:77], v[76:77], v[10:11], v[10:11] op_sel_hi:[1,0,0]
  v_pk_fma_f32 v[78:79], v[78:79], v[10:11], v[10:11] op_sel_hi:[1,0,0]
  v_pk_fma_f32 v[84:85], v[84:85], v[14:15], v[14:15] op_sel_hi:[1,0,0]
  v_pk_fma_f32 v[86:87], v[86:87], v[14:15], v[14:15] op_sel_hi:[1,0,0]
  v_pk_fma_f32 v[224:225], v[60:61], v[8:9], v[224:225] op_sel_hi:[1,0,1] neg_lo:[0,1,0] neg_hi:[0,1,0]
  v_pk_fma_f32 v[226:227], v[62:63], v[8:9], v[226:227] op_sel_hi:[1,0,1] neg_lo:[0,1,0] neg_hi:[0,1,0]
  v_pk_fma_f32 v[180:181], v[48:49], v[12:13], v[180:181] op_sel_hi:[1,0,1] neg_lo:[0,1,0] neg_hi:[0,1,0]
  v_pk_fma_f32 v[182:183], v[50:51], v[12:13], v[182:183] op_sel_hi:[1,0,1] neg_lo:[0,1,0] neg_hi:[0,1,0]
  v_rcp_f32 v68, v68
  v_rcp_f32 v69, v69
  v_rcp_f32 v70, v70
  v_rcp_f32 v71, v71
  v_cvt_pk_bf16_f32 v96, v80, v81
  v_cvt_pk_bf16_f32 v97, v82, v83
  v_cvt_pk_bf16_f32 v98, v88, v89
  v_cvt_pk_bf16_f32 v99, v90, v91
  v_pk_mul_f32 v[72:73], v[128:129], v[208:209]
  v_pk_mul_f32 v[74:75], v[130:131], v[210:211]
  v_rcp_f32 v76, v76
  v_rcp_f32 v77, v77
  v_rcp_f32 v78, v78
  v_rcp_f32 v79, v79
  v_rcp_f32 v84, v84
  v_rcp_f32 v85, v85
  v_rcp_f32 v86, v86
  v_rcp_f32 v87, v87
  v_pk_mul_f32 v[80:81], v[144:145], v[224:225]
  v_pk_mul_f32 v[82:83], v[146:147], v[226:227]
  v_pk_fma_f32 v[116:117], v[32:33], v[12:13], v[116:117] op_sel_hi:[1,0,1] neg_lo:[0,1,0] neg_hi:[0,1,0]
  v_pk_fma_f32 v[118:119], v[34:35], v[12:13], v[118:119] op_sel_hi:[1,0,1] neg_lo:[0,1,0] neg_hi:[0,1,0]
  v_pk_mul_f32 v[88:89], v[100:101], v[180:181]
  v_pk_mul_f32 v[90:91], v[102:103], v[182:183]
  v_pk_fma_f32 v[132:133], v[36:37], v[12:13], v[132:133] op_sel_hi:[1,0,1] neg_lo:[0,1,0] neg_hi:[0,1,0]
  v_pk_fma_f32 v[134:135], v[38:39], v[12:13], v[134:135] op_sel_hi:[1,0,1] neg_lo:[0,1,0] neg_hi:[0,1,0]
  v_pk_fma_f32 v[148:149], v[40:41], v[12:13], v[148:149] op_sel_hi:[1,0,1] neg_lo:[0,1,0] neg_hi:[0,1,0]
  v_pk_fma_f32 v[150:151], v[42:43], v[12:13], v[150:151] op_sel_hi:[1,0,1] neg_lo:[0,1,0] neg_hi:[0,1,0]
  v_pk_mul_f32 v[72:73], v[72:73], v[68:69]
  v_pk_mul_f32 v[74:75], v[74:75], v[70:71]
  v_pk_mul_f32 v[80:81], v[80:81], v[76:77]
  v_pk_mul_f32 v[82:83], v[82:83], v[78:79]
  v_pk_mul_f32 v[88:89], v[88:89], v[84:85]
  v_pk_mul_f32 v[90:91], v[90:91], v[86:87]
  v_pk_mul_f32 v[68:69], v[116:117], v[116:117]
  v_pk_mul_f32 v[70:71], v[118:119], v[118:119]
  v_pk_mul_f32 v[76:77], v[132:133], v[132:133]
  v_pk_mul_f32 v[78:79], v[134:135], v[134:135]
  v_pk_mul_f32 v[84:85], v[148:149], v[148:149]
  v_pk_mul_f32 v[86:87], v[150:151], v[150:151]
  v_pk_fma_f32 v[68:69], v[68:69], v[14:15], v[12:13] op_sel:[0,1,1] op_sel_hi:[1,1,1]
  v_pk_fma_f32 v[70:71], v[70:71], v[14:15], v[12:13] op_sel:[0,1,1] op_sel_hi:[1,1,1]
  v_pk_fma_f32 v[76:77], v[76:77], v[14:15], v[12:13] op_sel:[0,1,1] op_sel_hi:[1,1,1]
  v_pk_fma_f32 v[78:79], v[78:79], v[14:15], v[12:13] op_sel:[0,1,1] op_sel_hi:[1,1,1]
  v_pk_fma_f32 v[84:85], v[84:85], v[14:15], v[12:13] op_sel:[0,1,1] op_sel_hi:[1,1,1]
  v_pk_fma_f32 v[86:87], v[86:87], v[14:15], v[12:13] op_sel:[0,1,1] op_sel_hi:[1,1,1]
  v_pk_mul_f32 v[68:69], v[68:69], v[116:117]
  v_pk_mul_f32 v[70:71], v[70:71], v[118:119]
  v_pk_mul_f32 v[76:77], v[76:77], v[132:133]
  v_pk_mul_f32 v[78:79], v[78:79], v[134:135]
  v_pk_mul_f32 v[84:85], v[84:85], v[148:149]
  v_pk_mul_f32 v[86:87], v[86:87], v[150:151]
  v_exp_f32 v68, v68
  v_exp_f32 v69, v69
  v_exp_f32 v70, v70
  v_exp_f32 v71, v71
  v_exp_f32 v76, v76
  v_exp_f32 v77, v77
  v_exp_f32 v78, v78
  v_exp_f32 v79, v79
  v_exp_f32 v84, v84
  v_exp_f32 v85, v85
  v_exp_f32 v86, v86
  v_exp_f32 v87, v87
  v_pk_fma_f32 v[68:69], v[68:69], v[14:15], v[14:15] op_sel_hi:[1,0,0]
  v_pk_fma_f32 v[70:71], v[70:71], v[14:15], v[14:15] op_sel_hi:[1,0,0]
  v_pk_fma_f32 v[196:197], v[52:53], v[12:13], v[196:197] op_sel_hi:[1,0,1] neg_lo:[0,1,0] neg_hi:[0,1,0]
  v_pk_fma_f32 v[198:199], v[54:55], v[12:13], v[198:199] op_sel_hi:[1,0,1] neg_lo:[0,1,0] neg_hi:[0,1,0]
  v_pk_fma_f32 v[76:77], v[76:77], v[14:15], v[14:15] op_sel_hi:[1,0,0]
  v_pk_fma_f32 v[78:79], v[78:79], v[14:15], v[14:15] op_sel_hi:[1,0,0]
  v_pk_fma_f32 v[84:85], v[84:85], v[14:15], v[14:15] op_sel_hi:[1,0,0]
  v_pk_fma_f32 v[86:87], v[86:87], v[14:15], v[14:15] op_sel_hi:[1,0,0]
  v_mul_f32 v19, v17, v17
  v_pk_fma_f32 v[212:213], v[56:57], v[12:13], v[212:213] op_sel_hi:[1,0,1] neg_lo:[0,1,0] neg_hi:[0,1,0]
  v_pk_fma_f32 v[214:215], v[58:59], v[12:13], v[214:215] op_sel_hi:[1,0,1] neg_lo:[0,1,0] neg_hi:[0,1,0]
  v_pk_fma_f32 v[228:229], v[60:61], v[12:13], v[228:229] op_sel_hi:[1,0,1] neg_lo:[0,1,0] neg_hi:[0,1,0]
  v_pk_fma_f32 v[230:231], v[62:63], v[12:13], v[230:231] op_sel_hi:[1,0,1] neg_lo:[0,1,0] neg_hi:[0,1,0]
  v_mul_f32 v17, 0xc0135761, v17
  v_cvt_pk_bf16_f32 v128, v72, v73
  v_cvt_pk_bf16_f32 v129, v74, v75
  v_rcp_f32 v68, v68
  v_rcp_f32 v69, v69
  v_rcp_f32 v70, v70
  v_rcp_f32 v71, v71
  v_cvt_pk_bf16_f32 v130, v80, v81
  v_cvt_pk_bf16_f32 v131, v82, v83
  v_cvt_pk_bf16_f32 v100, v88, v89
  v_cvt_pk_bf16_f32 v101, v90, v91
  v_pk_mul_f32 v[72:73], v[116:117], v[196:197]
  v_pk_mul_f32 v[74:75], v[118:119], v[198:199]
  v_rcp_f32 v76, v76
  v_rcp_f32 v77, v77
  v_rcp_f32 v78, v78
  v_rcp_f32 v79, v79
  v_rcp_f32 v84, v84
  v_rcp_f32 v85, v85
  v_rcp_f32 v86, v86
  v_rcp_f32 v87, v87
  v_pk_mul_f32 v[80:81], v[132:133], v[212:213]
  v_pk_mul_f32 v[82:83], v[134:135], v[214:215]
  v_pk_mul_f32 v[88:89], v[148:149], v[228:229]
  v_pk_mul_f32 v[90:91], v[150:151], v[230:231]
  v_pk_fma_f32 v[104:105], v[28:29], v[16:17], v[104:105] op_sel_hi:[1,0,1] neg_lo:[0,1,0] neg_hi:[0,1,0]
  v_pk_fma_f32 v[106:107], v[30:31], v[16:17], v[106:107] op_sel_hi:[1,0,1] neg_lo:[0,1,0] neg_hi:[0,1,0]
  v_pk_fma_f32 v[120:121], v[32:33], v[16:17], v[120:121] op_sel_hi:[1,0,1] neg_lo:[0,1,0] neg_hi:[0,1,0]
  v_pk_fma_f32 v[122:123], v[34:35], v[16:17], v[122:123] op_sel_hi:[1,0,1] neg_lo:[0,1,0] neg_hi:[0,1,0]
  v_pk_fma_f32 v[136:137], v[36:37], v[16:17], v[136:137] op_sel_hi:[1,0,1] neg_lo:[0,1,0] neg_hi:[0,1,0]
  v_pk_fma_f32 v[138:139], v[38:39], v[16:17], v[138:139] op_sel_hi:[1,0,1] neg_lo:[0,1,0] neg_hi:[0,1,0]
  v_mul_f32 v19, v19, v17
  v_pk_mul_f32 v[72:73], v[72:73], v[68:69]
  v_pk_mul_f32 v[74:75], v[74:75], v[70:71]
  v_pk_mul_f32 v[80:81], v[80:81], v[76:77]
  v_pk_mul_f32 v[82:83], v[82:83], v[78:79]
  v_pk_mul_f32 v[88:89], v[88:89], v[84:85]
  v_pk_mul_f32 v[90:91], v[90:91], v[86:87]
  v_pk_mul_f32 v[68:69], v[104:105], v[104:105]
  v_pk_mul_f32 v[70:71], v[106:107], v[106:107]
  v_mul_f32 v19, 0x3d372713, v19
  v_pk_mul_f32 v[76:77], v[120:121], v[120:121]
  v_pk_mul_f32 v[78:79], v[122:123], v[122:123]
  v_pk_mul_f32 v[84:85], v[136:137], v[136:137]
  v_pk_mul_f32 v[86:87], v[138:139], v[138:139]
  v_pk_fma_f32 v[68:69], v[68:69], v[18:19], v[16:17] op_sel:[0,1,1] op_sel_hi:[1,1,1]
  v_pk_fma_f32 v[70:71], v[70:71], v[18:19], v[16:17] op_sel:[0,1,1] op_sel_hi:[1,1,1]
  v_pk_fma_f32 v[76:77], v[76:77], v[18:19], v[16:17] op_sel:[0,1,1] op_sel_hi:[1,1,1]
  v_pk_fma_f32 v[78:79], v[78:79], v[18:19], v[16:17] op_sel:[0,1,1] op_sel_hi:[1,1,1]
  v_pk_fma_f32 v[84:85], v[84:85], v[18:19], v[16:17] op_sel:[0,1,1] op_sel_hi:[1,1,1]
  v_pk_fma_f32 v[86:87], v[86:87], v[18:19], v[16:17] op_sel:[0,1,1] op_sel_hi:[1,1,1]
  v_pk_mul_f32 v[68:69], v[68:69], v[104:105]
  v_pk_mul_f32 v[70:71], v[70:71], v[106:107]
  v_pk_mul_f32 v[76:77], v[76:77], v[120:121]
  v_pk_mul_f32 v[78:79], v[78:79], v[122:123]
  v_pk_mul_f32 v[84:85], v[84:85], v[136:137]
  v_pk_mul_f32 v[86:87], v[86:87], v[138:139]
  v_exp_f32 v68, v68
  v_exp_f32 v69, v69
  v_exp_f32 v70, v70
  v_exp_f32 v71, v71
  v_exp_f32 v76, v76
  v_exp_f32 v77, v77
  v_exp_f32 v78, v78
  v_exp_f32 v79, v79
  v_exp_f32 v84, v84
  v_exp_f32 v85, v85
  v_exp_f32 v86, v86
  v_exp_f32 v87, v87
  v_pk_fma_f32 v[68:69], v[68:69], v[18:19], v[18:19] op_sel_hi:[1,0,0]
  v_pk_fma_f32 v[70:71], v[70:71], v[18:19], v[18:19] op_sel_hi:[1,0,0]
  v_pk_fma_f32 v[184:185], v[48:49], v[16:17], v[184:185] op_sel_hi:[1,0,1] neg_lo:[0,1,0] neg_hi:[0,1,0]
  v_pk_fma_f32 v[186:187], v[50:51], v[16:17], v[186:187] op_sel_hi:[1,0,1] neg_lo:[0,1,0] neg_hi:[0,1,0]
  v_pk_fma_f32 v[76:77], v[76:77], v[18:19], v[18:19] op_sel_hi:[1,0,0]
  v_pk_fma_f32 v[78:79], v[78:79], v[18:19], v[18:19] op_sel_hi:[1,0,0]
  v_pk_fma_f32 v[84:85], v[84:85], v[18:19], v[18:19] op_sel_hi:[1,0,0]
  v_pk_fma_f32 v[86:87], v[86:87], v[18:19], v[18:19] op_sel_hi:[1,0,0]
  v_pk_fma_f32 v[200:201], v[52:53], v[16:17], v[200:201] op_sel_hi:[1,0,1] neg_lo:[0,1,0] neg_hi:[0,1,0]
  v_pk_fma_f32 v[202:203], v[54:55], v[16:17], v[202:203] op_sel_hi:[1,0,1] neg_lo:[0,1,0] neg_hi:[0,1,0]
  v_pk_fma_f32 v[216:217], v[56:57], v[16:17], v[216:217] op_sel_hi:[1,0,1] neg_lo:[0,1,0] neg_hi:[0,1,0]
  v_pk_fma_f32 v[218:219], v[58:59], v[16:17], v[218:219] op_sel_hi:[1,0,1] neg_lo:[0,1,0] neg_hi:[0,1,0]
  v_mul_f32 v23, v21, v21
  v_cvt_pk_bf16_f32 v102, v72, v73
  v_cvt_pk_bf16_f32 v103, v74, v75
  v_rcp_f32 v68, v68
  v_rcp_f32 v69, v69
  v_rcp_f32 v70, v70
  v_rcp_f32 v71, v71
  v_mul_f32 v21, 0xc0135761, v21
  v_cvt_pk_bf16_f32 v132, v80, v81
  v_cvt_pk_bf16_f32 v133, v82, v83
  v_cvt_pk_bf16_f32 v134, v88, v89
  v_cvt_pk_bf16_f32 v135, v90, v91
  v_pk_mul_f32 v[72:73], v[104:105], v[184:185]
  v_pk_mul_f32 v[74:75], v[106:107], v[186:187]
  v_rcp_f32 v76, v76
  v_rcp_f32 v77, v77
  v_rcp_f32 v78, v78
  v_rcp_f32 v79, v79
  v_rcp_f32 v84, v84
  v_rcp_f32 v85, v85
  v_rcp_f32 v86, v86
  v_rcp_f32 v87, v87
  v_pk_mul_f32 v[80:81], v[120:121], v[200:201]
  v_pk_mul_f32 v[82:83], v[122:123], v[202:203]
  v_pk_fma_f32 v[152:153], v[40:41], v[16:17], v[152:153] op_sel_hi:[1,0,1] neg_lo:[0,1,0] neg_hi:[0,1,0]
  v_pk_fma_f32 v[154:155], v[42:43], v[16:17], v[154:155] op_sel_hi:[1,0,1] neg_lo:[0,1,0] neg_hi:[0,1,0]
  v_pk_mul_f32 v[88:89], v[136:137], v[216:217]
  v_pk_mul_f32 v[90:91], v[138:139], v[218:219]
  v_pk_fma_f32 v[108:109], v[28:29], v[20:21], v[108:109] op_sel_hi:[1,0,1] neg_lo:[0,1,0] neg_hi:[0,1,0]
  v_pk_fma_f32 v[110:111], v[30:31], v[20:21], v[110:111] op_sel_hi:[1,0,1] neg_lo:[0,1,0] neg_hi:[0,1,0]
  v_pk_fma_f32 v[124:125], v[32:33], v[20:21], v[124:125] op_sel_hi:[1,0,1] neg_lo:[0,1,0] neg_hi:[0,1,0]
  v_pk_fma_f32 v[126:127], v[34:35], v[20:21], v[126:127] op_sel_hi:[1,0,1] neg_lo:[0,1,0] neg_hi:[0,1,0]
  v_pk_mul_f32 v[72:73], v[72:73], v[68:69]
  v_pk_mul_f32 v[74:75], v[74:75], v[70:71]
  v_mul_f32 v23, v23, v21
  v_pk_mul_f32 v[80:81], v[80:81], v[76:77]
  v_pk_mul_f32 v[82:83], v[82:83], v[78:79]
  v_pk_mul_f32 v[88:89], v[88:89], v[84:85]
  v_pk_mul_f32 v[90:91], v[90:91], v[86:87]
  v_pk_mul_f32 v[68:69], v[152:153], v[152:153]
  v_pk_mul_f32 v[70:71], v[154:155], v[154:155]
  v_pk_mul_f32 v[76:77], v[108:109], v[108:109]
  v_pk_mul_f32 v[78:79], v[110:111], v[110:111]
  v_pk_mul_f32 v[84:85], v[124:125], v[124:125]
  v_pk_mul_f32 v[86:87], v[126:127], v[126:127]
  v_mul_f32 v23, 0x3d372713, v23
  v_pk_fma_f32 v[68:69], v[68:69], v[18:19], v[16:17] op_sel:[0,1,1] op_sel_hi:[1,1,1]
  v_pk_fma_f32 v[70:71], v[70:71], v[18:19], v[16:17] op_sel:[0,1,1] op_sel_hi:[1,1,1]
  v_pk_fma_f32 v[76:77], v[76:77], v[22:23], v[20:21] op_sel:[0,1,1] op_sel_hi:[1,1,1]
  v_pk_fma_f32 v[78:79], v[78:79], v[22:23], v[20:21] op_sel:[0,1,1] op_sel_hi:[1,1,1]
  v_pk_fma_f32 v[84:85], v[84:85], v[22:23], v[20:21] op_sel:[0,1,1] op_sel_hi:[1,1,1]
  v_pk_fma_f32 v[86:87], v[86:87], v[22:23], v[20:21] op_sel:[0,1,1] op_sel_hi:[1,1,1]
  v_pk_mul_f32 v[68:69], v[68:69], v[152:153]
  v_pk_mul_f32 v[70:71], v[70:71], v[154:155]
  v_pk_mul_f32 v[76:77], v[76:77], v[108:109]
  v_pk_mul_f32 v[78:79], v[78:79], v[110:111]
  v_pk_mul_f32 v[84:85], v[84:85], v[124:125]
  v_pk_mul_f32 v[86:87], v[86:87], v[126:127]
  v_exp_f32 v68, v68
  v_exp_f32 v69, v69
  v_exp_f32 v70, v70
  v_exp_f32 v71, v71
  v_exp_f32 v76, v76
  v_exp_f32 v77, v77
  v_exp_f32 v78, v78
  v_exp_f32 v79, v79
  v_exp_f32 v84, v84
  v_exp_f32 v85, v85
  v_exp_f32 v86, v86
  v_exp_f32 v87, v87
  v_pk_fma_f32 v[68:69], v[68:69], v[18:19], v[18:19] op_sel_hi:[1,0,0]
  v_pk_fma_f32 v[70:71], v[70:71], v[18:19], v[18:19] op_sel_hi:[1,0,0]
  v_pk_fma_f32 v[232:233], v[60:61], v[16:17], v[232:233] op_sel_hi:[1,0,1] neg_lo:[0,1,0] neg_hi:[0,1,0]
  v_pk_fma_f32 v[234:235], v[62:63], v[16:17], v[234:235] op_sel_hi:[1,0,1] neg_lo:[0,1,0] neg_hi:[0,1,0]
  v_pk_fma_f32 v[76:77], v[76:77], v[22:23], v[22:23] op_sel_hi:[1,0,0]
  v_pk_fma_f32 v[78:79], v[78:79], v[22:23], v[22:23] op_sel_hi:[1,0,0]
  v_pk_fma_f32 v[84:85], v[84:85], v[22:23], v[22:23] op_sel_hi:[1,0,0]
  v_pk_fma_f32 v[86:87], v[86:87], v[22:23], v[22:23] op_sel_hi:[1,0,0]
  v_pk_fma_f32 v[188:189], v[48:49], v[20:21], v[188:189] op_sel_hi:[1,0,1] neg_lo:[0,1,0] neg_hi:[0,1,0]
  v_pk_fma_f32 v[190:191], v[50:51], v[20:21], v[190:191] op_sel_hi:[1,0,1] neg_lo:[0,1,0] neg_hi:[0,1,0]
  v_pk_fma_f32 v[204:205], v[52:53], v[20:21], v[204:205] op_sel_hi:[1,0,1] neg_lo:[0,1,0] neg_hi:[0,1,0]
  v_pk_fma_f32 v[206:207], v[54:55], v[20:21], v[206:207] op_sel_hi:[1,0,1] neg_lo:[0,1,0] neg_hi:[0,1,0]
  v_cvt_pk_bf16_f32 v104, v72, v73
  v_cvt_pk_bf16_f32 v105, v74, v75
  v_rcp_f32 v68, v68
  v_rcp_f32 v69, v69
  v_rcp_f32 v70, v70
  v_rcp_f32 v71, v71
  v_cvt_pk_bf16_f32 v106, v80, v81
  v_cvt_pk_bf16_f32 v107, v82, v83
  v_cvt_pk_bf16_f32 v136, v88, v89
  v_cvt_pk_bf16_f32 v137, v90, v91
  v_pk_mul_f32 v[72:73], v[152:153], v[232:233]
  v_pk_mul_f32 v[74:75], v[154:155], v[234:235]
  v_rcp_f32 v76, v76
  v_rcp_f32 v77, v77
  v_rcp_f32 v78, v78
  v_rcp_f32 v79, v79
  v_rcp_f32 v84, v84
  v_rcp_f32 v85, v85
  v_rcp_f32 v86, v86
  v_rcp_f32 v87, v87
  v_pk_mul_f32 v[80:81], v[108:109], v[188:189]
  v_pk_mul_f32 v[82:83], v[110:111], v[190:191]
  v_pk_mul_f32 v[88:89], v[124:125], v[204:205]
  v_pk_mul_f32 v[90:91], v[126:127], v[206:207]
  v_pk_fma_f32 v[140:141], v[36:37], v[20:21], v[140:141] op_sel_hi:[1,0,1] neg_lo:[0,1,0] neg_hi:[0,1,0]
  v_pk_fma_f32 v[142:143], v[38:39], v[20:21], v[142:143] op_sel_hi:[1,0,1] neg_lo:[0,1,0] neg_hi:[0,1,0]
  v_pk_fma_f32 v[156:157], v[40:41], v[20:21], v[156:157] op_sel_hi:[1,0,1] neg_lo:[0,1,0] neg_hi:[0,1,0]
  v_pk_fma_f32 v[158:159], v[42:43], v[20:21], v[158:159] op_sel_hi:[1,0,1] neg_lo:[0,1,0] neg_hi:[0,1,0]
  v_pk_fma_f32 v[160:161], v[44:45], v[8:9], v[160:161] op_sel_hi:[1,0,1] neg_lo:[0,1,0] neg_hi:[0,1,0]
  v_pk_fma_f32 v[162:163], v[46:47], v[8:9], v[162:163] op_sel_hi:[1,0,1] neg_lo:[0,1,0] neg_hi:[0,1,0]
  v_pk_mul_f32 v[72:73], v[72:73], v[68:69]
  v_pk_mul_f32 v[74:75], v[74:75], v[70:71]
  v_pk_mul_f32 v[80:81], v[80:81], v[76:77]
  v_pk_mul_f32 v[82:83], v[82:83], v[78:79]
  v_pk_mul_f32 v[88:89], v[88:89], v[84:85]
  v_pk_mul_f32 v[90:91], v[90:91], v[86:87]
  v_pk_mul_f32 v[68:69], v[140:141], v[140:141]
  v_pk_mul_f32 v[70:71], v[142:143], v[142:143]
  v_pk_mul_f32 v[76:77], v[156:157], v[156:157]
  v_pk_mul_f32 v[78:79], v[158:159], v[158:159]
  v_pk_mul_f32 v[84:85], v[160:161], v[160:161]
  v_pk_mul_f32 v[86:87], v[162:163], v[162:163]
  v_pk_fma_f32 v[68:69], v[68:69], v[22:23], v[20:21] op_sel:[0,1,1] op_sel_hi:[1,1,1]
  v_pk_fma_f32 v[70:71], v[70:71], v[22:23], v[20:21] op_sel:[0,1,1] op_sel_hi:[1,1,1]
  v_pk_fma_f32 v[76:77], v[76:77], v[22:23], v[20:21] op_sel:[0,1,1] op_sel_hi:[1,1,1]
  v_pk_fma_f32 v[78:79], v[78:79], v[22:23], v[20:21] op_sel:[0,1,1] op_sel_hi:[1,1,1]
  v_pk_fma_f32 v[84:85], v[84:85], v[10:11], v[8:9] op_sel:[0,1,1] op_sel_hi:[1,1,1]
  v_pk_fma_f32 v[86:87], v[86:87], v[10:11], v[8:9] op_sel:[0,1,1] op_sel_hi:[1,1,1]
  v_pk_mul_f32 v[68:69], v[68:69], v[140:141]
  v_pk_mul_f32 v[70:71], v[70:71], v[142:143]
  v_pk_mul_f32 v[76:77], v[76:77], v[156:157]
  v_pk_mul_f32 v[78:79], v[78:79], v[158:159]
  v_pk_mul_f32 v[84:85], v[84:85], v[160:161]
  v_pk_mul_f32 v[86:87], v[86:87], v[162:163]
  v_exp_f32 v68, v68
  v_exp_f32 v69, v69
  v_exp_f32 v70, v70
  v_exp_f32 v71, v71
  v_exp_f32 v76, v76
  v_exp_f32 v77, v77
  v_exp_f32 v78, v78
  v_exp_f32 v79, v79
  v_exp_f32 v84, v84
  v_exp_f32 v85, v85
  v_exp_f32 v86, v86
  v_exp_f32 v87, v87
  v_pk_fma_f32 v[68:69], v[68:69], v[22:23], v[22:23] op_sel_hi:[1,0,0]
  v_pk_fma_f32 v[70:71], v[70:71], v[22:23], v[22:23] op_sel_hi:[1,0,0]
  v_pk_fma_f32 v[220:221], v[56:57], v[20:21], v[220:221] op_sel_hi:[1,0,1] neg_lo:[0,1,0] neg_hi:[0,1,0]
  v_pk_fma_f32 v[222:223], v[58:59], v[20:21], v[222:223] op_sel_hi:[1,0,1] neg_lo:[0,1,0] neg_hi:[0,1,0]
  v_pk_fma_f32 v[76:77], v[76:77], v[22:23], v[22:23] op_sel_hi:[1,0,0]
  v_pk_fma_f32 v[78:79], v[78:79], v[22:23], v[22:23] op_sel_hi:[1,0,0]
  v_pk_fma_f32 v[84:85], v[84:85], v[10:11], v[10:11] op_sel_hi:[1,0,0]
  v_pk_fma_f32 v[86:87], v[86:87], v[10:11], v[10:11] op_sel_hi:[1,0,0]
  v_pk_fma_f32 v[236:237], v[60:61], v[20:21], v[236:237] op_sel_hi:[1,0,1] neg_lo:[0,1,0] neg_hi:[0,1,0]
  v_pk_fma_f32 v[238:239], v[62:63], v[20:21], v[238:239] op_sel_hi:[1,0,1] neg_lo:[0,1,0] neg_hi:[0,1,0]
  v_pk_fma_f32 v[240:241], v[64:65], v[8:9], v[240:241] op_sel_hi:[1,0,1] neg_lo:[0,1,0] neg_hi:[0,1,0]
  v_pk_fma_f32 v[242:243], v[66:67], v[8:9], v[242:243] op_sel_hi:[1,0,1] neg_lo:[0,1,0] neg_hi:[0,1,0]
  v_cvt_pk_bf16_f32 v138, v72, v73
  v_cvt_pk_bf16_f32 v139, v74, v75
  v_rcp_f32 v68, v68
  v_rcp_f32 v69, v69
  v_rcp_f32 v70, v70
  v_rcp_f32 v71, v71
  v_cvt_pk_bf16_f32 v108, v80, v81
  v_cvt_pk_bf16_f32 v109, v82, v83
  v_cvt_pk_bf16_f32 v110, v88, v89
  v_cvt_pk_bf16_f32 v111, v90, v91
  v_pk_mul_f32 v[72:73], v[140:141], v[220:221]
  v_pk_mul_f32 v[74:75], v[142:143], v[222:223]
  v_rcp_f32 v76, v76
  v_rcp_f32 v77, v77
  v_rcp_f32 v78, v78
  v_rcp_f32 v79, v79
  v_rcp_f32 v84, v84
  v_rcp_f32 v85, v85
  v_rcp_f32 v86, v86
  v_rcp_f32 v87, v87
  v_pk_mul_f32 v[80:81], v[156:157], v[236:237]
  v_pk_mul_f32 v[82:83], v[158:159], v[238:239]
  v_pk_fma_f32 v[164:165], v[44:45], v[12:13], v[164:165] op_sel_hi:[1,0,1] neg_lo:[0,1,0] neg_hi:[0,1,0]
  v_pk_fma_f32 v[166:167], v[46:47], v[12:13], v[166:167] op_sel_hi:[1,0,1] neg_lo:[0,1,0] neg_hi:[0,1,0]
  v_pk_mul_f32 v[88:89], v[160:161], v[240:241]
  v_pk_mul_f32 v[90:91], v[162:163], v[242:243]
  v_pk_fma_f32 v[168:169], v[44:45], v[16:17], v[168:169] op_sel_hi:[1,0,1] neg_lo:[0,1,0] neg_hi:[0,1,0]
  v_pk_fma_f32 v[170:171], v[46:47], v[16:17], v[170:171] op_sel_hi:[1,0,1] neg_lo:[0,1,0] neg_hi:[0,1,0]
  v_pk_fma_f32 v[172:173], v[44:45], v[20:21], v[172:173] op_sel_hi:[1,0,1] neg_lo:[0,1,0] neg_hi:[0,1,0]
  v_pk_fma_f32 v[174:175], v[46:47], v[20:21], v[174:175] op_sel_hi:[1,0,1] neg_lo:[0,1,0] neg_hi:[0,1,0]
  v_pk_mul_f32 v[72:73], v[72:73], v[68:69]
  v_pk_mul_f32 v[74:75], v[74:75], v[70:71]
  v_pk_mul_f32 v[80:81], v[80:81], v[76:77]
  v_pk_mul_f32 v[82:83], v[82:83], v[78:79]
  v_pk_mul_f32 v[88:89], v[88:89], v[84:85]
  v_pk_mul_f32 v[90:91], v[90:91], v[86:87]
  v_pk_mul_f32 v[68:69], v[164:165], v[164:165]
  v_pk_mul_f32 v[70:71], v[166:167], v[166:167]
  v_pk_mul_f32 v[76:77], v[168:169], v[168:169]
  v_pk_mul_f32 v[78:79], v[170:171], v[170:171]
  v_pk_mul_f32 v[84:85], v[172:173], v[172:173]
  v_pk_mul_f32 v[86:87], v[174:175], v[174:175]
  v_pk_fma_f32 v[68:69], v[68:69], v[14:15], v[12:13] op_sel:[0,1,1] op_sel_hi:[1,1,1]
  v_pk_fma_f32 v[70:71], v[70:71], v[14:15], v[12:13] op_sel:[0,1,1] op_sel_hi:[1,1,1]
  v_pk_fma_f32 v[76:77], v[76:77], v[18:19], v[16:17] op_sel:[0,1,1] op_sel_hi:[1,1,1]
  v_pk_fma_f32 v[78:79], v[78:79], v[18:19], v[16:17] op_sel:[0,1,1] op_sel_hi:[1,1,1]
  v_pk_fma_f32 v[84:85], v[84:85], v[22:23], v[20:21] op_sel:[0,1,1] op_sel_hi:[1,1,1]
  v_pk_fma_f32 v[86:87], v[86:87], v[22:23], v[20:21] op_sel:[0,1,1] op_sel_hi:[1,1,1]
  v_pk_mul_f32 v[68:69], v[68:69], v[164:165]
  v_pk_mul_f32 v[70:71], v[70:71], v[166:167]
  v_pk_mul_f32 v[76:77], v[76:77], v[168:169]
  v_pk_mul_f32 v[78:79], v[78:79], v[170:171]
  v_pk_mul_f32 v[84:85], v[84:85], v[172:173]
  v_pk_mul_f32 v[86:87], v[86:87], v[174:175]
  v_exp_f32 v68, v68
  v_exp_f32 v69, v69
  v_exp_f32 v70, v70
  v_exp_f32 v71, v71
  v_exp_f32 v76, v76
  v_exp_f32 v77, v77
  v_exp_f32 v78, v78
  v_exp_f32 v79, v79
  v_exp_f32 v84, v84
  v_exp_f32 v85, v85
  v_exp_f32 v86, v86
  v_exp_f32 v87, v87
  v_pk_fma_f32 v[68:69], v[68:69], v[14:15], v[14:15] op_sel_hi:[1,0,0]
  v_pk_fma_f32 v[70:71], v[70:71], v[14:15], v[14:15] op_sel_hi:[1,0,0]
  v_pk_fma_f32 v[244:245], v[64:65], v[12:13], v[244:245] op_sel_hi:[1,0,1] neg_lo:[0,1,0] neg_hi:[0,1,0]
  v_pk_fma_f32 v[246:247], v[66:67], v[12:13], v[246:247] op_sel_hi:[1,0,1] neg_lo:[0,1,0] neg_hi:[0,1,0]
  v_pk_fma_f32 v[76:77], v[76:77], v[18:19], v[18:19] op_sel_hi:[1,0,0]
  v_pk_fma_f32 v[78:79], v[78:79], v[18:19], v[18:19] op_sel_hi:[1,0,0]
  v_pk_fma_f32 v[84:85], v[84:85], v[22:23], v[22:23] op_sel_hi:[1,0,0]
  v_pk_fma_f32 v[86:87], v[86:87], v[22:23], v[22:23] op_sel_hi:[1,0,0]
  v_pk_fma_f32 v[248:249], v[64:65], v[16:17], v[248:249] op_sel_hi:[1,0,1] neg_lo:[0,1,0] neg_hi:[0,1,0]
  v_pk_fma_f32 v[250:251], v[66:67], v[16:17], v[250:251] op_sel_hi:[1,0,1] neg_lo:[0,1,0] neg_hi:[0,1,0]
  v_pk_fma_f32 v[252:253], v[64:65], v[20:21], v[252:253] op_sel_hi:[1,0,1] neg_lo:[0,1,0] neg_hi:[0,1,0]
  v_pk_fma_f32 v[254:255], v[66:67], v[20:21], v[254:255] op_sel_hi:[1,0,1] neg_lo:[0,1,0] neg_hi:[0,1,0]
  v_cvt_pk_bf16_f32 v140, v72, v73
  v_cvt_pk_bf16_f32 v141, v74, v75
  v_rcp_f32 v68, v68
  v_rcp_f32 v69, v69
  v_rcp_f32 v70, v70
  v_rcp_f32 v71, v71
  buffer_store_dwordx4 v[96:99], v1, s[16:19], s14 offen offset:0 sc1
  v_cvt_pk_bf16_f32 v142, v80, v81
  v_cvt_pk_bf16_f32 v143, v82, v83
  v_cvt_pk_bf16_f32 v160, v88, v89
  v_cvt_pk_bf16_f32 v161, v90, v91
  v_pk_mul_f32 v[72:73], v[164:165], v[244:245]
  v_pk_mul_f32 v[74:75], v[166:167], v[246:247]
  v_rcp_f32 v76, v76
  v_rcp_f32 v77, v77
  v_rcp_f32 v78, v78
  v_rcp_f32 v79, v79
  v_rcp_f32 v84, v84
  v_rcp_f32 v85, v85
  v_rcp_f32 v86, v86
  v_rcp_f32 v87, v87
  buffer_store_dwordx4 v[128:131], v1, s[16:19], s15 offen offset:0 sc1
  v_pk_mul_f32 v[80:81], v[168:169], v[248:249]
  v_pk_mul_f32 v[82:83], v[170:171], v[250:251]
  v_pk_mul_f32 v[88:89], v[172:173], v[252:253]
  v_pk_mul_f32 v[90:91], v[174:175], v[254:255]
  buffer_store_dwordx4 v[100:103], v1, s[16:19], s14 offen offset:1024 sc1
  buffer_store_dwordx4 v[132:135], v1, s[16:19], s15 offen offset:1024 sc1
  v_pk_mul_f32 v[72:73], v[72:73], v[68:69]
  v_pk_mul_f32 v[74:75], v[74:75], v[70:71]
  buffer_store_dwordx4 v[104:107], v1, s[16:19], s14 offen offset:2048 sc1
  v_pk_mul_f32 v[80:81], v[80:81], v[76:77]
  v_pk_mul_f32 v[82:83], v[82:83], v[78:79]
  v_pk_mul_f32 v[88:89], v[88:89], v[84:85]
  v_pk_mul_f32 v[90:91], v[90:91], v[86:87]
  buffer_store_dwordx4 v[136:139], v1, s[16:19], s15 offen offset:2048 sc1
  buffer_store_dwordx4 v[108:111], v1, s[16:19], s14 offen offset:3072 sc1
  v_cvt_pk_bf16_f32 v162, v72, v73
  v_cvt_pk_bf16_f32 v163, v74, v75
  buffer_store_dwordx4 v[140:143], v1, s[16:19], s15 offen offset:3072 sc1
  v_cvt_pk_bf16_f32 v168, v80, v81
  v_cvt_pk_bf16_f32 v169, v82, v83
  v_cvt_pk_bf16_f32 v170, v88, v89
  v_cvt_pk_bf16_f32 v171, v90, v91
  buffer_store_dwordx4 v[160:163], v1, s[16:19], s35 offen offset:0 sc1
  buffer_store_dwordx4 v[168:171], v1, s[16:19], s35 offen offset:2048 sc1
  s_waitcnt vmcnt(10)
  s_branch L_g2_entry
L_g2_entry:
  s_cmp_lt_u32 s76, 4
  s_cbranch_scc1 L_g2_e0
  s_barrier
L_g2_e0:
  s_load_dwordx2 s[4:5], s[0:1], 0
  s_load_dwordx4 s[8:11], s[0:1], 56
  s_and_b32 s3, s2, 7
  s_lshr_b32 s16, s2, 3
  s_and_b32 s44, s16, 1
  s_lshr_b32 s16, s16, 1
  s_lshr_b32 s17, s3, 1
  s_lshl_b32 s17, s17, 2
  s_and_b32 s18, s16, 3
  s_add_u32 s45, s17, s18
  s_and_b32 s17, s3, 1
  s_lshl_b32 s17, s17, 2
  s_lshr_b32 s18, s16, 2
  s_add_u32 s46, s17, s18
  s_lshl_b32 s47, s45, 3
  s_add_u32 s47, s47, s46
  s_lshr_b32 s61, s76, 2
  s_and_b32 s19, s76, 3
  v_lshrrev_b32 v3, 4, v0
  v_lshlrev_b32 v4, 1, v3
  v_and_b32 v2, 15, v0
  v_xor_b32 v6, v4, v2
  v_xor_b32 v2, 8, v6
  s_lshl_b32 s17, s19, 3
  v_add_u32 v3, s17, v3
  v_lshlrev_b32 v3, 11, v3
  s_lshl_b32 s17, s46, 8
  v_add_u32 v3, s17, v3
  v_lshl_add_u32 v177, v6, 4, v3
  v_lshl_add_u32 v178, v2, 4, v3
  v_add_u32 v178, 8192, v178
  s_and_b32 s17, s19, 1
  s_lshl_b32 s17, s17, 11
  v_lshlrev_b32 v188, 4, v0
  v_add_u32 v176, s17, v188
  v_lshrrev_b32 v3, 2, v0
  v_and_b32 v4, 7, v3
  v_and_b32 v2, 3, v0
  v_lshlrev_b32 v2, 3, v2
  v_lshl_add_u32 v2, v3, 8, v2
  s_mul_i32 s17, s61, 49152
  v_add_u32 v2, s17, v2
  v_xor_b32 v6, 0, v4
  v_lshl_add_u32 v168, v6, 5, v2
  v_xor_b32 v6, 1, v4
  v_lshl_add_u32 v169, v6, 5, v2
  v_xor_b32 v6, 2, v4
  v_lshl_add_u32 v170, v6, 5, v2
  v_xor_b32 v6, 3, v4
  v_lshl_add_u32 v171, v6, 5, v2
  v_xor_b32 v6, 4, v4
  v_lshl_add_u32 v172, v6, 5, v2
  v_xor_b32 v6, 5, v4
  v_lshl_add_u32 v173, v6, 5, v2
  v_xor_b32 v6, 6, v4
  v_lshl_add_u32 v174, v6, 5, v2
  v_xor_b32 v6, 7, v4
  v_lshl_add_u32 v175, v6, 5, v2
  s_lshl_b32 s16, s45, 7
  s_lshl_b32 s17, s19, 5
  s_add_u32 s16, s16, s17
  v_and_b32 v3, 15, v0
  v_add_u32 v3, s16, v3
  v_lshlrev_b32 v3, 11, v3
  s_lshl_b32 s17, s46, 8
  s_lshl_b32 s18, s61, 7
  s_add_u32 s17, s17, s18
  s_lshl_b32 s18, s44, 6
  s_add_u32 s17, s17, s18
  v_add_u32 v179, s17, v3
  s_lshl_b32 s16, s45, 1
  s_bfe_u32 s17, s76, 0x10001
  s_add_u32 s16, s16, s17
  s_mul_i32 s16, s16, 589824
  s_add_u32 s16, s16, 4194304
  s_add_u32 s40, s6, s16
  s_addc_u32 s41, s7, 0
  s_mul_i32 s60, s44, 294912
  s_add_u32 s42, s60, 294912
  s_mov_b32 s43, 0x20000
  s_lshl_b32 s16, s61, 13
  s_add_u32 s60, s60, s16
  s_lshl_b32 s16, s47, 7
  s_lshl_b32 s17, s44, 2
  s_add_u32 s33, s16, s17
  s_lshl_b32 s71, s61, 1
  v_mov_b32 v8, 0
  v_mov_b32 v9, 0
  v_mov_b32 v10, 0
  v_mov_b32 v11, 0
  v_mov_b32 v12, 0
  v_mov_b32 v13, 0
  v_mov_b32 v14, 0
  v_mov_b32 v15, 0
  v_mov_b32 v16, 0
  v_mov_b32 v17, 0
  v_mov_b32 v18, 0
  v_mov_b32 v19, 0
  v_mov_b32 v20, 0
  v_mov_b32 v21, 0
  v_mov_b32 v22, 0
  v_mov_b32 v23, 0
  v_mov_b32 v24, 0
  v_mov_b32 v25, 0
  v_mov_b32 v26, 0
  v_mov_b32 v27, 0
  v_mov_b32 v28, 0
  v_mov_b32 v29, 0
  v_mov_b32 v30, 0
  v_mov_b32 v31, 0
  v_mov_b32 v32, 0
  v_mov_b32 v33, 0
  v_mov_b32 v34, 0
  v_mov_b32 v35, 0
  v_mov_b32 v36, 0
  v_mov_b32 v37, 0
  v_mov_b32 v38, 0
  v_mov_b32 v39, 0
  v_mov_b32 v40, 0
  v_mov_b32 v41, 0
  v_mov_b32 v42, 0
  v_mov_b32 v43, 0
  v_mov_b32 v44, 0
  v_mov_b32 v45, 0
  v_mov_b32 v46, 0
  v_mov_b32 v47, 0
  v_mov_b32 v48, 0
  v_mov_b32 v49, 0
  v_mov_b32 v50, 0
  v_mov_b32 v51, 0
  v_mov_b32 v52, 0
  v_mov_b32 v53, 0
  v_mov_b32 v54, 0
  v_mov_b32 v55, 0
  v_mov_b32 v56, 0
  v_mov_b32 v57, 0
  v_mov_b32 v58, 0
  v_mov_b32 v59, 0
  v_mov_b32 v60, 0
  v_mov_b32 v61, 0
  v_mov_b32 v62, 0
  v_mov_b32 v63, 0
  v_mov_b32 v64, 0
  v_mov_b32 v65, 0
  v_mov_b32 v66, 0
  v_mov_b32 v67, 0
  v_mov_b32 v68, 0
  v_mov_b32 v69, 0
  v_mov_b32 v70, 0
  v_mov_b32 v71, 0
  s_waitcnt lgkmcnt(0)
  s_mov_b32 s48, s4
  s_mov_b32 s49, s5
  s_mov_b32 s50, 4194304
  s_mov_b32 s51, 0x20000
  s_mov_b32 s52, s8
  s_mov_b32 s53, s9
  s_mov_b32 s54, 4194304
  s_mov_b32 s55, 0x20000
  s_add_u32 s28, s6, 104857600
  s_addc_u32 s29, s7, 0
  s_mov_b32 s30, 21504
  s_mov_b32 s31, 0x20000
  s_lshr_b32 s16, s45, 1
  s_lshl_b32 s16, s16, 7
  s_lshl_b32 s17, s44, 6
  s_add_u32 s16, s16, s17
  s_add_u32 s16, s16, 16384
  v_and_b32 v4, 15, v0
  v_lshlrev_b32 v4, 2, v4
  v_add_u32 v189, s16, v4
  s_cmp_lg_u32 s76, 0
  s_cbranch_scc1 L_g2_go
  s_mov_b32 s62, 0x40000
  v_add_u32 v4, 1024, v189
L_g2_p1:
  buffer_load_dword v3, v4, s[28:31], 0 offen sc1
  s_waitcnt vmcnt(0)
  v_cmp_eq_u32 vcc, 1, v3
  s_cmp_eq_u64 vcc, exec
  s_cbranch_scc1 L_g2_p1_ok
  s_sub_u32 s62, s62, 1
  s_cmp_eq_u32 s62, 0
  s_cbranch_scc1 L_g2_p1_ok
  s_sleep 1
  s_branch L_g2_p1
L_g2_p1_ok:
L_g2_go:
  s_cmp_ge_u32 s76, 4
  s_cbranch_scc1 L_g2_e1
  s_barrier
L_g2_e1:
  s_add_u32 s58, s60, 4096
  buffer_load_dwordx4 v[136:139], v176, s[40:43], s60 offen offset:0 sc1
  buffer_load_dwordx4 v[140:143], v176, s[40:43], s60 offen offset:1024 sc1
  buffer_load_dwordx4 v[144:147], v176, s[40:43], s58 offen offset:0 sc1
  buffer_load_dwordx4 v[148:151], v176, s[40:43], s58 offen offset:1024 sc1
  s_add_u32 s60, s60, 16384
  v_mov_b32 v4, 157188
  ds_read_b32 v2, v4
  s_waitcnt lgkmcnt(0)
  v_readfirstlane_b32 s83, v2
  s_cmp_eq_u32 s61, 0
  s_cbranch_scc0 L_g2_Y
  .p2align 3
  s_add_u32 s58, s60, 4096
  buffer_load_dwordx4 v[152:155], v176, s[40:43], s60 offen offset:0 sc1
  ds_read_b64_tr_b16 v[72:73], v168 offset:0
  ds_read_b64_tr_b16 v[74:75], v168 offset:4096
  ds_read_b64_tr_b16 v[76:77], v169 offset:0
  ds_read_b64_tr_b16 v[78:79], v169 offset:4096
  buffer_load_dwordx4 v[156:159], v176, s[40:43], s60 offen offset:1024 sc1
  ds_read_b64_tr_b16 v[80:81], v170 offset:0
  ds_read_b64_tr_b16 v[82:83], v170 offset:4096
  ds_read_b64_tr_b16 v[84:85], v171 offset:0
  ds_read_b64_tr_b16 v[86:87], v171 offset:4096
  buffer_load_dwordx4 v[160:163], v176, s[40:43], s58 offen offset:0 sc1
  ds_read_b64_tr_b16 v[88:89], v172 offset:0
  ds_read_b64_tr_b16 v[90:91], v172 offset:4096
  ds_read_b64_tr_b16 v[92:93], v173 offset:0
  ds_read_b64_tr_b16 v[94:95], v173 offset:4096
  buffer_load_dwordx4 v[164:167], v176, s[40:43], s58 offen offset:1024 sc1
  s_add_u32 s60, s60, 16384
  ds_read_b64_tr_b16 v[96:97], v174 offset:0
  ds_read_b64_tr_b16 v[98:99], v174 offset:4096
  ds_read_b64_tr_b16 v[100:101], v175 offset:0
  ds_read_b64_tr_b16 v[102:103], v175 offset:4096
  s_add_u32 m0, s74, 32768
  s_add_u32 s75, s73, s72
  buffer_load_dwordx4 v177, s[64:67], s73 offen lds
  ds_read_b64_tr_b16 v[104:105], v168 offset:8192
  ds_read_b64_tr_b16 v[106:107], v168 offset:12288
  ds_read_b64_tr_b16 v[108:109], v169 offset:8192
  ds_read_b64_tr_b16 v[110:111], v169 offset:12288
  s_add_u32 m0, s74, 33792
  s_sub_u32 s68, s68, 1
  buffer_load_dwordx4 v178, s[64:67], s73 offen lds
  ds_read_b64_tr_b16 v[112:113], v170 offset:8192
  ds_read_b64_tr_b16 v[114:115], v170 offset:12288
  ds_read_b64_tr_b16 v[116:117], v171 offset:8192
  ds_read_b64_tr_b16 v[118:119], v171 offset:12288
  s_add_u32 m0, s74, 40960
  s_add_u32 s73, s73, s70
  buffer_load_dwordx4 v177, s[64:67], s75 offen lds
  ds_read_b64_tr_b16 v[120:121], v172 offset:8192
  ds_read_b64_tr_b16 v[122:123], v172 offset:12288
  ds_read_b64_tr_b16 v[124:125], v173 offset:8192
  ds_read_b64_tr_b16 v[126:127], v173 offset:12288
  s_add_u32 m0, s74, 41984
  s_cmp_eq_u32 s68, 0
  buffer_load_dwordx4 v178, s[64:67], s75 offen lds
  s_cbranch_scc0 L_bo11
  s_add_u32 s69, s69, 1
  s_mov_b32 s64, s26
  s_mov_b32 s65, s27
  s_mov_b32 s66, 7340032
  s_mov_b32 s73, s80
  s_mov_b32 s70, 917504
  s_mov_b32 s72, 196608
  s_mov_b32 s68, 4
  s_cmp_eq_u32 s69, 1
  s_cbranch_scc1 L_bo11
  s_mov_b32 s73, s81
  s_mov_b32 s70, 458752
  s_mov_b32 s72, 65536
  s_mov_b32 s68, 8
  s_cmp_eq_u32 s69, 2
  s_cbranch_scc1 L_bo11
  s_mov_b32 s73, s82
  s_mov_b32 s70, 1835008
  s_mov_b32 s72, 458752
  s_mov_b32 s68, 2
  s_cmp_eq_u32 s69, 3
  s_cbranch_scc1 L_bo11
  s_mov_b32 s66, 0
  s_mov_b32 s68, 64
L_bo11:
  ds_read_b64_tr_b16 v[128:129], v174 offset:8192
  ds_read_b64_tr_b16 v[130:131], v174 offset:12288
  ds_read_b64_tr_b16 v[132:133], v175 offset:8192
  ds_read_b64_tr_b16 v[134:135], v175 offset:12288
  s_waitcnt vmcnt(8) lgkmcnt(0)
  s_barrier
  s_mov_b32 s57, 3
  .p2align 6
L_g2_xl:
  s_cmp_ge_u32 s71, 64
  s_cbranch_scc0 3f
  v_swap_b32 v138, v140
  v_swap_b32 v139, v141
  v_swap_b32 v146, v148
  v_swap_b32 v147, v149
3:
  s_add_u32 s71, s71, 4
  .p2align 3
  v_mfma_f32_16x16x32_bf16 v[8:11], v[72:75], v[136:139], v[8:11]
  v_mfma_f32_16x16x32_bf16 v[12:15], v[72:75], v[140:143], v[12:15]
  v_mfma_f32_16x16x32_bf16 v[16:19], v[76:79], v[136:139], v[16:19]
  v_mfma_f32_16x16x32_bf16 v[20:23], v[76:79], v[140:143], v[20:23]
  v_mfma_f32_16x16x32_bf16 v[24:27], v[80:83], v[136:139], v[24:27]
  v_mfma_f32_16x16x32_bf16 v[28:31], v[80:83], v[140:143], v[28:31]
  v_mfma_f32_16x16x32_bf16 v[32:35], v[84:87], v[136:139], v[32:35]
  v_mfma_f32_16x16x32_bf16 v[36:39], v[84:87], v[140:143], v[36:39]
  v_mfma_f32_16x16x32_bf16 v[40:43], v[88:91], v[136:139], v[40:43]
  v_mfma_f32_16x16x32_bf16 v[44:47], v[88:91], v[140:143], v[44:47]
  v_mfma_f32_16x16x32_bf16 v[48:51], v[92:95], v[136:139], v[48:51]
  v_mfma_f32_16x16x32_bf16 v[52:55], v[92:95], v[140:143], v[52:55]
  v_mfma_f32_16x16x32_bf16 v[56:59], v[96:99], v[136:139], v[56:59]
  v_mfma_f32_16x16x32_bf16 v[60:63], v[96:99], v[140:143], v[60:63]
  v_mfma_f32_16x16x32_bf16 v[64:67], v[100:103], v[136:139], v[64:67]
  v_mfma_f32_16x16x32_bf16 v[68:71], v[100:103], v[140:143], v[68:71]
  v_mfma_f32_16x16x32_bf16 v[8:11], v[104:107], v[144:147], v[8:11]
  v_mfma_f32_16x16x32_bf16 v[12:15], v[104:107], v[148:151], v[12:15]
  v_mfma_f32_16x16x32_bf16 v[16:19], v[108:111], v[144:147], v[16:19]
  v_mfma_f32_16x16x32_bf16 v[20:23], v[108:111], v[148:151], v[20:23]
  v_mfma_f32_16x16x32_bf16 v[24:27], v[112:115], v[144:147], v[24:27]
  v_mfma_f32_16x16x32_bf16 v[28:31], v[112:115], v[148:151], v[28:31]
  v_mfma_f32_16x16x32_bf16 v[32:35], v[116:119], v[144:147], v[32:35]
  v_mfma_f32_16x16x32_bf16 v[36:39], v[116:119], v[148:151], v[36:39]
  v_mfma_f32_16x16x32_bf16 v[40:43], v[120:123], v[144:147], v[40:43]
  v_mfma_f32_16x16x32_bf16 v[44:47], v[120:123], v[148:151], v[44:47]
  v_mfma_f32_16x16x32_bf16 v[48:51], v[124:127], v[144:147], v[48:51]
  v_mfma_f32_16x16x32_bf16 v[52:55], v[124:127], v[148:151], v[52:55]
  v_mfma_f32_16x16x32_bf16 v[56:59], v[128:131], v[144:147], v[56:59]
  v_mfma_f32_16x16x32_bf16 v[60:63], v[128:131], v[148:151], v[60:63]
  v_mfma_f32_16x16x32_bf16 v[64:67], v[132:135], v[144:147], v[64:67]
  v_mfma_f32_16x16x32_bf16 v[68:71], v[132:135], v[148:151], v[68:71]
  s_barrier
  .p2align 3
  s_add_u32 s58, s60, 4096
  buffer_load_dwordx4 v[136:139], v176, s[40:43], s60 offen offset:0 sc1
  ds_read_b64_tr_b16 v[72:73], v168 offset:16384
  ds_read_b64_tr_b16 v[74:75], v168 offset:20480
  ds_read_b64_tr_b16 v[76:77], v169 offset:16384
  ds_read_b64_tr_b16 v[78:79], v169 offset:20480
  buffer_load_dwordx4 v[140:143], v176, s[40:43], s60 offen offset:1024 sc1
  ds_read_b64_tr_b16 v[80:81], v170 offset:16384
  ds_read_b64_tr_b16 v[82:83], v170 offset:20480
  ds_read_b64_tr_b16 v[84:85], v171 offset:16384
  ds_read_b64_tr_b16 v[86:87], v171 offset:20480
  buffer_load_dwordx4 v[144:147], v176, s[40:43], s58 offen offset:0 sc1
  ds_read_b64_tr_b16 v[88:89], v172 offset:16384
  ds_read_b64_tr_b16 v[90:91], v172 offset:20480
  ds_read_b64_tr_b16 v[92:93], v173 offset:16384
  ds_read_b64_tr_b16 v[94:95], v173 offset:20480
  buffer_load_dwordx4 v[148:151], v176, s[40:43], s58 offen offset:1024 sc1
  s_add_u32 s60, s60, 16384
  ds_read_b64_tr_b16 v[96:97], v174 offset:16384
  ds_read_b64_tr_b16 v[98:99], v174 offset:20480
  ds_read_b64_tr_b16 v[100:101], v175 offset:16384
  ds_read_b64_tr_b16 v[102:103], v175 offset:20480
  s_add_u32 m0, s74, 0
  s_add_u32 s75, s73, s72
  buffer_load_dwordx4 v177, s[64:67], s73 offen lds
  ds_read_b64_tr_b16 v[104:105], v168 offset:24576
  ds_read_b64_tr_b16 v[106:107], v168 offset:28672
  ds_read_b64_tr_b16 v[108:109], v169 offset:24576
  ds_read_b64_tr_b16 v[110:111], v169 offset:28672
  s_add_u32 m0, s74, 1024
  s_sub_u32 s68, s68, 1
  buffer_load_dwordx4 v178, s[64:67], s73 offen lds
  ds_read_b64_tr_b16 v[112:113], v170 offset:24576
  ds_read_b64_tr_b16 v[114:115], v170 offset:28672
  ds_read_b64_tr_b16 v[116:117], v171 offset:24576
  ds_read_b64_tr_b16 v[118:119], v171 offset:28672
  s_add_u32 m0, s74, 8192
  s_add_u32 s73, s73, s70
  buffer_load_dwordx4 v177, s[64:67], s75 offen lds
  ds_read_b64_tr_b16 v[120:121], v172 offset:24576
  ds_read_b64_tr_b16 v[122:123], v172 offset:28672
  ds_read_b64_tr_b16 v[124:125], v173 offset:24576
  ds_read_b64_tr_b16 v[126:127], v173 offset:28672
  s_add_u32 m0, s74, 9216
  s_cmp_eq_u32 s68, 0
  buffer_load_dwordx4 v178, s[64:67], s75 offen lds
  s_cbranch_scc0 L_bo12
  s_add_u32 s69, s69, 1
  s_mov_b32 s64, s26
  s_mov_b32 s65, s27
  s_mov_b32 s66, 7340032
  s_mov_b32 s73, s80
  s_mov_b32 s70, 917504
  s_mov_b32 s72, 196608
  s_mov_b32 s68, 4
  s_cmp_eq_u32 s69, 1
  s_cbranch_scc1 L_bo12
  s_mov_b32 s73, s81
  s_mov_b32 s70, 458752
  s_mov_b32 s72, 65536
  s_mov_b32 s68, 8
  s_cmp_eq_u32 s69, 2
  s_cbranch_scc1 L_bo12
  s_mov_b32 s73, s82
  s_mov_b32 s70, 1835008
  s_mov_b32 s72, 458752
  s_mov_b32 s68, 2
  s_cmp_eq_u32 s69, 3
  s_cbranch_scc1 L_bo12
  s_mov_b32 s66, 0
  s_mov_b32 s68, 64
L_bo12:
  ds_read_b64_tr_b16 v[128:129], v174 offset:24576
  ds_read_b64_tr_b16 v[130:131], v174 offset:28672
  ds_read_b64_tr_b16 v[132:133], v175 offset:24576
  ds_read_b64_tr_b16 v[134:135], v175 offset:28672
  s_waitcnt vmcnt(8) lgkmcnt(0)
  s_barrier
  s_cmp_ge_u32 s71, 64
  s_cbranch_scc0 3f
  v_swap_b32 v154, v156
  v_swap_b32 v155, v157
  v_swap_b32 v162, v164
  v_swap_b32 v163, v165
3:
  s_add_u32 s71, s71, 4
  .p2align 3
  v_mfma_f32_16x16x32_bf16 v[8:11], v[72:75], v[152:155], v[8:11]
  v_mfma_f32_16x16x32_bf16 v[12:15], v[72:75], v[156:159], v[12:15]
  v_mfma_f32_16x16x32_bf16 v[16:19], v[76:79], v[152:155], v[16:19]
  v_mfma_f32_16x16x32_bf16 v[20:23], v[76:79], v[156:159], v[20:23]
  v_mfma_f32_16x16x32_bf16 v[24:27], v[80:83], v[152:155], v[24:27]
  v_mfma_f32_16x16x32_bf16 v[28:31], v[80:83], v[156:159], v[28:31]
  v_mfma_f32_16x16x32_bf16 v[32:35], v[84:87], v[152:155], v[32:35]
  v_mfma_f32_16x16x32_bf16 v[36:39], v[84:87], v[156:159], v[36:39]
  v_mfma_f32_16x16x32_bf16 v[40:43], v[88:91], v[152:155], v[40:43]
  v_mfma_f32_16x16x32_bf16 v[44:47], v[88:91], v[156:159], v[44:47]
  v_mfma_f32_16x16x32_bf16 v[48:51], v[92:95], v[152:155], v[48:51]
  v_mfma_f32_16x16x32_bf16 v[52:55], v[92:95], v[156:159], v[52:55]
  v_mfma_f32_16x16x32_bf16 v[56:59], v[96:99], v[152:155], v[56:59]
  v_mfma_f32_16x16x32_bf16 v[60:63], v[96:99], v[156:159], v[60:63]
  v_mfma_f32_16x16x32_bf16 v[64:67], v[100:103], v[152:155], v[64:67]
  v_mfma_f32_16x16x32_bf16 v[68:71], v[100:103], v[156:159], v[68:71]
  v_mfma_f32_16x16x32_bf16 v[8:11], v[104:107], v[160:163], v[8:11]
  v_mfma_f32_16x16x32_bf16 v[12:15], v[104:107], v[164:167], v[12:15]
  v_mfma_f32_16x16x32_bf16 v[16:19], v[108:111], v[160:163], v[16:19]
  v_mfma_f32_16x16x32_bf16 v[20:23], v[108:111], v[164:167], v[20:23]
  v_mfma_f32_16x16x32_bf16 v[24:27], v[112:115], v[160:163], v[24:27]
  v_mfma_f32_16x16x32_bf16 v[28:31], v[112:115], v[164:167], v[28:31]
  v_mfma_f32_16x16x32_bf16 v[32:35], v[116:119], v[160:163], v[32:35]
  v_mfma_f32_16x16x32_bf16 v[36:39], v[116:119], v[164:167], v[36:39]
  v_mfma_f32_16x16x32_bf16 v[40:43], v[120:123], v[160:163], v[40:43]
  v_mfma_f32_16x16x32_bf16 v[44:47], v[120:123], v[164:167], v[44:47]
  v_mfma_f32_16x16x32_bf16 v[48:51], v[124:127], v[160:163], v[48:51]
  v_mfma_f32_16x16x32_bf16 v[52:55], v[124:127], v[164:167], v[52:55]
  v_mfma_f32_16x16x32_bf16 v[56:59], v[128:131], v[160:163], v[56:59]
  v_mfma_f32_16x16x32_bf16 v[60:63], v[128:131], v[164:167], v[60:63]
  v_mfma_f32_16x16x32_bf16 v[64:67], v[132:135], v[160:163], v[64:67]
  v_mfma_f32_16x16x32_bf16 v[68:71], v[132:135], v[164:167], v[68:71]
  s_barrier
  s_cmp_eq_u32 s57, 3
  s_cbranch_scc0 L_g2_nc1
  s_cmp_eq_u32 s76, 0
  s_cbranch_scc0 L_g2_nc1
  buffer_load_dword v3, v189, s[28:31], 0 offen sc1
L_g2_nc1:
  .p2align 3
  s_add_u32 s58, s60, 4096
  buffer_load_dwordx4 v[152:155], v176, s[40:43], s60 offen offset:0 sc1
  ds_read_b64_tr_b16 v[72:73], v168 offset:32768
  ds_read_b64_tr_b16 v[74:75], v168 offset:36864
  ds_read_b64_tr_b16 v[76:77], v169 offset:32768
  ds_read_b64_tr_b16 v[78:79], v169 offset:36864
  buffer_load_dwordx4 v[156:159], v176, s[40:43], s60 offen offset:1024 sc1
  ds_read_b64_tr_b16 v[80:81], v170 offset:32768
  ds_read_b64_tr_b16 v[82:83], v170 offset:36864
  ds_read_b64_tr_b16 v[84:85], v171 offset:32768
  ds_read_b64_tr_b16 v[86:87], v171 offset:36864
  buffer_load_dwordx4 v[160:163], v176, s[40:43], s58 offen offset:0 sc1
  ds_read_b64_tr_b16 v[88:89], v172 offset:32768
  ds_read_b64_tr_b16 v[90:91], v172 offset:36864
  ds_read_b64_tr_b16 v[92:93], v173 offset:32768
  ds_read_b64_tr_b16 v[94:95], v173 offset:36864
  buffer_load_dwordx4 v[164:167], v176, s[40:43], s58 offen offset:1024 sc1
  s_add_u32 s60, s60, 16384
  ds_read_b64_tr_b16 v[96:97], v174 offset:32768
  ds_read_b64_tr_b16 v[98:99], v174 offset:36864
  ds_read_b64_tr_b16 v[100:101], v175 offset:32768
  ds_read_b64_tr_b16 v[102:103], v175 offset:36864
  s_add_u32 m0, s74, 16384
  s_add_u32 s75, s73, s72
  buffer_load_dwordx4 v177, s[64:67], s73 offen lds
  ds_read_b64_tr_b16 v[104:105], v168 offset:40960
  ds_read_b64_tr_b16 v[106:107], v168 offset:45056
  ds_read_b64_tr_b16 v[108:109], v169 offset:40960
  ds_read_b64_tr_b16 v[110:111], v169 offset:45056
  s_add_u32 m0, s74, 17408
  s_sub_u32 s68, s68, 1
  buffer_load_dwordx4 v178, s[64:67], s73 offen lds
  ds_read_b64_tr_b16 v[112:113], v170 offset:40960
  ds_read_b64_tr_b16 v[114:115], v170 offset:45056
  ds_read_b64_tr_b16 v[116:117], v171 offset:40960
  ds_read_b64_tr_b16 v[118:119], v171 offset:45056
  s_add_u32 m0, s74, 24576
  s_add_u32 s73, s73, s70
  buffer_load_dwordx4 v177, s[64:67], s75 offen lds
  ds_read_b64_tr_b16 v[120:121], v172 offset:40960
  ds_read_b64_tr_b16 v[122:123], v172 offset:45056
  ds_read_b64_tr_b16 v[124:125], v173 offset:40960
  ds_read_b64_tr_b16 v[126:127], v173 offset:45056
  s_add_u32 m0, s74, 25600
  s_cmp_eq_u32 s68, 0
  buffer_load_dwordx4 v178, s[64:67], s75 offen lds
  s_cbranch_scc0 L_bo13
  s_add_u32 s69, s69, 1
  s_mov_b32 s64, s26
  s_mov_b32 s65, s27
  s_mov_b32 s66, 7340032
  s_mov_b32 s73, s80
  s_mov_b32 s70, 917504
  s_mov_b32 s72, 196608
  s_mov_b32 s68, 4
  s_cmp_eq_u32 s69, 1
  s_cbranch_scc1 L_bo13
  s_mov_b32 s73, s81
  s_mov_b32 s70, 458752
  s_mov_b32 s72, 65536
  s_mov_b32 s68, 8
  s_cmp_eq_u32 s69, 2
  s_cbranch_scc1 L_bo13
  s_mov_b32 s73, s82
  s_mov_b32 s70, 1835008
  s_mov_b32 s72, 458752
  s_mov_b32 s68, 2
  s_cmp_eq_u32 s69, 3
  s_cbranch_scc1 L_bo13
  s_mov_b32 s66, 0
  s_mov_b32 s68, 64
L_bo13:
  ds_read_b64_tr_b16 v[128:129], v174 offset:40960
  ds_read_b64_tr_b16 v[130:131], v174 offset:45056
  ds_read_b64_tr_b16 v[132:133], v175 offset:40960
  ds_read_b64_tr_b16 v[134:135], v175 offset:45056
  s_waitcnt vmcnt(8) lgkmcnt(0)
  s_cmp_eq_u32 s57, 3
  s_cbranch_scc0 L_g2_nc2
  s_cmp_eq_u32 s76, 0
  s_cbranch_scc0 L_g2_nc2
  v_cmp_eq_u32 vcc, 1, v3
  s_cmp_eq_u64 vcc, exec
  s_cbranch_scc1 L_g2_nc2
  s_mov_b32 s62, 0x40000
L_g2_p3:
  buffer_load_dword v3, v189, s[28:31], 0 offen sc1
  s_waitcnt vmcnt(0)
  v_cmp_eq_u32 vcc, 1, v3
  s_cmp_eq_u64 vcc, exec
  s_cbranch_scc1 L_g2_p3_ok
  s_sub_u32 s62, s62, 1
  s_cmp_eq_u32 s62, 0
  s_cbranch_scc1 L_g2_p3_ok
  s_sleep 1
  s_branch L_g2_p3
L_g2_p3_ok:
L_g2_nc2:
  s_barrier
  s_cmp_ge_u32 s71, 64
  s_cbranch_scc0 3f
  v_swap_b32 v138, v140
  v_swap_b32 v139, v141
  v_swap_b32 v146, v148
  v_swap_b32 v147, v149
3:
  s_add_u32 s71, s71, 4
  .p2align 3
  v_mfma_f32_16x16x32_bf16 v[8:11], v[72:75], v[136:139], v[8:11]
  v_mfma_f32_16x16x32_bf16 v[12:15], v[72:75], v[140:143], v[12:15]
  v_mfma_f32_16x16x32_bf16 v[16:19], v[76:79], v[136:139], v[16:19]
  v_mfma_f32_16x16x32_bf16 v[20:23], v[76:79], v[140:143], v[20:23]
  v_mfma_f32_16x16x32_bf16 v[24:27], v[80:83], v[136:139], v[24:27]
  v_mfma_f32_16x16x32_bf16 v[28:31], v[80:83], v[140:143], v[28:31]
  v_mfma_f32_16x16x32_bf16 v[32:35], v[84:87], v[136:139], v[32:35]
  v_mfma_f32_16x16x32_bf16 v[36:39], v[84:87], v[140:143], v[36:39]
  v_mfma_f32_16x16x32_bf16 v[40:43], v[88:91], v[136:139], v[40:43]
  v_mfma_f32_16x16x32_bf16 v[44:47], v[88:91], v[140:143], v[44:47]
  v_mfma_f32_16x16x32_bf16 v[48:51], v[92:95], v[136:139], v[48:51]
  v_mfma_f32_16x16x32_bf16 v[52:55], v[92:95], v[140:143], v[52:55]
  v_mfma_f32_16x16x32_bf16 v[56:59], v[96:99], v[136:139], v[56:59]
  v_mfma_f32_16x16x32_bf16 v[60:63], v[96:99], v[140:143], v[60:63]
  v_mfma_f32_16x16x32_bf16 v[64:67], v[100:103], v[136:139], v[64:67]
  v_mfma_f32_16x16x32_bf16 v[68:71], v[100:103], v[140:143], v[68:71]
  v_mfma_f32_16x16x32_bf16 v[8:11], v[104:107], v[144:147], v[8:11]
  v_mfma_f32_16x16x32_bf16 v[12:15], v[104:107], v[148:151], v[12:15]
  v_mfma_f32_16x16x32_bf16 v[16:19], v[108:111], v[144:147], v[16:19]
  v_mfma_f32_16x16x32_bf16 v[20:23], v[108:111], v[148:151], v[20:23]
  v_mfma_f32_16x16x32_bf16 v[24:27], v[112:115], v[144:147], v[24:27]
  v_mfma_f32_16x16x32_bf16 v[28:31], v[112:115], v[148:151], v[28:31]
  v_mfma_f32_16x16x32_bf16 v[32:35], v[116:119], v[144:147], v[32:35]
  v_mfma_f32_16x16x32_bf16 v[36:39], v[116:119], v[148:151], v[36:39]
  v_mfma_f32_16x16x32_bf16 v[40:43], v[120:123], v[144:147], v[40:43]
  v_mfma_f32_16x16x32_bf16 v[44:47], v[120:123], v[148:151], v[44:47]
  v_mfma_f32_16x16x32_bf16 v[48:51], v[124:127], v[144:147], v[48:51]
  v_mfma_f32_16x16x32_bf16 v[52:55], v[124:127], v[148:151], v[52:55]
  v_mfma_f32_16x16x32_bf16 v[56:59], v[128:131], v[144:147], v[56:59]
  v_mfma_f32_16x16x32_bf16 v[60:63], v[128:131], v[148:151], v[60:63]
  v_mfma_f32_16x16x32_bf16 v[64:67], v[132:135], v[144:147], v[64:67]
  v_mfma_f32_16x16x32_bf16 v[68:71], v[132:135], v[148:151], v[68:71]
  s_barrier
  .p2align 3
  s_add_u32 s58, s60, 4096
  buffer_load_dwordx4 v[136:139], v176, s[40:43], s60 offen offset:0 sc1
  ds_read_b64_tr_b16 v[72:73], v168 offset:0
  ds_read_b64_tr_b16 v[74:75], v168 offset:4096
  ds_read_b64_tr_b16 v[76:77], v169 offset:0
  ds_read_b64_tr_b16 v[78:79], v169 offset:4096
  buffer_load_dwordx4 v[140:143], v176, s[40:43], s60 offen offset:1024 sc1
  ds_read_b64_tr_b16 v[80:81], v170 offset:0
  ds_read_b64_tr_b16 v[82:83], v170 offset:4096
  ds_read_b64_tr_b16 v[84:85], v171 offset:0
  ds_read_b64_tr_b16 v[86:87], v171 offset:4096
  buffer_load_dwordx4 v[144:147], v176, s[40:43], s58 offen offset:0 sc1
  ds_read_b64_tr_b16 v[88:89], v172 offset:0
  ds_read_b64_tr_b16 v[90:91], v172 offset:4096
  ds_read_b64_tr_b16 v[92:93], v173 offset:0
  ds_read_b64_tr_b16 v[94:95], v173 offset:4096
  buffer_load_dwordx4 v[148:151], v176, s[40:43], s58 offen offset:1024 sc1
  s_add_u32 s60, s60, 16384
  ds_read_b64_tr_b16 v[96:97], v174 offset:0
  ds_read_b64_tr_b16 v[98:99], v174 offset:4096
  ds_read_b64_tr_b16 v[100:101], v175 offset:0
  ds_read_b64_tr_b16 v[102:103], v175 offset:4096
  s_add_u32 m0, s74, 32768
  s_add_u32 s75, s73, s72
  buffer_load_dwordx4 v177, s[64:67], s73 offen lds
  ds_read_b64_tr_b16 v[104:105], v168 offset:8192
  ds_read_b64_tr_b16 v[106:107], v168 offset:12288
  ds_read_b64_tr_b16 v[108:109], v169 offset:8192
  ds_read_b64_tr_b16 v[110:111], v169 offset:12288
  s_add_u32 m0, s74, 33792
  s_sub_u32 s68, s68, 1
  buffer_load_dwordx4 v178, s[64:67], s73 offen lds
  ds_read_b64_tr_b16 v[112:113], v170 offset:8192
  ds_read_b64_tr_b16 v[114:115], v170 offset:12288
  ds_read_b64_tr_b16 v[116:117], v171 offset:8192
  ds_read_b64_tr_b16 v[118:119], v171 offset:12288
  s_add_u32 m0, s74, 40960
  s_add_u32 s73, s73, s70
  buffer_load_dwordx4 v177, s[64:67], s75 offen lds
  ds_read_b64_tr_b16 v[120:121], v172 offset:8192
  ds_read_b64_tr_b16 v[122:123], v172 offset:12288
  ds_read_b64_tr_b16 v[124:125], v173 offset:8192
  ds_read_b64_tr_b16 v[126:127], v173 offset:12288
  s_add_u32 m0, s74, 41984
  s_cmp_eq_u32 s68, 0
  buffer_load_dwordx4 v178, s[64:67], s75 offen lds
  s_cbranch_scc0 L_bo14
  s_add_u32 s69, s69, 1
  s_mov_b32 s64, s26
  s_mov_b32 s65, s27
  s_mov_b32 s66, 7340032
  s_mov_b32 s73, s80
  s_mov_b32 s70, 917504
  s_mov_b32 s72, 196608
  s_mov_b32 s68, 4
  s_cmp_eq_u32 s69, 1
  s_cbranch_scc1 L_bo14
  s_mov_b32 s73, s81
  s_mov_b32 s70, 458752
  s_mov_b32 s72, 65536
  s_mov_b32 s68, 8
  s_cmp_eq_u32 s69, 2
  s_cbranch_scc1 L_bo14
  s_mov_b32 s73, s82
  s_mov_b32 s70, 1835008
  s_mov_b32 s72, 458752
  s_mov_b32 s68, 2
  s_cmp_eq_u32 s69, 3
  s_cbranch_scc1 L_bo14
  s_mov_b32 s66, 0
  s_mov_b32 s68, 64
L_bo14:
  ds_read_b64_tr_b16 v[128:129], v174 offset:8192
  ds_read_b64_tr_b16 v[130:131], v174 offset:12288
  ds_read_b64_tr_b16 v[132:133], v175 offset:8192
  ds_read_b64_tr_b16 v[134:135], v175 offset:12288
  s_waitcnt vmcnt(8) lgkmcnt(0)
  s_barrier
  s_cmp_ge_u32 s71, 64
  s_cbranch_scc0 3f
  v_swap_b32 v154, v156
  v_swap_b32 v155, v157
  v_swap_b32 v162, v164
  v_swap_b32 v163, v165
3:
  s_add_u32 s71, s71, 4
  .p2align 3
  v_mfma_f32_16x16x32_bf16 v[8:11], v[72:75], v[152:155], v[8:11]
  v_mfma_f32_16x16x32_bf16 v[12:15], v[72:75], v[156:159], v[12:15]
  v_mfma_f32_16x16x32_bf16 v[16:19], v[76:79], v[152:155], v[16:19]
  v_mfma_f32_16x16x32_bf16 v[20:23], v[76:79], v[156:159], v[20:23]
  v_mfma_f32_16x16x32_bf16 v[24:27], v[80:83], v[152:155], v[24:27]
  v_mfma_f32_16x16x32_bf16 v[28:31], v[80:83], v[156:159], v[28:31]
  v_mfma_f32_16x16x32_bf16 v[32:35], v[84:87], v[152:155], v[32:35]
  v_mfma_f32_16x16x32_bf16 v[36:39], v[84:87], v[156:159], v[36:39]
  v_mfma_f32_16x16x32_bf16 v[40:43], v[88:91], v[152:155], v[40:43]
  v_mfma_f32_16x16x32_bf16 v[44:47], v[88:91], v[156:159], v[44:47]
  v_mfma_f32_16x16x32_bf16 v[48:51], v[92:95], v[152:155], v[48:51]
  v_mfma_f32_16x16x32_bf16 v[52:55], v[92:95], v[156:159], v[52:55]
  v_mfma_f32_16x16x32_bf16 v[56:59], v[96:99], v[152:155], v[56:59]
  v_mfma_f32_16x16x32_bf16 v[60:63], v[96:99], v[156:159], v[60:63]
  v_mfma_f32_16x16x32_bf16 v[64:67], v[100:103], v[152:155], v[64:67]
  v_mfma_f32_16x16x32_bf16 v[68:71], v[100:103], v[156:159], v[68:71]
  v_mfma_f32_16x16x32_bf16 v[8:11], v[104:107], v[160:163], v[8:11]
  v_mfma_f32_16x16x32_bf16 v[12:15], v[104:107], v[164:167], v[12:15]
  v_mfma_f32_16x16x32_bf16 v[16:19], v[108:111], v[160:163], v[16:19]
  v_mfma_f32_16x16x32_bf16 v[20:23], v[108:111], v[164:167], v[20:23]
  v_mfma_f32_16x16x32_bf16 v[24:27], v[112:115], v[160:163], v[24:27]
  v_mfma_f32_16x16x32_bf16 v[28:31], v[112:115], v[164:167], v[28:31]
  v_mfma_f32_16x16x32_bf16 v[32:35], v[116:119], v[160:163], v[32:35]
  v_mfma_f32_16x16x32_bf16 v[36:39], v[116:119], v[164:167], v[36:39]
  v_mfma_f32_16x16x32_bf16 v[40:43], v[120:123], v[160:163], v[40:43]
  v_mfma_f32_16x16x32_bf16 v[44:47], v[120:123], v[164:167], v[44:47]
  v_mfma_f32_16x16x32_bf16 v[48:51], v[124:127], v[160:163], v[48:51]
  v_mfma_f32_16x16x32_bf16 v[52:55], v[124:127], v[164:167], v[52:55]
  v_mfma_f32_16x16x32_bf16 v[56:59], v[128:131], v[160:163], v[56:59]
  v_mfma_f32_16x16x32_bf16 v[60:63], v[128:131], v[164:167], v[60:63]
  v_mfma_f32_16x16x32_bf16 v[64:67], v[132:135], v[160:163], v[64:67]
  v_mfma_f32_16x16x32_bf16 v[68:71], v[132:135], v[164:167], v[68:71]
  s_barrier
  .p2align 3
  s_add_u32 s58, s60, 4096
  buffer_load_dwordx4 v[152:155], v176, s[40:43], s60 offen offset:0 sc1
  ds_read_b64_tr_b16 v[72:73], v168 offset:16384
  ds_read_b64_tr_b16 v[74:75], v168 offset:20480
  ds_read_b64_tr_b16 v[76:77], v169 offset:16384
  ds_read_b64_tr_b16 v[78:79], v169 offset:20480
  buffer_load_dwordx4 v[156:159], v176, s[40:43], s60 offen offset:1024 sc1
  ds_read_b64_tr_b16 v[80:81], v170 offset:16384
  ds_read_b64_tr_b16 v[82:83], v170 offset:20480
  ds_read_b64_tr_b16 v[84:85], v171 offset:16384
  ds_read_b64_tr_b16 v[86:87], v171 offset:20480
  buffer_load_dwordx4 v[160:163], v176, s[40:43], s58 offen offset:0 sc1
  ds_read_b64_tr_b16 v[88:89], v172 offset:16384
  ds_read_b64_tr_b16 v[90:91], v172 offset:20480
  ds_read_b64_tr_b16 v[92:93], v173 offset:16384
  ds_read_b64_tr_b16 v[94:95], v173 offset:20480
  buffer_load_dwordx4 v[164:167], v176, s[40:43], s58 offen offset:1024 sc1
  s_add_u32 s60, s60, 16384
  ds_read_b64_tr_b16 v[96:97], v174 offset:16384
  ds_read_b64_tr_b16 v[98:99], v174 offset:20480
  ds_read_b64_tr_b16 v[100:101], v175 offset:16384
  ds_read_b64_tr_b16 v[102:103], v175 offset:20480
  s_add_u32 m0, s74, 0
  s_add_u32 s75, s73, s72
  buffer_load_dwordx4 v177, s[64:67], s73 offen lds
  ds_read_b64_tr_b16 v[104:105], v168 offset:24576
  ds_read_b64_tr_b16 v[106:107], v168 offset:28672
  ds_read_b64_tr_b16 v[108:109], v169 offset:24576
  ds_read_b64_tr_b16 v[110:111], v169 offset:28672
  s_add_u32 m0, s74, 1024
  s_sub_u32 s68, s68, 1
  buffer_load_dwordx4 v178, s[64:67], s73 offen lds
  ds_read_b64_tr_b16 v[112:113], v170 offset:24576
  ds_read_b64_tr_b16 v[114:115], v170 offset:28672
  ds_read_b64_tr_b16 v[116:117], v171 offset:24576
  ds_read_b64_tr_b16 v[118:119], v171 offset:28672
  s_add_u32 m0, s74, 8192
  s_add_u32 s73, s73, s70
  buffer_load_dwordx4 v177, s[64:67], s75 offen lds
  ds_read_b64_tr_b16 v[120:121], v172 offset:24576
  ds_read_b64_tr_b16 v[122:123], v172 offset:28672
  ds_read_b64_tr_b16 v[124:125], v173 offset:24576
  ds_read_b64_tr_b16 v[126:127], v173 offset:28672
  s_add_u32 m0, s74, 9216
  s_cmp_eq_u32 s68, 0
  buffer_load_dwordx4 v178, s[64:67], s75 offen lds
  s_cbranch_scc0 L_bo15
  s_add_u32 s69, s69, 1
  s_mov_b32 s64, s26
  s_mov_b32 s65, s27
  s_mov_b32 s66, 7340032
  s_mov_b32 s73, s80
  s_mov_b32 s70, 917504
  s_mov_b32 s72, 196608
  s_mov_b32 s68, 4
  s_cmp_eq_u32 s69, 1
  s_cbranch_scc1 L_bo15
  s_mov_b32 s73, s81
  s_mov_b32 s70, 458752
  s_mov_b32 s72, 65536
  s_mov_b32 s68, 8
  s_cmp_eq_u32 s69, 2
  s_cbranch_scc1 L_bo15
  s_mov_b32 s73, s82
  s_mov_b32 s70, 1835008
  s_mov_b32 s72, 458752
  s_mov_b32 s68, 2
  s_cmp_eq_u32 s69, 3
  s_cbranch_scc1 L_bo15
  s_mov_b32 s66, 0
  s_mov_b32 s68, 64
L_bo15:
  ds_read_b64_tr_b16 v[128:129], v174 offset:24576
  ds_read_b64_tr_b16 v[130:131], v174 offset:28672
  ds_read_b64_tr_b16 v[132:133], v175 offset:24576
  ds_read_b64_tr_b16 v[134:135], v175 offset:28672
  s_waitcnt vmcnt(8) lgkmcnt(0)
  s_barrier
  s_cmp_ge_u32 s71, 64
  s_cbranch_scc0 3f
  v_swap_b32 v138, v140
  v_swap_b32 v139, v141
  v_swap_b32 v146, v148
  v_swap_b32 v147, v149
3:
  s_add_u32 s71, s71, 4
  .p2align 3
  v_mfma_f32_16x16x32_bf16 v[8:11], v[72:75], v[136:139], v[8:11]
  v_mfma_f32_16x16x32_bf16 v[12:15], v[72:75], v[140:143], v[12:15]
  v_mfma_f32_16x16x32_bf16 v[16:19], v[76:79], v[136:139], v[16:19]
  v_mfma_f32_16x16x32_bf16 v[20:23], v[76:79], v[140:143], v[20:23]
  v_mfma_f32_16x16x32_bf16 v[24:27], v[80:83], v[136:139], v[24:27]
  v_mfma_f32_16x16x32_bf16 v[28:31], v[80:83], v[140:143], v[28:31]
  v_mfma_f32_16x16x32_bf16 v[32:35], v[84:87], v[136:139], v[32:35]
  v_mfma_f32_16x16x32_bf16 v[36:39], v[84:87], v[140:143], v[36:39]
  v_mfma_f32_16x16x32_bf16 v[40:43], v[88:91], v[136:139], v[40:43]
  v_mfma_f32_16x16x32_bf16 v[44:47], v[88:91], v[140:143], v[44:47]
  v_mfma_f32_16x16x32_bf16 v[48:51], v[92:95], v[136:139], v[48:51]
  v_mfma_f32_16x16x32_bf16 v[52:55], v[92:95], v[140:143], v[52:55]
  v_mfma_f32_16x16x32_bf16 v[56:59], v[96:99], v[136:139], v[56:59]
  v_mfma_f32_16x16x32_bf16 v[60:63], v[96:99], v[140:143], v[60:63]
  v_mfma_f32_16x16x32_bf16 v[64:67], v[100:103], v[136:139], v[64:67]
  v_mfma_f32_16x16x32_bf16 v[68:71], v[100:103], v[140:143], v[68:71]
  v_mfma_f32_16x16x32_bf16 v[8:11], v[104:107], v[144:147], v[8:11]
  v_mfma_f32_16x16x32_bf16 v[12:15], v[104:107], v[148:151], v[12:15]
  v_mfma_f32_16x16x32_bf16 v[16:19], v[108:111], v[144:147], v[16:19]
  v_mfma_f32_16x16x32_bf16 v[20:23], v[108:111], v[148:151], v[20:23]
  v_mfma_f32_16x16x32_bf16 v[24:27], v[112:115], v[144:147], v[24:27]
  v_mfma_f32_16x16x32_bf16 v[28:31], v[112:115], v[148:151], v[28:31]
  v_mfma_f32_16x16x32_bf16 v[32:35], v[116:119], v[144:147], v[32:35]
  v_mfma_f32_16x16x32_bf16 v[36:39], v[116:119], v[148:151], v[36:39]
  v_mfma_f32_16x16x32_bf16 v[40:43], v[120:123], v[144:147], v[40:43]
  v_mfma_f32_16x16x32_bf16 v[44:47], v[120:123], v[148:151], v[44:47]
  v_mfma_f32_16x16x32_bf16 v[48:51], v[124:127], v[144:147], v[48:51]
  v_mfma_f32_16x16x32_bf16 v[52:55], v[124:127], v[148:151], v[52:55]
  v_mfma_f32_16x16x32_bf16 v[56:59], v[128:131], v[144:147], v[56:59]
  v_mfma_f32_16x16x32_bf16 v[60:63], v[128:131], v[148:151], v[60:63]
  v_mfma_f32_16x16x32_bf16 v[64:67], v[132:135], v[144:147], v[64:67]
  v_mfma_f32_16x16x32_bf16 v[68:71], v[132:135], v[148:151], v[68:71]
  s_barrier
  .p2align 3
  s_add_u32 s58, s60, 4096
  buffer_load_dwordx4 v[136:139], v176, s[40:43], s60 offen offset:0 sc1
  ds_read_b64_tr_b16 v[72:73], v168 offset:32768
  ds_read_b64_tr_b16 v[74:75], v168 offset:36864
  ds_read_b64_tr_b16 v[76:77], v169 offset:32768
  ds_read_b64_tr_b16 v[78:79], v169 offset:36864
  buffer_load_dwordx4 v[140:143], v176, s[40:43], s60 offen offset:1024 sc1
  ds_read_b64_tr_b16 v[80:81], v170 offset:32768
  ds_read_b64_tr_b16 v[82:83], v170 offset:36864
  ds_read_b64_tr_b16 v[84:85], v171 offset:32768
  ds_read_b64_tr_b16 v[86:87], v171 offset:36864
  buffer_load_dwordx4 v[144:147], v176, s[40:43], s58 offen offset:0 sc1
  ds_read_b64_tr_b16 v[88:89], v172 offset:32768
  ds_read_b64_tr_b16 v[90:91], v172 offset:36864
  ds_read_b64_tr_b16 v[92:93], v173 offset:32768
  ds_read_b64_tr_b16 v[94:95], v173 offset:36864
  buffer_load_dwordx4 v[148:151], v176, s[40:43], s58 offen offset:1024 sc1
  s_add_u32 s60, s60, 16384
  ds_read_b64_tr_b16 v[96:97], v174 offset:32768
  ds_read_b64_tr_b16 v[98:99], v174 offset:36864
  ds_read_b64_tr_b16 v[100:101], v175 offset:32768
  ds_read_b64_tr_b16 v[102:103], v175 offset:36864
  s_add_u32 m0, s74, 16384
  s_add_u32 s75, s73, s72
  buffer_load_dwordx4 v177, s[64:67], s73 offen lds
  ds_read_b64_tr_b16 v[104:105], v168 offset:40960
  ds_read_b64_tr_b16 v[106:107], v168 offset:45056
  ds_read_b64_tr_b16 v[108:109], v169 offset:40960
  ds_read_b64_tr_b16 v[110:111], v169 offset:45056
  s_add_u32 m0, s74, 17408
  s_sub_u32 s68, s68, 1
  buffer_load_dwordx4 v178, s[64:67], s73 offen lds
  ds_read_b64_tr_b16 v[112:113], v170 offset:40960
  ds_read_b64_tr_b16 v[114:115], v170 offset:45056
  ds_read_b64_tr_b16 v[116:117], v171 offset:40960
  ds_read_b64_tr_b16 v[118:119], v171 offset:45056
  s_add_u32 m0, s74, 24576
  s_add_u32 s73, s73, s70
  buffer_load_dwordx4 v177, s[64:67], s75 offen lds
  ds_read_b64_tr_b16 v[120:121], v172 offset:40960
  ds_read_b64_tr_b16 v[122:123], v172 offset:45056
  ds_read_b64_tr_b16 v[124:125], v173 offset:40960
  ds_read_b64_tr_b16 v[126:127], v173 offset:45056
  s_add_u32 m0, s74, 25600
  s_cmp_eq_u32 s68, 0
  buffer_load_dwordx4 v178, s[64:67], s75 offen lds
  s_cbranch_scc0 L_bo16
  s_add_u32 s69, s69, 1
  s_mov_b32 s64, s26
  s_mov_b32 s65, s27
  s_mov_b32 s66, 7340032
  s_mov_b32 s73, s80
  s_mov_b32 s70, 917504
  s_mov_b32 s72, 196608
  s_mov_b32 s68, 4
  s_cmp_eq_u32 s69, 1
  s_cbranch_scc1 L_bo16
  s_mov_b32 s73, s81
  s_mov_b32 s70, 458752
  s_mov_b32 s72, 65536
  s_mov_b32 s68, 8
  s_cmp_eq_u32 s69, 2
  s_cbranch_scc1 L_bo16
  s_mov_b32 s73, s82
  s_mov_b32 s70, 1835008
  s_mov_b32 s72, 458752
  s_mov_b32 s68, 2
  s_cmp_eq_u32 s69, 3
  s_cbranch_scc1 L_bo16
  s_mov_b32 s66, 0
  s_mov_b32 s68, 64
L_bo16:
  ds_read_b64_tr_b16 v[128:129], v174 offset:40960
  ds_read_b64_tr_b16 v[130:131], v174 offset:45056
  ds_read_b64_tr_b16 v[132:133], v175 offset:40960
  ds_read_b64_tr_b16 v[134:135], v175 offset:45056
  s_waitcnt vmcnt(8) lgkmcnt(0)
  s_barrier
  s_cmp_ge_u32 s71, 64
  s_cbranch_scc0 3f
  v_swap_b32 v154, v156
  v_swap_b32 v155, v157
  v_swap_b32 v162, v164
  v_swap_b32 v163, v165
3:
  s_add_u32 s71, s71, 4
  .p2align 3
  v_mfma_f32_16x16x32_bf16 v[8:11], v[72:75], v[152:155], v[8:11]
  v_mfma_f32_16x16x32_bf16 v[12:15], v[72:75], v[156:159], v[12:15]
  v_mfma_f32_16x16x32_bf16 v[16:19], v[76:79], v[152:155], v[16:19]
  v_mfma_f32_16x16x32_bf16 v[20:23], v[76:79], v[156:159], v[20:23]
  v_mfma_f32_16x16x32_bf16 v[24:27], v[80:83], v[152:155], v[24:27]
  v_mfma_f32_16x16x32_bf16 v[28:31], v[80:83], v[156:159], v[28:31]
  v_mfma_f32_16x16x32_bf16 v[32:35], v[84:87], v[152:155], v[32:35]
  v_mfma_f32_16x16x32_bf16 v[36:39], v[84:87], v[156:159], v[36:39]
  v_mfma_f32_16x16x32_bf16 v[40:43], v[88:91], v[152:155], v[40:43]
  v_mfma_f32_16x16x32_bf16 v[44:47], v[88:91], v[156:159], v[44:47]
  v_mfma_f32_16x16x32_bf16 v[48:51], v[92:95], v[152:155], v[48:51]
  v_mfma_f32_16x16x32_bf16 v[52:55], v[92:95], v[156:159], v[52:55]
  v_mfma_f32_16x16x32_bf16 v[56:59], v[96:99], v[152:155], v[56:59]
  v_mfma_f32_16x16x32_bf16 v[60:63], v[96:99], v[156:159], v[60:63]
  v_mfma_f32_16x16x32_bf16 v[64:67], v[100:103], v[152:155], v[64:67]
  v_mfma_f32_16x16x32_bf16 v[68:71], v[100:103], v[156:159], v[68:71]
  v_mfma_f32_16x16x32_bf16 v[8:11], v[104:107], v[160:163], v[8:11]
  v_mfma_f32_16x16x32_bf16 v[12:15], v[104:107], v[164:167], v[12:15]
  v_mfma_f32_16x16x32_bf16 v[16:19], v[108:111], v[160:163], v[16:19]
  v_mfma_f32_16x16x32_bf16 v[20:23], v[108:111], v[164:167], v[20:23]
  v_mfma_f32_16x16x32_bf16 v[24:27], v[112:115], v[160:163], v[24:27]
  v_mfma_f32_16x16x32_bf16 v[28:31], v[112:115], v[164:167], v[28:31]
  v_mfma_f32_16x16x32_bf16 v[32:35], v[116:119], v[160:163], v[32:35]
  v_mfma_f32_16x16x32_bf16 v[36:39], v[116:119], v[164:167], v[36:39]
  v_mfma_f32_16x16x32_bf16 v[40:43], v[120:123], v[160:163], v[40:43]
  v_mfma_f32_16x16x32_bf16 v[44:47], v[120:123], v[164:167], v[44:47]
  v_mfma_f32_16x16x32_bf16 v[48:51], v[124:127], v[160:163], v[48:51]
  v_mfma_f32_16x16x32_bf16 v[52:55], v[124:127], v[164:167], v[52:55]
  v_mfma_f32_16x16x32_bf16 v[56:59], v[128:131], v[160:163], v[56:59]
  v_mfma_f32_16x16x32_bf16 v[60:63], v[128:131], v[164:167], v[60:63]
  v_mfma_f32_16x16x32_bf16 v[64:67], v[132:135], v[160:163], v[64:67]
  v_mfma_f32_16x16x32_bf16 v[68:71], v[132:135], v[164:167], v[68:71]
  s_barrier
  s_cmp_eq_u32 s57, 1
  s_cbranch_scc1 L_g2_xlast
  .p2align 3
  s_add_u32 s58, s60, 4096
  buffer_load_dwordx4 v[152:155], v176, s[40:43], s60 offen offset:0 sc1
  ds_read_b64_tr_b16 v[72:73], v168 offset:0
  ds_read_b64_tr_b16 v[74:75], v168 offset:4096
  ds_read_b64_tr_b16 v[76:77], v169 offset:0
  ds_read_b64_tr_b16 v[78:79], v169 offset:4096
  buffer_load_dwordx4 v[156:159], v176, s[40:43], s60 offen offset:1024 sc1
  ds_read_b64_tr_b16 v[80:81], v170 offset:0
  ds_read_b64_tr_b16 v[82:83], v170 offset:4096
  ds_read_b64_tr_b16 v[84:85], v171 offset:0
  ds_read_b64_tr_b16 v[86:87], v171 offset:4096
  buffer_load_dwordx4 v[160:163], v176, s[40:43], s58 offen offset:0 sc1
  ds_read_b64_tr_b16 v[88:89], v172 offset:0
  ds_read_b64_tr_b16 v[90:91], v172 offset:4096
  ds_read_b64_tr_b16 v[92:93], v173 offset:0
  ds_read_b64_tr_b16 v[94:95], v173 offset:4096
  buffer_load_dwordx4 v[164:167], v176, s[40:43], s58 offen offset:1024 sc1
  s_add_u32 s60, s60, 16384
  ds_read_b64_tr_b16 v[96:97], v174 offset:0
  ds_read_b64_tr_b16 v[98:99], v174 offset:4096
  ds_read_b64_tr_b16 v[100:101], v175 offset:0
  ds_read_b64_tr_b16 v[102:103], v175 offset:4096
  s_add_u32 m0, s74, 32768
  s_add_u32 s75, s73, s72
  buffer_load_dwordx4 v177, s[64:67], s73 offen lds
  ds_read_b64_tr_b16 v[104:105], v168 offset:8192
  ds_read_b64_tr_b16 v[106:107], v168 offset:12288
  ds_read_b64_tr_b16 v[108:109], v169 offset:8192
  ds_read_b64_tr_b16 v[110:111], v169 offset:12288
  s_add_u32 m0, s74, 33792
  s_sub_u32 s68, s68, 1
  buffer_load_dwordx4 v178, s[64:67], s73 offen lds
  ds_read_b64_tr_b16 v[112:113], v170 offset:8192
  ds_read_b64_tr_b16 v[114:115], v170 offset:12288
  ds_read_b64_tr_b16 v[116:117], v171 offset:8192
  ds_read_b64_tr_b16 v[118:119], v171 offset:12288
  s_add_u32 m0, s74, 40960
  s_add_u32 s73, s73, s70
  buffer_load_dwordx4 v177, s[64:67], s75 offen lds
  ds_read_b64_tr_b16 v[120:121], v172 offset:8192
  ds_read_b64_tr_b16 v[122:123], v172 offset:12288
  ds_read_b64_tr_b16 v[124:125], v173 offset:8192
  ds_read_b64_tr_b16 v[126:127], v173 offset:12288
  s_add_u32 m0, s74, 41984
  s_cmp_eq_u32 s68, 0
  buffer_load_dwordx4 v178, s[64:67], s75 offen lds
  s_cbranch_scc0 L_bo17
  s_add_u32 s69, s69, 1
  s_mov_b32 s64, s26
  s_mov_b32 s65, s27
  s_mov_b32 s66, 7340032
  s_mov_b32 s73, s80
  s_mov_b32 s70, 917504
  s_mov_b32 s72, 196608
  s_mov_b32 s68, 4
  s_cmp_eq_u32 s69, 1
  s_cbranch_scc1 L_bo17
  s_mov_b32 s73, s81
  s_mov_b32 s70, 458752
  s_mov_b32 s72, 65536
  s_mov_b32 s68, 8
  s_cmp_eq_u32 s69, 2
  s_cbranch_scc1 L_bo17
  s_mov_b32 s73, s82
  s_mov_b32 s70, 1835008
  s_mov_b32 s72, 458752
  s_mov_b32 s68, 2
  s_cmp_eq_u32 s69, 3
  s_cbranch_scc1 L_bo17
  s_mov_b32 s66, 0
  s_mov_b32 s68, 64
L_bo17:
  ds_read_b64_tr_b16 v[128:129], v174 offset:8192
  ds_read_b64_tr_b16 v[130:131], v174 offset:12288
  ds_read_b64_tr_b16 v[132:133], v175 offset:8192
  ds_read_b64_tr_b16 v[134:135], v175 offset:12288
  s_waitcnt vmcnt(8) lgkmcnt(0)
  s_barrier
  s_sub_u32 s57, s57, 1
  s_branch L_g2_xl
L_g2_xlast:
  v_lshrrev_b32 v4, 4, v0
  v_lshl_add_u32 v2, v4, 3, v179
  v_add_u32 v3, 32768, v2
  buffer_load_dwordx2 v[180:181], v2, s[48:51], 0 offen offset:0
  buffer_load_dwordx2 v[182:183], v2, s[48:51], 0 offen offset:32
  buffer_load_dwordx2 v[184:185], v3, s[48:51], 0 offen offset:0
  buffer_load_dwordx2 v[186:187], v3, s[48:51], 0 offen offset:32
  s_and_b32 s16, s76, 3
  s_lshl_b32 s16, s16, 13
  s_add_u32 s16, s16, 98304
  v_add_u32 v3, s16, v188
  ds_write_b128 v3, v[40:43] offset:0
  ds_write_b128 v3, v[44:47] offset:1024
  ds_write_b128 v3, v[48:51] offset:2048
  ds_write_b128 v3, v[52:55] offset:3072
  ds_write_b128 v3, v[56:59] offset:4096
  ds_write_b128 v3, v[60:63] offset:5120
  ds_write_b128 v3, v[64:67] offset:6144
  ds_write_b128 v3, v[68:71] offset:7168
  s_waitcnt lgkmcnt(0)
  s_barrier
  ds_read_b128 v[104:107], v3 offset:32768
  ds_read_b128 v[108:111], v3 offset:33792
  ds_read_b128 v[112:115], v3 offset:34816
  ds_read_b128 v[116:119], v3 offset:35840
  ds_read_b128 v[120:123], v3 offset:36864
  ds_read_b128 v[124:127], v3 offset:37888
  ds_read_b128 v[128:131], v3 offset:38912
  ds_read_b128 v[132:135], v3 offset:39936
  s_waitcnt lgkmcnt(7)
  v_add_f32 v72, v8, v104
  v_add_f32 v73, v9, v105
  v_add_f32 v74, v10, v106
  v_add_f32 v75, v11, v107
  s_waitcnt lgkmcnt(6)
  v_add_f32 v76, v12, v108
  v_add_f32 v77, v13, v109
  v_add_f32 v78, v14, v110
  v_add_f32 v79, v15, v111
  s_waitcnt lgkmcnt(5)
  v_add_f32 v80, v16, v112
  v_add_f32 v81, v17, v113
  v_add_f32 v82, v18, v114
  v_add_f32 v83, v19, v115
  s_waitcnt lgkmcnt(4)
  v_add_f32 v84, v20, v116
  v_add_f32 v85, v21, v117
  v_add_f32 v86, v22, v118
  v_add_f32 v87, v23, v119
  s_waitcnt lgkmcnt(3)
  v_add_f32 v88, v24, v120
  v_add_f32 v89, v25, v121
  v_add_f32 v90, v26, v122
  v_add_f32 v91, v27, v123
  s_waitcnt lgkmcnt(2)
  v_add_f32 v92, v28, v124
  v_add_f32 v93, v29, v125
  v_add_f32 v94, v30, v126
  v_add_f32 v95, v31, v127
  s_waitcnt lgkmcnt(1)
  v_add_f32 v96, v32, v128
  v_add_f32 v97, v33, v129
  v_add_f32 v98, v34, v130
  v_add_f32 v99, v35, v131
  s_waitcnt lgkmcnt(0)
  v_add_f32 v100, v36, v132
  v_add_f32 v101, v37, v133
  v_add_f32 v102, v38, v134
  v_add_f32 v103, v39, v135
  s_branch L_g2_x
L_g2_Y:
  s_waitcnt vmcnt(4)
  s_barrier
  s_mov_b32 s57, 3
  .p2align 6
L_g2_yl:
  .p2align 3
  s_add_u32 s58, s60, 4096
  buffer_load_dwordx4 v[152:155], v176, s[40:43], s60 offen offset:0 sc1
  ds_read_b64_tr_b16 v[72:73], v168 offset:0
  ds_read_b64_tr_b16 v[74:75], v168 offset:4096
  ds_read_b64_tr_b16 v[76:77], v169 offset:0
  ds_read_b64_tr_b16 v[78:79], v169 offset:4096
  buffer_load_dwordx4 v[156:159], v176, s[40:43], s60 offen offset:1024 sc1
  ds_read_b64_tr_b16 v[80:81], v170 offset:0
  ds_read_b64_tr_b16 v[82:83], v170 offset:4096
  ds_read_b64_tr_b16 v[84:85], v171 offset:0
  ds_read_b64_tr_b16 v[86:87], v171 offset:4096
  buffer_load_dwordx4 v[160:163], v176, s[40:43], s58 offen offset:0 sc1
  ds_read_b64_tr_b16 v[88:89], v172 offset:0
  ds_read_b64_tr_b16 v[90:91], v172 offset:4096
  ds_read_b64_tr_b16 v[92:93], v173 offset:0
  ds_read_b64_tr_b16 v[94:95], v173 offset:4096
  buffer_load_dwordx4 v[164:167], v176, s[40:43], s58 offen offset:1024 sc1
  s_add_u32 s60, s60, 16384
  ds_read_b64_tr_b16 v[96:97], v174 offset:0
  ds_read_b64_tr_b16 v[98:99], v174 offset:4096
  ds_read_b64_tr_b16 v[100:101], v175 offset:0
  ds_read_b64_tr_b16 v[102:103], v175 offset:4096
  s_add_u32 m0, s74, 32768
  s_add_u32 s75, s73, s72
  buffer_load_dwordx4 v177, s[64:67], s73 offen lds
  ds_read_b64_tr_b16 v[104:105], v168 offset:8192
  ds_read_b64_tr_b16 v[106:107], v168 offset:12288
  ds_read_b64_tr_b16 v[108:109], v169 offset:8192
  ds_read_b64_tr_b16 v[110:111], v169 offset:12288
  s_add_u32 m0, s74, 33792
  s_sub_u32 s68, s68, 1
  buffer_load_dwordx4 v178, s[64:67], s73 offen lds
  ds_read_b64_tr_b16 v[112:113], v170 offset:8192
  ds_read_b64_tr_b16 v[114:115], v170 offset:12288
  ds_read_b64_tr_b16 v[116:117], v171 offset:8192
  ds_read_b64_tr_b16 v[118:119], v171 offset:12288
  s_add_u32 m0, s74, 40960
  s_add_u32 s73, s73, s70
  buffer_load_dwordx4 v177, s[64:67], s75 offen lds
  ds_read_b64_tr_b16 v[120:121], v172 offset:8192
  ds_read_b64_tr_b16 v[122:123], v172 offset:12288
  ds_read_b64_tr_b16 v[124:125], v173 offset:8192
  ds_read_b64_tr_b16 v[126:127], v173 offset:12288
  s_add_u32 m0, s74, 41984
  s_cmp_eq_u32 s68, 0
  buffer_load_dwordx4 v178, s[64:67], s75 offen lds
  s_cbranch_scc0 L_bo18
  s_add_u32 s69, s69, 1
  s_mov_b32 s64, s26
  s_mov_b32 s65, s27
  s_mov_b32 s66, 7340032
  s_mov_b32 s73, s80
  s_mov_b32 s70, 917504
  s_mov_b32 s72, 196608
  s_mov_b32 s68, 4
  s_cmp_eq_u32 s69, 1
  s_cbranch_scc1 L_bo18
  s_mov_b32 s73, s81
  s_mov_b32 s70, 458752
  s_mov_b32 s72, 65536
  s_mov_b32 s68, 8
  s_cmp_eq_u32 s69, 2
  s_cbranch_scc1 L_bo18
  s_mov_b32 s73, s82
  s_mov_b32 s70, 1835008
  s_mov_b32 s72, 458752
  s_mov_b32 s68, 2
  s_cmp_eq_u32 s69, 3
  s_cbranch_scc1 L_bo18
  s_mov_b32 s66, 0
  s_mov_b32 s68, 64
L_bo18:
  ds_read_b64_tr_b16 v[128:129], v174 offset:8192
  ds_read_b64_tr_b16 v[130:131], v174 offset:12288
  ds_read_b64_tr_b16 v[132:133], v175 offset:8192
  ds_read_b64_tr_b16 v[134:135], v175 offset:12288
  s_cmp_eq_u32 s57, 3
  s_cbranch_scc0 L_g2_nf
  s_cmp_eq_u32 s76, 4
  s_cbranch_scc0 L_g2_nf
  s_lshl_b32 s12, s79, 7
  s_lshl_b32 s13, s78, 2
  s_add_u32 s12, s12, s13
  s_add_u32 s12, s12, 16384
  v_mov_b32 v2, s12
  v_mov_b32 v3, 1
  s_mov_b64 exec, 1
  buffer_store_dword v3, v2, s[28:31], 0 offen sc1
  s_mov_b64 exec, -1
L_g2_nf:
  s_waitcnt vmcnt(8) lgkmcnt(0)
  s_barrier
  s_cmp_ge_u32 s71, 64
  s_cbranch_scc0 3f
  v_swap_b32 v138, v140
  v_swap_b32 v139, v141
  v_swap_b32 v146, v148
  v_swap_b32 v147, v149
3:
  s_add_u32 s71, s71, 4
  .p2align 3
  v_mfma_f32_16x16x32_bf16 v[8:11], v[72:75], v[136:139], v[8:11]
  v_mfma_f32_16x16x32_bf16 v[12:15], v[72:75], v[140:143], v[12:15]
  v_mfma_f32_16x16x32_bf16 v[16:19], v[76:79], v[136:139], v[16:19]
  v_mfma_f32_16x16x32_bf16 v[20:23], v[76:79], v[140:143], v[20:23]
  v_mfma_f32_16x16x32_bf16 v[24:27], v[80:83], v[136:139], v[24:27]
  v_mfma_f32_16x16x32_bf16 v[28:31], v[80:83], v[140:143], v[28:31]
  v_mfma_f32_16x16x32_bf16 v[32:35], v[84:87], v[136:139], v[32:35]
  v_mfma_f32_16x16x32_bf16 v[36:39], v[84:87], v[140:143], v[36:39]
  v_mfma_f32_16x16x32_bf16 v[40:43], v[88:91], v[136:139], v[40:43]
  v_mfma_f32_16x16x32_bf16 v[44:47], v[88:91], v[140:143], v[44:47]
  v_mfma_f32_16x16x32_bf16 v[48:51], v[92:95], v[136:139], v[48:51]
  v_mfma_f32_16x16x32_bf16 v[52:55], v[92:95], v[140:143], v[52:55]
  v_mfma_f32_16x16x32_bf16 v[56:59], v[96:99], v[136:139], v[56:59]
  v_mfma_f32_16x16x32_bf16 v[60:63], v[96:99], v[140:143], v[60:63]
  v_mfma_f32_16x16x32_bf16 v[64:67], v[100:103], v[136:139], v[64:67]
  v_mfma_f32_16x16x32_bf16 v[68:71], v[100:103], v[140:143], v[68:71]
  v_mfma_f32_16x16x32_bf16 v[8:11], v[104:107], v[144:147], v[8:11]
  v_mfma_f32_16x16x32_bf16 v[12:15], v[104:107], v[148:151], v[12:15]
  v_mfma_f32_16x16x32_bf16 v[16:19], v[108:111], v[144:147], v[16:19]
  v_mfma_f32_16x16x32_bf16 v[20:23], v[108:111], v[148:151], v[20:23]
  v_mfma_f32_16x16x32_bf16 v[24:27], v[112:115], v[144:147], v[24:27]
  v_mfma_f32_16x16x32_bf16 v[28:31], v[112:115], v[148:151], v[28:31]
  v_mfma_f32_16x16x32_bf16 v[32:35], v[116:119], v[144:147], v[32:35]
  v_mfma_f32_16x16x32_bf16 v[36:39], v[116:119], v[148:151], v[36:39]
  v_mfma_f32_16x16x32_bf16 v[40:43], v[120:123], v[144:147], v[40:43]
  v_mfma_f32_16x16x32_bf16 v[44:47], v[120:123], v[148:151], v[44:47]
  v_mfma_f32_16x16x32_bf16 v[48:51], v[124:127], v[144:147], v[48:51]
  v_mfma_f32_16x16x32_bf16 v[52:55], v[124:127], v[148:151], v[52:55]
  v_mfma_f32_16x16x32_bf16 v[56:59], v[128:131], v[144:147], v[56:59]
  v_mfma_f32_16x16x32_bf16 v[60:63], v[128:131], v[148:151], v[60:63]
  v_mfma_f32_16x16x32_bf16 v[64:67], v[132:135], v[144:147], v[64:67]
  v_mfma_f32_16x16x32_bf16 v[68:71], v[132:135], v[148:151], v[68:71]
  s_barrier
  .p2align 3
  s_add_u32 s58, s60, 4096
  buffer_load_dwordx4 v[136:139], v176, s[40:43], s60 offen offset:0 sc1
  ds_read_b64_tr_b16 v[72:73], v168 offset:16384
  ds_read_b64_tr_b16 v[74:75], v168 offset:20480
  ds_read_b64_tr_b16 v[76:77], v169 offset:16384
  ds_read_b64_tr_b16 v[78:79], v169 offset:20480
  buffer_load_dwordx4 v[140:143], v176, s[40:43], s60 offen offset:1024 sc1
  ds_read_b64_tr_b16 v[80:81], v170 offset:16384
  ds_read_b64_tr_b16 v[82:83], v170 offset:20480
  ds_read_b64_tr_b16 v[84:85], v171 offset:16384
  ds_read_b64_tr_b16 v[86:87], v171 offset:20480
  buffer_load_dwordx4 v[144:147], v176, s[40:43], s58 offen offset:0 sc1
  ds_read_b64_tr_b16 v[88:89], v172 offset:16384
  ds_read_b64_tr_b16 v[90:91], v172 offset:20480
  ds_read_b64_tr_b16 v[92:93], v173 offset:16384
  ds_read_b64_tr_b16 v[94:95], v173 offset:20480
  buffer_load_dwordx4 v[148:151], v176, s[40:43], s58 offen offset:1024 sc1
  s_add_u32 s60, s60, 16384
  ds_read_b64_tr_b16 v[96:97], v174 offset:16384
  ds_read_b64_tr_b16 v[98:99], v174 offset:20480
  ds_read_b64_tr_b16 v[100:101], v175 offset:16384
  ds_read_b64_tr_b16 v[102:103], v175 offset:20480
  s_add_u32 m0, s74, 0
  s_add_u32 s75, s73, s72
  buffer_load_dwordx4 v177, s[64:67], s73 offen lds
  ds_read_b64_tr_b16 v[104:105], v168 offset:24576
  ds_read_b64_tr_b16 v[106:107], v168 offset:28672
  ds_read_b64_tr_b16 v[108:109], v169 offset:24576
  ds_read_b64_tr_b16 v[110:111], v169 offset:28672
  s_add_u32 m0, s74, 1024
  s_sub_u32 s68, s68, 1
  buffer_load_dwordx4 v178, s[64:67], s73 offen lds
  ds_read_b64_tr_b16 v[112:113], v170 offset:24576
  ds_read_b64_tr_b16 v[114:115], v170 offset:28672
  ds_read_b64_tr_b16 v[116:117], v171 offset:24576
  ds_read_b64_tr_b16 v[118:119], v171 offset:28672
  s_add_u32 m0, s74, 8192
  s_add_u32 s73, s73, s70
  buffer_load_dwordx4 v177, s[64:67], s75 offen lds
  ds_read_b64_tr_b16 v[120:121], v172 offset:24576
  ds_read_b64_tr_b16 v[122:123], v172 offset:28672
  ds_read_b64_tr_b16 v[124:125], v173 offset:24576
  ds_read_b64_tr_b16 v[126:127], v173 offset:28672
  s_add_u32 m0, s74, 9216
  s_cmp_eq_u32 s68, 0
  buffer_load_dwordx4 v178, s[64:67], s75 offen lds
  s_cbranch_scc0 L_bo19
  s_add_u32 s69, s69, 1
  s_mov_b32 s64, s26
  s_mov_b32 s65, s27
  s_mov_b32 s66, 7340032
  s_mov_b32 s73, s80
  s_mov_b32 s70, 917504
  s_mov_b32 s72, 196608
  s_mov_b32 s68, 4
  s_cmp_eq_u32 s69, 1
  s_cbranch_scc1 L_bo19
  s_mov_b32 s73, s81
  s_mov_b32 s70, 458752
  s_mov_b32 s72, 65536
  s_mov_b32 s68, 8
  s_cmp_eq_u32 s69, 2
  s_cbranch_scc1 L_bo19
  s_mov_b32 s73, s82
  s_mov_b32 s70, 1835008
  s_mov_b32 s72, 458752
  s_mov_b32 s68, 2
  s_cmp_eq_u32 s69, 3
  s_cbranch_scc1 L_bo19
  s_mov_b32 s66, 0
  s_mov_b32 s68, 64
L_bo19:
  ds_read_b64_tr_b16 v[128:129], v174 offset:24576
  ds_read_b64_tr_b16 v[130:131], v174 offset:28672
  ds_read_b64_tr_b16 v[132:133], v175 offset:24576
  ds_read_b64_tr_b16 v[134:135], v175 offset:28672
  s_waitcnt vmcnt(8) lgkmcnt(0)
  s_barrier
  s_cmp_ge_u32 s71, 64
  s_cbranch_scc0 3f
  v_swap_b32 v154, v156
  v_swap_b32 v155, v157
  v_swap_b32 v162, v164
  v_swap_b32 v163, v165
3:
  s_add_u32 s71, s71, 4
  .p2align 3
  v_mfma_f32_16x16x32_bf16 v[8:11], v[72:75], v[152:155], v[8:11]
  v_mfma_f32_16x16x32_bf16 v[12:15], v[72:75], v[156:159], v[12:15]
  v_mfma_f32_16x16x32_bf16 v[16:19], v[76:79], v[152:155], v[16:19]
  v_mfma_f32_16x16x32_bf16 v[20:23], v[76:79], v[156:159], v[20:23]
  v_mfma_f32_16x16x32_bf16 v[24:27], v[80:83], v[152:155], v[24:27]
  v_mfma_f32_16x16x32_bf16 v[28:31], v[80:83], v[156:159], v[28:31]
  v_mfma_f32_16x16x32_bf16 v[32:35], v[84:87], v[152:155], v[32:35]
  v_mfma_f32_16x16x32_bf16 v[36:39], v[84:87], v[156:159], v[36:39]
  v_mfma_f32_16x16x32_bf16 v[40:43], v[88:91], v[152:155], v[40:43]
  v_mfma_f32_16x16x32_bf16 v[44:47], v[88:91], v[156:159], v[44:47]
  v_mfma_f32_16x16x32_bf16 v[48:51], v[92:95], v[152:155], v[48:51]
  v_mfma_f32_16x16x32_bf16 v[52:55], v[92:95], v[156:159], v[52:55]
  v_mfma_f32_16x16x32_bf16 v[56:59], v[96:99], v[152:155], v[56:59]
  v_mfma_f32_16x16x32_bf16 v[60:63], v[96:99], v[156:159], v[60:63]
  v_mfma_f32_16x16x32_bf16 v[64:67], v[100:103], v[152:155], v[64:67]
  v_mfma_f32_16x16x32_bf16 v[68:71], v[100:103], v[156:159], v[68:71]
  v_mfma_f32_16x16x32_bf16 v[8:11], v[104:107], v[160:163], v[8:11]
  v_mfma_f32_16x16x32_bf16 v[12:15], v[104:107], v[164:167], v[12:15]
  v_mfma_f32_16x16x32_bf16 v[16:19], v[108:111], v[160:163], v[16:19]
  v_mfma_f32_16x16x32_bf16 v[20:23], v[108:111], v[164:167], v[20:23]
  v_mfma_f32_16x16x32_bf16 v[24:27], v[112:115], v[160:163], v[24:27]
  v_mfma_f32_16x16x32_bf16 v[28:31], v[112:115], v[164:167], v[28:31]
  v_mfma_f32_16x16x32_bf16 v[32:35], v[116:119], v[160:163], v[32:35]
  v_mfma_f32_16x16x32_bf16 v[36:39], v[116:119], v[164:167], v[36:39]
  v_mfma_f32_16x16x32_bf16 v[40:43], v[120:123], v[160:163], v[40:43]
  v_mfma_f32_16x16x32_bf16 v[44:47], v[120:123], v[164:167], v[44:47]
  v_mfma_f32_16x16x32_bf16 v[48:51], v[124:127], v[160:163], v[48:51]
  v_mfma_f32_16x16x32_bf16 v[52:55], v[124:127], v[164:167], v[52:55]
  v_mfma_f32_16x16x32_bf16 v[56:59], v[128:131], v[160:163], v[56:59]
  v_mfma_f32_16x16x32_bf16 v[60:63], v[128:131], v[164:167], v[60:63]
  v_mfma_f32_16x16x32_bf16 v[64:67], v[132:135], v[160:163], v[64:67]
  v_mfma_f32_16x16x32_bf16 v[68:71], v[132:135], v[164:167], v[68:71]
  s_barrier
  .p2align 3
  s_add_u32 s58, s60, 4096
  buffer_load_dwordx4 v[152:155], v176, s[40:43], s60 offen offset:0 sc1
  ds_read_b64_tr_b16 v[72:73], v168 offset:32768
  ds_read_b64_tr_b16 v[74:75], v168 offset:36864
  ds_read_b64_tr_b16 v[76:77], v169 offset:32768
  ds_read_b64_tr_b16 v[78:79], v169 offset:36864
  buffer_load_dwordx4 v[156:159], v176, s[40:43], s60 offen offset:1024 sc1
  ds_read_b64_tr_b16 v[80:81], v170 offset:32768
  ds_read_b64_tr_b16 v[82:83], v170 offset:36864
  ds_read_b64_tr_b16 v[84:85], v171 offset:32768
  ds_read_b64_tr_b16 v[86:87], v171 offset:36864
  buffer_load_dwordx4 v[160:163], v176, s[40:43], s58 offen offset:0 sc1
  ds_read_b64_tr_b16 v[88:89], v172 offset:32768
  ds_read_b64_tr_b16 v[90:91], v172 offset:36864
  ds_read_b64_tr_b16 v[92:93], v173 offset:32768
  ds_read_b64_tr_b16 v[94:95], v173 offset:36864
  buffer_load_dwordx4 v[164:167], v176, s[40:43], s58 offen offset:1024 sc1
  s_add_u32 s60, s60, 16384
  ds_read_b64_tr_b16 v[96:97], v174 offset:32768
  ds_read_b64_tr_b16 v[98:99], v174 offset:36864
  ds_read_b64_tr_b16 v[100:101], v175 offset:32768
  ds_read_b64_tr_b16 v[102:103], v175 offset:36864
  s_add_u32 m0, s74, 16384
  s_add_u32 s75, s73, s72
  buffer_load_dwordx4 v177, s[64:67], s73 offen lds
  ds_read_b64_tr_b16 v[104:105], v168 offset:40960
  ds_read_b64_tr_b16 v[106:107], v168 offset:45056
  ds_read_b64_tr_b16 v[108:109], v169 offset:40960
  ds_read_b64_tr_b16 v[110:111], v169 offset:45056
  s_add_u32 m0, s74, 17408
  s_sub_u32 s68, s68, 1
  buffer_load_dwordx4 v178, s[64:67], s73 offen lds
  ds_read_b64_tr_b16 v[112:113], v170 offset:40960
  ds_read_b64_tr_b16 v[114:115], v170 offset:45056
  ds_read_b64_tr_b16 v[116:117], v171 offset:40960
  ds_read_b64_tr_b16 v[118:119], v171 offset:45056
  s_add_u32 m0, s74, 24576
  s_add_u32 s73, s73, s70
  buffer_load_dwordx4 v177, s[64:67], s75 offen lds
  ds_read_b64_tr_b16 v[120:121], v172 offset:40960
  ds_read_b64_tr_b16 v[122:123], v172 offset:45056
  ds_read_b64_tr_b16 v[124:125], v173 offset:40960
  ds_read_b64_tr_b16 v[126:127], v173 offset:45056
  s_add_u32 m0, s74, 25600
  s_cmp_eq_u32 s68, 0
  buffer_load_dwordx4 v178, s[64:67], s75 offen lds
  s_cbranch_scc0 L_bo20
  s_add_u32 s69, s69, 1
  s_mov_b32 s64, s26
  s_mov_b32 s65, s27
  s_mov_b32 s66, 7340032
  s_mov_b32 s73, s80
  s_mov_b32 s70, 917504
  s_mov_b32 s72, 196608
  s_mov_b32 s68, 4
  s_cmp_eq_u32 s69, 1
  s_cbranch_scc1 L_bo20
  s_mov_b32 s73, s81
  s_mov_b32 s70, 458752
  s_mov_b32 s72, 65536
  s_mov_b32 s68, 8
  s_cmp_eq_u32 s69, 2
  s_cbranch_scc1 L_bo20
  s_mov_b32 s73, s82
  s_mov_b32 s70, 1835008
  s_mov_b32 s72, 458752
  s_mov_b32 s68, 2
  s_cmp_eq_u32 s69, 3
  s_cbranch_scc1 L_bo20
  s_mov_b32 s66, 0
  s_mov_b32 s68, 64
L_bo20:
  ds_read_b64_tr_b16 v[128:129], v174 offset:40960
  ds_read_b64_tr_b16 v[130:131], v174 offset:45056
  ds_read_b64_tr_b16 v[132:133], v175 offset:40960
  ds_read_b64_tr_b16 v[134:135], v175 offset:45056
  s_waitcnt vmcnt(8) lgkmcnt(0)
  s_barrier
  s_cmp_ge_u32 s71, 64
  s_cbranch_scc0 3f
  v_swap_b32 v138, v140
  v_swap_b32 v139, v141
  v_swap_b32 v146, v148
  v_swap_b32 v147, v149
3:
  s_add_u32 s71, s71, 4
  .p2align 3
  v_mfma_f32_16x16x32_bf16 v[8:11], v[72:75], v[136:139], v[8:11]
  v_mfma_f32_16x16x32_bf16 v[12:15], v[72:75], v[140:143], v[12:15]
  v_mfma_f32_16x16x32_bf16 v[16:19], v[76:79], v[136:139], v[16:19]
  v_mfma_f32_16x16x32_bf16 v[20:23], v[76:79], v[140:143], v[20:23]
  v_mfma_f32_16x16x32_bf16 v[24:27], v[80:83], v[136:139], v[24:27]
  v_mfma_f32_16x16x32_bf16 v[28:31], v[80:83], v[140:143], v[28:31]
  v_mfma_f32_16x16x32_bf16 v[32:35], v[84:87], v[136:139], v[32:35]
  v_mfma_f32_16x16x32_bf16 v[36:39], v[84:87], v[140:143], v[36:39]
  v_mfma_f32_16x16x32_bf16 v[40:43], v[88:91], v[136:139], v[40:43]
  v_mfma_f32_16x16x32_bf16 v[44:47], v[88:91], v[140:143], v[44:47]
  v_mfma_f32_16x16x32_bf16 v[48:51], v[92:95], v[136:139], v[48:51]
  v_mfma_f32_16x16x32_bf16 v[52:55], v[92:95], v[140:143], v[52:55]
  v_mfma_f32_16x16x32_bf16 v[56:59], v[96:99], v[136:139], v[56:59]
  v_mfma_f32_16x16x32_bf16 v[60:63], v[96:99], v[140:143], v[60:63]
  v_mfma_f32_16x16x32_bf16 v[64:67], v[100:103], v[136:139], v[64:67]
  v_mfma_f32_16x16x32_bf16 v[68:71], v[100:103], v[140:143], v[68:71]
  v_mfma_f32_16x16x32_bf16 v[8:11], v[104:107], v[144:147], v[8:11]
  v_mfma_f32_16x16x32_bf16 v[12:15], v[104:107], v[148:151], v[12:15]
  v_mfma_f32_16x16x32_bf16 v[16:19], v[108:111], v[144:147], v[16:19]
  v_mfma_f32_16x16x32_bf16 v[20:23], v[108:111], v[148:151], v[20:23]
  v_mfma_f32_16x16x32_bf16 v[24:27], v[112:115], v[144:147], v[24:27]
  v_mfma_f32_16x16x32_bf16 v[28:31], v[112:115], v[148:151], v[28:31]
  v_mfma_f32_16x16x32_bf16 v[32:35], v[116:119], v[144:147], v[32:35]
  v_mfma_f32_16x16x32_bf16 v[36:39], v[116:119], v[148:151], v[36:39]
  v_mfma_f32_16x16x32_bf16 v[40:43], v[120:123], v[144:147], v[40:43]
  v_mfma_f32_16x16x32_bf16 v[44:47], v[120:123], v[148:151], v[44:47]
  v_mfma_f32_16x16x32_bf16 v[48:51], v[124:127], v[144:147], v[48:51]
  v_mfma_f32_16x16x32_bf16 v[52:55], v[124:127], v[148:151], v[52:55]
  v_mfma_f32_16x16x32_bf16 v[56:59], v[128:131], v[144:147], v[56:59]
  v_mfma_f32_16x16x32_bf16 v[60:63], v[128:131], v[148:151], v[60:63]
  v_mfma_f32_16x16x32_bf16 v[64:67], v[132:135], v[144:147], v[64:67]
  v_mfma_f32_16x16x32_bf16 v[68:71], v[132:135], v[148:151], v[68:71]
  s_barrier
  .p2align 3
  s_add_u32 s58, s60, 4096
  buffer_load_dwordx4 v[136:139], v176, s[40:43], s60 offen offset:0 sc1
  ds_read_b64_tr_b16 v[72:73], v168 offset:0
  ds_read_b64_tr_b16 v[74:75], v168 offset:4096
  ds_read_b64_tr_b16 v[76:77], v169 offset:0
  ds_read_b64_tr_b16 v[78:79], v169 offset:4096
  buffer_load_dwordx4 v[140:143], v176, s[40:43], s60 offen offset:1024 sc1
  ds_read_b64_tr_b16 v[80:81], v170 offset:0
  ds_read_b64_tr_b16 v[82:83], v170 offset:4096
  ds_read_b64_tr_b16 v[84:85], v171 offset:0
  ds_read_b64_tr_b16 v[86:87], v171 offset:4096
  buffer_load_dwordx4 v[144:147], v176, s[40:43], s58 offen offset:0 sc1
  ds_read_b64_tr_b16 v[88:89], v172 offset:0
  ds_read_b64_tr_b16 v[90:91], v172 offset:4096
  ds_read_b64_tr_b16 v[92:93], v173 offset:0
  ds_read_b64_tr_b16 v[94:95], v173 offset:4096
  buffer_load_dwordx4 v[148:151], v176, s[40:43], s58 offen offset:1024 sc1
  s_add_u32 s60, s60, 16384
  ds_read_b64_tr_b16 v[96:97], v174 offset:0
  ds_read_b64_tr_b16 v[98:99], v174 offset:4096
  ds_read_b64_tr_b16 v[100:101], v175 offset:0
  ds_read_b64_tr_b16 v[102:103], v175 offset:4096
  s_add_u32 m0, s74, 32768
  s_add_u32 s75, s73, s72
  buffer_load_dwordx4 v177, s[64:67], s73 offen lds
  ds_read_b64_tr_b16 v[104:105], v168 offset:8192
  ds_read_b64_tr_b16 v[106:107], v168 offset:12288
  ds_read_b64_tr_b16 v[108:109], v169 offset:8192
  ds_read_b64_tr_b16 v[110:111], v169 offset:12288
  s_add_u32 m0, s74, 33792
  s_sub_u32 s68, s68, 1
  buffer_load_dwordx4 v178, s[64:67], s73 offen lds
  ds_read_b64_tr_b16 v[112:113], v170 offset:8192
  ds_read_b64_tr_b16 v[114:115], v170 offset:12288
  ds_read_b64_tr_b16 v[116:117], v171 offset:8192
  ds_read_b64_tr_b16 v[118:119], v171 offset:12288
  s_add_u32 m0, s74, 40960
  s_add_u32 s73, s73, s70
  buffer_load_dwordx4 v177, s[64:67], s75 offen lds
  ds_read_b64_tr_b16 v[120:121], v172 offset:8192
  ds_read_b64_tr_b16 v[122:123], v172 offset:12288
  ds_read_b64_tr_b16 v[124:125], v173 offset:8192
  ds_read_b64_tr_b16 v[126:127], v173 offset:12288
  s_add_u32 m0, s74, 41984
  s_cmp_eq_u32 s68, 0
  buffer_load_dwordx4 v178, s[64:67], s75 offen lds
  s_cbranch_scc0 L_bo21
  s_add_u32 s69, s69, 1
  s_mov_b32 s64, s26
  s_mov_b32 s65, s27
  s_mov_b32 s66, 7340032
  s_mov_b32 s73, s80
  s_mov_b32 s70, 917504
  s_mov_b32 s72, 196608
  s_mov_b32 s68, 4
  s_cmp_eq_u32 s69, 1
  s_cbranch_scc1 L_bo21
  s_mov_b32 s73, s81
  s_mov_b32 s70, 458752
  s_mov_b32 s72, 65536
  s_mov_b32 s68, 8
  s_cmp_eq_u32 s69, 2
  s_cbranch_scc1 L_bo21
  s_mov_b32 s73, s82
  s_mov_b32 s70, 1835008
  s_mov_b32 s72, 458752
  s_mov_b32 s68, 2
  s_cmp_eq_u32 s69, 3
  s_cbranch_scc1 L_bo21
  s_mov_b32 s66, 0
  s_mov_b32 s68, 64
L_bo21:
  ds_read_b64_tr_b16 v[128:129], v174 offset:8192
  ds_read_b64_tr_b16 v[130:131], v174 offset:12288
  ds_read_b64_tr_b16 v[132:133], v175 offset:8192
  ds_read_b64_tr_b16 v[134:135], v175 offset:12288
  s_waitcnt vmcnt(8) lgkmcnt(0)
  s_barrier
  s_cmp_ge_u32 s71, 64
  s_cbranch_scc0 3f
  v_swap_b32 v154, v156
  v_swap_b32 v155, v157
  v_swap_b32 v162, v164
  v_swap_b32 v163, v165
3:
  s_add_u32 s71, s71, 4
  .p2align 3
  v_mfma_f32_16x16x32_bf16 v[8:11], v[72:75], v[152:155], v[8:11]
  v_mfma_f32_16x16x32_bf16 v[12:15], v[72:75], v[156:159], v[12:15]
  v_mfma_f32_16x16x32_bf16 v[16:19], v[76:79], v[152:155], v[16:19]
  v_mfma_f32_16x16x32_bf16 v[20:23], v[76:79], v[156:159], v[20:23]
  v_mfma_f32_16x16x32_bf16 v[24:27], v[80:83], v[152:155], v[24:27]
  v_mfma_f32_16x16x32_bf16 v[28:31], v[80:83], v[156:159], v[28:31]
  v_mfma_f32_16x16x32_bf16 v[32:35], v[84:87], v[152:155], v[32:35]
  v_mfma_f32_16x16x32_bf16 v[36:39], v[84:87], v[156:159], v[36:39]
  v_mfma_f32_16x16x32_bf16 v[40:43], v[88:91], v[152:155], v[40:43]
  v_mfma_f32_16x16x32_bf16 v[44:47], v[88:91], v[156:159], v[44:47]
  v_mfma_f32_16x16x32_bf16 v[48:51], v[92:95], v[152:155], v[48:51]
  v_mfma_f32_16x16x32_bf16 v[52:55], v[92:95], v[156:159], v[52:55]
  v_mfma_f32_16x16x32_bf16 v[56:59], v[96:99], v[152:155], v[56:59]
  v_mfma_f32_16x16x32_bf16 v[60:63], v[96:99], v[156:159], v[60:63]
  v_mfma_f32_16x16x32_bf16 v[64:67], v[100:103], v[152:155], v[64:67]
  v_mfma_f32_16x16x32_bf16 v[68:71], v[100:103], v[156:159], v[68:71]
  v_mfma_f32_16x16x32_bf16 v[8:11], v[104:107], v[160:163], v[8:11]
  v_mfma_f32_16x16x32_bf16 v[12:15], v[104:107], v[164:167], v[12:15]
  v_mfma_f32_16x16x32_bf16 v[16:19], v[108:111], v[160:163], v[16:19]
  v_mfma_f32_16x16x32_bf16 v[20:23], v[108:111], v[164:167], v[20:23]
  v_mfma_f32_16x16x32_bf16 v[24:27], v[112:115], v[160:163], v[24:27]
  v_mfma_f32_16x16x32_bf16 v[28:31], v[112:115], v[164:167], v[28:31]
  v_mfma_f32_16x16x32_bf16 v[32:35], v[116:119], v[160:163], v[32:35]
  v_mfma_f32_16x16x32_bf16 v[36:39], v[116:119], v[164:167], v[36:39]
  v_mfma_f32_16x16x32_bf16 v[40:43], v[120:123], v[160:163], v[40:43]
  v_mfma_f32_16x16x32_bf16 v[44:47], v[120:123], v[164:167], v[44:47]
  v_mfma_f32_16x16x32_bf16 v[48:51], v[124:127], v[160:163], v[48:51]
  v_mfma_f32_16x16x32_bf16 v[52:55], v[124:127], v[164:167], v[52:55]
  v_mfma_f32_16x16x32_bf16 v[56:59], v[128:131], v[160:163], v[56:59]
  v_mfma_f32_16x16x32_bf16 v[60:63], v[128:131], v[164:167], v[60:63]
  v_mfma_f32_16x16x32_bf16 v[64:67], v[132:135], v[160:163], v[64:67]
  v_mfma_f32_16x16x32_bf16 v[68:71], v[132:135], v[164:167], v[68:71]
  s_barrier
  .p2align 3
  s_add_u32 s58, s60, 4096
  buffer_load_dwordx4 v[152:155], v176, s[40:43], s60 offen offset:0 sc1
  ds_read_b64_tr_b16 v[72:73], v168 offset:16384
  ds_read_b64_tr_b16 v[74:75], v168 offset:20480
  ds_read_b64_tr_b16 v[76:77], v169 offset:16384
  ds_read_b64_tr_b16 v[78:79], v169 offset:20480
  buffer_load_dwordx4 v[156:159], v176, s[40:43], s60 offen offset:1024 sc1
  ds_read_b64_tr_b16 v[80:81], v170 offset:16384
  ds_read_b64_tr_b16 v[82:83], v170 offset:20480
  ds_read_b64_tr_b16 v[84:85], v171 offset:16384
  ds_read_b64_tr_b16 v[86:87], v171 offset:20480
  buffer_load_dwordx4 v[160:163], v176, s[40:43], s58 offen offset:0 sc1
  ds_read_b64_tr_b16 v[88:89], v172 offset:16384
  ds_read_b64_tr_b16 v[90:91], v172 offset:20480
  ds_read_b64_tr_b16 v[92:93], v173 offset:16384
  ds_read_b64_tr_b16 v[94:95], v173 offset:20480
  buffer_load_dwordx4 v[164:167], v176, s[40:43], s58 offen offset:1024 sc1
  s_add_u32 s60, s60, 16384
  ds_read_b64_tr_b16 v[96:97], v174 offset:16384
  ds_read_b64_tr_b16 v[98:99], v174 offset:20480
  ds_read_b64_tr_b16 v[100:101], v175 offset:16384
  ds_read_b64_tr_b16 v[102:103], v175 offset:20480
  s_add_u32 m0, s74, 0
  s_add_u32 s75, s73, s72
  buffer_load_dwordx4 v177, s[64:67], s73 offen lds
  ds_read_b64_tr_b16 v[104:105], v168 offset:24576
  ds_read_b64_tr_b16 v[106:107], v168 offset:28672
  ds_read_b64_tr_b16 v[108:109], v169 offset:24576
  ds_read_b64_tr_b16 v[110:111], v169 offset:28672
  s_add_u32 m0, s74, 1024
  s_sub_u32 s68, s68, 1
  buffer_load_dwordx4 v178, s[64:67], s73 offen lds
  ds_read_b64_tr_b16 v[112:113], v170 offset:24576
  ds_read_b64_tr_b16 v[114:115], v170 offset:28672
  ds_read_b64_tr_b16 v[116:117], v171 offset:24576
  ds_read_b64_tr_b16 v[118:119], v171 offset:28672
  s_add_u32 m0, s74, 8192
  s_add_u32 s73, s73, s70
  buffer_load_dwordx4 v177, s[64:67], s75 offen lds
  ds_read_b64_tr_b16 v[120:121], v172 offset:24576
  ds_read_b64_tr_b16 v[122:123], v172 offset:28672
  ds_read_b64_tr_b16 v[124:125], v173 offset:24576
  ds_read_b64_tr_b16 v[126:127], v173 offset:28672
  s_add_u32 m0, s74, 9216
  s_cmp_eq_u32 s68, 0
  buffer_load_dwordx4 v178, s[64:67], s75 offen lds
  s_cbranch_scc0 L_bo22
  s_add_u32 s69, s69, 1
  s_mov_b32 s64, s26
  s_mov_b32 s65, s27
  s_mov_b32 s66, 7340032
  s_mov_b32 s73, s80
  s_mov_b32 s70, 917504
  s_mov_b32 s72, 196608
  s_mov_b32 s68, 4
  s_cmp_eq_u32 s69, 1
  s_cbranch_scc1 L_bo22
  s_mov_b32 s73, s81
  s_mov_b32 s70, 458752
  s_mov_b32 s72, 65536
  s_mov_b32 s68, 8
  s_cmp_eq_u32 s69, 2
  s_cbranch_scc1 L_bo22
  s_mov_b32 s73, s82
  s_mov_b32 s70, 1835008
  s_mov_b32 s72, 458752
  s_mov_b32 s68, 2
  s_cmp_eq_u32 s69, 3
  s_cbranch_scc1 L_bo22
  s_mov_b32 s66, 0
  s_mov_b32 s68, 64
L_bo22:
  ds_read_b64_tr_b16 v[128:129], v174 offset:24576
  ds_read_b64_tr_b16 v[130:131], v174 offset:28672
  ds_read_b64_tr_b16 v[132:133], v175 offset:24576
  ds_read_b64_tr_b16 v[134:135], v175 offset:28672
  s_waitcnt vmcnt(8) lgkmcnt(0)
  s_barrier
  s_cmp_ge_u32 s71, 64
  s_cbranch_scc0 3f
  v_swap_b32 v138, v140
  v_swap_b32 v139, v141
  v_swap_b32 v146, v148
  v_swap_b32 v147, v149
3:
  s_add_u32 s71, s71, 4
  .p2align 3
  v_mfma_f32_16x16x32_bf16 v[8:11], v[72:75], v[136:139], v[8:11]
  v_mfma_f32_16x16x32_bf16 v[12:15], v[72:75], v[140:143], v[12:15]
  v_mfma_f32_16x16x32_bf16 v[16:19], v[76:79], v[136:139], v[16:19]
  v_mfma_f32_16x16x32_bf16 v[20:23], v[76:79], v[140:143], v[20:23]
  v_mfma_f32_16x16x32_bf16 v[24:27], v[80:83], v[136:139], v[24:27]
  v_mfma_f32_16x16x32_bf16 v[28:31], v[80:83], v[140:143], v[28:31]
  v_mfma_f32_16x16x32_bf16 v[32:35], v[84:87], v[136:139], v[32:35]
  v_mfma_f32_16x16x32_bf16 v[36:39], v[84:87], v[140:143], v[36:39]
  v_mfma_f32_16x16x32_bf16 v[40:43], v[88:91], v[136:139], v[40:43]
  v_mfma_f32_16x16x32_bf16 v[44:47], v[88:91], v[140:143], v[44:47]
  v_mfma_f32_16x16x32_bf16 v[48:51], v[92:95], v[136:139], v[48:51]
  v_mfma_f32_16x16x32_bf16 v[52:55], v[92:95], v[140:143], v[52:55]
  v_mfma_f32_16x16x32_bf16 v[56:59], v[96:99], v[136:139], v[56:59]
  v_mfma_f32_16x16x32_bf16 v[60:63], v[96:99], v[140:143], v[60:63]
  v_mfma_f32_16x16x32_bf16 v[64:67], v[100:103], v[136:139], v[64:67]
  v_mfma_f32_16x16x32_bf16 v[68:71], v[100:103], v[140:143], v[68:71]
  v_mfma_f32_16x16x32_bf16 v[8:11], v[104:107], v[144:147], v[8:11]
  v_mfma_f32_16x16x32_bf16 v[12:15], v[104:107], v[148:151], v[12:15]
  v_mfma_f32_16x16x32_bf16 v[16:19], v[108:111], v[144:147], v[16:19]
  v_mfma_f32_16x16x32_bf16 v[20:23], v[108:111], v[148:151], v[20:23]
  v_mfma_f32_16x16x32_bf16 v[24:27], v[112:115], v[144:147], v[24:27]
  v_mfma_f32_16x16x32_bf16 v[28:31], v[112:115], v[148:151], v[28:31]
  v_mfma_f32_16x16x32_bf16 v[32:35], v[116:119], v[144:147], v[32:35]
  v_mfma_f32_16x16x32_bf16 v[36:39], v[116:119], v[148:151], v[36:39]
  v_mfma_f32_16x16x32_bf16 v[40:43], v[120:123], v[144:147], v[40:43]
  v_mfma_f32_16x16x32_bf16 v[44:47], v[120:123], v[148:151], v[44:47]
  v_mfma_f32_16x16x32_bf16 v[48:51], v[124:127], v[144:147], v[48:51]
  v_mfma_f32_16x16x32_bf16 v[52:55], v[124:127], v[148:151], v[52:55]
  v_mfma_f32_16x16x32_bf16 v[56:59], v[128:131], v[144:147], v[56:59]
  v_mfma_f32_16x16x32_bf16 v[60:63], v[128:131], v[148:151], v[60:63]
  v_mfma_f32_16x16x32_bf16 v[64:67], v[132:135], v[144:147], v[64:67]
  v_mfma_f32_16x16x32_bf16 v[68:71], v[132:135], v[148:151], v[68:71]
  s_barrier
  s_cmp_eq_u32 s57, 1
  s_cbranch_scc1 L_g2_ylast
  .p2align 3
  s_add_u32 s58, s60, 4096
  buffer_load_dwordx4 v[136:139], v176, s[40:43], s60 offen offset:0 sc1
  ds_read_b64_tr_b16 v[72:73], v168 offset:32768
  ds_read_b64_tr_b16 v[74:75], v168 offset:36864
  ds_read_b64_tr_b16 v[76:77], v169 offset:32768
  ds_read_b64_tr_b16 v[78:79], v169 offset:36864
  buffer_load_dwordx4 v[140:143], v176, s[40:43], s60 offen offset:1024 sc1
  ds_read_b64_tr_b16 v[80:81], v170 offset:32768
  ds_read_b64_tr_b16 v[82:83], v170 offset:36864
  ds_read_b64_tr_b16 v[84:85], v171 offset:32768
  ds_read_b64_tr_b16 v[86:87], v171 offset:36864
  buffer_load_dwordx4 v[144:147], v176, s[40:43], s58 offen offset:0 sc1
  ds_read_b64_tr_b16 v[88:89], v172 offset:32768
  ds_read_b64_tr_b16 v[90:91], v172 offset:36864
  ds_read_b64_tr_b16 v[92:93], v173 offset:32768
  ds_read_b64_tr_b16 v[94:95], v173 offset:36864
  buffer_load_dwordx4 v[148:151], v176, s[40:43], s58 offen offset:1024 sc1
  s_add_u32 s60, s60, 16384
  ds_read_b64_tr_b16 v[96:97], v174 offset:32768
  ds_read_b64_tr_b16 v[98:99], v174 offset:36864
  ds_read_b64_tr_b16 v[100:101], v175 offset:32768
  ds_read_b64_tr_b16 v[102:103], v175 offset:36864
  s_add_u32 m0, s74, 16384
  s_add_u32 s75, s73, s72
  buffer_load_dwordx4 v177, s[64:67], s73 offen lds
  ds_read_b64_tr_b16 v[104:105], v168 offset:40960
  ds_read_b64_tr_b16 v[106:107], v168 offset:45056
  ds_read_b64_tr_b16 v[108:109], v169 offset:40960
  ds_read_b64_tr_b16 v[110:111], v169 offset:45056
  s_add_u32 m0, s74, 17408
  s_sub_u32 s68, s68, 1
  buffer_load_dwordx4 v178, s[64:67], s73 offen lds
  ds_read_b64_tr_b16 v[112:113], v170 offset:40960
  ds_read_b64_tr_b16 v[114:115], v170 offset:45056
  ds_read_b64_tr_b16 v[116:117], v171 offset:40960
  ds_read_b64_tr_b16 v[118:119], v171 offset:45056
  s_add_u32 m0, s74, 24576
  s_add_u32 s73, s73, s70
  buffer_load_dwordx4 v177, s[64:67], s75 offen lds
  ds_read_b64_tr_b16 v[120:121], v172 offset:40960
  ds_read_b64_tr_b16 v[122:123], v172 offset:45056
  ds_read_b64_tr_b16 v[124:125], v173 offset:40960
  ds_read_b64_tr_b16 v[126:127], v173 offset:45056
  s_add_u32 m0, s74, 25600
  s_cmp_eq_u32 s68, 0
  buffer_load_dwordx4 v178, s[64:67], s75 offen lds
  s_cbranch_scc0 L_bo23
  s_add_u32 s69, s69, 1
  s_mov_b32 s64, s26
  s_mov_b32 s65, s27
  s_mov_b32 s66, 7340032
  s_mov_b32 s73, s80
  s_mov_b32 s70, 917504
  s_mov_b32 s72, 196608
  s_mov_b32 s68, 4
  s_cmp_eq_u32 s69, 1
  s_cbranch_scc1 L_bo23
  s_mov_b32 s73, s81
  s_mov_b32 s70, 458752
  s_mov_b32 s72, 65536
  s_mov_b32 s68, 8
  s_cmp_eq_u32 s69, 2
  s_cbranch_scc1 L_bo23
  s_mov_b32 s73, s82
  s_mov_b32 s70, 1835008
  s_mov_b32 s72, 458752
  s_mov_b32 s68, 2
  s_cmp_eq_u32 s69, 3
  s_cbranch_scc1 L_bo23
  s_mov_b32 s66, 0
  s_mov_b32 s68, 64
L_bo23:
  ds_read_b64_tr_b16 v[128:129], v174 offset:40960
  ds_read_b64_tr_b16 v[130:131], v174 offset:45056
  ds_read_b64_tr_b16 v[132:133], v175 offset:40960
  ds_read_b64_tr_b16 v[134:135], v175 offset:45056
  s_waitcnt vmcnt(8) lgkmcnt(0)
  s_barrier
  s_cmp_ge_u32 s71, 64
  s_cbranch_scc0 3f
  v_swap_b32 v154, v156
  v_swap_b32 v155, v157
  v_swap_b32 v162, v164
  v_swap_b32 v163, v165
3:
  s_add_u32 s71, s71, 4
  .p2align 3
  v_mfma_f32_16x16x32_bf16 v[8:11], v[72:75], v[152:155], v[8:11]
  v_mfma_f32_16x16x32_bf16 v[12:15], v[72:75], v[156:159], v[12:15]
  v_mfma_f32_16x16x32_bf16 v[16:19], v[76:79], v[152:155], v[16:19]
  v_mfma_f32_16x16x32_bf16 v[20:23], v[76:79], v[156:159], v[20:23]
  v_mfma_f32_16x16x32_bf16 v[24:27], v[80:83], v[152:155], v[24:27]
  v_mfma_f32_16x16x32_bf16 v[28:31], v[80:83], v[156:159], v[28:31]
  v_mfma_f32_16x16x32_bf16 v[32:35], v[84:87], v[152:155], v[32:35]
  v_mfma_f32_16x16x32_bf16 v[36:39], v[84:87], v[156:159], v[36:39]
  v_mfma_f32_16x16x32_bf16 v[40:43], v[88:91], v[152:155], v[40:43]
  v_mfma_f32_16x16x32_bf16 v[44:47], v[88:91], v[156:159], v[44:47]
  v_mfma_f32_16x16x32_bf16 v[48:51], v[92:95], v[152:155], v[48:51]
  v_mfma_f32_16x16x32_bf16 v[52:55], v[92:95], v[156:159], v[52:55]
  v_mfma_f32_16x16x32_bf16 v[56:59], v[96:99], v[152:155], v[56:59]
  v_mfma_f32_16x16x32_bf16 v[60:63], v[96:99], v[156:159], v[60:63]
  v_mfma_f32_16x16x32_bf16 v[64:67], v[100:103], v[152:155], v[64:67]
  v_mfma_f32_16x16x32_bf16 v[68:71], v[100:103], v[156:159], v[68:71]
  v_mfma_f32_16x16x32_bf16 v[8:11], v[104:107], v[160:163], v[8:11]
  v_mfma_f32_16x16x32_bf16 v[12:15], v[104:107], v[164:167], v[12:15]
  v_mfma_f32_16x16x32_bf16 v[16:19], v[108:111], v[160:163], v[16:19]
  v_mfma_f32_16x16x32_bf16 v[20:23], v[108:111], v[164:167], v[20:23]
  v_mfma_f32_16x16x32_bf16 v[24:27], v[112:115], v[160:163], v[24:27]
  v_mfma_f32_16x16x32_bf16 v[28:31], v[112:115], v[164:167], v[28:31]
  v_mfma_f32_16x16x32_bf16 v[32:35], v[116:119], v[160:163], v[32:35]
  v_mfma_f32_16x16x32_bf16 v[36:39], v[116:119], v[164:167], v[36:39]
  v_mfma_f32_16x16x32_bf16 v[40:43], v[120:123], v[160:163], v[40:43]
  v_mfma_f32_16x16x32_bf16 v[44:47], v[120:123], v[164:167], v[44:47]
  v_mfma_f32_16x16x32_bf16 v[48:51], v[124:127], v[160:163], v[48:51]
  v_mfma_f32_16x16x32_bf16 v[52:55], v[124:127], v[164:167], v[52:55]
  v_mfma_f32_16x16x32_bf16 v[56:59], v[128:131], v[160:163], v[56:59]
  v_mfma_f32_16x16x32_bf16 v[60:63], v[128:131], v[164:167], v[60:63]
  v_mfma_f32_16x16x32_bf16 v[64:67], v[132:135], v[160:163], v[64:67]
  v_mfma_f32_16x16x32_bf16 v[68:71], v[132:135], v[164:167], v[68:71]
  s_barrier
  s_sub_u32 s57, s57, 1
  s_branch L_g2_yl
L_g2_ylast:
  ds_read_b64_tr_b16 v[72:73], v168 offset:32768
  ds_read_b64_tr_b16 v[74:75], v168 offset:36864
  ds_read_b64_tr_b16 v[76:77], v169 offset:32768
  ds_read_b64_tr_b16 v[78:79], v169 offset:36864
  ds_read_b64_tr_b16 v[80:81], v170 offset:32768
  ds_read_b64_tr_b16 v[82:83], v170 offset:36864
  ds_read_b64_tr_b16 v[84:85], v171 offset:32768
  ds_read_b64_tr_b16 v[86:87], v171 offset:36864
  ds_read_b64_tr_b16 v[88:89], v172 offset:32768
  ds_read_b64_tr_b16 v[90:91], v172 offset:36864
  ds_read_b64_tr_b16 v[92:93], v173 offset:32768
  ds_read_b64_tr_b16 v[94:95], v173 offset:36864
  ds_read_b64_tr_b16 v[96:97], v174 offset:32768
  ds_read_b64_tr_b16 v[98:99], v174 offset:36864
  ds_read_b64_tr_b16 v[100:101], v175 offset:32768
  ds_read_b64_tr_b16 v[102:103], v175 offset:36864
  ds_read_b64_tr_b16 v[104:105], v168 offset:40960
  ds_read_b64_tr_b16 v[106:107], v168 offset:45056
  ds_read_b64_tr_b16 v[108:109], v169 offset:40960
  ds_read_b64_tr_b16 v[110:111], v169 offset:45056
  ds_read_b64_tr_b16 v[112:113], v170 offset:40960
  ds_read_b64_tr_b16 v[114:115], v170 offset:45056
  ds_read_b64_tr_b16 v[116:117], v171 offset:40960
  ds_read_b64_tr_b16 v[118:119], v171 offset:45056
  ds_read_b64_tr_b16 v[120:121], v172 offset:40960
  ds_read_b64_tr_b16 v[122:123], v172 offset:45056
  ds_read_b64_tr_b16 v[124:125], v173 offset:40960
  ds_read_b64_tr_b16 v[126:127], v173 offset:45056
  ds_read_b64_tr_b16 v[128:129], v174 offset:40960
  ds_read_b64_tr_b16 v[130:131], v174 offset:45056
  ds_read_b64_tr_b16 v[132:133], v175 offset:40960
  ds_read_b64_tr_b16 v[134:135], v175 offset:45056
  v_lshrrev_b32 v4, 4, v0
  v_lshl_add_u32 v2, v4, 3, v179
  v_add_u32 v3, 32768, v2
  buffer_load_dwordx2 v[180:181], v2, s[48:51], 0 offen offset:0
  buffer_load_dwordx2 v[182:183], v2, s[48:51], 0 offen offset:32
  buffer_load_dwordx2 v[184:185], v3, s[48:51], 0 offen offset:0
  buffer_load_dwordx2 v[186:187], v3, s[48:51], 0 offen offset:32
  s_and_b32 s16, s76, 3
  s_lshl_b32 s16, s16, 13
  s_add_u32 s16, s16, 98304
  v_add_u32 v3, s16, v188
  s_waitcnt vmcnt(4) lgkmcnt(0)
  s_barrier
  s_cmp_ge_u32 s71, 64
  s_cbranch_scc0 3f
  v_swap_b32 v154, v156
  v_swap_b32 v155, v157
  v_swap_b32 v162, v164
  v_swap_b32 v163, v165
3:
  s_add_u32 s71, s71, 4
  v_mfma_f32_16x16x32_bf16 v[8:11], v[72:75], v[152:155], v[8:11]
  v_mfma_f32_16x16x32_bf16 v[12:15], v[72:75], v[156:159], v[12:15]
  v_mfma_f32_16x16x32_bf16 v[16:19], v[76:79], v[152:155], v[16:19]
  v_mfma_f32_16x16x32_bf16 v[20:23], v[76:79], v[156:159], v[20:23]
  v_mfma_f32_16x16x32_bf16 v[24:27], v[80:83], v[152:155], v[24:27]
  v_mfma_f32_16x16x32_bf16 v[28:31], v[80:83], v[156:159], v[28:31]
  v_mfma_f32_16x16x32_bf16 v[32:35], v[84:87], v[152:155], v[32:35]
  v_mfma_f32_16x16x32_bf16 v[36:39], v[84:87], v[156:159], v[36:39]
  v_mfma_f32_16x16x32_bf16 v[8:11], v[104:107], v[160:163], v[8:11]
  v_mfma_f32_16x16x32_bf16 v[12:15], v[104:107], v[164:167], v[12:15]
  v_mfma_f32_16x16x32_bf16 v[16:19], v[108:111], v[160:163], v[16:19]
  v_mfma_f32_16x16x32_bf16 v[20:23], v[108:111], v[164:167], v[20:23]
  v_mfma_f32_16x16x32_bf16 v[24:27], v[112:115], v[160:163], v[24:27]
  v_mfma_f32_16x16x32_bf16 v[28:31], v[112:115], v[164:167], v[28:31]
  v_mfma_f32_16x16x32_bf16 v[32:35], v[116:119], v[160:163], v[32:35]
  v_mfma_f32_16x16x32_bf16 v[36:39], v[116:119], v[164:167], v[36:39]
  v_mfma_f32_16x16x32_bf16 v[40:43], v[88:91], v[152:155], v[40:43]
  v_mfma_f32_16x16x32_bf16 v[44:47], v[88:91], v[156:159], v[44:47]
  v_mfma_f32_16x16x32_bf16 v[48:51], v[92:95], v[152:155], v[48:51]
  v_mfma_f32_16x16x32_bf16 v[52:55], v[92:95], v[156:159], v[52:55]
  ds_write_b128 v3, v[8:11] offset:32768
  v_mfma_f32_16x16x32_bf16 v[56:59], v[96:99], v[152:155], v[56:59]
  ds_write_b128 v3, v[12:15] offset:33792
  v_mfma_f32_16x16x32_bf16 v[60:63], v[96:99], v[156:159], v[60:63]
  ds_write_b128 v3, v[16:19] offset:34816
  v_mfma_f32_16x16x32_bf16 v[64:67], v[100:103], v[152:155], v[64:67]
  ds_write_b128 v3, v[20:23] offset:35840
  v_mfma_f32_16x16x32_bf16 v[68:71], v[100:103], v[156:159], v[68:71]
  ds_write_b128 v3, v[24:27] offset:36864
  v_mfma_f32_16x16x32_bf16 v[40:43], v[120:123], v[160:163], v[40:43]
  ds_write_b128 v3, v[28:31] offset:37888
  v_mfma_f32_16x16x32_bf16 v[44:47], v[120:123], v[164:167], v[44:47]
  ds_write_b128 v3, v[32:35] offset:38912
  v_mfma_f32_16x16x32_bf16 v[48:51], v[124:127], v[160:163], v[48:51]
  ds_write_b128 v3, v[36:39] offset:39936
  v_mfma_f32_16x16x32_bf16 v[52:55], v[124:127], v[164:167], v[52:55]
  v_mfma_f32_16x16x32_bf16 v[56:59], v[128:131], v[160:163], v[56:59]
  v_mfma_f32_16x16x32_bf16 v[60:63], v[128:131], v[164:167], v[60:63]
  v_mfma_f32_16x16x32_bf16 v[64:67], v[132:135], v[160:163], v[64:67]
  v_mfma_f32_16x16x32_bf16 v[68:71], v[132:135], v[164:167], v[68:71]
  s_waitcnt lgkmcnt(0)
  s_barrier
  ds_read_b128 v[104:107], v3 offset:0
  ds_read_b128 v[108:111], v3 offset:1024
  ds_read_b128 v[112:115], v3 offset:2048
  ds_read_b128 v[116:119], v3 offset:3072
  ds_read_b128 v[120:123], v3 offset:4096
  ds_read_b128 v[124:127], v3 offset:5120
  ds_read_b128 v[128:131], v3 offset:6144
  ds_read_b128 v[132:135], v3 offset:7168
  s_waitcnt lgkmcnt(7)
  v_add_f32 v72, v40, v104
  v_add_f32 v73, v41, v105
  v_add_f32 v74, v42, v106
  v_add_f32 v75, v43, v107
  s_waitcnt lgkmcnt(6)
  v_add_f32 v76, v44, v108
  v_add_f32 v77, v45, v109
  v_add_f32 v78, v46, v110
  v_add_f32 v79, v47, v111
  s_waitcnt lgkmcnt(5)
  v_add_f32 v80, v48, v112
  v_add_f32 v81, v49, v113
  v_add_f32 v82, v50, v114
  v_add_f32 v83, v51, v115
  s_waitcnt lgkmcnt(4)
  v_add_f32 v84, v52, v116
  v_add_f32 v85, v53, v117
  v_add_f32 v86, v54, v118
  v_add_f32 v87, v55, v119
  s_waitcnt lgkmcnt(3)
  v_add_f32 v88, v56, v120
  v_add_f32 v89, v57, v121
  v_add_f32 v90, v58, v122
  v_add_f32 v91, v59, v123
  s_waitcnt lgkmcnt(2)
  v_add_f32 v92, v60, v124
  v_add_f32 v93, v61, v125
  v_add_f32 v94, v62, v126
  v_add_f32 v95, v63, v127
  s_waitcnt lgkmcnt(1)
  v_add_f32 v96, v64, v128
  v_add_f32 v97, v65, v129
  v_add_f32 v98, v66, v130
  v_add_f32 v99, v67, v131
  s_waitcnt lgkmcnt(0)
  v_add_f32 v100, v68, v132
  v_add_f32 v101, v69, v133
  v_add_f32 v102, v70, v134
  v_add_f32 v103, v71, v135
L_g2_x:
  s_lshl_b32 s16, s47, 16
  s_add_u32 s16, s16, 67108864
  s_add_u32 s40, s6, s16
  s_addc_u32 s41, s7, 0
  s_mov_b32 s42, 65536
  s_mov_b32 s43, 0x20000
  s_xor_b32 s16, s44, 1
  s_lshl_b32 s16, s16, 15
  s_lshl_b32 s17, s76, 12
  s_add_u32 s60, s16, s17
  s_lshl_b32 s16, s44, 15
  s_add_u32 s63, s16, s17
  s_cmp_eq_u32 s44, 0
  s_cbranch_scc0 L_g2_s1
  s_cmp_eq_u32 s83, 1
  s_cbranch_scc1 L_g2_pa
  buffer_store_dwordx4 v[88:91], v188, s[40:43], s60 offen offset:0 sc1
  buffer_store_dwordx4 v[92:95], v188, s[40:43], s60 offen offset:1024 sc1
  buffer_store_dwordx4 v[96:99], v188, s[40:43], s60 offen offset:2048 sc1
  buffer_store_dwordx4 v[100:103], v188, s[40:43], s60 offen offset:3072 sc1
  s_branch L_g2_pa_d
L_g2_pa:
  buffer_store_dwordx4 v[88:91], v188, s[40:43], s60 offen offset:0
  buffer_store_dwordx4 v[92:95], v188, s[40:43], s60 offen offset:1024
  buffer_store_dwordx4 v[96:99], v188, s[40:43], s60 offen offset:2048
  buffer_store_dwordx4 v[100:103], v188, s[40:43], s60 offen offset:3072
L_g2_pa_d:
  v_mov_b32 v8, v72
  v_mov_b32 v9, v73
  v_mov_b32 v10, v74
  v_mov_b32 v11, v75
  v_mov_b32 v12, v76
  v_mov_b32 v13, v77
  v_mov_b32 v14, v78
  v_mov_b32 v15, v79
  v_mov_b32 v16, v80
  v_mov_b32 v17, v81
  v_mov_b32 v18, v82
  v_mov_b32 v19, v83
  v_mov_b32 v20, v84
  v_mov_b32 v21, v85
  v_mov_b32 v22, v86
  v_mov_b32 v23, v87
  s_branch L_g2_s2
L_g2_s1:
  s_cmp_eq_u32 s83, 1
  s_cbranch_scc1 L_g2_pb
  buffer_store_dwordx4 v[72:75], v188, s[40:43], s60 offen offset:0 sc1
  buffer_store_dwordx4 v[76:79], v188, s[40:43], s60 offen offset:1024 sc1
  buffer_store_dwordx4 v[80:83], v188, s[40:43], s60 offen offset:2048 sc1
  buffer_store_dwordx4 v[84:87], v188, s[40:43], s60 offen offset:3072 sc1
  s_branch L_g2_pb_d
L_g2_pb:
  buffer_store_dwordx4 v[72:75], v188, s[40:43], s60 offen offset:0
  buffer_store_dwordx4 v[76:79], v188, s[40:43], s60 offen offset:1024
  buffer_store_dwordx4 v[80:83], v188, s[40:43], s60 offen offset:2048
  buffer_store_dwordx4 v[84:87], v188, s[40:43], s60 offen offset:3072
L_g2_pb_d:
  v_mov_b32 v8, v88
  v_mov_b32 v9, v89
  v_mov_b32 v10, v90
  v_mov_b32 v11, v91
  v_mov_b32 v12, v92
  v_mov_b32 v13, v93
  v_mov_b32 v14, v94
  v_mov_b32 v15, v95
  v_mov_b32 v16, v96
  v_mov_b32 v17, v97
  v_mov_b32 v18, v98
  v_mov_b32 v19, v99
  v_mov_b32 v20, v100
  v_mov_b32 v21, v101
  v_mov_b32 v22, v102
  v_mov_b32 v23, v103
L_g2_s2:
  v_lshrrev_b32 v4, 4, v0
  v_and_b32 v5, 1, v4
  v_lshlrev_b32 v5, 5, v5
  v_lshrrev_b32 v4, 1, v4
  v_lshl_add_u32 v5, v4, 4, v5
  v_add_u32 v5, v179, v5
  v_add_u32 v6, 32768, v5
  s_waitcnt vmcnt(4)
  v_lshlrev_b32 v40, 16, v180
  v_and_b32 v41, 0xffff0000, v180
  v_lshlrev_b32 v42, 16, v181
  v_and_b32 v43, 0xffff0000, v181
  v_add_f32 v8, v8, v40
  v_add_f32 v9, v9, v41
  v_add_f32 v10, v10, v42
  v_add_f32 v11, v11, v43
  v_lshlrev_b32 v40, 16, v184
  v_and_b32 v41, 0xffff0000, v184
  v_lshlrev_b32 v42, 16, v185
  v_and_b32 v43, 0xffff0000, v185
  v_add_f32 v12, v12, v40
  v_add_f32 v13, v13, v41
  v_add_f32 v14, v14, v42
  v_add_f32 v15, v15, v43
  v_lshlrev_b32 v40, 16, v182
  v_and_b32 v41, 0xffff0000, v182
  v_lshlrev_b32 v42, 16, v183
  v_and_b32 v43, 0xffff0000, v183
  v_add_f32 v16, v16, v40
  v_add_f32 v17, v17, v41
  v_add_f32 v18, v18, v42
  v_add_f32 v19, v19, v43
  v_lshlrev_b32 v40, 16, v186
  v_and_b32 v41, 0xffff0000, v186
  v_lshlrev_b32 v42, 16, v187
  v_and_b32 v43, 0xffff0000, v187
  v_add_f32 v20, v20, v40
  v_add_f32 v21, v21, v41
  v_add_f32 v22, v22, v42
  v_add_f32 v23, v23, v43
  s_mov_b32 s62, 0x40000
L_g2_rx:
  buffer_load_dwordx4 v[24:27], v188, s[40:43], s63 offen offset:0 sc1
  buffer_load_dwordx4 v[28:31], v188, s[40:43], s63 offen offset:1024 sc1
  buffer_load_dwordx4 v[32:35], v188, s[40:43], s63 offen offset:2048 sc1
  buffer_load_dwordx4 v[36:39], v188, s[40:43], s63 offen offset:3072 sc1
  s_waitcnt vmcnt(0)
  v_max3_u32 v40, v24, v25, v26
  v_max3_u32 v40, v40, v27, v28
  v_max3_u32 v40, v40, v29, v30
  v_max3_u32 v40, v40, v31, v32
  v_max3_u32 v40, v40, v33, v34
  v_max3_u32 v40, v40, v35, v36
  v_max3_u32 v40, v40, v37, v38
  v_max_u32 v40, v40, v39
  v_cmp_eq_u32 vcc, -1, v40
  s_cmp_eq_u64 vcc, 0
  s_cbranch_scc1 L_g2_rxok
  s_sub_u32 s62, s62, 1
  s_cmp_eq_u32 s62, 0
  s_cbranch_scc1 L_g2_rxok
  s_sleep 1
  s_branch L_g2_rx
L_g2_rxok:
  v_add_f32 v8, v8, v24
  v_add_f32 v9, v9, v25
  v_add_f32 v10, v10, v26
  v_add_f32 v11, v11, v27
  v_cvt_pk_bf16_f32 v44, v8, v9
  v_cvt_pk_bf16_f32 v45, v10, v11
  v_add_f32 v12, v12, v28
  v_add_f32 v13, v13, v29
  v_add_f32 v14, v14, v30
  v_add_f32 v15, v15, v31
  v_cvt_pk_bf16_f32 v48, v12, v13
  v_cvt_pk_bf16_f32 v49, v14, v15
  v_add_f32 v16, v16, v32
  v_add_f32 v17, v17, v33
  v_add_f32 v18, v18, v34
  v_add_f32 v19, v19, v35
  v_cvt_pk_bf16_f32 v46, v16, v17
  v_cvt_pk_bf16_f32 v47, v18, v19
  v_add_f32 v20, v20, v36
  v_add_f32 v21, v21, v37
  v_add_f32 v22, v22, v38
  v_add_f32 v23, v23, v39
  v_cvt_pk_bf16_f32 v50, v20, v21
  v_cvt_pk_bf16_f32 v51, v22, v23
  v_permlane16_swap_b32 v44, v46
  v_permlane16_swap_b32 v45, v47
  buffer_store_dwordx4 v[44:47], v5, s[52:55], 0 offen
  v_permlane16_swap_b32 v48, v50
  v_permlane16_swap_b32 v49, v51
  buffer_store_dwordx4 v[48:51], v6, s[52:55], 0 offen
  s_endpgm
L_code_end:
.section .rodata,"a"
.p2align 6
.amdhsa_kernel parallel_sum__sliding_local_dilated__geglu_ffn__prompt_kernel
  .amdhsa_next_free_vgpr 256
  .amdhsa_next_free_sgpr 100
  .amdhsa_accum_offset 256
  .amdhsa_group_segment_fixed_size 0
  .amdhsa_kernarg_size 80
  .amdhsa_user_sgpr_count 2
  .amdhsa_user_sgpr_kernarg_segment_ptr 1
  .amdhsa_system_sgpr_workgroup_id_x 1
  .amdhsa_float_denorm_mode_32 3
.end_amdhsa_kernel
```
